```python
import torch

def _softmax(x, axis=-1):
    return torch.softmax(x, dim=axis)
def _gelu(x):
    return torch.nn.functional.gelu(x, approximate="tanh")
def _silu(x):
    return torch.nn.functional.silu(x)
def _sigmoid(x):
    return torch.sigmoid(x)
def _layernorm(x, axis=-1, eps=1e-5):
    m = x.mean(dim=axis, keepdim=True)
    v = x.var(dim=axis, keepdim=True, unbiased=False)
    return (x - m) / torch.sqrt(v + eps)
def _scatter_add(tgt, idx, src, axis=0):
    return tgt.clone().index_add_(axis, idx, src)
def _segment_sum(src, seg, n):
    out = torch.zeros((n,) + src.shape[1:], dtype=src.dtype)
    return out.index_add_(0, seg, src)
def _pad(x, pw):
    flat = tuple(v for pair in reversed(pw) for v in pair)
    return torch.nn.functional.pad(x, flat)

kernel_name = 'standalone__gqa_softmax__near_ridge'

def setup_inputs():

    _w = (lambda a: (lambda t: t.to(torch.bfloat16) if t.is_floating_point() else t)(torch.as_tensor(a)))
    B, Hq, Hkv, Sq, Sk, D = 16, 32, 16, 288, 512, 128
    return {
        "q": _w((lambda *s: torch.randn(*s, dtype=torch.bfloat16) * 0.8)(B, Hq, Sq, D)),
        "k": _w((lambda *s: torch.randn(*s, dtype=torch.bfloat16) * 0.8)(B, Hkv, Sk, D)),
        "v": _w((lambda *s: torch.randn(*s, dtype=torch.bfloat16) * 0.05)(B, Hkv, Sk, D)),
    }

def reference(q, k, v):
    B, Hq, Sq, D = q.shape
    Hkv = k.shape[1]
    rep = Hq // Hkv
    k = (lambda x, n, axis: torch.repeat_interleave(x, n, dim=axis))(k, rep, axis=1)
    v = (lambda x, n, axis: torch.repeat_interleave(x, n, dim=axis))(v, rep, axis=1)
    scale = D ** -0.5
    scores = torch.einsum("bhqd,bhkd->bhqk", q, k) * scale
    p = _softmax(scores, axis=-1)
    return torch.einsum("bhqk,bhkd->bhqd", p, v)
```

```asm
; @launch grid=(256,1,1) block=(256,1,1) lds=163840
.amdgcn_target "amdgcn-amd-amdhsa--gfx950"
.text
.globl standalone__gqa_softmax__near_ridge_kernel
.p2align 8
.type standalone__gqa_softmax__near_ridge_kernel,@function
standalone__gqa_softmax__near_ridge_kernel:
    s_cmp_ge_u32 s2, 256
    s_cbranch_scc1 L_done
    s_load_dwordx4 s[4:7], s[0:1], 0
    s_load_dwordx4 s[8:11], s[0:1], 16
    v_lshrrev_b32 v245, 6, v0
    v_and_b32 v242, 63, v0
    v_readfirstlane_b32 s3, v245
    v_lshrrev_b32 v246, 4, v242
    v_and_b32 v247, 15, v242
    v_lshlrev_b32 v248, 8, v246
    v_xor_b32 v249, v247, v246
    v_xor_b32 v250, 0, v249
    v_lshl_add_u32 v235, v250, 4, v248
    v_xor_b32 v250, 4, v249
    v_lshl_add_u32 v236, v250, 4, v248
    v_xor_b32 v250, 8, v249
    v_lshl_add_u32 v237, v250, 4, v248
    v_xor_b32 v250, 12, v249
    v_lshl_add_u32 v238, v250, 4, v248
    v_lshlrev_b32 v249, 2, v246
    v_xor_b32 v249, v247, v249
    v_lshl_add_u32 v239, v249, 4, v248
    s_and_b32 s45, s2, 7
    s_lshr_b32 s46, s2, 4
    s_lshl_b32 s46, s46, 3
    s_add_u32 s45, s45, s46
    s_lshr_b32 s43, s2, 3
    s_and_b32 s43, s43, 1
    s_lshl_b32 s60, s45, 18
    s_lshl_b32 s55, s3, 12
    s_mov_b32 s34, s55
    s_mov_b32 s33, s55
    s_lshl_b32 s45, s45, 1
    s_add_u32 s46, s45, s43
    s_mul_i32 s46, s46, 147456
    s_lshl_b32 s47, s3, 14
    s_add_u32 s37, s46, s47
    s_lshr_b32 s38, s3, 1
    s_lshl_b32 s38, s38, 13
    s_add_u32 s38, s38, s46
    s_add_u32 s38, s38, 65536
    s_xor_b32 s46, s43, 1
    s_add_u32 s46, s45, s46
    s_mul_i32 s46, s46, 147456
    s_add_u32 s39, s46, s47
    s_add_u32 s39, s39, 81920
    s_mov_b32 s28, 0x3e0293ee
    s_mov_b32 s94, s28
    s_mov_b32 s95, s28
    s_mov_b32 s56, 0x47800000
    s_mov_b32 s63, 0xffff0000
    s_mov_b32 s86, 0
    s_mov_b32 s87, 0
    s_mov_b32 s57, 1916
    s_mov_b32 s58, 1852
    s_mov_b32 s23, 0x0f03
    s_mov_b32 s40, 163840
    s_mov_b32 s41, 163840
    s_mov_b32 s59, 0x1fe02
    s_mov_b32 s32, 0
    s_mov_b32 s35, 0
    s_mov_b32 s44, 0
    s_mov_b32 s36, 0
    s_mov_b32 s51, 0
    s_mov_b32 s52, 0
    s_mov_b32 s15, 0x20000
    s_mov_b32 s19, 0x20000
    s_mov_b32 s26, 37748736
    s_mov_b32 s27, 0x20000
    s_waitcnt lgkmcnt(0)
    s_mov_b32 s24, s10
    s_mov_b32 s25, s11
    s_add_u32 s6, s6, s60
    s_addc_u32 s7, s7, 0
    s_add_u32 s8, s8, s60
    s_addc_u32 s9, s9, 0
    s_cmp_lg_u32 s43, 0
    s_cbranch_scc1 L_pro_B
    s_mov_b32 s48, s37
    s_add_u32 s49, s37, 8192
    s_mov_b32 s50, s38
    s_mov_b32 s42, 3
    s_mov_b64 s[12:13], s[4:5]
    s_mov_b64 s[16:17], s[4:5]
    s_mov_b32 s14, 37748736
    s_mov_b32 s18, 37748736
    s_mov_b32 s20, s48
    s_add_u32 s21, s48, 4096
    s_mov_b32 m0, s34
    s_nop 0
    buffer_load_dwordx4 v235, s[12:15], s20 offen offset:0 nt lds
    buffer_load_dwordx4 v236, s[12:15], s20 offen offset:1024 nt lds
    buffer_load_dwordx4 v237, s[12:15], s20 offen offset:2048 nt lds
    buffer_load_dwordx4 v238, s[12:15], s20 offen offset:3072 nt lds
    s_add_u32 m0, s34, 16384
    s_nop 0
    buffer_load_dwordx4 v239, s[16:19], s21 offen offset:0 nt lds
    buffer_load_dwordx4 v239, s[16:19], s21 offen offset:1024 nt lds
    buffer_load_dwordx4 v239, s[16:19], s21 offen offset:2048 nt lds
    buffer_load_dwordx4 v239, s[16:19], s21 offen offset:3072 nt lds
    s_add_u32 s34, s34, 32768
    s_cmp_ge_u32 s34, s40
    s_cselect_b32 s60, s41, 0
    s_sub_u32 s34, s34, s60
    s_mov_b64 s[12:13], s[4:5]
    s_mov_b64 s[16:17], s[4:5]
    s_mov_b32 s14, 37748736
    s_mov_b32 s18, 37748736
    s_mov_b32 s20, s49
    s_add_u32 s21, s49, 4096
    s_mov_b32 m0, s34
    s_nop 0
    buffer_load_dwordx4 v235, s[12:15], s20 offen offset:0 nt lds
    buffer_load_dwordx4 v236, s[12:15], s20 offen offset:1024 nt lds
    buffer_load_dwordx4 v237, s[12:15], s20 offen offset:2048 nt lds
    buffer_load_dwordx4 v238, s[12:15], s20 offen offset:3072 nt lds
    s_add_u32 m0, s34, 16384
    s_nop 0
    buffer_load_dwordx4 v239, s[16:19], s21 offen offset:0 nt lds
    buffer_load_dwordx4 v239, s[16:19], s21 offen offset:1024 nt lds
    buffer_load_dwordx4 v239, s[16:19], s21 offen offset:2048 nt lds
    buffer_load_dwordx4 v239, s[16:19], s21 offen offset:3072 nt lds
    s_add_u32 s34, s34, 32768
    s_cmp_ge_u32 s34, s40
    s_cselect_b32 s60, s41, 0
    s_sub_u32 s34, s34, s60
    v_and_b32 v243, 31, v242
    v_lshrrev_b32 v244, 5, v242
    v_lshlrev_b32 v254, 3, v242
    v_lshlrev_b32 v255, 4, v242
    v_lshlrev_b32 v245, 8, v243
    v_and_b32 v246, 15, v243
    v_xor_b32 v246, v246, v244
    v_xor_b32 v247, 0, v246
    v_lshl_add_u32 v223, v247, 4, v245
    v_xor_b32 v247, 2, v246
    v_lshl_add_u32 v224, v247, 4, v245
    v_xor_b32 v247, 4, v246
    v_lshl_add_u32 v225, v247, 4, v245
    v_xor_b32 v247, 6, v246
    v_lshl_add_u32 v226, v247, 4, v245
    v_xor_b32 v247, 8, v246
    v_lshl_add_u32 v227, v247, 4, v245
    v_xor_b32 v247, 10, v246
    v_lshl_add_u32 v228, v247, 4, v245
    v_xor_b32 v247, 12, v246
    v_lshl_add_u32 v229, v247, 4, v245
    v_xor_b32 v247, 14, v246
    v_lshl_add_u32 v230, v247, 4, v245
    v_and_b32 v247, 15, v243
    v_lshlrev_b32 v248, 8, v247
    v_bfe_u32 v249, v243, 4, 1
    v_lshl_add_u32 v248, v249, 14, v248
    v_add_u32 v240, s55, v248
    v_and_b32 v248, 3, v243
    v_lshlrev_b32 v248, 2, v248
    v_cmp_ne_u32 vcc, 0, v249
    s_nop 1
    v_cndmask_b32 v247, v247, v248, vcc
    v_xor_b32 v241, v247, v244
    v_bfe_u32 v246, v242, 2, 2
    v_and_b32 v247, 3, v242
    v_bfe_u32 v248, v242, 4, 1
    v_lshl_add_u32 v249, v244, 2, v246
    v_lshlrev_b32 v249, 8, v249
    v_lshl_add_u32 v249, v248, 5, v249
    v_lshl_add_u32 v249, v247, 3, v249
    v_add_u32 v249, 16384, v249
    v_xor_b32 v250, 0, v246
    v_lshl_add_u32 v231, v250, 6, v249
    v_xor_b32 v250, 1, v246
    v_lshl_add_u32 v232, v250, 6, v249
    v_xor_b32 v250, 2, v246
    v_lshl_add_u32 v233, v250, 6, v249
    v_xor_b32 v250, 3, v246
    v_lshl_add_u32 v234, v250, 6, v249
    v_mov_b32 v128, 0
    v_mov_b32 v129, 0
    v_mov_b32 v130, 0
    v_mov_b32 v131, 0
    v_mov_b32 v132, 0
    v_mov_b32 v133, 0
    v_mov_b32 v134, 0
    v_mov_b32 v135, 0
    v_mov_b32 v136, 0
    v_mov_b32 v137, 0
    v_mov_b32 v138, 0
    v_mov_b32 v139, 0
    v_mov_b32 v140, 0
    v_mov_b32 v141, 0
    v_mov_b32 v142, 0
    v_mov_b32 v143, 0
    v_mov_b32 v144, 0
    v_mov_b32 v145, 0
    v_mov_b32 v146, 0
    v_mov_b32 v147, 0
    v_mov_b32 v148, 0
    v_mov_b32 v149, 0
    v_mov_b32 v150, 0
    v_mov_b32 v151, 0
    v_mov_b32 v152, 0
    v_mov_b32 v153, 0
    v_mov_b32 v154, 0
    v_mov_b32 v155, 0
    v_mov_b32 v156, 0
    v_mov_b32 v157, 0
    v_mov_b32 v158, 0
    v_mov_b32 v159, 0
    v_mov_b32 v200, 0
    v_mov_b32 v201, 0
    v_mov_b32 v202, 0
    v_mov_b32 v203, 0
    v_mov_b32 v204, 0
    v_mov_b32 v205, 0
    v_mov_b32 v206, 0
    v_mov_b32 v207, 0
    v_xor_b32 v208, 0, v241
    v_lshl_add_u32 v208, v208, 4, v240
    v_xor_b32 v209, 2, v241
    v_lshl_add_u32 v209, v209, 4, v240
    v_xor_b32 v210, 4, v241
    v_lshl_add_u32 v210, v210, 4, v240
    v_xor_b32 v211, 6, v241
    v_lshl_add_u32 v211, v211, 4, v240
    v_xor_b32 v212, 8, v241
    v_lshl_add_u32 v212, v212, 4, v240
    v_xor_b32 v213, 10, v241
    v_lshl_add_u32 v213, v213, 4, v240
    v_xor_b32 v214, 12, v241
    v_lshl_add_u32 v214, v214, 4, v240
    v_xor_b32 v215, 14, v241
    v_lshl_add_u32 v215, v215, 4, v240
    s_waitcnt vmcnt(8)
    v_add_u32 v242, s35, v208
    v_add_u32 v243, s35, v209
    v_add_u32 v244, s35, v210
    v_add_u32 v245, s35, v211
    v_add_u32 v246, s35, v212
    v_add_u32 v247, s35, v213
    v_add_u32 v248, s35, v214
    v_add_u32 v249, s35, v215
    ds_read_b128 v[160:163], v242
    ds_read_b128 v[164:167], v243
    ds_read_b128 v[168:171], v244
    ds_read_b128 v[172:175], v245
    ds_read_b128 v[176:179], v246
    ds_read_b128 v[180:183], v247
    ds_read_b128 v[184:187], v248
    ds_read_b128 v[188:191], v249
    s_add_u32 s35, s35, 32768
    s_cmp_ge_u32 s35, s40
    s_cselect_b32 s46, s41, 0
    s_sub_u32 s35, s35, s46
    s_mov_b64 s[12:13], s[4:5]
    s_mov_b64 s[16:17], s[4:5]
    s_mov_b32 s14, 37748736
    s_mov_b32 s18, 37748736
    s_mov_b32 s20, s50
    s_add_u32 s21, s50, 4096
    s_mov_b32 m0, s34
    s_nop 0
    buffer_load_dwordx4 v235, s[12:15], s20 offen offset:0 nt lds
    v_mov_b32 v32, 0
    v_mov_b32 v33, 0
    v_mov_b32 v34, 0
    v_mov_b32 v35, 0
    v_mov_b32 v36, 0
    v_mov_b32 v37, 0
    v_mov_b32 v38, 0
    v_mov_b32 v39, 0
    v_mov_b32 v40, 0
    v_mov_b32 v41, 0
    v_mov_b32 v42, 0
    v_mov_b32 v43, 0
    v_mov_b32 v44, 0
    v_mov_b32 v45, 0
    v_mov_b32 v46, 0
    v_mov_b32 v47, 0
    v_mov_b32 v219, 0
    v_mfma_f32_32x32x16_bf16 a[0:15], v[128:131], v[200:203], 0
    s_waitcnt lgkmcnt(7)
    v_lshlrev_b32 v80, 16, v160
    buffer_load_dwordx4 v236, s[12:15], s20 offen offset:1024 nt lds
    v_and_b32 v81, s63, v160
    v_lshlrev_b32 v82, 16, v161
    v_and_b32 v83, s63, v161
    v_lshlrev_b32 v84, 16, v162
    v_and_b32 v85, s63, v162
    v_lshlrev_b32 v86, 16, v163
    v_and_b32 v87, s63, v163
    v_pk_mul_f32 v[80:81], v[80:81], s[94:95]
    v_pk_mul_f32 v[82:83], v[82:83], s[94:95]
    v_pk_mul_f32 v[84:85], v[84:85], s[94:95]
    v_pk_mul_f32 v[86:87], v[86:87], s[94:95]
    v_cvt_pk_bf16_f32 v0, v80, v81
    v_cvt_pk_bf16_f32 v1, v82, v83
    v_cvt_pk_bf16_f32 v2, v84, v85
    v_cvt_pk_bf16_f32 v3, v86, v87
    s_waitcnt lgkmcnt(6)
    v_lshlrev_b32 v80, 16, v164
    v_and_b32 v81, s63, v164
    buffer_load_dwordx4 v237, s[12:15], s20 offen offset:2048 nt lds
    v_lshlrev_b32 v82, 16, v165
    v_and_b32 v83, s63, v165
    v_lshlrev_b32 v84, 16, v166
    v_and_b32 v85, s63, v166
    v_lshlrev_b32 v86, 16, v167
    v_and_b32 v87, s63, v167
    v_pk_mul_f32 v[80:81], v[80:81], s[94:95]
    v_pk_mul_f32 v[82:83], v[82:83], s[94:95]
    v_pk_mul_f32 v[84:85], v[84:85], s[94:95]
    v_pk_mul_f32 v[86:87], v[86:87], s[94:95]
    v_cvt_pk_bf16_f32 v4, v80, v81
    v_cvt_pk_bf16_f32 v5, v82, v83
    v_cvt_pk_bf16_f32 v6, v84, v85
    v_cvt_pk_bf16_f32 v7, v86, v87
    v_mfma_f32_32x32x16_bf16 a[16:31], v[128:131], v[200:203], 0
    s_waitcnt lgkmcnt(5)
    v_lshlrev_b32 v80, 16, v168
    buffer_load_dwordx4 v238, s[12:15], s20 offen offset:3072 nt lds
    v_and_b32 v81, s63, v168
    v_lshlrev_b32 v82, 16, v169
    v_and_b32 v83, s63, v169
    v_lshlrev_b32 v84, 16, v170
    v_and_b32 v85, s63, v170
    v_lshlrev_b32 v86, 16, v171
    v_and_b32 v87, s63, v171
    v_pk_mul_f32 v[80:81], v[80:81], s[94:95]
    v_pk_mul_f32 v[82:83], v[82:83], s[94:95]
    v_pk_mul_f32 v[84:85], v[84:85], s[94:95]
    v_pk_mul_f32 v[86:87], v[86:87], s[94:95]
    v_cvt_pk_bf16_f32 v8, v80, v81
    v_cvt_pk_bf16_f32 v9, v82, v83
    v_cvt_pk_bf16_f32 v10, v84, v85
    v_cvt_pk_bf16_f32 v11, v86, v87
    s_waitcnt lgkmcnt(4)
    v_lshlrev_b32 v80, 16, v172
    v_and_b32 v81, s63, v172
    s_add_u32 m0, s34, 16384
    s_nop 0
    buffer_load_dwordx4 v239, s[16:19], s21 offen offset:0 nt lds
    v_lshlrev_b32 v82, 16, v173
    v_and_b32 v83, s63, v173
    v_lshlrev_b32 v84, 16, v174
    v_and_b32 v85, s63, v174
    v_lshlrev_b32 v86, 16, v175
    v_and_b32 v87, s63, v175
    v_pk_mul_f32 v[80:81], v[80:81], s[94:95]
    v_pk_mul_f32 v[82:83], v[82:83], s[94:95]
    v_pk_mul_f32 v[84:85], v[84:85], s[94:95]
    v_pk_mul_f32 v[86:87], v[86:87], s[94:95]
    v_cvt_pk_bf16_f32 v12, v80, v81
    v_cvt_pk_bf16_f32 v13, v82, v83
    v_cvt_pk_bf16_f32 v14, v84, v85
    v_cvt_pk_bf16_f32 v15, v86, v87
    v_mfma_f32_32x32x16_bf16 a[32:47], v[128:131], v[200:203], 0
    s_waitcnt lgkmcnt(3)
    v_lshlrev_b32 v80, 16, v176
    buffer_load_dwordx4 v239, s[16:19], s21 offen offset:1024 nt lds
    v_and_b32 v81, s63, v176
    v_lshlrev_b32 v82, 16, v177
    v_and_b32 v83, s63, v177
    v_lshlrev_b32 v84, 16, v178
    v_and_b32 v85, s63, v178
    v_lshlrev_b32 v86, 16, v179
    v_and_b32 v87, s63, v179
    v_pk_mul_f32 v[80:81], v[80:81], s[94:95]
    v_pk_mul_f32 v[82:83], v[82:83], s[94:95]
    v_pk_mul_f32 v[84:85], v[84:85], s[94:95]
    v_pk_mul_f32 v[86:87], v[86:87], s[94:95]
    v_cvt_pk_bf16_f32 v16, v80, v81
    v_cvt_pk_bf16_f32 v17, v82, v83
    v_cvt_pk_bf16_f32 v18, v84, v85
    v_cvt_pk_bf16_f32 v19, v86, v87
    s_waitcnt lgkmcnt(2)
    v_lshlrev_b32 v80, 16, v180
    v_and_b32 v81, s63, v180
    buffer_load_dwordx4 v239, s[16:19], s21 offen offset:2048 nt lds
    v_lshlrev_b32 v82, 16, v181
    v_and_b32 v83, s63, v181
    v_lshlrev_b32 v84, 16, v182
    v_and_b32 v85, s63, v182
    v_lshlrev_b32 v86, 16, v183
    v_and_b32 v87, s63, v183
    v_pk_mul_f32 v[80:81], v[80:81], s[94:95]
    v_pk_mul_f32 v[82:83], v[82:83], s[94:95]
    v_pk_mul_f32 v[84:85], v[84:85], s[94:95]
    v_pk_mul_f32 v[86:87], v[86:87], s[94:95]
    v_cvt_pk_bf16_f32 v20, v80, v81
    v_cvt_pk_bf16_f32 v21, v82, v83
    v_cvt_pk_bf16_f32 v22, v84, v85
    v_cvt_pk_bf16_f32 v23, v86, v87
    v_mfma_f32_32x32x16_bf16 a[48:63], v[128:131], v[200:203], 0
    s_waitcnt lgkmcnt(1)
    v_lshlrev_b32 v80, 16, v184
    buffer_load_dwordx4 v239, s[16:19], s21 offen offset:3072 nt lds
    s_add_u32 s34, s34, 32768
    s_cmp_ge_u32 s34, s40
    s_cselect_b32 s60, s41, 0
    s_sub_u32 s34, s34, s60
    v_and_b32 v81, s63, v184
    v_lshlrev_b32 v82, 16, v185
    v_and_b32 v83, s63, v185
    v_lshlrev_b32 v84, 16, v186
    v_and_b32 v85, s63, v186
    v_lshlrev_b32 v86, 16, v187
    v_and_b32 v87, s63, v187
    v_pk_mul_f32 v[80:81], v[80:81], s[94:95]
    v_pk_mul_f32 v[82:83], v[82:83], s[94:95]
    v_pk_mul_f32 v[84:85], v[84:85], s[94:95]
    v_pk_mul_f32 v[86:87], v[86:87], s[94:95]
    v_cvt_pk_bf16_f32 v24, v80, v81
    v_cvt_pk_bf16_f32 v25, v82, v83
    v_cvt_pk_bf16_f32 v26, v84, v85
    v_cvt_pk_bf16_f32 v27, v86, v87
    s_waitcnt lgkmcnt(0)
    v_lshlrev_b32 v80, 16, v188
    v_and_b32 v81, s63, v188
    v_lshlrev_b32 v82, 16, v189
    v_and_b32 v83, s63, v189
    v_lshlrev_b32 v84, 16, v190
    v_and_b32 v85, s63, v190
    v_lshlrev_b32 v86, 16, v191
    v_and_b32 v87, s63, v191
    v_pk_mul_f32 v[80:81], v[80:81], s[94:95]
    v_pk_mul_f32 v[82:83], v[82:83], s[94:95]
    v_pk_mul_f32 v[84:85], v[84:85], s[94:95]
    v_pk_mul_f32 v[86:87], v[86:87], s[94:95]
    v_cvt_pk_bf16_f32 v28, v80, v81
    v_cvt_pk_bf16_f32 v29, v82, v83
    v_cvt_pk_bf16_f32 v30, v84, v85
    v_cvt_pk_bf16_f32 v31, v86, v87
    s_waitcnt vmcnt(8)
    v_add_u32 v242, s35, v208
    v_add_u32 v243, s35, v209
    v_add_u32 v244, s35, v210
    v_add_u32 v245, s35, v211
    v_add_u32 v246, s35, v212
    v_add_u32 v247, s35, v213
    v_add_u32 v248, s35, v214
    v_add_u32 v249, s35, v215
    ds_read_b128 v[160:163], v242
    ds_read_b128 v[164:167], v243
    ds_read_b128 v[168:171], v244
    ds_read_b128 v[172:175], v245
    ds_read_b128 v[176:179], v246
    ds_read_b128 v[180:183], v247
    ds_read_b128 v[184:187], v248
    ds_read_b128 v[188:191], v249
    s_add_u32 s35, s35, 32768
    s_cmp_ge_u32 s35, s40
    s_cselect_b32 s46, s41, 0
    s_sub_u32 s35, s35, s46
    s_mov_b64 s[12:13], s[6:7]
    s_mov_b64 s[16:17], s[8:9]
    s_mov_b32 s14, 262144
    s_mov_b32 s18, 262144
    s_mov_b32 s20, s33
    s_mov_b32 s21, s33
    s_mov_b32 m0, s34
    s_nop 0
    buffer_load_dwordx4 v235, s[12:15], s20 offen offset:0 nt lds
    v_mov_b32 v48, 0
    v_mov_b32 v49, 0
    v_mov_b32 v50, 0
    v_mov_b32 v51, 0
    v_mov_b32 v52, 0
    v_mov_b32 v53, 0
    v_mov_b32 v54, 0
    v_mov_b32 v55, 0
    v_mov_b32 v56, 0
    v_mov_b32 v57, 0
    v_mov_b32 v58, 0
    v_mov_b32 v59, 0
    v_mov_b32 v60, 0
    v_mov_b32 v61, 0
    v_mov_b32 v62, 0
    v_mov_b32 v63, 0
    v_mov_b32 v220, 0
    v_mfma_f32_32x32x16_bf16 a[64:79], v[128:131], v[200:203], 0
    s_waitcnt lgkmcnt(7)
    v_lshlrev_b32 v80, 16, v160
    v_and_b32 v81, s63, v160
    v_lshlrev_b32 v82, 16, v161
    v_and_b32 v83, s63, v161
    buffer_load_dwordx4 v236, s[12:15], s20 offen offset:1024 nt lds
    v_lshlrev_b32 v84, 16, v162
    v_and_b32 v85, s63, v162
    v_lshlrev_b32 v86, 16, v163
    v_and_b32 v87, s63, v163
    v_pk_mul_f32 v[80:81], v[80:81], s[94:95]
    v_pk_mul_f32 v[82:83], v[82:83], s[94:95]
    v_pk_mul_f32 v[84:85], v[84:85], s[94:95]
    v_pk_mul_f32 v[86:87], v[86:87], s[94:95]
    v_cvt_pk_bf16_f32 v88, v80, v81
    v_cvt_pk_bf16_f32 v89, v82, v83
    v_cvt_pk_bf16_f32 v90, v84, v85
    v_cvt_pk_bf16_f32 v91, v86, v87
    v_accvgpr_write_b32 a192, v88
    v_accvgpr_write_b32 a193, v89
    v_accvgpr_write_b32 a194, v90
    v_accvgpr_write_b32 a195, v91
    s_waitcnt lgkmcnt(6)
    v_lshlrev_b32 v80, 16, v164
    v_and_b32 v81, s63, v164
    v_lshlrev_b32 v82, 16, v165
    v_and_b32 v83, s63, v165
    v_lshlrev_b32 v84, 16, v166
    buffer_load_dwordx4 v237, s[12:15], s20 offen offset:2048 nt lds
    v_and_b32 v85, s63, v166
    v_lshlrev_b32 v86, 16, v167
    v_and_b32 v87, s63, v167
    v_pk_mul_f32 v[80:81], v[80:81], s[94:95]
    v_pk_mul_f32 v[82:83], v[82:83], s[94:95]
    v_pk_mul_f32 v[84:85], v[84:85], s[94:95]
    v_pk_mul_f32 v[86:87], v[86:87], s[94:95]
    v_cvt_pk_bf16_f32 v88, v80, v81
    v_cvt_pk_bf16_f32 v89, v82, v83
    v_cvt_pk_bf16_f32 v90, v84, v85
    v_cvt_pk_bf16_f32 v91, v86, v87
    v_accvgpr_write_b32 a196, v88
    v_accvgpr_write_b32 a197, v89
    v_accvgpr_write_b32 a198, v90
    v_accvgpr_write_b32 a199, v91
    v_mfma_f32_32x32x16_bf16 a[80:95], v[128:131], v[200:203], 0
    s_waitcnt lgkmcnt(5)
    v_lshlrev_b32 v80, 16, v168
    v_and_b32 v81, s63, v168
    v_lshlrev_b32 v82, 16, v169
    buffer_load_dwordx4 v238, s[12:15], s20 offen offset:3072 nt lds
    v_and_b32 v83, s63, v169
    v_lshlrev_b32 v84, 16, v170
    v_and_b32 v85, s63, v170
    v_lshlrev_b32 v86, 16, v171
    v_and_b32 v87, s63, v171
    v_pk_mul_f32 v[80:81], v[80:81], s[94:95]
    v_pk_mul_f32 v[82:83], v[82:83], s[94:95]
    v_pk_mul_f32 v[84:85], v[84:85], s[94:95]
    v_pk_mul_f32 v[86:87], v[86:87], s[94:95]
    v_cvt_pk_bf16_f32 v88, v80, v81
    v_cvt_pk_bf16_f32 v89, v82, v83
    v_cvt_pk_bf16_f32 v90, v84, v85
    v_cvt_pk_bf16_f32 v91, v86, v87
    v_accvgpr_write_b32 a200, v88
    v_accvgpr_write_b32 a201, v89
    v_accvgpr_write_b32 a202, v90
    v_accvgpr_write_b32 a203, v91
    s_waitcnt lgkmcnt(4)
    v_lshlrev_b32 v80, 16, v172
    v_and_b32 v81, s63, v172
    v_lshlrev_b32 v82, 16, v173
    v_and_b32 v83, s63, v173
    s_add_u32 m0, s34, 16384
    s_nop 0
    buffer_load_dwordx4 v239, s[16:19], s21 offen offset:0 nt lds
    v_lshlrev_b32 v84, 16, v174
    v_and_b32 v85, s63, v174
    v_lshlrev_b32 v86, 16, v175
    v_and_b32 v87, s63, v175
    v_pk_mul_f32 v[80:81], v[80:81], s[94:95]
    v_pk_mul_f32 v[82:83], v[82:83], s[94:95]
    v_pk_mul_f32 v[84:85], v[84:85], s[94:95]
    v_pk_mul_f32 v[86:87], v[86:87], s[94:95]
    v_cvt_pk_bf16_f32 v88, v80, v81
    v_cvt_pk_bf16_f32 v89, v82, v83
    v_cvt_pk_bf16_f32 v90, v84, v85
    v_cvt_pk_bf16_f32 v91, v86, v87
    v_accvgpr_write_b32 a204, v88
    v_accvgpr_write_b32 a205, v89
    v_accvgpr_write_b32 a206, v90
    v_accvgpr_write_b32 a207, v91
    v_mfma_f32_32x32x16_bf16 a[96:111], v[128:131], v[200:203], 0
    s_waitcnt lgkmcnt(3)
    v_lshlrev_b32 v80, 16, v176
    v_and_b32 v81, s63, v176
    v_lshlrev_b32 v82, 16, v177
    buffer_load_dwordx4 v239, s[16:19], s21 offen offset:1024 nt lds
    v_and_b32 v83, s63, v177
    v_lshlrev_b32 v84, 16, v178
    v_and_b32 v85, s63, v178
    v_lshlrev_b32 v86, 16, v179
    v_and_b32 v87, s63, v179
    v_pk_mul_f32 v[80:81], v[80:81], s[94:95]
    v_pk_mul_f32 v[82:83], v[82:83], s[94:95]
    v_pk_mul_f32 v[84:85], v[84:85], s[94:95]
    v_pk_mul_f32 v[86:87], v[86:87], s[94:95]
    v_cvt_pk_bf16_f32 v88, v80, v81
    v_cvt_pk_bf16_f32 v89, v82, v83
    v_cvt_pk_bf16_f32 v90, v84, v85
    v_cvt_pk_bf16_f32 v91, v86, v87
    v_accvgpr_write_b32 a208, v88
    v_accvgpr_write_b32 a209, v89
    v_accvgpr_write_b32 a210, v90
    v_accvgpr_write_b32 a211, v91
    s_waitcnt lgkmcnt(2)
    v_lshlrev_b32 v80, 16, v180
    v_and_b32 v81, s63, v180
    v_lshlrev_b32 v82, 16, v181
    buffer_load_dwordx4 v239, s[16:19], s21 offen offset:2048 nt lds
    v_and_b32 v83, s63, v181
    v_lshlrev_b32 v84, 16, v182
    v_and_b32 v85, s63, v182
    v_lshlrev_b32 v86, 16, v183
    v_and_b32 v87, s63, v183
    v_pk_mul_f32 v[80:81], v[80:81], s[94:95]
    v_pk_mul_f32 v[82:83], v[82:83], s[94:95]
    v_pk_mul_f32 v[84:85], v[84:85], s[94:95]
    v_pk_mul_f32 v[86:87], v[86:87], s[94:95]
    v_cvt_pk_bf16_f32 v88, v80, v81
    v_cvt_pk_bf16_f32 v89, v82, v83
    v_cvt_pk_bf16_f32 v90, v84, v85
    v_cvt_pk_bf16_f32 v91, v86, v87
    v_accvgpr_write_b32 a212, v88
    v_accvgpr_write_b32 a213, v89
    v_accvgpr_write_b32 a214, v90
    v_accvgpr_write_b32 a215, v91
    v_mfma_f32_32x32x16_bf16 a[112:127], v[128:131], v[200:203], 0
    s_waitcnt lgkmcnt(1)
    v_lshlrev_b32 v80, 16, v184
    v_and_b32 v81, s63, v184
    buffer_load_dwordx4 v239, s[16:19], s21 offen offset:3072 nt lds
    s_add_u32 s34, s34, 32768
    s_cmp_ge_u32 s34, s40
    s_cselect_b32 s60, s41, 0
    s_sub_u32 s34, s34, s60
    s_add_u32 s20, s20, 16384
    s_add_u32 s21, s21, 16384
    v_lshlrev_b32 v82, 16, v185
    v_and_b32 v83, s63, v185
    v_lshlrev_b32 v84, 16, v186
    v_and_b32 v85, s63, v186
    v_lshlrev_b32 v86, 16, v187
    v_and_b32 v87, s63, v187
    v_pk_mul_f32 v[80:81], v[80:81], s[94:95]
    v_pk_mul_f32 v[82:83], v[82:83], s[94:95]
    v_pk_mul_f32 v[84:85], v[84:85], s[94:95]
    v_pk_mul_f32 v[86:87], v[86:87], s[94:95]
    v_cvt_pk_bf16_f32 v88, v80, v81
    v_cvt_pk_bf16_f32 v89, v82, v83
    v_cvt_pk_bf16_f32 v90, v84, v85
    v_cvt_pk_bf16_f32 v91, v86, v87
    v_accvgpr_write_b32 a216, v88
    v_accvgpr_write_b32 a217, v89
    v_accvgpr_write_b32 a218, v90
    v_accvgpr_write_b32 a219, v91
    s_waitcnt lgkmcnt(0)
    v_lshlrev_b32 v80, 16, v188
    v_and_b32 v81, s63, v188
    v_lshlrev_b32 v82, 16, v189
    v_and_b32 v83, s63, v189
    v_lshlrev_b32 v84, 16, v190
    v_and_b32 v85, s63, v190
    v_lshlrev_b32 v86, 16, v191
    v_and_b32 v87, s63, v191
    v_pk_mul_f32 v[80:81], v[80:81], s[94:95]
    v_pk_mul_f32 v[82:83], v[82:83], s[94:95]
    v_pk_mul_f32 v[84:85], v[84:85], s[94:95]
    v_pk_mul_f32 v[86:87], v[86:87], s[94:95]
    v_cvt_pk_bf16_f32 v88, v80, v81
    v_cvt_pk_bf16_f32 v89, v82, v83
    v_cvt_pk_bf16_f32 v90, v84, v85
    v_cvt_pk_bf16_f32 v91, v86, v87
    v_accvgpr_write_b32 a220, v88
    v_accvgpr_write_b32 a221, v89
    v_accvgpr_write_b32 a222, v90
    v_accvgpr_write_b32 a223, v91
    s_waitcnt vmcnt(8)
    v_add_u32 v242, s35, v208
    v_add_u32 v243, s35, v209
    v_add_u32 v244, s35, v210
    v_add_u32 v245, s35, v211
    v_add_u32 v246, s35, v212
    v_add_u32 v247, s35, v213
    v_add_u32 v248, s35, v214
    v_add_u32 v249, s35, v215
    ds_read_b128 v[160:163], v242
    ds_read_b128 v[164:167], v243
    ds_read_b128 v[168:171], v244
    ds_read_b128 v[172:175], v245
    ds_read_b128 v[176:179], v246
    ds_read_b128 v[180:183], v247
    ds_read_b128 v[184:187], v248
    ds_read_b128 v[188:191], v249
    s_add_u32 s35, s35, 32768
    s_cmp_ge_u32 s35, s40
    s_cselect_b32 s46, s41, 0
    s_sub_u32 s35, s35, s46
    s_mov_b32 m0, s34
    s_nop 0
    buffer_load_dwordx4 v235, s[12:15], s20 offen offset:0 nt lds
    v_mov_b32 v64, 0
    v_mov_b32 v65, 0
    v_mov_b32 v66, 0
    v_mov_b32 v67, 0
    v_mov_b32 v68, 0
    v_mov_b32 v69, 0
    v_mov_b32 v70, 0
    v_mov_b32 v71, 0
    v_mov_b32 v72, 0
    v_mov_b32 v73, 0
    v_mov_b32 v74, 0
    v_mov_b32 v75, 0
    v_mov_b32 v76, 0
    v_mov_b32 v77, 0
    v_mov_b32 v78, 0
    v_mov_b32 v79, 0
    v_mov_b32 v221, 0
    v_mfma_f32_32x32x16_bf16 a[128:143], v[128:131], v[200:203], 0
    s_waitcnt lgkmcnt(7)
    v_lshlrev_b32 v80, 16, v160
    v_and_b32 v81, s63, v160
    v_lshlrev_b32 v82, 16, v161
    v_and_b32 v83, s63, v161
    buffer_load_dwordx4 v236, s[12:15], s20 offen offset:1024 nt lds
    v_lshlrev_b32 v84, 16, v162
    v_and_b32 v85, s63, v162
    v_lshlrev_b32 v86, 16, v163
    v_and_b32 v87, s63, v163
    v_pk_mul_f32 v[80:81], v[80:81], s[94:95]
    v_pk_mul_f32 v[82:83], v[82:83], s[94:95]
    v_pk_mul_f32 v[84:85], v[84:85], s[94:95]
    v_pk_mul_f32 v[86:87], v[86:87], s[94:95]
    v_cvt_pk_bf16_f32 v88, v80, v81
    v_cvt_pk_bf16_f32 v89, v82, v83
    v_cvt_pk_bf16_f32 v90, v84, v85
    v_cvt_pk_bf16_f32 v91, v86, v87
    v_accvgpr_write_b32 a224, v88
    v_accvgpr_write_b32 a225, v89
    v_accvgpr_write_b32 a226, v90
    v_accvgpr_write_b32 a227, v91
    s_waitcnt lgkmcnt(6)
    v_lshlrev_b32 v80, 16, v164
    v_and_b32 v81, s63, v164
    v_lshlrev_b32 v82, 16, v165
    v_and_b32 v83, s63, v165
    v_lshlrev_b32 v84, 16, v166
    buffer_load_dwordx4 v237, s[12:15], s20 offen offset:2048 nt lds
    v_and_b32 v85, s63, v166
    v_lshlrev_b32 v86, 16, v167
    v_and_b32 v87, s63, v167
    v_pk_mul_f32 v[80:81], v[80:81], s[94:95]
    v_pk_mul_f32 v[82:83], v[82:83], s[94:95]
    v_pk_mul_f32 v[84:85], v[84:85], s[94:95]
    v_pk_mul_f32 v[86:87], v[86:87], s[94:95]
    v_cvt_pk_bf16_f32 v88, v80, v81
    v_cvt_pk_bf16_f32 v89, v82, v83
    v_cvt_pk_bf16_f32 v90, v84, v85
    v_cvt_pk_bf16_f32 v91, v86, v87
    v_accvgpr_write_b32 a228, v88
    v_accvgpr_write_b32 a229, v89
    v_accvgpr_write_b32 a230, v90
    v_accvgpr_write_b32 a231, v91
    v_mfma_f32_32x32x16_bf16 a[144:159], v[128:131], v[200:203], 0
    s_waitcnt lgkmcnt(5)
    v_lshlrev_b32 v80, 16, v168
    v_and_b32 v81, s63, v168
    v_lshlrev_b32 v82, 16, v169
    buffer_load_dwordx4 v238, s[12:15], s20 offen offset:3072 nt lds
    v_and_b32 v83, s63, v169
    v_lshlrev_b32 v84, 16, v170
    v_and_b32 v85, s63, v170
    v_lshlrev_b32 v86, 16, v171
    v_and_b32 v87, s63, v171
    v_pk_mul_f32 v[80:81], v[80:81], s[94:95]
    v_pk_mul_f32 v[82:83], v[82:83], s[94:95]
    v_pk_mul_f32 v[84:85], v[84:85], s[94:95]
    v_pk_mul_f32 v[86:87], v[86:87], s[94:95]
    v_cvt_pk_bf16_f32 v88, v80, v81
    v_cvt_pk_bf16_f32 v89, v82, v83
    v_cvt_pk_bf16_f32 v90, v84, v85
    v_cvt_pk_bf16_f32 v91, v86, v87
    v_accvgpr_write_b32 a232, v88
    v_accvgpr_write_b32 a233, v89
    v_accvgpr_write_b32 a234, v90
    v_accvgpr_write_b32 a235, v91
    s_waitcnt lgkmcnt(4)
    v_lshlrev_b32 v80, 16, v172
    v_and_b32 v81, s63, v172
    v_lshlrev_b32 v82, 16, v173
    v_and_b32 v83, s63, v173
    s_add_u32 m0, s34, 16384
    s_nop 0
    buffer_load_dwordx4 v239, s[16:19], s21 offen offset:0 nt lds
    v_lshlrev_b32 v84, 16, v174
    v_and_b32 v85, s63, v174
    v_lshlrev_b32 v86, 16, v175
    v_and_b32 v87, s63, v175
    v_pk_mul_f32 v[80:81], v[80:81], s[94:95]
    v_pk_mul_f32 v[82:83], v[82:83], s[94:95]
    v_pk_mul_f32 v[84:85], v[84:85], s[94:95]
    v_pk_mul_f32 v[86:87], v[86:87], s[94:95]
    v_cvt_pk_bf16_f32 v88, v80, v81
    v_cvt_pk_bf16_f32 v89, v82, v83
    v_cvt_pk_bf16_f32 v90, v84, v85
    v_cvt_pk_bf16_f32 v91, v86, v87
    v_accvgpr_write_b32 a236, v88
    v_accvgpr_write_b32 a237, v89
    v_accvgpr_write_b32 a238, v90
    v_accvgpr_write_b32 a239, v91
    v_mfma_f32_32x32x16_bf16 a[160:175], v[128:131], v[200:203], 0
    s_waitcnt lgkmcnt(3)
    v_lshlrev_b32 v80, 16, v176
    v_and_b32 v81, s63, v176
    v_lshlrev_b32 v82, 16, v177
    buffer_load_dwordx4 v239, s[16:19], s21 offen offset:1024 nt lds
    v_and_b32 v83, s63, v177
    v_lshlrev_b32 v84, 16, v178
    v_and_b32 v85, s63, v178
    v_lshlrev_b32 v86, 16, v179
    v_and_b32 v87, s63, v179
    v_pk_mul_f32 v[80:81], v[80:81], s[94:95]
    v_pk_mul_f32 v[82:83], v[82:83], s[94:95]
    v_pk_mul_f32 v[84:85], v[84:85], s[94:95]
    v_pk_mul_f32 v[86:87], v[86:87], s[94:95]
    v_cvt_pk_bf16_f32 v88, v80, v81
    v_cvt_pk_bf16_f32 v89, v82, v83
    v_cvt_pk_bf16_f32 v90, v84, v85
    v_cvt_pk_bf16_f32 v91, v86, v87
    v_accvgpr_write_b32 a240, v88
    v_accvgpr_write_b32 a241, v89
    v_accvgpr_write_b32 a242, v90
    v_accvgpr_write_b32 a243, v91
    s_waitcnt lgkmcnt(2)
    v_lshlrev_b32 v80, 16, v180
    v_and_b32 v81, s63, v180
    v_lshlrev_b32 v82, 16, v181
    buffer_load_dwordx4 v239, s[16:19], s21 offen offset:2048 nt lds
    v_and_b32 v83, s63, v181
    v_lshlrev_b32 v84, 16, v182
    v_and_b32 v85, s63, v182
    v_lshlrev_b32 v86, 16, v183
    v_and_b32 v87, s63, v183
    v_pk_mul_f32 v[80:81], v[80:81], s[94:95]
    v_pk_mul_f32 v[82:83], v[82:83], s[94:95]
    v_pk_mul_f32 v[84:85], v[84:85], s[94:95]
    v_pk_mul_f32 v[86:87], v[86:87], s[94:95]
    v_cvt_pk_bf16_f32 v88, v80, v81
    v_cvt_pk_bf16_f32 v89, v82, v83
    v_cvt_pk_bf16_f32 v90, v84, v85
    v_cvt_pk_bf16_f32 v91, v86, v87
    v_accvgpr_write_b32 a244, v88
    v_accvgpr_write_b32 a245, v89
    v_accvgpr_write_b32 a246, v90
    v_accvgpr_write_b32 a247, v91
    v_mfma_f32_32x32x16_bf16 a[176:191], v[128:131], v[200:203], 0
    s_waitcnt lgkmcnt(1)
    v_lshlrev_b32 v80, 16, v184
    v_and_b32 v81, s63, v184
    buffer_load_dwordx4 v239, s[16:19], s21 offen offset:3072 nt lds
    s_add_u32 s34, s34, 32768
    s_cmp_ge_u32 s34, s40
    s_cselect_b32 s60, s41, 0
    s_sub_u32 s34, s34, s60
    s_add_u32 s20, s20, 16384
    s_add_u32 s21, s21, 16384
    v_lshlrev_b32 v82, 16, v185
    v_and_b32 v83, s63, v185
    v_lshlrev_b32 v84, 16, v186
    v_and_b32 v85, s63, v186
    v_lshlrev_b32 v86, 16, v187
    v_and_b32 v87, s63, v187
    v_pk_mul_f32 v[80:81], v[80:81], s[94:95]
    v_pk_mul_f32 v[82:83], v[82:83], s[94:95]
    v_pk_mul_f32 v[84:85], v[84:85], s[94:95]
    v_pk_mul_f32 v[86:87], v[86:87], s[94:95]
    v_cvt_pk_bf16_f32 v88, v80, v81
    v_cvt_pk_bf16_f32 v89, v82, v83
    v_cvt_pk_bf16_f32 v90, v84, v85
    v_cvt_pk_bf16_f32 v91, v86, v87
    v_accvgpr_write_b32 a248, v88
    v_accvgpr_write_b32 a249, v89
    v_accvgpr_write_b32 a250, v90
    v_accvgpr_write_b32 a251, v91
    s_waitcnt lgkmcnt(0)
    v_lshlrev_b32 v80, 16, v188
    v_and_b32 v81, s63, v188
    v_lshlrev_b32 v82, 16, v189
    v_and_b32 v83, s63, v189
    v_lshlrev_b32 v84, 16, v190
    v_and_b32 v85, s63, v190
    v_lshlrev_b32 v86, 16, v191
    v_and_b32 v87, s63, v191
    v_pk_mul_f32 v[80:81], v[80:81], s[94:95]
    v_pk_mul_f32 v[82:83], v[82:83], s[94:95]
    v_pk_mul_f32 v[84:85], v[84:85], s[94:95]
    v_pk_mul_f32 v[86:87], v[86:87], s[94:95]
    v_cvt_pk_bf16_f32 v88, v80, v81
    v_cvt_pk_bf16_f32 v89, v82, v83
    v_cvt_pk_bf16_f32 v90, v84, v85
    v_cvt_pk_bf16_f32 v91, v86, v87
    v_accvgpr_write_b32 a252, v88
    v_accvgpr_write_b32 a253, v89
    v_accvgpr_write_b32 a254, v90
    v_accvgpr_write_b32 a255, v91
    s_mov_b32 s48, s39
    s_add_u32 s49, s39, 8192
    s_mov_b32 s50, s39
    s_mov_b32 s42, 2
    s_mov_b32 s43, 8
    s_waitcnt vmcnt(8)
    s_barrier
    s_branch L_go_A
L_pro_B:
    s_mov_b32 s48, s39
    s_add_u32 s49, s39, 8192
    s_mov_b32 s50, s39
    s_mov_b32 s42, 2
    s_mov_b64 s[12:13], s[4:5]
    s_mov_b64 s[16:17], s[4:5]
    s_mov_b32 s14, 37748736
    s_mov_b32 s18, 37748736
    s_mov_b32 s20, s48
    s_add_u32 s21, s48, 4096
    s_mov_b32 m0, s34
    s_nop 0
    buffer_load_dwordx4 v235, s[12:15], s20 offen offset:0 nt lds
    buffer_load_dwordx4 v236, s[12:15], s20 offen offset:1024 nt lds
    buffer_load_dwordx4 v237, s[12:15], s20 offen offset:2048 nt lds
    buffer_load_dwordx4 v238, s[12:15], s20 offen offset:3072 nt lds
    s_add_u32 m0, s34, 16384
    s_nop 0
    buffer_load_dwordx4 v239, s[16:19], s21 offen offset:0 nt lds
    buffer_load_dwordx4 v239, s[16:19], s21 offen offset:1024 nt lds
    buffer_load_dwordx4 v239, s[16:19], s21 offen offset:2048 nt lds
    buffer_load_dwordx4 v239, s[16:19], s21 offen offset:3072 nt lds
    s_add_u32 s34, s34, 32768
    s_cmp_ge_u32 s34, s40
    s_cselect_b32 s60, s41, 0
    s_sub_u32 s34, s34, s60
    s_mov_b64 s[12:13], s[4:5]
    s_mov_b64 s[16:17], s[4:5]
    s_mov_b32 s14, 37748736
    s_mov_b32 s18, 37748736
    s_mov_b32 s20, s49
    s_add_u32 s21, s49, 4096
    s_mov_b32 m0, s34
    s_nop 0
    buffer_load_dwordx4 v235, s[12:15], s20 offen offset:0 nt lds
    buffer_load_dwordx4 v236, s[12:15], s20 offen offset:1024 nt lds
    buffer_load_dwordx4 v237, s[12:15], s20 offen offset:2048 nt lds
    buffer_load_dwordx4 v238, s[12:15], s20 offen offset:3072 nt lds
    s_add_u32 m0, s34, 16384
    s_nop 0
    buffer_load_dwordx4 v239, s[16:19], s21 offen offset:0 nt lds
    buffer_load_dwordx4 v239, s[16:19], s21 offen offset:1024 nt lds
    buffer_load_dwordx4 v239, s[16:19], s21 offen offset:2048 nt lds
    buffer_load_dwordx4 v239, s[16:19], s21 offen offset:3072 nt lds
    s_add_u32 s34, s34, 32768
    s_cmp_ge_u32 s34, s40
    s_cselect_b32 s60, s41, 0
    s_sub_u32 s34, s34, s60
    v_and_b32 v243, 31, v242
    v_lshrrev_b32 v244, 5, v242
    v_lshlrev_b32 v254, 3, v242
    v_lshlrev_b32 v255, 4, v242
    v_lshlrev_b32 v245, 8, v243
    v_and_b32 v246, 15, v243
    v_xor_b32 v246, v246, v244
    v_xor_b32 v247, 0, v246
    v_lshl_add_u32 v223, v247, 4, v245
    v_xor_b32 v247, 2, v246
    v_lshl_add_u32 v224, v247, 4, v245
    v_xor_b32 v247, 4, v246
    v_lshl_add_u32 v225, v247, 4, v245
    v_xor_b32 v247, 6, v246
    v_lshl_add_u32 v226, v247, 4, v245
    v_xor_b32 v247, 8, v246
    v_lshl_add_u32 v227, v247, 4, v245
    v_xor_b32 v247, 10, v246
    v_lshl_add_u32 v228, v247, 4, v245
    v_xor_b32 v247, 12, v246
    v_lshl_add_u32 v229, v247, 4, v245
    v_xor_b32 v247, 14, v246
    v_lshl_add_u32 v230, v247, 4, v245
    v_and_b32 v247, 15, v243
    v_lshlrev_b32 v248, 8, v247
    v_bfe_u32 v249, v243, 4, 1
    v_lshl_add_u32 v248, v249, 14, v248
    v_add_u32 v240, s55, v248
    v_and_b32 v248, 3, v243
    v_lshlrev_b32 v248, 2, v248
    v_cmp_ne_u32 vcc, 0, v249
    s_nop 1
    v_cndmask_b32 v247, v247, v248, vcc
    v_xor_b32 v241, v247, v244
    v_bfe_u32 v246, v242, 2, 2
    v_and_b32 v247, 3, v242
    v_bfe_u32 v248, v242, 4, 1
    v_lshl_add_u32 v249, v244, 2, v246
    v_lshlrev_b32 v249, 8, v249
    v_lshl_add_u32 v249, v248, 5, v249
    v_lshl_add_u32 v249, v247, 3, v249
    v_add_u32 v249, 16384, v249
    v_xor_b32 v250, 0, v246
    v_lshl_add_u32 v231, v250, 6, v249
    v_xor_b32 v250, 1, v246
    v_lshl_add_u32 v232, v250, 6, v249
    v_xor_b32 v250, 2, v246
    v_lshl_add_u32 v233, v250, 6, v249
    v_xor_b32 v250, 3, v246
    v_lshl_add_u32 v234, v250, 6, v249
    v_mov_b32 v128, 0
    v_mov_b32 v129, 0
    v_mov_b32 v130, 0
    v_mov_b32 v131, 0
    v_mov_b32 v132, 0
    v_mov_b32 v133, 0
    v_mov_b32 v134, 0
    v_mov_b32 v135, 0
    v_mov_b32 v136, 0
    v_mov_b32 v137, 0
    v_mov_b32 v138, 0
    v_mov_b32 v139, 0
    v_mov_b32 v140, 0
    v_mov_b32 v141, 0
    v_mov_b32 v142, 0
    v_mov_b32 v143, 0
    v_mov_b32 v144, 0
    v_mov_b32 v145, 0
    v_mov_b32 v146, 0
    v_mov_b32 v147, 0
    v_mov_b32 v148, 0
    v_mov_b32 v149, 0
    v_mov_b32 v150, 0
    v_mov_b32 v151, 0
    v_mov_b32 v152, 0
    v_mov_b32 v153, 0
    v_mov_b32 v154, 0
    v_mov_b32 v155, 0
    v_mov_b32 v156, 0
    v_mov_b32 v157, 0
    v_mov_b32 v158, 0
    v_mov_b32 v159, 0
    v_mov_b32 v200, 0
    v_mov_b32 v201, 0
    v_mov_b32 v202, 0
    v_mov_b32 v203, 0
    v_mov_b32 v204, 0
    v_mov_b32 v205, 0
    v_mov_b32 v206, 0
    v_mov_b32 v207, 0
    v_xor_b32 v208, 0, v241
    v_lshl_add_u32 v208, v208, 4, v240
    v_xor_b32 v209, 2, v241
    v_lshl_add_u32 v209, v209, 4, v240
    v_xor_b32 v210, 4, v241
    v_lshl_add_u32 v210, v210, 4, v240
    v_xor_b32 v211, 6, v241
    v_lshl_add_u32 v211, v211, 4, v240
    v_xor_b32 v212, 8, v241
    v_lshl_add_u32 v212, v212, 4, v240
    v_xor_b32 v213, 10, v241
    v_lshl_add_u32 v213, v213, 4, v240
    v_xor_b32 v214, 12, v241
    v_lshl_add_u32 v214, v214, 4, v240
    v_xor_b32 v215, 14, v241
    v_lshl_add_u32 v215, v215, 4, v240
    s_waitcnt vmcnt(8)
    v_add_u32 v242, s35, v208
    v_add_u32 v243, s35, v209
    v_add_u32 v244, s35, v210
    v_add_u32 v245, s35, v211
    v_add_u32 v246, s35, v212
    v_add_u32 v247, s35, v213
    v_add_u32 v248, s35, v214
    v_add_u32 v249, s35, v215
    ds_read_b128 v[160:163], v242
    ds_read_b128 v[164:167], v243
    ds_read_b128 v[168:171], v244
    ds_read_b128 v[172:175], v245
    ds_read_b128 v[176:179], v246
    ds_read_b128 v[180:183], v247
    ds_read_b128 v[184:187], v248
    ds_read_b128 v[188:191], v249
    s_add_u32 s35, s35, 32768
    s_cmp_ge_u32 s35, s40
    s_cselect_b32 s46, s41, 0
    s_sub_u32 s35, s35, s46
    s_mov_b64 s[12:13], s[6:7]
    s_mov_b64 s[16:17], s[8:9]
    s_mov_b32 s14, 262144
    s_mov_b32 s18, 262144
    s_mov_b32 s20, s33
    s_mov_b32 s21, s33
    s_mov_b32 m0, s34
    s_nop 0
    buffer_load_dwordx4 v235, s[12:15], s20 offen offset:0 nt lds
    v_mov_b32 v32, 0
    v_mov_b32 v33, 0
    v_mov_b32 v34, 0
    v_mov_b32 v35, 0
    v_mov_b32 v36, 0
    v_mov_b32 v37, 0
    v_mov_b32 v38, 0
    v_mov_b32 v39, 0
    v_mov_b32 v40, 0
    v_mov_b32 v41, 0
    v_mov_b32 v42, 0
    v_mov_b32 v43, 0
    v_mov_b32 v44, 0
    v_mov_b32 v45, 0
    v_mov_b32 v46, 0
    v_mov_b32 v47, 0
    v_mov_b32 v219, 0
    v_mfma_f32_32x32x16_bf16 a[0:15], v[128:131], v[200:203], 0
    s_waitcnt lgkmcnt(7)
    v_lshlrev_b32 v80, 16, v160
    buffer_load_dwordx4 v236, s[12:15], s20 offen offset:1024 nt lds
    v_and_b32 v81, s63, v160
    v_lshlrev_b32 v82, 16, v161
    v_and_b32 v83, s63, v161
    v_lshlrev_b32 v84, 16, v162
    v_and_b32 v85, s63, v162
    v_lshlrev_b32 v86, 16, v163
    v_and_b32 v87, s63, v163
    v_pk_mul_f32 v[80:81], v[80:81], s[94:95]
    v_pk_mul_f32 v[82:83], v[82:83], s[94:95]
    v_pk_mul_f32 v[84:85], v[84:85], s[94:95]
    v_pk_mul_f32 v[86:87], v[86:87], s[94:95]
    v_cvt_pk_bf16_f32 v0, v80, v81
    v_cvt_pk_bf16_f32 v1, v82, v83
    v_cvt_pk_bf16_f32 v2, v84, v85
    v_cvt_pk_bf16_f32 v3, v86, v87
    s_waitcnt lgkmcnt(6)
    v_lshlrev_b32 v80, 16, v164
    v_and_b32 v81, s63, v164
    buffer_load_dwordx4 v237, s[12:15], s20 offen offset:2048 nt lds
    v_lshlrev_b32 v82, 16, v165
    v_and_b32 v83, s63, v165
    v_lshlrev_b32 v84, 16, v166
    v_and_b32 v85, s63, v166
    v_lshlrev_b32 v86, 16, v167
    v_and_b32 v87, s63, v167
    v_pk_mul_f32 v[80:81], v[80:81], s[94:95]
    v_pk_mul_f32 v[82:83], v[82:83], s[94:95]
    v_pk_mul_f32 v[84:85], v[84:85], s[94:95]
    v_pk_mul_f32 v[86:87], v[86:87], s[94:95]
    v_cvt_pk_bf16_f32 v4, v80, v81
    v_cvt_pk_bf16_f32 v5, v82, v83
    v_cvt_pk_bf16_f32 v6, v84, v85
    v_cvt_pk_bf16_f32 v7, v86, v87
    v_mfma_f32_32x32x16_bf16 a[16:31], v[128:131], v[200:203], 0
    s_waitcnt lgkmcnt(5)
    v_lshlrev_b32 v80, 16, v168
    buffer_load_dwordx4 v238, s[12:15], s20 offen offset:3072 nt lds
    v_and_b32 v81, s63, v168
    v_lshlrev_b32 v82, 16, v169
    v_and_b32 v83, s63, v169
    v_lshlrev_b32 v84, 16, v170
    v_and_b32 v85, s63, v170
    v_lshlrev_b32 v86, 16, v171
    v_and_b32 v87, s63, v171
    v_pk_mul_f32 v[80:81], v[80:81], s[94:95]
    v_pk_mul_f32 v[82:83], v[82:83], s[94:95]
    v_pk_mul_f32 v[84:85], v[84:85], s[94:95]
    v_pk_mul_f32 v[86:87], v[86:87], s[94:95]
    v_cvt_pk_bf16_f32 v8, v80, v81
    v_cvt_pk_bf16_f32 v9, v82, v83
    v_cvt_pk_bf16_f32 v10, v84, v85
    v_cvt_pk_bf16_f32 v11, v86, v87
    s_waitcnt lgkmcnt(4)
    v_lshlrev_b32 v80, 16, v172
    v_and_b32 v81, s63, v172
    s_add_u32 m0, s34, 16384
    s_nop 0
    buffer_load_dwordx4 v239, s[16:19], s21 offen offset:0 nt lds
    v_lshlrev_b32 v82, 16, v173
    v_and_b32 v83, s63, v173
    v_lshlrev_b32 v84, 16, v174
    v_and_b32 v85, s63, v174
    v_lshlrev_b32 v86, 16, v175
    v_and_b32 v87, s63, v175
    v_pk_mul_f32 v[80:81], v[80:81], s[94:95]
    v_pk_mul_f32 v[82:83], v[82:83], s[94:95]
    v_pk_mul_f32 v[84:85], v[84:85], s[94:95]
    v_pk_mul_f32 v[86:87], v[86:87], s[94:95]
    v_cvt_pk_bf16_f32 v12, v80, v81
    v_cvt_pk_bf16_f32 v13, v82, v83
    v_cvt_pk_bf16_f32 v14, v84, v85
    v_cvt_pk_bf16_f32 v15, v86, v87
    v_mfma_f32_32x32x16_bf16 a[32:47], v[128:131], v[200:203], 0
    s_waitcnt lgkmcnt(3)
    v_lshlrev_b32 v80, 16, v176
    buffer_load_dwordx4 v239, s[16:19], s21 offen offset:1024 nt lds
    v_and_b32 v81, s63, v176
    v_lshlrev_b32 v82, 16, v177
    v_and_b32 v83, s63, v177
    v_lshlrev_b32 v84, 16, v178
    v_and_b32 v85, s63, v178
    v_lshlrev_b32 v86, 16, v179
    v_and_b32 v87, s63, v179
    v_pk_mul_f32 v[80:81], v[80:81], s[94:95]
    v_pk_mul_f32 v[82:83], v[82:83], s[94:95]
    v_pk_mul_f32 v[84:85], v[84:85], s[94:95]
    v_pk_mul_f32 v[86:87], v[86:87], s[94:95]
    v_cvt_pk_bf16_f32 v16, v80, v81
    v_cvt_pk_bf16_f32 v17, v82, v83
    v_cvt_pk_bf16_f32 v18, v84, v85
    v_cvt_pk_bf16_f32 v19, v86, v87
    s_waitcnt lgkmcnt(2)
    v_lshlrev_b32 v80, 16, v180
    v_and_b32 v81, s63, v180
    buffer_load_dwordx4 v239, s[16:19], s21 offen offset:2048 nt lds
    v_lshlrev_b32 v82, 16, v181
    v_and_b32 v83, s63, v181
    v_lshlrev_b32 v84, 16, v182
    v_and_b32 v85, s63, v182
    v_lshlrev_b32 v86, 16, v183
    v_and_b32 v87, s63, v183
    v_pk_mul_f32 v[80:81], v[80:81], s[94:95]
    v_pk_mul_f32 v[82:83], v[82:83], s[94:95]
    v_pk_mul_f32 v[84:85], v[84:85], s[94:95]
    v_pk_mul_f32 v[86:87], v[86:87], s[94:95]
    v_cvt_pk_bf16_f32 v20, v80, v81
    v_cvt_pk_bf16_f32 v21, v82, v83
    v_cvt_pk_bf16_f32 v22, v84, v85
    v_cvt_pk_bf16_f32 v23, v86, v87
    v_mfma_f32_32x32x16_bf16 a[48:63], v[128:131], v[200:203], 0
    s_waitcnt lgkmcnt(1)
    v_lshlrev_b32 v80, 16, v184
    buffer_load_dwordx4 v239, s[16:19], s21 offen offset:3072 nt lds
    s_add_u32 s34, s34, 32768
    s_cmp_ge_u32 s34, s40
    s_cselect_b32 s60, s41, 0
    s_sub_u32 s34, s34, s60
    s_add_u32 s20, s20, 16384
    s_add_u32 s21, s21, 16384
    v_and_b32 v81, s63, v184
    v_lshlrev_b32 v82, 16, v185
    v_and_b32 v83, s63, v185
    v_lshlrev_b32 v84, 16, v186
    v_and_b32 v85, s63, v186
    v_lshlrev_b32 v86, 16, v187
    v_and_b32 v87, s63, v187
    v_pk_mul_f32 v[80:81], v[80:81], s[94:95]
    v_pk_mul_f32 v[82:83], v[82:83], s[94:95]
    v_pk_mul_f32 v[84:85], v[84:85], s[94:95]
    v_pk_mul_f32 v[86:87], v[86:87], s[94:95]
    v_cvt_pk_bf16_f32 v24, v80, v81
    v_cvt_pk_bf16_f32 v25, v82, v83
    v_cvt_pk_bf16_f32 v26, v84, v85
    v_cvt_pk_bf16_f32 v27, v86, v87
    s_waitcnt lgkmcnt(0)
    v_lshlrev_b32 v80, 16, v188
    v_and_b32 v81, s63, v188
    v_lshlrev_b32 v82, 16, v189
    v_and_b32 v83, s63, v189
    v_lshlrev_b32 v84, 16, v190
    v_and_b32 v85, s63, v190
    v_lshlrev_b32 v86, 16, v191
    v_and_b32 v87, s63, v191
    v_pk_mul_f32 v[80:81], v[80:81], s[94:95]
    v_pk_mul_f32 v[82:83], v[82:83], s[94:95]
    v_pk_mul_f32 v[84:85], v[84:85], s[94:95]
    v_pk_mul_f32 v[86:87], v[86:87], s[94:95]
    v_cvt_pk_bf16_f32 v28, v80, v81
    v_cvt_pk_bf16_f32 v29, v82, v83
    v_cvt_pk_bf16_f32 v30, v84, v85
    v_cvt_pk_bf16_f32 v31, v86, v87
    s_waitcnt vmcnt(8)
    v_add_u32 v242, s35, v208
    v_add_u32 v243, s35, v209
    v_add_u32 v244, s35, v210
    v_add_u32 v245, s35, v211
    v_add_u32 v246, s35, v212
    v_add_u32 v247, s35, v213
    v_add_u32 v248, s35, v214
    v_add_u32 v249, s35, v215
    ds_read_b128 v[160:163], v242
    ds_read_b128 v[164:167], v243
    ds_read_b128 v[168:171], v244
    ds_read_b128 v[172:175], v245
    ds_read_b128 v[176:179], v246
    ds_read_b128 v[180:183], v247
    ds_read_b128 v[184:187], v248
    ds_read_b128 v[188:191], v249
    s_add_u32 s35, s35, 32768
    s_cmp_ge_u32 s35, s40
    s_cselect_b32 s46, s41, 0
    s_sub_u32 s35, s35, s46
    s_mov_b32 m0, s34
    s_nop 0
    buffer_load_dwordx4 v235, s[12:15], s20 offen offset:0 nt lds
    v_mov_b32 v48, 0
    v_mov_b32 v49, 0
    v_mov_b32 v50, 0
    v_mov_b32 v51, 0
    v_mov_b32 v52, 0
    v_mov_b32 v53, 0
    v_mov_b32 v54, 0
    v_mov_b32 v55, 0
    v_mov_b32 v56, 0
    v_mov_b32 v57, 0
    v_mov_b32 v58, 0
    v_mov_b32 v59, 0
    v_mov_b32 v60, 0
    v_mov_b32 v61, 0
    v_mov_b32 v62, 0
    v_mov_b32 v63, 0
    v_mov_b32 v220, 0
    v_mfma_f32_32x32x16_bf16 a[64:79], v[128:131], v[200:203], 0
    s_waitcnt lgkmcnt(7)
    v_lshlrev_b32 v80, 16, v160
    v_and_b32 v81, s63, v160
    v_lshlrev_b32 v82, 16, v161
    v_and_b32 v83, s63, v161
    buffer_load_dwordx4 v236, s[12:15], s20 offen offset:1024 nt lds
    v_lshlrev_b32 v84, 16, v162
    v_and_b32 v85, s63, v162
    v_lshlrev_b32 v86, 16, v163
    v_and_b32 v87, s63, v163
    v_pk_mul_f32 v[80:81], v[80:81], s[94:95]
    v_pk_mul_f32 v[82:83], v[82:83], s[94:95]
    v_pk_mul_f32 v[84:85], v[84:85], s[94:95]
    v_pk_mul_f32 v[86:87], v[86:87], s[94:95]
    v_cvt_pk_bf16_f32 v88, v80, v81
    v_cvt_pk_bf16_f32 v89, v82, v83
    v_cvt_pk_bf16_f32 v90, v84, v85
    v_cvt_pk_bf16_f32 v91, v86, v87
    v_accvgpr_write_b32 a192, v88
    v_accvgpr_write_b32 a193, v89
    v_accvgpr_write_b32 a194, v90
    v_accvgpr_write_b32 a195, v91
    s_waitcnt lgkmcnt(6)
    v_lshlrev_b32 v80, 16, v164
    v_and_b32 v81, s63, v164
    v_lshlrev_b32 v82, 16, v165
    v_and_b32 v83, s63, v165
    v_lshlrev_b32 v84, 16, v166
    buffer_load_dwordx4 v237, s[12:15], s20 offen offset:2048 nt lds
    v_and_b32 v85, s63, v166
    v_lshlrev_b32 v86, 16, v167
    v_and_b32 v87, s63, v167
    v_pk_mul_f32 v[80:81], v[80:81], s[94:95]
    v_pk_mul_f32 v[82:83], v[82:83], s[94:95]
    v_pk_mul_f32 v[84:85], v[84:85], s[94:95]
    v_pk_mul_f32 v[86:87], v[86:87], s[94:95]
    v_cvt_pk_bf16_f32 v88, v80, v81
    v_cvt_pk_bf16_f32 v89, v82, v83
    v_cvt_pk_bf16_f32 v90, v84, v85
    v_cvt_pk_bf16_f32 v91, v86, v87
    v_accvgpr_write_b32 a196, v88
    v_accvgpr_write_b32 a197, v89
    v_accvgpr_write_b32 a198, v90
    v_accvgpr_write_b32 a199, v91
    v_mfma_f32_32x32x16_bf16 a[80:95], v[128:131], v[200:203], 0
    s_waitcnt lgkmcnt(5)
    v_lshlrev_b32 v80, 16, v168
    v_and_b32 v81, s63, v168
    v_lshlrev_b32 v82, 16, v169
    buffer_load_dwordx4 v238, s[12:15], s20 offen offset:3072 nt lds
    v_and_b32 v83, s63, v169
    v_lshlrev_b32 v84, 16, v170
    v_and_b32 v85, s63, v170
    v_lshlrev_b32 v86, 16, v171
    v_and_b32 v87, s63, v171
    v_pk_mul_f32 v[80:81], v[80:81], s[94:95]
    v_pk_mul_f32 v[82:83], v[82:83], s[94:95]
    v_pk_mul_f32 v[84:85], v[84:85], s[94:95]
    v_pk_mul_f32 v[86:87], v[86:87], s[94:95]
    v_cvt_pk_bf16_f32 v88, v80, v81
    v_cvt_pk_bf16_f32 v89, v82, v83
    v_cvt_pk_bf16_f32 v90, v84, v85
    v_cvt_pk_bf16_f32 v91, v86, v87
    v_accvgpr_write_b32 a200, v88
    v_accvgpr_write_b32 a201, v89
    v_accvgpr_write_b32 a202, v90
    v_accvgpr_write_b32 a203, v91
    s_waitcnt lgkmcnt(4)
    v_lshlrev_b32 v80, 16, v172
    v_and_b32 v81, s63, v172
    v_lshlrev_b32 v82, 16, v173
    v_and_b32 v83, s63, v173
    s_add_u32 m0, s34, 16384
    s_nop 0
    buffer_load_dwordx4 v239, s[16:19], s21 offen offset:0 nt lds
    v_lshlrev_b32 v84, 16, v174
    v_and_b32 v85, s63, v174
    v_lshlrev_b32 v86, 16, v175
    v_and_b32 v87, s63, v175
    v_pk_mul_f32 v[80:81], v[80:81], s[94:95]
    v_pk_mul_f32 v[82:83], v[82:83], s[94:95]
    v_pk_mul_f32 v[84:85], v[84:85], s[94:95]
    v_pk_mul_f32 v[86:87], v[86:87], s[94:95]
    v_cvt_pk_bf16_f32 v88, v80, v81
    v_cvt_pk_bf16_f32 v89, v82, v83
    v_cvt_pk_bf16_f32 v90, v84, v85
    v_cvt_pk_bf16_f32 v91, v86, v87
    v_accvgpr_write_b32 a204, v88
    v_accvgpr_write_b32 a205, v89
    v_accvgpr_write_b32 a206, v90
    v_accvgpr_write_b32 a207, v91
    v_mfma_f32_32x32x16_bf16 a[96:111], v[128:131], v[200:203], 0
    s_waitcnt lgkmcnt(3)
    v_lshlrev_b32 v80, 16, v176
    v_and_b32 v81, s63, v176
    v_lshlrev_b32 v82, 16, v177
    buffer_load_dwordx4 v239, s[16:19], s21 offen offset:1024 nt lds
    v_and_b32 v83, s63, v177
    v_lshlrev_b32 v84, 16, v178
    v_and_b32 v85, s63, v178
    v_lshlrev_b32 v86, 16, v179
    v_and_b32 v87, s63, v179
    v_pk_mul_f32 v[80:81], v[80:81], s[94:95]
    v_pk_mul_f32 v[82:83], v[82:83], s[94:95]
    v_pk_mul_f32 v[84:85], v[84:85], s[94:95]
    v_pk_mul_f32 v[86:87], v[86:87], s[94:95]
    v_cvt_pk_bf16_f32 v88, v80, v81
    v_cvt_pk_bf16_f32 v89, v82, v83
    v_cvt_pk_bf16_f32 v90, v84, v85
    v_cvt_pk_bf16_f32 v91, v86, v87
    v_accvgpr_write_b32 a208, v88
    v_accvgpr_write_b32 a209, v89
    v_accvgpr_write_b32 a210, v90
    v_accvgpr_write_b32 a211, v91
    s_waitcnt lgkmcnt(2)
    v_lshlrev_b32 v80, 16, v180
    v_and_b32 v81, s63, v180
    v_lshlrev_b32 v82, 16, v181
    buffer_load_dwordx4 v239, s[16:19], s21 offen offset:2048 nt lds
    v_and_b32 v83, s63, v181
    v_lshlrev_b32 v84, 16, v182
    v_and_b32 v85, s63, v182
    v_lshlrev_b32 v86, 16, v183
    v_and_b32 v87, s63, v183
    v_pk_mul_f32 v[80:81], v[80:81], s[94:95]
    v_pk_mul_f32 v[82:83], v[82:83], s[94:95]
    v_pk_mul_f32 v[84:85], v[84:85], s[94:95]
    v_pk_mul_f32 v[86:87], v[86:87], s[94:95]
    v_cvt_pk_bf16_f32 v88, v80, v81
    v_cvt_pk_bf16_f32 v89, v82, v83
    v_cvt_pk_bf16_f32 v90, v84, v85
    v_cvt_pk_bf16_f32 v91, v86, v87
    v_accvgpr_write_b32 a212, v88
    v_accvgpr_write_b32 a213, v89
    v_accvgpr_write_b32 a214, v90
    v_accvgpr_write_b32 a215, v91
    v_mfma_f32_32x32x16_bf16 a[112:127], v[128:131], v[200:203], 0
    s_waitcnt lgkmcnt(1)
    v_lshlrev_b32 v80, 16, v184
    v_and_b32 v81, s63, v184
    buffer_load_dwordx4 v239, s[16:19], s21 offen offset:3072 nt lds
    s_add_u32 s34, s34, 32768
    s_cmp_ge_u32 s34, s40
    s_cselect_b32 s60, s41, 0
    s_sub_u32 s34, s34, s60
    s_add_u32 s20, s20, 16384
    s_add_u32 s21, s21, 16384
    v_lshlrev_b32 v82, 16, v185
    v_and_b32 v83, s63, v185
    v_lshlrev_b32 v84, 16, v186
    v_and_b32 v85, s63, v186
    v_lshlrev_b32 v86, 16, v187
    v_and_b32 v87, s63, v187
    v_pk_mul_f32 v[80:81], v[80:81], s[94:95]
    v_pk_mul_f32 v[82:83], v[82:83], s[94:95]
    v_pk_mul_f32 v[84:85], v[84:85], s[94:95]
    v_pk_mul_f32 v[86:87], v[86:87], s[94:95]
    v_cvt_pk_bf16_f32 v88, v80, v81
    v_cvt_pk_bf16_f32 v89, v82, v83
    v_cvt_pk_bf16_f32 v90, v84, v85
    v_cvt_pk_bf16_f32 v91, v86, v87
    v_accvgpr_write_b32 a216, v88
    v_accvgpr_write_b32 a217, v89
    v_accvgpr_write_b32 a218, v90
    v_accvgpr_write_b32 a219, v91
    s_waitcnt lgkmcnt(0)
    v_lshlrev_b32 v80, 16, v188
    v_and_b32 v81, s63, v188
    v_lshlrev_b32 v82, 16, v189
    v_and_b32 v83, s63, v189
    v_lshlrev_b32 v84, 16, v190
    v_and_b32 v85, s63, v190
    v_lshlrev_b32 v86, 16, v191
    v_and_b32 v87, s63, v191
    v_pk_mul_f32 v[80:81], v[80:81], s[94:95]
    v_pk_mul_f32 v[82:83], v[82:83], s[94:95]
    v_pk_mul_f32 v[84:85], v[84:85], s[94:95]
    v_pk_mul_f32 v[86:87], v[86:87], s[94:95]
    v_cvt_pk_bf16_f32 v88, v80, v81
    v_cvt_pk_bf16_f32 v89, v82, v83
    v_cvt_pk_bf16_f32 v90, v84, v85
    v_cvt_pk_bf16_f32 v91, v86, v87
    v_accvgpr_write_b32 a220, v88
    v_accvgpr_write_b32 a221, v89
    v_accvgpr_write_b32 a222, v90
    v_accvgpr_write_b32 a223, v91
    s_mov_b32 s48, s37
    s_add_u32 s49, s37, 8192
    s_mov_b32 s50, s38
    s_mov_b32 s42, 3
    s_mov_b32 s43, 8
    s_waitcnt vmcnt(8)
    s_barrier
    s_branch L_go_B
L_go_A:
    s_and_b32 s45, s3, 1
    s_cmp_lg_u32 s45, 0
    s_cbranch_scc1 L_item_A1
    s_branch L_item_A0
L_go_B:
    s_branch L_item_B
L_item_A0:
    s_sub_u32 s36, s35, s51
    s_mov_b32 s51, s35
    v_add_u32 v223, s36, v223
    v_add_u32 v224, s36, v224
    v_add_u32 v225, s36, v225
    v_add_u32 v226, s36, v226
    v_add_u32 v227, s36, v227
    v_add_u32 v228, s36, v228
    v_add_u32 v229, s36, v229
    v_add_u32 v230, s36, v230
    ds_read_b128 v[96:99], v223 offset:0
    ds_read_b128 v[100:103], v224 offset:0
    ds_read_b128 v[104:107], v225 offset:0
    ds_read_b128 v[108:111], v226 offset:0
    ds_read_b128 v[112:115], v227 offset:0
    ds_read_b128 v[116:119], v228 offset:0
    ds_read_b128 v[120:123], v229 offset:0
    ds_read_b128 v[124:127], v230 offset:0
    s_sub_u32 s36, s35, s52
    s_mov_b32 s52, s35
    s_mov_b32 s29, 0x35800000
    s_mov_b32 s22, 0x12000000
    s_waitcnt lgkmcnt(0)
    v_mfma_f32_32x32x16_bf16 v[160:175], v[96:99], v[0:3], v[32:47]
    v_mfma_f32_32x32x16_bf16 v[160:175], v[100:103], v[4:7], v[160:175]
    v_mfma_f32_32x32x16_bf16 v[160:175], v[104:107], v[8:11], v[160:175]
    v_mfma_f32_32x32x16_bf16 v[160:175], v[108:111], v[12:15], v[160:175]
    v_mfma_f32_32x32x16_bf16 v[160:175], v[112:115], v[16:19], v[160:175]
    v_mfma_f32_32x32x16_bf16 v[160:175], v[116:119], v[20:23], v[160:175]
    v_mfma_f32_32x32x16_bf16 v[160:175], v[120:123], v[24:27], v[160:175]
    v_mfma_f32_32x32x16_bf16 v[160:175], v[124:127], v[28:31], v[160:175]
    v_add_u32 v231, s36, v231
    v_add_u32 v232, s36, v232
    v_add_u32 v233, s36, v233
    v_add_u32 v234, s36, v234
    v_mfma_f32_32x32x16_bf16 a[64:79], v[128:131], v[200:203], a[64:79]
L_loop_A0:
    ds_read_b64_tr_b16 v[128:129], v231 offset:0
    ds_read_b64_tr_b16 v[130:131], v231 offset:2048
    s_bitcmp1_b32 s23, s32
    s_cbranch_scc1 L_ex23
L_exr24:
    v_mfma_f32_32x32x16_bf16 a[80:95], v[136:139], v[200:203], a[80:95]
    ds_read_b64_tr_b16 v[136:137], v232 offset:0
    ds_read_b64_tr_b16 v[138:139], v232 offset:2048
    s_mov_b32 m0, s34
    s_nop 0
    buffer_load_dwordx4 v235, s[12:15], s20 offen offset:0 nt lds
    buffer_load_dwordx4 v236, s[12:15], s20 offen offset:1024 nt lds
    v_mfma_f32_32x32x16_bf16 a[96:111], v[144:147], v[200:203], a[96:111]
    ds_read_b64_tr_b16 v[144:145], v233 offset:0
    ds_read_b64_tr_b16 v[146:147], v233 offset:2048
    v_exp_f32 v208, v160
    v_exp_f32 v209, v161
    v_mfma_f32_32x32x16_bf16 a[112:127], v[152:155], v[200:203], a[112:127]
    ds_read_b64_tr_b16 v[152:153], v234 offset:0
    ds_read_b64_tr_b16 v[154:155], v234 offset:2048
    v_exp_f32 v210, v162
    v_mfma_f32_32x32x16_bf16 a[64:79], v[132:135], v[204:207], a[64:79]
    ds_read_b64_tr_b16 v[132:133], v231 offset:4096
    ds_read_b64_tr_b16 v[134:135], v231 offset:6144
    v_exp_f32 v211, v163
    v_add_f32 v222, v208, v209
    v_cvt_pk_bf16_f32 v192, v208, v209
    v_mfma_f32_32x32x16_bf16 a[80:95], v[140:143], v[204:207], a[80:95]
    ds_read_b64_tr_b16 v[140:141], v232 offset:4096
    ds_read_b64_tr_b16 v[142:143], v232 offset:6144
    v_exp_f32 v212, v164
    v_add_f32 v222, v222, v210
    v_mfma_f32_32x32x16_bf16 a[96:111], v[148:151], v[204:207], a[96:111]
    ds_read_b64_tr_b16 v[148:149], v233 offset:4096
    ds_read_b64_tr_b16 v[150:151], v233 offset:6144
    v_exp_f32 v213, v165
    v_add_f32 v222, v222, v211
    v_mfma_f32_32x32x16_bf16 a[112:127], v[156:159], v[204:207], a[112:127]
    ds_read_b64_tr_b16 v[156:157], v234 offset:4096
    ds_read_b64_tr_b16 v[158:159], v234 offset:6144
    v_cvt_pk_bf16_f32 v193, v210, v211
    v_exp_f32 v214, v166
    v_mfma_f32_32x32x16_bf16 v[176:191], v[96:99], a[192:195], v[48:63]
    v_add_f32 v222, v222, v212
    v_exp_f32 v215, v167
    v_add_f32 v222, v222, v213
    v_cvt_pk_bf16_f32 v194, v212, v213
    v_mfma_f32_32x32x16_bf16 v[176:191], v[100:103], a[196:199], v[176:191]
    v_exp_f32 v208, v168
    v_add_f32 v222, v222, v214
    v_exp_f32 v209, v169
    v_add_f32 v222, v222, v215
    v_mfma_f32_32x32x16_bf16 v[176:191], v[104:107], a[200:203], v[176:191]
    v_cvt_pk_bf16_f32 v195, v214, v215
    v_exp_f32 v210, v170
    v_add_f32 v222, v222, v208
    v_mfma_f32_32x32x16_bf16 v[176:191], v[108:111], a[204:207], v[176:191]
    v_exp_f32 v211, v171
    v_add_f32 v222, v222, v209
    v_cvt_pk_bf16_f32 v196, v208, v209
    v_exp_f32 v212, v172
    v_mfma_f32_32x32x16_bf16 v[176:191], v[112:115], a[208:211], v[176:191]
    v_add_f32 v222, v222, v210
    v_exp_f32 v213, v173
    v_add_f32 v222, v222, v211
    v_exp_f32 v214, v174
    v_mfma_f32_32x32x16_bf16 v[176:191], v[116:119], a[212:215], v[176:191]
    v_add_f32 v222, v222, v212
    v_exp_f32 v215, v175
    v_add_f32 v222, v222, v213
    v_add_f32 v222, v222, v214
    v_mfma_f32_32x32x16_bf16 v[176:191], v[120:123], a[216:219], v[176:191]
    v_add_f32 v222, v222, v215
    v_subrev_u32 v253, s29, v222
    v_cmp_lt_u32 vcc, s22, v253
    v_cvt_pk_bf16_f32 v197, v210, v211
    v_cvt_pk_bf16_f32 v198, v212, v213
    v_mfma_f32_32x32x16_bf16 v[176:191], v[124:127], a[220:223], v[176:191]
    v_cvt_pk_bf16_f32 v199, v214, v215
    s_cbranch_vccnz L_stub0
L_ret0:
    v_add_f32 v219, v219, v222
    s_waitcnt lgkmcnt(0)
    v_mfma_f32_32x32x16_bf16 a[0:15], v[128:131], v[192:195], a[0:15]
    buffer_load_dwordx4 v237, s[12:15], s20 offen offset:2048 nt lds
    buffer_load_dwordx4 v238, s[12:15], s20 offen offset:3072 nt lds
    v_mfma_f32_32x32x16_bf16 a[16:31], v[136:139], v[192:195], a[16:31]
    s_add_u32 m0, s34, 16384
    s_nop 0
    buffer_load_dwordx4 v239, s[16:19], s21 offen offset:0 nt lds
    buffer_load_dwordx4 v239, s[16:19], s21 offen offset:1024 nt lds
    v_mfma_f32_32x32x16_bf16 a[32:47], v[144:147], v[192:195], a[32:47]
    v_exp_f32 v208, v176
    v_exp_f32 v209, v177
    v_exp_f32 v210, v178
    v_mfma_f32_32x32x16_bf16 a[48:63], v[152:155], v[192:195], a[48:63]
    v_exp_f32 v211, v179
    v_add_f32 v222, v208, v209
    v_cvt_pk_bf16_f32 v200, v208, v209
    v_mfma_f32_32x32x16_bf16 a[0:15], v[132:135], v[196:199], a[0:15]
    v_exp_f32 v212, v180
    v_add_f32 v222, v222, v210
    v_exp_f32 v213, v181
    v_add_f32 v222, v222, v211
    v_mfma_f32_32x32x16_bf16 a[16:31], v[140:143], v[196:199], a[16:31]
    v_cvt_pk_bf16_f32 v201, v210, v211
    v_exp_f32 v214, v182
    v_add_f32 v222, v222, v212
    v_mfma_f32_32x32x16_bf16 a[32:47], v[148:151], v[196:199], a[32:47]
    v_exp_f32 v215, v183
    v_add_f32 v222, v222, v213
    v_cvt_pk_bf16_f32 v202, v212, v213
    v_exp_f32 v208, v184
    v_mfma_f32_32x32x16_bf16 a[48:63], v[156:159], v[196:199], a[48:63]
    v_add_f32 v222, v222, v214
    v_exp_f32 v209, v185
    v_add_f32 v222, v222, v215
    v_cvt_pk_bf16_f32 v203, v214, v215
    v_mfma_f32_32x32x16_bf16 v[160:175], v[96:99], a[224:227], v[64:79]
    ds_read_b128 v[96:99], v223 offset:8192
    v_exp_f32 v210, v186
    v_add_f32 v222, v222, v208
    v_mfma_f32_32x32x16_bf16 v[160:175], v[100:103], a[228:231], v[160:175]
    ds_read_b128 v[100:103], v224 offset:8192
    v_exp_f32 v211, v187
    v_add_f32 v222, v222, v209
    v_cvt_pk_bf16_f32 v204, v208, v209
    v_mfma_f32_32x32x16_bf16 v[160:175], v[104:107], a[232:235], v[160:175]
    ds_read_b128 v[104:107], v225 offset:8192
    v_exp_f32 v212, v188
    v_add_f32 v222, v222, v210
    v_exp_f32 v213, v189
    v_mfma_f32_32x32x16_bf16 v[160:175], v[108:111], a[236:239], v[160:175]
    ds_read_b128 v[108:111], v226 offset:8192
    v_add_f32 v222, v222, v211
    v_exp_f32 v214, v190
    v_mfma_f32_32x32x16_bf16 v[160:175], v[112:115], a[240:243], v[160:175]
    ds_read_b128 v[112:115], v227 offset:8192
    v_add_f32 v222, v222, v212
    v_exp_f32 v215, v191
    v_add_f32 v222, v222, v213
    v_mfma_f32_32x32x16_bf16 v[160:175], v[116:119], a[244:247], v[160:175]
    ds_read_b128 v[116:119], v228 offset:8192
    v_add_f32 v222, v222, v214
    v_add_f32 v222, v222, v215
    v_subrev_u32 v253, s29, v222
    v_cmp_lt_u32 vcc, s22, v253
    v_mfma_f32_32x32x16_bf16 v[160:175], v[120:123], a[248:251], v[160:175]
    ds_read_b128 v[120:123], v229 offset:8192
    v_cvt_pk_bf16_f32 v205, v210, v211
    v_cvt_pk_bf16_f32 v206, v212, v213
    v_cvt_pk_bf16_f32 v207, v214, v215
    v_mfma_f32_32x32x16_bf16 v[160:175], v[124:127], a[252:255], v[160:175]
    ds_read_b128 v[124:127], v230 offset:8192
    s_cbranch_vccnz L_stub1
L_ret1:
    v_add_f32 v220, v220, v222
    v_mfma_f32_32x32x16_bf16 a[64:79], v[128:131], v[200:203], a[64:79]
    buffer_load_dwordx4 v239, s[16:19], s21 offen offset:2048 nt lds
    buffer_load_dwordx4 v239, s[16:19], s21 offen offset:3072 nt lds
    v_mfma_f32_32x32x16_bf16 a[80:95], v[136:139], v[200:203], a[80:95]
    s_add_u32 s34, s34, 32768
    s_cmp_ge_u32 s34, s40
    s_cselect_b32 s60, s41, 0
    s_sub_u32 s34, s34, s60
    v_mfma_f32_32x32x16_bf16 a[96:111], v[144:147], v[200:203], a[96:111]
    v_exp_f32 v208, v160
    v_exp_f32 v209, v161
    v_mfma_f32_32x32x16_bf16 a[112:127], v[152:155], v[200:203], a[112:127]
    v_exp_f32 v210, v162
    v_exp_f32 v211, v163
    v_add_f32 v222, v208, v209
    v_mfma_f32_32x32x16_bf16 a[64:79], v[132:135], v[204:207], a[64:79]
    v_cvt_pk_bf16_f32 v192, v208, v209
    v_exp_f32 v212, v164
    v_add_f32 v222, v222, v210
    v_mfma_f32_32x32x16_bf16 a[80:95], v[140:143], v[204:207], a[80:95]
    v_exp_f32 v213, v165
    v_add_f32 v222, v222, v211
    v_cvt_pk_bf16_f32 v193, v210, v211
    v_mfma_f32_32x32x16_bf16 a[96:111], v[148:151], v[204:207], a[96:111]
    v_exp_f32 v214, v166
    v_add_f32 v222, v222, v212
    v_exp_f32 v215, v167
    v_mfma_f32_32x32x16_bf16 a[112:127], v[156:159], v[204:207], a[112:127]
    v_add_f32 v222, v222, v213
    v_cvt_pk_bf16_f32 v194, v212, v213
    v_exp_f32 v208, v168
    s_waitcnt lgkmcnt(0)
    v_mfma_f32_32x32x16_bf16 v[176:191], v[96:99], v[0:3], v[32:47]
    v_add_f32 v222, v222, v214
    v_exp_f32 v209, v169
    v_add_f32 v222, v222, v215
    v_mfma_f32_32x32x16_bf16 v[176:191], v[100:103], v[4:7], v[176:191]
    v_cvt_pk_bf16_f32 v195, v214, v215
    v_exp_f32 v210, v170
    v_add_f32 v222, v222, v208
    v_mfma_f32_32x32x16_bf16 v[176:191], v[104:107], v[8:11], v[176:191]
    v_exp_f32 v211, v171
    v_add_f32 v222, v222, v209
    v_cvt_pk_bf16_f32 v196, v208, v209
    v_mfma_f32_32x32x16_bf16 v[176:191], v[108:111], v[12:15], v[176:191]
    v_exp_f32 v212, v172
    v_add_f32 v222, v222, v210
    v_exp_f32 v213, v173
    v_mfma_f32_32x32x16_bf16 v[176:191], v[112:115], v[16:19], v[176:191]
    v_add_f32 v222, v222, v211
    v_exp_f32 v214, v174
    v_add_f32 v222, v222, v212
    v_mfma_f32_32x32x16_bf16 v[176:191], v[116:119], v[20:23], v[176:191]
    v_exp_f32 v215, v175
    v_add_f32 v222, v222, v213
    v_add_f32 v222, v222, v214
    v_add_f32 v222, v222, v215
    v_mfma_f32_32x32x16_bf16 v[176:191], v[120:123], v[24:27], v[176:191]
    v_subrev_u32 v253, s29, v222
    v_cmp_lt_u32 vcc, s22, v253
    v_cvt_pk_bf16_f32 v197, v210, v211
    v_cvt_pk_bf16_f32 v198, v212, v213
    v_mfma_f32_32x32x16_bf16 v[176:191], v[124:127], v[28:31], v[176:191]
    v_cvt_pk_bf16_f32 v199, v214, v215
    s_cbranch_vccnz L_stub2
L_ret2:
    v_add_f32 v221, v221, v222
    v_mfma_f32_32x32x16_bf16 a[128:143], v[128:131], v[192:195], a[128:143]
    ds_read_b64_tr_b16 v[128:129], v231 offset:8192
    ds_read_b64_tr_b16 v[130:131], v231 offset:10240
    s_add_u32 s20, s20, 16384
    s_add_u32 s21, s21, 16384
    s_bitcmp1_b32 s58, s32
    s_cbranch_scc1 L_sp16
L_spr17:
    v_mfma_f32_32x32x16_bf16 a[144:159], v[136:139], v[192:195], a[144:159]
    ds_read_b64_tr_b16 v[136:137], v232 offset:8192
    ds_read_b64_tr_b16 v[138:139], v232 offset:10240
    v_mfma_f32_32x32x16_bf16 a[160:175], v[144:147], v[192:195], a[160:175]
    ds_read_b64_tr_b16 v[144:145], v233 offset:8192
    ds_read_b64_tr_b16 v[146:147], v233 offset:10240
    v_exp_f32 v208, v176
    v_exp_f32 v209, v177
    v_mfma_f32_32x32x16_bf16 a[176:191], v[152:155], v[192:195], a[176:191]
    ds_read_b64_tr_b16 v[152:153], v234 offset:8192
    ds_read_b64_tr_b16 v[154:155], v234 offset:10240
    v_exp_f32 v210, v178
    v_exp_f32 v211, v179
    v_add_f32 v222, v208, v209
    v_mfma_f32_32x32x16_bf16 a[128:143], v[132:135], v[196:199], a[128:143]
    ds_read_b64_tr_b16 v[132:133], v231 offset:12288
    ds_read_b64_tr_b16 v[134:135], v231 offset:14336
    v_cvt_pk_bf16_f32 v200, v208, v209
    v_exp_f32 v212, v180
    v_add_f32 v222, v222, v210
    v_mfma_f32_32x32x16_bf16 a[144:159], v[140:143], v[196:199], a[144:159]
    ds_read_b64_tr_b16 v[140:141], v232 offset:12288
    ds_read_b64_tr_b16 v[142:143], v232 offset:14336
    v_exp_f32 v213, v181
    v_add_f32 v222, v222, v211
    v_cvt_pk_bf16_f32 v201, v210, v211
    v_mfma_f32_32x32x16_bf16 a[160:175], v[148:151], v[196:199], a[160:175]
    ds_read_b64_tr_b16 v[148:149], v233 offset:12288
    ds_read_b64_tr_b16 v[150:151], v233 offset:14336
    v_exp_f32 v214, v182
    v_add_f32 v222, v222, v212
    v_exp_f32 v215, v183
    v_mfma_f32_32x32x16_bf16 a[176:191], v[156:159], v[196:199], a[176:191]
    ds_read_b64_tr_b16 v[156:157], v234 offset:12288
    ds_read_b64_tr_b16 v[158:159], v234 offset:14336
    v_add_f32 v222, v222, v213
    v_cvt_pk_bf16_f32 v202, v212, v213
    v_exp_f32 v208, v184
    v_mfma_f32_32x32x16_bf16 v[160:175], v[96:99], a[192:195], v[48:63]
    s_add_u32 s35, s35, 32768
    s_cmp_ge_u32 s35, s40
    s_cselect_b32 s46, s41, 0
    s_sub_u32 s35, s35, s46
    v_add_f32 v222, v222, v214
    v_exp_f32 v209, v185
    v_mfma_f32_32x32x16_bf16 v[160:175], v[100:103], a[196:199], v[160:175]
    s_sub_u32 s36, s35, s51
    s_mov_b32 s51, s35
    s_mov_b32 s52, s35
    s_add_u32 s32, s32, 1
    v_add_f32 v222, v222, v215
    v_cvt_pk_bf16_f32 v203, v214, v215
    v_mfma_f32_32x32x16_bf16 v[160:175], v[104:107], a[200:203], v[160:175]
    v_add_u32 v223, s36, v223
    v_add_u32 v224, s36, v224
    v_exp_f32 v210, v186
    v_add_f32 v222, v222, v208
    v_exp_f32 v211, v187
    v_mfma_f32_32x32x16_bf16 v[160:175], v[108:111], a[204:207], v[160:175]
    v_add_u32 v225, s36, v225
    v_add_f32 v222, v222, v209
    v_cvt_pk_bf16_f32 v204, v208, v209
    v_exp_f32 v212, v188
    v_mfma_f32_32x32x16_bf16 v[160:175], v[112:115], a[208:211], v[160:175]
    v_add_u32 v226, s36, v226
    v_add_f32 v222, v222, v210
    v_exp_f32 v213, v189
    v_add_f32 v222, v222, v211
    v_exp_f32 v214, v190
    v_mfma_f32_32x32x16_bf16 v[160:175], v[116:119], a[212:215], v[160:175]
    v_add_u32 v227, s36, v227
    v_add_u32 v228, s36, v228
    v_add_f32 v222, v222, v212
    v_exp_f32 v215, v191
    v_add_f32 v222, v222, v213
    v_mfma_f32_32x32x16_bf16 v[160:175], v[120:123], a[216:219], v[160:175]
    v_add_u32 v229, s36, v229
    v_add_f32 v222, v222, v214
    v_add_f32 v222, v222, v215
    v_subrev_u32 v253, s29, v222
    v_cmp_lt_u32 vcc, s22, v253
    v_cvt_pk_bf16_f32 v205, v210, v211
    v_mfma_f32_32x32x16_bf16 v[160:175], v[124:127], a[220:223], v[160:175]
    v_add_u32 v230, s36, v230
    v_cvt_pk_bf16_f32 v206, v212, v213
    v_cvt_pk_bf16_f32 v207, v214, v215
    s_cbranch_vccnz L_stub3
L_ret3:
    v_add_f32 v219, v219, v222
    s_waitcnt lgkmcnt(0)
    v_mfma_f32_32x32x16_bf16 a[0:15], v[128:131], v[200:203], a[0:15]
    s_waitcnt lgkmcnt(0)
    s_bitcmp1_b32 s59, s32
    s_cbranch_scc1 L_bw1
    s_waitcnt vmcnt(24)
L_bwr2:
    s_barrier
    v_mfma_f32_32x32x16_bf16 a[16:31], v[136:139], v[200:203], a[16:31]
    ds_read_b128 v[96:99], v223 offset:0
    ds_read_b128 v[100:103], v224 offset:0
    ds_read_b128 v[104:107], v225 offset:0
    v_mfma_f32_32x32x16_bf16 a[32:47], v[144:147], v[200:203], a[32:47]
    ds_read_b128 v[108:111], v226 offset:0
    ds_read_b128 v[112:115], v227 offset:0
    ds_read_b128 v[116:119], v228 offset:0
    v_exp_f32 v208, v160
    v_mfma_f32_32x32x16_bf16 a[48:63], v[152:155], v[200:203], a[48:63]
    ds_read_b128 v[120:123], v229 offset:0
    ds_read_b128 v[124:127], v230 offset:0
    v_exp_f32 v209, v161
    v_mfma_f32_32x32x16_bf16 a[0:15], v[132:135], v[204:207], a[0:15]
    s_bitcmp1_b32 s23, s32
    s_cbranch_scc1 L_ex10
L_exr11:
    v_exp_f32 v210, v162
    v_mfma_f32_32x32x16_bf16 a[16:31], v[140:143], v[204:207], a[16:31]
    v_exp_f32 v211, v163
    v_add_f32 v222, v208, v209
    v_cvt_pk_bf16_f32 v192, v208, v209
    v_exp_f32 v212, v164
    v_mfma_f32_32x32x16_bf16 a[32:47], v[148:151], v[204:207], a[32:47]
    v_add_f32 v222, v222, v210
    v_exp_f32 v213, v165
    v_add_f32 v222, v222, v211
    v_cvt_pk_bf16_f32 v193, v210, v211
    v_mfma_f32_32x32x16_bf16 a[48:63], v[156:159], v[204:207], a[48:63]
    v_exp_f32 v214, v166
    v_add_f32 v222, v222, v212
    v_exp_f32 v215, v167
    s_waitcnt lgkmcnt(0)
    v_mfma_f32_32x32x16_bf16 v[176:191], v[96:99], v[0:3], v[32:47]
    v_add_f32 v222, v222, v213
    v_cvt_pk_bf16_f32 v194, v212, v213
    v_exp_f32 v208, v168
    v_add_f32 v222, v222, v214
    v_mfma_f32_32x32x16_bf16 v[176:191], v[100:103], v[4:7], v[176:191]
    v_exp_f32 v209, v169
    v_add_f32 v222, v222, v215
    v_cvt_pk_bf16_f32 v195, v214, v215
    v_exp_f32 v210, v170
    v_mfma_f32_32x32x16_bf16 v[176:191], v[104:107], v[8:11], v[176:191]
    v_add_f32 v222, v222, v208
    v_exp_f32 v211, v171
    v_add_f32 v222, v222, v209
    v_cvt_pk_bf16_f32 v196, v208, v209
    v_mfma_f32_32x32x16_bf16 v[176:191], v[108:111], v[12:15], v[176:191]
    s_mov_b32 m0, s34
    s_nop 0
    buffer_load_dwordx4 v235, s[12:15], s20 offen offset:0 nt lds
    buffer_load_dwordx4 v236, s[12:15], s20 offen offset:1024 nt lds
    v_mfma_f32_32x32x16_bf16 v[176:191], v[112:115], v[16:19], v[176:191]
    v_exp_f32 v212, v172
    v_add_f32 v222, v222, v210
    v_exp_f32 v213, v173
    v_add_f32 v222, v222, v211
    v_mfma_f32_32x32x16_bf16 v[176:191], v[116:119], v[20:23], v[176:191]
    v_exp_f32 v214, v174
    v_add_f32 v222, v222, v212
    v_exp_f32 v215, v175
    v_add_f32 v222, v222, v213
    v_mfma_f32_32x32x16_bf16 v[176:191], v[120:123], v[24:27], v[176:191]
    v_add_f32 v222, v222, v214
    v_add_f32 v222, v222, v215
    v_subrev_u32 v253, s29, v222
    v_cmp_lt_u32 vcc, s22, v253
    v_cvt_pk_bf16_f32 v197, v210, v211
    v_mfma_f32_32x32x16_bf16 v[176:191], v[124:127], v[28:31], v[176:191]
    v_cvt_pk_bf16_f32 v198, v212, v213
    v_cvt_pk_bf16_f32 v199, v214, v215
    s_cbranch_vccnz L_stub4
L_ret4:
    v_add_f32 v220, v220, v222
    v_add_u32 v231, s36, v231
    v_add_u32 v232, s36, v232
    v_add_u32 v233, s36, v233
    v_add_u32 v234, s36, v234
    v_mfma_f32_32x32x16_bf16 a[64:79], v[128:131], v[192:195], a[64:79]
    ds_read_b64_tr_b16 v[128:129], v231 offset:0
    ds_read_b64_tr_b16 v[130:131], v231 offset:2048
    v_mfma_f32_32x32x16_bf16 a[80:95], v[136:139], v[192:195], a[80:95]
    ds_read_b64_tr_b16 v[136:137], v232 offset:0
    ds_read_b64_tr_b16 v[138:139], v232 offset:2048
    buffer_load_dwordx4 v237, s[12:15], s20 offen offset:2048 nt lds
    buffer_load_dwordx4 v238, s[12:15], s20 offen offset:3072 nt lds
    v_mfma_f32_32x32x16_bf16 a[96:111], v[144:147], v[192:195], a[96:111]
    ds_read_b64_tr_b16 v[144:145], v233 offset:0
    ds_read_b64_tr_b16 v[146:147], v233 offset:2048
    v_exp_f32 v208, v176
    v_exp_f32 v209, v177
    v_mfma_f32_32x32x16_bf16 a[112:127], v[152:155], v[192:195], a[112:127]
    ds_read_b64_tr_b16 v[152:153], v234 offset:0
    ds_read_b64_tr_b16 v[154:155], v234 offset:2048
    v_exp_f32 v210, v178
    v_mfma_f32_32x32x16_bf16 a[64:79], v[132:135], v[196:199], a[64:79]
    ds_read_b64_tr_b16 v[132:133], v231 offset:4096
    ds_read_b64_tr_b16 v[134:135], v231 offset:6144
    v_exp_f32 v211, v179
    v_add_f32 v222, v208, v209
    v_cvt_pk_bf16_f32 v200, v208, v209
    v_mfma_f32_32x32x16_bf16 a[80:95], v[140:143], v[196:199], a[80:95]
    ds_read_b64_tr_b16 v[140:141], v232 offset:4096
    ds_read_b64_tr_b16 v[142:143], v232 offset:6144
    v_exp_f32 v212, v180
    v_add_f32 v222, v222, v210
    v_mfma_f32_32x32x16_bf16 a[96:111], v[148:151], v[196:199], a[96:111]
    ds_read_b64_tr_b16 v[148:149], v233 offset:4096
    ds_read_b64_tr_b16 v[150:151], v233 offset:6144
    v_exp_f32 v213, v181
    v_add_f32 v222, v222, v211
    v_mfma_f32_32x32x16_bf16 a[112:127], v[156:159], v[196:199], a[112:127]
    ds_read_b64_tr_b16 v[156:157], v234 offset:4096
    ds_read_b64_tr_b16 v[158:159], v234 offset:6144
    v_cvt_pk_bf16_f32 v201, v210, v211
    v_exp_f32 v214, v182
    v_mfma_f32_32x32x16_bf16 v[160:175], v[96:99], a[192:195], v[48:63]
    v_add_f32 v222, v222, v212
    v_exp_f32 v215, v183
    v_add_f32 v222, v222, v213
    v_cvt_pk_bf16_f32 v202, v212, v213
    v_mfma_f32_32x32x16_bf16 v[160:175], v[100:103], a[196:199], v[160:175]
    v_exp_f32 v208, v184
    v_add_f32 v222, v222, v214
    v_exp_f32 v209, v185
    v_add_f32 v222, v222, v215
    v_mfma_f32_32x32x16_bf16 v[160:175], v[104:107], a[200:203], v[160:175]
    v_cvt_pk_bf16_f32 v203, v214, v215
    v_exp_f32 v210, v186
    v_add_f32 v222, v222, v208
    v_mfma_f32_32x32x16_bf16 v[160:175], v[108:111], a[204:207], v[160:175]
    v_exp_f32 v211, v187
    v_add_f32 v222, v222, v209
    v_cvt_pk_bf16_f32 v204, v208, v209
    v_exp_f32 v212, v188
    v_mfma_f32_32x32x16_bf16 v[160:175], v[112:115], a[208:211], v[160:175]
    v_add_f32 v222, v222, v210
    v_exp_f32 v213, v189
    v_add_f32 v222, v222, v211
    v_exp_f32 v214, v190
    v_mfma_f32_32x32x16_bf16 v[160:175], v[116:119], a[212:215], v[160:175]
    v_add_f32 v222, v222, v212
    v_exp_f32 v215, v191
    v_add_f32 v222, v222, v213
    v_add_f32 v222, v222, v214
    v_mfma_f32_32x32x16_bf16 v[160:175], v[120:123], a[216:219], v[160:175]
    v_add_f32 v222, v222, v215
    v_subrev_u32 v253, s29, v222
    v_cmp_lt_u32 vcc, s22, v253
    v_cvt_pk_bf16_f32 v205, v210, v211
    v_cvt_pk_bf16_f32 v206, v212, v213
    v_mfma_f32_32x32x16_bf16 v[160:175], v[124:127], a[220:223], v[160:175]
    v_cvt_pk_bf16_f32 v207, v214, v215
    s_cbranch_vccnz L_stub5
L_ret5:
    v_add_f32 v219, v219, v222
    s_waitcnt lgkmcnt(0)
    v_mfma_f32_32x32x16_bf16 a[0:15], v[128:131], v[200:203], a[0:15]
    s_add_u32 m0, s34, 16384
    s_nop 0
    buffer_load_dwordx4 v239, s[16:19], s21 offen offset:0 nt lds
    buffer_load_dwordx4 v239, s[16:19], s21 offen offset:1024 nt lds
    v_mfma_f32_32x32x16_bf16 a[16:31], v[136:139], v[200:203], a[16:31]
    v_mfma_f32_32x32x16_bf16 a[32:47], v[144:147], v[200:203], a[32:47]
    s_nop 0
    v_exp_f32 v208, v160
    v_exp_f32 v209, v161
    v_exp_f32 v210, v162
    v_mfma_f32_32x32x16_bf16 a[48:63], v[152:155], v[200:203], a[48:63]
    v_exp_f32 v211, v163
    v_add_f32 v222, v208, v209
    v_cvt_pk_bf16_f32 v192, v208, v209
    v_mfma_f32_32x32x16_bf16 a[0:15], v[132:135], v[204:207], a[0:15]
    v_exp_f32 v212, v164
    v_add_f32 v222, v222, v210
    v_exp_f32 v213, v165
    v_add_f32 v222, v222, v211
    v_mfma_f32_32x32x16_bf16 a[16:31], v[140:143], v[204:207], a[16:31]
    v_cvt_pk_bf16_f32 v193, v210, v211
    v_exp_f32 v214, v166
    v_add_f32 v222, v222, v212
    v_exp_f32 v215, v167
    v_mfma_f32_32x32x16_bf16 a[32:47], v[148:151], v[204:207], a[32:47]
    v_add_f32 v222, v222, v213
    v_cvt_pk_bf16_f32 v194, v212, v213
    v_exp_f32 v208, v168
    v_add_f32 v222, v222, v214
    v_mfma_f32_32x32x16_bf16 a[48:63], v[156:159], v[204:207], a[48:63]
    v_exp_f32 v209, v169
    v_add_f32 v222, v222, v215
    v_cvt_pk_bf16_f32 v195, v214, v215
    v_exp_f32 v210, v170
    v_mfma_f32_32x32x16_bf16 v[176:191], v[96:99], a[224:227], v[64:79]
    ds_read_b128 v[96:99], v223 offset:8192
    v_add_f32 v222, v222, v208
    v_exp_f32 v211, v171
    v_add_f32 v222, v222, v209
    v_mfma_f32_32x32x16_bf16 v[176:191], v[100:103], a[228:231], v[176:191]
    ds_read_b128 v[100:103], v224 offset:8192
    v_cvt_pk_bf16_f32 v196, v208, v209
    v_exp_f32 v212, v172
    v_add_f32 v222, v222, v210
    v_mfma_f32_32x32x16_bf16 v[176:191], v[104:107], a[232:235], v[176:191]
    ds_read_b128 v[104:107], v225 offset:8192
    v_exp_f32 v213, v173
    v_add_f32 v222, v222, v211
    v_mfma_f32_32x32x16_bf16 v[176:191], v[108:111], a[236:239], v[176:191]
    ds_read_b128 v[108:111], v226 offset:8192
    buffer_load_dwordx4 v239, s[16:19], s21 offen offset:2048 nt lds
    buffer_load_dwordx4 v239, s[16:19], s21 offen offset:3072 nt lds
    v_mfma_f32_32x32x16_bf16 v[176:191], v[112:115], a[240:243], v[176:191]
    ds_read_b128 v[112:115], v227 offset:8192
    v_exp_f32 v214, v174
    v_add_f32 v222, v222, v212
    v_exp_f32 v215, v175
    v_mfma_f32_32x32x16_bf16 v[176:191], v[116:119], a[244:247], v[176:191]
    ds_read_b128 v[116:119], v228 offset:8192
    v_add_f32 v222, v222, v213
    v_add_f32 v222, v222, v214
    v_add_f32 v222, v222, v215
    v_subrev_u32 v253, s29, v222
    v_mfma_f32_32x32x16_bf16 v[176:191], v[120:123], a[248:251], v[176:191]
    ds_read_b128 v[120:123], v229 offset:8192
    v_cmp_lt_u32 vcc, s22, v253
    v_cvt_pk_bf16_f32 v197, v210, v211
    v_cvt_pk_bf16_f32 v198, v212, v213
    v_cvt_pk_bf16_f32 v199, v214, v215
    v_mfma_f32_32x32x16_bf16 v[176:191], v[124:127], a[252:255], v[176:191]
    ds_read_b128 v[124:127], v230 offset:8192
    s_cbranch_vccnz L_stub6
L_ret6:
    v_add_f32 v220, v220, v222
    v_mfma_f32_32x32x16_bf16 a[64:79], v[128:131], v[192:195], a[64:79]
    v_mfma_f32_32x32x16_bf16 a[80:95], v[136:139], v[192:195], a[80:95]
    s_add_u32 s34, s34, 32768
    s_cmp_ge_u32 s34, s40
    s_cselect_b32 s60, s41, 0
    s_sub_u32 s34, s34, s60
    v_mfma_f32_32x32x16_bf16 a[96:111], v[144:147], v[192:195], a[96:111]
    s_nop 1
    v_exp_f32 v208, v176
    v_exp_f32 v209, v177
    v_mfma_f32_32x32x16_bf16 a[112:127], v[152:155], v[192:195], a[112:127]
    v_exp_f32 v210, v178
    v_exp_f32 v211, v179
    v_add_f32 v222, v208, v209
    v_mfma_f32_32x32x16_bf16 a[64:79], v[132:135], v[196:199], a[64:79]
    v_cvt_pk_bf16_f32 v200, v208, v209
    v_exp_f32 v212, v180
    v_add_f32 v222, v222, v210
    v_mfma_f32_32x32x16_bf16 a[80:95], v[140:143], v[196:199], a[80:95]
    v_exp_f32 v213, v181
    v_add_f32 v222, v222, v211
    v_cvt_pk_bf16_f32 v201, v210, v211
    v_mfma_f32_32x32x16_bf16 a[96:111], v[148:151], v[196:199], a[96:111]
    v_exp_f32 v214, v182
    v_add_f32 v222, v222, v212
    v_exp_f32 v215, v183
    v_mfma_f32_32x32x16_bf16 a[112:127], v[156:159], v[196:199], a[112:127]
    v_add_f32 v222, v222, v213
    v_cvt_pk_bf16_f32 v202, v212, v213
    v_exp_f32 v208, v184
    s_waitcnt lgkmcnt(0)
    v_mfma_f32_32x32x16_bf16 v[160:175], v[96:99], v[0:3], v[32:47]
    v_add_f32 v222, v222, v214
    v_exp_f32 v209, v185
    v_add_f32 v222, v222, v215
    v_mfma_f32_32x32x16_bf16 v[160:175], v[100:103], v[4:7], v[160:175]
    v_cvt_pk_bf16_f32 v203, v214, v215
    v_exp_f32 v210, v186
    v_add_f32 v222, v222, v208
    v_mfma_f32_32x32x16_bf16 v[160:175], v[104:107], v[8:11], v[160:175]
    v_exp_f32 v211, v187
    v_add_f32 v222, v222, v209
    v_cvt_pk_bf16_f32 v204, v208, v209
    v_mfma_f32_32x32x16_bf16 v[160:175], v[108:111], v[12:15], v[160:175]
    v_exp_f32 v212, v188
    v_add_f32 v222, v222, v210
    v_exp_f32 v213, v189
    v_mfma_f32_32x32x16_bf16 v[160:175], v[112:115], v[16:19], v[160:175]
    v_add_f32 v222, v222, v211
    v_exp_f32 v214, v190
    v_add_f32 v222, v222, v212
    v_mfma_f32_32x32x16_bf16 v[160:175], v[116:119], v[20:23], v[160:175]
    v_exp_f32 v215, v191
    v_add_f32 v222, v222, v213
    v_add_f32 v222, v222, v214
    v_add_f32 v222, v222, v215
    v_mfma_f32_32x32x16_bf16 v[160:175], v[120:123], v[24:27], v[160:175]
    v_subrev_u32 v253, s29, v222
    v_cmp_lt_u32 vcc, s22, v253
    v_cvt_pk_bf16_f32 v205, v210, v211
    v_cvt_pk_bf16_f32 v206, v212, v213
    v_mfma_f32_32x32x16_bf16 v[160:175], v[124:127], v[28:31], v[160:175]
    v_cvt_pk_bf16_f32 v207, v214, v215
    s_cbranch_vccnz L_stub7
L_ret7:
    v_add_f32 v221, v221, v222
    v_mfma_f32_32x32x16_bf16 a[128:143], v[128:131], v[200:203], a[128:143]
    ds_read_b64_tr_b16 v[128:129], v231 offset:8192
    ds_read_b64_tr_b16 v[130:131], v231 offset:10240
    s_add_u32 s20, s20, 16384
    s_add_u32 s21, s21, 16384
    s_bitcmp1_b32 s58, s32
    s_cbranch_scc1 L_sp3
L_spr4:
    v_mfma_f32_32x32x16_bf16 a[144:159], v[136:139], v[200:203], a[144:159]
    ds_read_b64_tr_b16 v[136:137], v232 offset:8192
    ds_read_b64_tr_b16 v[138:139], v232 offset:10240
    v_mfma_f32_32x32x16_bf16 a[160:175], v[144:147], v[200:203], a[160:175]
    ds_read_b64_tr_b16 v[144:145], v233 offset:8192
    ds_read_b64_tr_b16 v[146:147], v233 offset:10240
    v_exp_f32 v208, v160
    v_exp_f32 v209, v161
    v_mfma_f32_32x32x16_bf16 a[176:191], v[152:155], v[200:203], a[176:191]
    ds_read_b64_tr_b16 v[152:153], v234 offset:8192
    ds_read_b64_tr_b16 v[154:155], v234 offset:10240
    v_exp_f32 v210, v162
    v_exp_f32 v211, v163
    v_add_f32 v222, v208, v209
    v_mfma_f32_32x32x16_bf16 a[128:143], v[132:135], v[204:207], a[128:143]
    ds_read_b64_tr_b16 v[132:133], v231 offset:12288
    ds_read_b64_tr_b16 v[134:135], v231 offset:14336
    v_cvt_pk_bf16_f32 v192, v208, v209
    v_exp_f32 v212, v164
    v_add_f32 v222, v222, v210
    v_mfma_f32_32x32x16_bf16 a[144:159], v[140:143], v[204:207], a[144:159]
    ds_read_b64_tr_b16 v[140:141], v232 offset:12288
    ds_read_b64_tr_b16 v[142:143], v232 offset:14336
    v_exp_f32 v213, v165
    v_add_f32 v222, v222, v211
    v_cvt_pk_bf16_f32 v193, v210, v211
    v_mfma_f32_32x32x16_bf16 a[160:175], v[148:151], v[204:207], a[160:175]
    ds_read_b64_tr_b16 v[148:149], v233 offset:12288
    ds_read_b64_tr_b16 v[150:151], v233 offset:14336
    v_exp_f32 v214, v166
    v_add_f32 v222, v222, v212
    v_exp_f32 v215, v167
    v_mfma_f32_32x32x16_bf16 a[176:191], v[156:159], v[204:207], a[176:191]
    ds_read_b64_tr_b16 v[156:157], v234 offset:12288
    ds_read_b64_tr_b16 v[158:159], v234 offset:14336
    v_add_f32 v222, v222, v213
    v_cvt_pk_bf16_f32 v194, v212, v213
    v_exp_f32 v208, v168
    v_mfma_f32_32x32x16_bf16 v[176:191], v[96:99], a[192:195], v[48:63]
    s_add_u32 s35, s35, 32768
    s_cmp_ge_u32 s35, s40
    s_cselect_b32 s46, s41, 0
    s_sub_u32 s35, s35, s46
    v_add_f32 v222, v222, v214
    v_exp_f32 v209, v169
    v_mfma_f32_32x32x16_bf16 v[176:191], v[100:103], a[196:199], v[176:191]
    s_sub_u32 s36, s35, s51
    s_mov_b32 s51, s35
    s_mov_b32 s52, s35
    s_add_u32 s32, s32, 1
    v_add_f32 v222, v222, v215
    v_cvt_pk_bf16_f32 v195, v214, v215
    v_mfma_f32_32x32x16_bf16 v[176:191], v[104:107], a[200:203], v[176:191]
    v_add_u32 v223, s36, v223
    v_add_u32 v224, s36, v224
    v_exp_f32 v210, v170
    v_add_f32 v222, v222, v208
    v_exp_f32 v211, v171
    v_mfma_f32_32x32x16_bf16 v[176:191], v[108:111], a[204:207], v[176:191]
    v_add_u32 v225, s36, v225
    v_add_f32 v222, v222, v209
    v_cvt_pk_bf16_f32 v196, v208, v209
    v_exp_f32 v212, v172
    v_mfma_f32_32x32x16_bf16 v[176:191], v[112:115], a[208:211], v[176:191]
    v_add_u32 v226, s36, v226
    v_add_f32 v222, v222, v210
    v_exp_f32 v213, v173
    v_add_f32 v222, v222, v211
    v_exp_f32 v214, v174
    v_mfma_f32_32x32x16_bf16 v[176:191], v[116:119], a[212:215], v[176:191]
    v_add_u32 v227, s36, v227
    v_add_u32 v228, s36, v228
    v_add_f32 v222, v222, v212
    v_exp_f32 v215, v175
    v_add_f32 v222, v222, v213
    v_mfma_f32_32x32x16_bf16 v[176:191], v[120:123], a[216:219], v[176:191]
    v_add_u32 v229, s36, v229
    v_add_f32 v222, v222, v214
    v_add_f32 v222, v222, v215
    v_subrev_u32 v253, s29, v222
    v_cmp_lt_u32 vcc, s22, v253
    v_cvt_pk_bf16_f32 v197, v210, v211
    v_mfma_f32_32x32x16_bf16 v[176:191], v[124:127], a[220:223], v[176:191]
    v_add_u32 v230, s36, v230
    v_cvt_pk_bf16_f32 v198, v212, v213
    v_cvt_pk_bf16_f32 v199, v214, v215
    s_cbranch_vccnz L_stub8
L_ret8:
    v_add_f32 v219, v219, v222
    s_waitcnt lgkmcnt(0)
    v_mfma_f32_32x32x16_bf16 a[0:15], v[128:131], v[192:195], a[0:15]
    s_waitcnt lgkmcnt(0)
    s_bitcmp1_b32 s59, s32
    s_cbranch_scc1 L_bw14
    s_waitcnt vmcnt(24)
L_bwr15:
    s_barrier
    v_mfma_f32_32x32x16_bf16 a[16:31], v[136:139], v[192:195], a[16:31]
    ds_read_b128 v[96:99], v223 offset:0
    ds_read_b128 v[100:103], v224 offset:0
    ds_read_b128 v[104:107], v225 offset:0
    v_mfma_f32_32x32x16_bf16 a[32:47], v[144:147], v[192:195], a[32:47]
    ds_read_b128 v[108:111], v226 offset:0
    ds_read_b128 v[112:115], v227 offset:0
    ds_read_b128 v[116:119], v228 offset:0
    v_mfma_f32_32x32x16_bf16 a[48:63], v[152:155], v[192:195], a[48:63]
    ds_read_b128 v[120:123], v229 offset:0
    ds_read_b128 v[124:127], v230 offset:0
    v_exp_f32 v208, v176
    v_mfma_f32_32x32x16_bf16 a[0:15], v[132:135], v[196:199], a[0:15]
    v_exp_f32 v209, v177
    v_exp_f32 v210, v178
    v_exp_f32 v211, v179
    v_mfma_f32_32x32x16_bf16 a[16:31], v[140:143], v[196:199], a[16:31]
    v_add_f32 v222, v208, v209
    v_cvt_pk_bf16_f32 v200, v208, v209
    v_exp_f32 v212, v180
    v_mfma_f32_32x32x16_bf16 a[32:47], v[148:151], v[196:199], a[32:47]
    v_add_f32 v222, v222, v210
    v_exp_f32 v213, v181
    v_add_f32 v222, v222, v211
    v_cvt_pk_bf16_f32 v201, v210, v211
    v_mfma_f32_32x32x16_bf16 a[48:63], v[156:159], v[196:199], a[48:63]
    v_exp_f32 v214, v182
    v_add_f32 v222, v222, v212
    v_exp_f32 v215, v183
    s_waitcnt lgkmcnt(0)
    v_mfma_f32_32x32x16_bf16 v[160:175], v[96:99], v[0:3], v[32:47]
    v_add_f32 v222, v222, v213
    v_cvt_pk_bf16_f32 v202, v212, v213
    v_exp_f32 v208, v184
    v_add_f32 v222, v222, v214
    v_mfma_f32_32x32x16_bf16 v[160:175], v[100:103], v[4:7], v[160:175]
    v_exp_f32 v209, v185
    v_add_f32 v222, v222, v215
    v_cvt_pk_bf16_f32 v203, v214, v215
    v_mfma_f32_32x32x16_bf16 v[160:175], v[104:107], v[8:11], v[160:175]
    v_exp_f32 v210, v186
    v_add_f32 v222, v222, v208
    v_exp_f32 v211, v187
    v_add_f32 v222, v222, v209
    v_mfma_f32_32x32x16_bf16 v[160:175], v[108:111], v[12:15], v[160:175]
    v_cvt_pk_bf16_f32 v204, v208, v209
    v_exp_f32 v212, v188
    v_add_f32 v222, v222, v210
    v_mfma_f32_32x32x16_bf16 v[160:175], v[112:115], v[16:19], v[160:175]
    v_exp_f32 v213, v189
    v_add_f32 v222, v222, v211
    v_exp_f32 v214, v190
    v_mfma_f32_32x32x16_bf16 v[160:175], v[116:119], v[20:23], v[160:175]
    v_add_f32 v222, v222, v212
    v_exp_f32 v215, v191
    v_add_f32 v222, v222, v213
    v_add_f32 v222, v222, v214
    v_mfma_f32_32x32x16_bf16 v[160:175], v[120:123], v[24:27], v[160:175]
    v_add_f32 v222, v222, v215
    v_subrev_u32 v253, s29, v222
    v_cmp_lt_u32 vcc, s22, v253
    v_cvt_pk_bf16_f32 v205, v210, v211
    v_cvt_pk_bf16_f32 v206, v212, v213
    v_mfma_f32_32x32x16_bf16 v[160:175], v[124:127], v[28:31], v[160:175]
    v_cvt_pk_bf16_f32 v207, v214, v215
    s_cbranch_vccnz L_stub9
L_ret9:
    v_add_f32 v220, v220, v222
    v_add_u32 v231, s36, v231
    v_add_u32 v232, s36, v232
    v_add_u32 v233, s36, v233
    v_add_u32 v234, s36, v234
    v_mfma_f32_32x32x16_bf16 a[64:79], v[128:131], v[200:203], a[64:79]
    s_cmp_lg_u32 s32, s43
    s_cbranch_scc1 L_loop_A0
    s_cmp_lg_u32 s44, 0
    s_cbranch_scc1 L_last_A0
    v_mfma_f32_32x32x16_bf16 a[80:95], v[136:139], v[200:203], a[80:95]
    v_mfma_f32_32x32x16_bf16 a[96:111], v[144:147], v[200:203], a[96:111]
    v_mfma_f32_32x32x16_bf16 a[112:127], v[152:155], v[200:203], a[112:127]
    v_mfma_f32_32x32x16_bf16 a[64:79], v[132:135], v[204:207], a[64:79]
    v_mfma_f32_32x32x16_bf16 a[80:95], v[140:143], v[204:207], a[80:95]
    v_mfma_f32_32x32x16_bf16 a[96:111], v[148:151], v[204:207], a[96:111]
    v_mfma_f32_32x32x16_bf16 a[112:127], v[156:159], v[204:207], a[112:127]
    s_waitcnt vmcnt(8)
    s_waitcnt lgkmcnt(0)
    s_xor_b32 s54, s34, 4096
    v_mov_b32 v74, v64
    v_mov_b32 v242, v221
    v_mov_b32 v243, v221
    s_nop 1
    v_permlane32_swap_b32 v242, v243
    s_nop 1
    v_add_f32 v75, v242, v243
    v_add_u32 v246, s54, v254
    ds_write_b64 v246, v[74:75]
    v_add_u32 v72, s54, v255
    v_add_u32 v73, s34, v255
    ds_write_b128 v73, a[164:167] offset:1024
    ds_write_b128 v73, a[168:171] offset:2048
    ds_write_b128 v73, a[172:175] offset:3072
    ds_write_b128 v73, a[176:179] offset:16384
    ds_write_b128 v73, a[180:183] offset:17408
    ds_write_b128 v73, a[184:187] offset:18432
    ds_write_b128 v73, a[188:191] offset:19456
    s_add_u32 s42, s35, s55
    s_mov_b32 s62, s34
    s_mov_b32 s53, s37
    s_mov_b32 s61, 0
    v_add_u32 v251, s35, v240
    v_xor_b32 v208, 0, v241
    v_lshl_add_u32 v208, v208, 4, v251
    v_xor_b32 v209, 2, v241
    v_lshl_add_u32 v209, v209, 4, v251
    v_xor_b32 v210, 4, v241
    v_lshl_add_u32 v210, v210, 4, v251
    v_xor_b32 v211, 6, v241
    v_lshl_add_u32 v211, v211, 4, v251
    v_xor_b32 v212, 8, v241
    v_lshl_add_u32 v212, v212, 4, v251
    v_xor_b32 v213, 10, v241
    v_lshl_add_u32 v213, v213, 4, v251
    v_xor_b32 v214, 12, v241
    v_lshl_add_u32 v214, v214, 4, v251
    v_xor_b32 v215, 14, v241
    v_lshl_add_u32 v215, v215, 4, v251
    ds_read_b128 v[160:163], v208
    ds_read_b128 v[164:167], v209
    ds_read_b128 v[168:171], v210
    ds_read_b128 v[172:175], v211
    ds_read_b128 v[176:179], v212
    ds_read_b128 v[180:183], v213
    ds_read_b128 v[184:187], v214
    ds_read_b128 v[188:191], v215
    s_add_u32 s35, s35, 32768
    s_cmp_ge_u32 s35, s40
    s_cselect_b32 s46, s41, 0
    s_sub_u32 s35, s35, s46
    s_waitcnt lgkmcnt(7)
    v_lshlrev_b32 v80, 16, v160
    v_and_b32 v81, s63, v160
    v_lshlrev_b32 v82, 16, v161
    v_and_b32 v83, s63, v161
    v_lshlrev_b32 v84, 16, v162
    v_and_b32 v85, s63, v162
    v_lshlrev_b32 v86, 16, v163
    v_and_b32 v87, s63, v163
    v_pk_mul_f32 v[80:81], v[80:81], s[94:95]
    v_pk_mul_f32 v[82:83], v[82:83], s[94:95]
    v_pk_mul_f32 v[84:85], v[84:85], s[94:95]
    v_pk_mul_f32 v[86:87], v[86:87], s[94:95]
    v_cvt_pk_bf16_f32 v0, v80, v81
    v_cvt_pk_bf16_f32 v1, v82, v83
    v_cvt_pk_bf16_f32 v2, v84, v85
    v_cvt_pk_bf16_f32 v3, v86, v87
    s_waitcnt lgkmcnt(6)
    v_lshlrev_b32 v80, 16, v164
    v_and_b32 v81, s63, v164
    v_lshlrev_b32 v82, 16, v165
    v_and_b32 v83, s63, v165
    v_lshlrev_b32 v84, 16, v166
    v_and_b32 v85, s63, v166
    v_lshlrev_b32 v86, 16, v167
    v_and_b32 v87, s63, v167
    v_pk_mul_f32 v[80:81], v[80:81], s[94:95]
    v_pk_mul_f32 v[82:83], v[82:83], s[94:95]
    v_pk_mul_f32 v[84:85], v[84:85], s[94:95]
    v_pk_mul_f32 v[86:87], v[86:87], s[94:95]
    v_cvt_pk_bf16_f32 v4, v80, v81
    v_cvt_pk_bf16_f32 v5, v82, v83
    v_cvt_pk_bf16_f32 v6, v84, v85
    v_cvt_pk_bf16_f32 v7, v86, v87
    s_waitcnt lgkmcnt(5)
    v_lshlrev_b32 v80, 16, v168
    v_and_b32 v81, s63, v168
    v_lshlrev_b32 v82, 16, v169
    v_and_b32 v83, s63, v169
    v_lshlrev_b32 v84, 16, v170
    v_and_b32 v85, s63, v170
    v_lshlrev_b32 v86, 16, v171
    v_and_b32 v87, s63, v171
    v_pk_mul_f32 v[80:81], v[80:81], s[94:95]
    v_pk_mul_f32 v[82:83], v[82:83], s[94:95]
    v_pk_mul_f32 v[84:85], v[84:85], s[94:95]
    v_pk_mul_f32 v[86:87], v[86:87], s[94:95]
    v_cvt_pk_bf16_f32 v8, v80, v81
    v_cvt_pk_bf16_f32 v9, v82, v83
    v_cvt_pk_bf16_f32 v10, v84, v85
    v_cvt_pk_bf16_f32 v11, v86, v87
    s_waitcnt lgkmcnt(4)
    v_lshlrev_b32 v80, 16, v172
    v_and_b32 v81, s63, v172
    v_lshlrev_b32 v82, 16, v173
    v_and_b32 v83, s63, v173
    v_lshlrev_b32 v84, 16, v174
    v_and_b32 v85, s63, v174
    v_lshlrev_b32 v86, 16, v175
    v_and_b32 v87, s63, v175
    v_pk_mul_f32 v[80:81], v[80:81], s[94:95]
    v_pk_mul_f32 v[82:83], v[82:83], s[94:95]
    v_pk_mul_f32 v[84:85], v[84:85], s[94:95]
    v_pk_mul_f32 v[86:87], v[86:87], s[94:95]
    v_cvt_pk_bf16_f32 v12, v80, v81
    v_cvt_pk_bf16_f32 v13, v82, v83
    v_cvt_pk_bf16_f32 v14, v84, v85
    v_cvt_pk_bf16_f32 v15, v86, v87
    s_waitcnt lgkmcnt(3)
    v_lshlrev_b32 v80, 16, v176
    v_and_b32 v81, s63, v176
    v_lshlrev_b32 v82, 16, v177
    v_and_b32 v83, s63, v177
    v_lshlrev_b32 v84, 16, v178
    v_and_b32 v85, s63, v178
    v_lshlrev_b32 v86, 16, v179
    v_and_b32 v87, s63, v179
    v_pk_mul_f32 v[80:81], v[80:81], s[94:95]
    v_pk_mul_f32 v[82:83], v[82:83], s[94:95]
    v_pk_mul_f32 v[84:85], v[84:85], s[94:95]
    v_pk_mul_f32 v[86:87], v[86:87], s[94:95]
    v_cvt_pk_bf16_f32 v16, v80, v81
    v_cvt_pk_bf16_f32 v17, v82, v83
    v_cvt_pk_bf16_f32 v18, v84, v85
    v_cvt_pk_bf16_f32 v19, v86, v87
    s_waitcnt lgkmcnt(2)
    v_lshlrev_b32 v80, 16, v180
    v_and_b32 v81, s63, v180
    v_lshlrev_b32 v82, 16, v181
    v_and_b32 v83, s63, v181
    v_lshlrev_b32 v84, 16, v182
    v_and_b32 v85, s63, v182
    v_lshlrev_b32 v86, 16, v183
    v_and_b32 v87, s63, v183
    v_pk_mul_f32 v[80:81], v[80:81], s[94:95]
    v_pk_mul_f32 v[82:83], v[82:83], s[94:95]
    v_pk_mul_f32 v[84:85], v[84:85], s[94:95]
    v_pk_mul_f32 v[86:87], v[86:87], s[94:95]
    v_cvt_pk_bf16_f32 v20, v80, v81
    v_cvt_pk_bf16_f32 v21, v82, v83
    v_cvt_pk_bf16_f32 v22, v84, v85
    v_cvt_pk_bf16_f32 v23, v86, v87
    s_waitcnt lgkmcnt(1)
    v_lshlrev_b32 v80, 16, v184
    v_and_b32 v81, s63, v184
    v_lshlrev_b32 v82, 16, v185
    v_and_b32 v83, s63, v185
    v_lshlrev_b32 v84, 16, v186
    v_and_b32 v85, s63, v186
    v_lshlrev_b32 v86, 16, v187
    v_and_b32 v87, s63, v187
    v_pk_mul_f32 v[80:81], v[80:81], s[94:95]
    v_pk_mul_f32 v[82:83], v[82:83], s[94:95]
    v_pk_mul_f32 v[84:85], v[84:85], s[94:95]
    v_pk_mul_f32 v[86:87], v[86:87], s[94:95]
    v_cvt_pk_bf16_f32 v24, v80, v81
    v_cvt_pk_bf16_f32 v25, v82, v83
    v_cvt_pk_bf16_f32 v26, v84, v85
    v_cvt_pk_bf16_f32 v27, v86, v87
    s_waitcnt lgkmcnt(0)
    v_lshlrev_b32 v80, 16, v188
    v_and_b32 v81, s63, v188
    v_lshlrev_b32 v82, 16, v189
    v_and_b32 v83, s63, v189
    v_lshlrev_b32 v84, 16, v190
    v_and_b32 v85, s63, v190
    v_lshlrev_b32 v86, 16, v191
    v_and_b32 v87, s63, v191
    v_pk_mul_f32 v[80:81], v[80:81], s[94:95]
    v_pk_mul_f32 v[82:83], v[82:83], s[94:95]
    v_pk_mul_f32 v[84:85], v[84:85], s[94:95]
    v_pk_mul_f32 v[86:87], v[86:87], s[94:95]
    v_cvt_pk_bf16_f32 v28, v80, v81
    v_cvt_pk_bf16_f32 v29, v82, v83
    v_cvt_pk_bf16_f32 v30, v84, v85
    v_cvt_pk_bf16_f32 v31, v86, v87
    s_waitcnt lgkmcnt(0)
    s_barrier
    v_add_u32 v247, s34, v254
    ds_read_b64 v[248:249], v247
    s_waitcnt lgkmcnt(0)
    ds_write_b128 v73, a[160:163] offset:0
    v_min_f32 v242, v74, v248
    v_sub_f32 v243, v242, v74
    v_sub_f32 v242, v242, v248
    v_exp_f32 v243, v243
    v_exp_f32 v242, v242
    v_mul_f32 v245, v75, v243
    v_fma_f32 v245, v249, v242, v245
    v_rcp_f32 v245, v245
    s_nop 0
    v_mul_f32 v70, v245, v242
    v_mul_f32 v68, v245, v243
    v_mov_b32 v71, v70
    v_mov_b32 v69, v68
    v_mov_b32 v242, v219
    v_mov_b32 v243, v219
    s_nop 1
    v_permlane32_swap_b32 v242, v243
    s_nop 1
    v_add_f32 v244, v242, v243
    v_rcp_f32 v244, v244
    s_nop 0
    v_mov_b32 v245, v244
    v_accvgpr_read_b32 v160, a0
    v_accvgpr_read_b32 v161, a1
    v_accvgpr_read_b32 v162, a2
    v_accvgpr_read_b32 v163, a3
    v_accvgpr_read_b32 v164, a4
    v_accvgpr_read_b32 v165, a5
    v_accvgpr_read_b32 v166, a6
    v_accvgpr_read_b32 v167, a7
    v_pk_mul_f32 v[160:161], v[160:161], v[244:245]
    v_pk_mul_f32 v[162:163], v[162:163], v[244:245]
    v_pk_mul_f32 v[164:165], v[164:165], v[244:245]
    v_pk_mul_f32 v[166:167], v[166:167], v[244:245]
    v_cvt_pk_bf16_f32 v168, v160, v161
    v_cvt_pk_bf16_f32 v169, v162, v163
    v_cvt_pk_bf16_f32 v170, v164, v165
    v_cvt_pk_bf16_f32 v171, v166, v167
    s_nop 0
    v_permlane32_swap_b32 v168, v170
    v_permlane32_swap_b32 v169, v171
    ds_write_b128 v208, v[168:171] offset:0
    v_accvgpr_read_b32 v172, a8
    v_accvgpr_read_b32 v173, a9
    v_accvgpr_read_b32 v174, a10
    v_accvgpr_read_b32 v175, a11
    v_accvgpr_read_b32 v176, a12
    v_accvgpr_read_b32 v177, a13
    v_accvgpr_read_b32 v178, a14
    v_accvgpr_read_b32 v179, a15
    v_pk_mul_f32 v[172:173], v[172:173], v[244:245]
    v_pk_mul_f32 v[174:175], v[174:175], v[244:245]
    v_pk_mul_f32 v[176:177], v[176:177], v[244:245]
    v_pk_mul_f32 v[178:179], v[178:179], v[244:245]
    v_cvt_pk_bf16_f32 v180, v172, v173
    v_cvt_pk_bf16_f32 v181, v174, v175
    v_cvt_pk_bf16_f32 v182, v176, v177
    v_cvt_pk_bf16_f32 v183, v178, v179
    s_nop 0
    v_permlane32_swap_b32 v180, v182
    v_permlane32_swap_b32 v181, v183
    ds_write_b128 v209, v[180:183] offset:0
    v_accvgpr_read_b32 v184, a16
    v_accvgpr_read_b32 v185, a17
    v_accvgpr_read_b32 v186, a18
    v_accvgpr_read_b32 v187, a19
    v_accvgpr_read_b32 v188, a20
    v_accvgpr_read_b32 v189, a21
    v_accvgpr_read_b32 v190, a22
    v_accvgpr_read_b32 v191, a23
    v_pk_mul_f32 v[184:185], v[184:185], v[244:245]
    v_pk_mul_f32 v[186:187], v[186:187], v[244:245]
    v_pk_mul_f32 v[188:189], v[188:189], v[244:245]
    v_pk_mul_f32 v[190:191], v[190:191], v[244:245]
    v_cvt_pk_bf16_f32 v192, v184, v185
    v_cvt_pk_bf16_f32 v193, v186, v187
    v_cvt_pk_bf16_f32 v194, v188, v189
    v_cvt_pk_bf16_f32 v195, v190, v191
    s_nop 0
    v_permlane32_swap_b32 v192, v194
    v_permlane32_swap_b32 v193, v195
    ds_write_b128 v210, v[192:195] offset:0
    v_accvgpr_read_b32 v196, a24
    v_accvgpr_read_b32 v197, a25
    v_accvgpr_read_b32 v198, a26
    v_accvgpr_read_b32 v199, a27
    v_accvgpr_read_b32 v200, a28
    v_accvgpr_read_b32 v201, a29
    v_accvgpr_read_b32 v202, a30
    v_accvgpr_read_b32 v203, a31
    v_pk_mul_f32 v[196:197], v[196:197], v[244:245]
    v_pk_mul_f32 v[198:199], v[198:199], v[244:245]
    v_pk_mul_f32 v[200:201], v[200:201], v[244:245]
    v_pk_mul_f32 v[202:203], v[202:203], v[244:245]
    v_cvt_pk_bf16_f32 v204, v196, v197
    v_cvt_pk_bf16_f32 v205, v198, v199
    v_cvt_pk_bf16_f32 v206, v200, v201
    v_cvt_pk_bf16_f32 v207, v202, v203
    s_nop 0
    v_permlane32_swap_b32 v204, v206
    v_permlane32_swap_b32 v205, v207
    ds_write_b128 v211, v[204:207] offset:0
    v_accvgpr_read_b32 v160, a32
    v_accvgpr_read_b32 v161, a33
    v_accvgpr_read_b32 v162, a34
    v_accvgpr_read_b32 v163, a35
    v_accvgpr_read_b32 v164, a36
    v_accvgpr_read_b32 v165, a37
    v_accvgpr_read_b32 v166, a38
    v_accvgpr_read_b32 v167, a39
    v_pk_mul_f32 v[160:161], v[160:161], v[244:245]
    v_pk_mul_f32 v[162:163], v[162:163], v[244:245]
    v_pk_mul_f32 v[164:165], v[164:165], v[244:245]
    v_pk_mul_f32 v[166:167], v[166:167], v[244:245]
    v_cvt_pk_bf16_f32 v168, v160, v161
    v_cvt_pk_bf16_f32 v169, v162, v163
    v_cvt_pk_bf16_f32 v170, v164, v165
    v_cvt_pk_bf16_f32 v171, v166, v167
    s_nop 0
    v_permlane32_swap_b32 v168, v170
    v_permlane32_swap_b32 v169, v171
    ds_write_b128 v212, v[168:171] offset:0
    v_accvgpr_read_b32 v172, a40
    v_accvgpr_read_b32 v173, a41
    v_accvgpr_read_b32 v174, a42
    v_accvgpr_read_b32 v175, a43
    v_accvgpr_read_b32 v176, a44
    v_accvgpr_read_b32 v177, a45
    v_accvgpr_read_b32 v178, a46
    v_accvgpr_read_b32 v179, a47
    v_pk_mul_f32 v[172:173], v[172:173], v[244:245]
    v_pk_mul_f32 v[174:175], v[174:175], v[244:245]
    v_pk_mul_f32 v[176:177], v[176:177], v[244:245]
    v_pk_mul_f32 v[178:179], v[178:179], v[244:245]
    v_cvt_pk_bf16_f32 v180, v172, v173
    v_cvt_pk_bf16_f32 v181, v174, v175
    v_cvt_pk_bf16_f32 v182, v176, v177
    v_cvt_pk_bf16_f32 v183, v178, v179
    s_nop 0
    v_permlane32_swap_b32 v180, v182
    v_permlane32_swap_b32 v181, v183
    ds_write_b128 v213, v[180:183] offset:0
    v_accvgpr_read_b32 v184, a48
    v_accvgpr_read_b32 v185, a49
    v_accvgpr_read_b32 v186, a50
    v_accvgpr_read_b32 v187, a51
    v_accvgpr_read_b32 v188, a52
    v_accvgpr_read_b32 v189, a53
    v_accvgpr_read_b32 v190, a54
    v_accvgpr_read_b32 v191, a55
    v_pk_mul_f32 v[184:185], v[184:185], v[244:245]
    v_pk_mul_f32 v[186:187], v[186:187], v[244:245]
    v_pk_mul_f32 v[188:189], v[188:189], v[244:245]
    v_pk_mul_f32 v[190:191], v[190:191], v[244:245]
    v_cvt_pk_bf16_f32 v192, v184, v185
    v_cvt_pk_bf16_f32 v193, v186, v187
    v_cvt_pk_bf16_f32 v194, v188, v189
    v_cvt_pk_bf16_f32 v195, v190, v191
    s_nop 0
    v_permlane32_swap_b32 v192, v194
    v_permlane32_swap_b32 v193, v195
    ds_write_b128 v214, v[192:195] offset:0
    v_accvgpr_read_b32 v196, a56
    v_accvgpr_read_b32 v197, a57
    v_accvgpr_read_b32 v198, a58
    v_accvgpr_read_b32 v199, a59
    v_accvgpr_read_b32 v200, a60
    v_accvgpr_read_b32 v201, a61
    v_accvgpr_read_b32 v202, a62
    v_accvgpr_read_b32 v203, a63
    v_pk_mul_f32 v[196:197], v[196:197], v[244:245]
    v_pk_mul_f32 v[198:199], v[198:199], v[244:245]
    v_pk_mul_f32 v[200:201], v[200:201], v[244:245]
    v_pk_mul_f32 v[202:203], v[202:203], v[244:245]
    v_cvt_pk_bf16_f32 v204, v196, v197
    v_cvt_pk_bf16_f32 v205, v198, v199
    v_cvt_pk_bf16_f32 v206, v200, v201
    v_cvt_pk_bf16_f32 v207, v202, v203
    s_nop 0
    v_permlane32_swap_b32 v204, v206
    v_permlane32_swap_b32 v205, v207
    ds_write_b128 v215, v[204:207] offset:0
    s_waitcnt lgkmcnt(0)
    s_barrier
    ds_read_b128 v[32:35], v72 offset:0
    ds_read_b128 v[36:39], v72 offset:1024
    ds_read_b128 v[40:43], v72 offset:2048
    ds_read_b128 v[44:47], v72 offset:3072
    ds_read_b128 v[48:51], v72 offset:16384
    ds_read_b128 v[52:55], v72 offset:17408
    ds_read_b128 v[56:59], v72 offset:18432
    ds_read_b128 v[60:63], v72 offset:19456
    v_add_u32 v251, s35, v240
    v_xor_b32 v208, 0, v241
    v_lshl_add_u32 v208, v208, 4, v251
    v_xor_b32 v209, 2, v241
    v_lshl_add_u32 v209, v209, 4, v251
    v_xor_b32 v210, 4, v241
    v_lshl_add_u32 v210, v210, 4, v251
    v_xor_b32 v211, 6, v241
    v_lshl_add_u32 v211, v211, 4, v251
    v_xor_b32 v212, 8, v241
    v_lshl_add_u32 v212, v212, 4, v251
    v_xor_b32 v213, 10, v241
    v_lshl_add_u32 v213, v213, 4, v251
    v_xor_b32 v214, 12, v241
    v_lshl_add_u32 v214, v214, 4, v251
    v_xor_b32 v215, 14, v241
    v_lshl_add_u32 v215, v215, 4, v251
    ds_read_b128 v[160:163], v208
    ds_read_b128 v[164:167], v209
    ds_read_b128 v[168:171], v210
    ds_read_b128 v[172:175], v211
    ds_read_b128 v[176:179], v212
    ds_read_b128 v[180:183], v213
    ds_read_b128 v[184:187], v214
    ds_read_b128 v[188:191], v215
    s_add_u32 s35, s35, 32768
    s_cmp_ge_u32 s35, s40
    s_cselect_b32 s46, s41, 0
    s_sub_u32 s35, s35, s46
    s_waitcnt lgkmcnt(7)
    v_lshlrev_b32 v80, 16, v160
    v_and_b32 v81, s63, v160
    v_lshlrev_b32 v82, 16, v161
    v_and_b32 v83, s63, v161
    v_lshlrev_b32 v84, 16, v162
    v_and_b32 v85, s63, v162
    v_lshlrev_b32 v86, 16, v163
    v_and_b32 v87, s63, v163
    v_pk_mul_f32 v[80:81], v[80:81], s[94:95]
    v_pk_mul_f32 v[82:83], v[82:83], s[94:95]
    v_pk_mul_f32 v[84:85], v[84:85], s[94:95]
    v_pk_mul_f32 v[86:87], v[86:87], s[94:95]
    v_cvt_pk_bf16_f32 v88, v80, v81
    v_cvt_pk_bf16_f32 v89, v82, v83
    v_cvt_pk_bf16_f32 v90, v84, v85
    v_cvt_pk_bf16_f32 v91, v86, v87
    v_accvgpr_write_b32 a192, v88
    v_accvgpr_write_b32 a193, v89
    v_accvgpr_write_b32 a194, v90
    v_accvgpr_write_b32 a195, v91
    s_waitcnt lgkmcnt(6)
    v_lshlrev_b32 v80, 16, v164
    v_and_b32 v81, s63, v164
    v_lshlrev_b32 v82, 16, v165
    v_and_b32 v83, s63, v165
    v_lshlrev_b32 v84, 16, v166
    v_and_b32 v85, s63, v166
    v_lshlrev_b32 v86, 16, v167
    v_and_b32 v87, s63, v167
    v_pk_mul_f32 v[80:81], v[80:81], s[94:95]
    v_pk_mul_f32 v[82:83], v[82:83], s[94:95]
    v_pk_mul_f32 v[84:85], v[84:85], s[94:95]
    v_pk_mul_f32 v[86:87], v[86:87], s[94:95]
    v_cvt_pk_bf16_f32 v88, v80, v81
    v_cvt_pk_bf16_f32 v89, v82, v83
    v_cvt_pk_bf16_f32 v90, v84, v85
    v_cvt_pk_bf16_f32 v91, v86, v87
    v_accvgpr_write_b32 a196, v88
    v_accvgpr_write_b32 a197, v89
    v_accvgpr_write_b32 a198, v90
    v_accvgpr_write_b32 a199, v91
    s_waitcnt lgkmcnt(5)
    v_lshlrev_b32 v80, 16, v168
    v_and_b32 v81, s63, v168
    v_lshlrev_b32 v82, 16, v169
    v_and_b32 v83, s63, v169
    v_lshlrev_b32 v84, 16, v170
    v_and_b32 v85, s63, v170
    v_lshlrev_b32 v86, 16, v171
    v_and_b32 v87, s63, v171
    v_pk_mul_f32 v[80:81], v[80:81], s[94:95]
    v_pk_mul_f32 v[82:83], v[82:83], s[94:95]
    v_pk_mul_f32 v[84:85], v[84:85], s[94:95]
    v_pk_mul_f32 v[86:87], v[86:87], s[94:95]
    v_cvt_pk_bf16_f32 v88, v80, v81
    v_cvt_pk_bf16_f32 v89, v82, v83
    v_cvt_pk_bf16_f32 v90, v84, v85
    v_cvt_pk_bf16_f32 v91, v86, v87
    v_accvgpr_write_b32 a200, v88
    v_accvgpr_write_b32 a201, v89
    v_accvgpr_write_b32 a202, v90
    v_accvgpr_write_b32 a203, v91
    s_waitcnt lgkmcnt(4)
    v_lshlrev_b32 v80, 16, v172
    v_and_b32 v81, s63, v172
    v_lshlrev_b32 v82, 16, v173
    v_and_b32 v83, s63, v173
    v_lshlrev_b32 v84, 16, v174
    v_and_b32 v85, s63, v174
    v_lshlrev_b32 v86, 16, v175
    v_and_b32 v87, s63, v175
    v_pk_mul_f32 v[80:81], v[80:81], s[94:95]
    v_pk_mul_f32 v[82:83], v[82:83], s[94:95]
    v_pk_mul_f32 v[84:85], v[84:85], s[94:95]
    v_pk_mul_f32 v[86:87], v[86:87], s[94:95]
    v_cvt_pk_bf16_f32 v88, v80, v81
    v_cvt_pk_bf16_f32 v89, v82, v83
    v_cvt_pk_bf16_f32 v90, v84, v85
    v_cvt_pk_bf16_f32 v91, v86, v87
    v_accvgpr_write_b32 a204, v88
    v_accvgpr_write_b32 a205, v89
    v_accvgpr_write_b32 a206, v90
    v_accvgpr_write_b32 a207, v91
    s_waitcnt lgkmcnt(3)
    v_lshlrev_b32 v80, 16, v176
    v_and_b32 v81, s63, v176
    v_lshlrev_b32 v82, 16, v177
    v_and_b32 v83, s63, v177
    v_lshlrev_b32 v84, 16, v178
    v_and_b32 v85, s63, v178
    v_lshlrev_b32 v86, 16, v179
    v_and_b32 v87, s63, v179
    v_pk_mul_f32 v[80:81], v[80:81], s[94:95]
    v_pk_mul_f32 v[82:83], v[82:83], s[94:95]
    v_pk_mul_f32 v[84:85], v[84:85], s[94:95]
    v_pk_mul_f32 v[86:87], v[86:87], s[94:95]
    v_cvt_pk_bf16_f32 v88, v80, v81
    v_cvt_pk_bf16_f32 v89, v82, v83
    v_cvt_pk_bf16_f32 v90, v84, v85
    v_cvt_pk_bf16_f32 v91, v86, v87
    v_accvgpr_write_b32 a208, v88
    v_accvgpr_write_b32 a209, v89
    v_accvgpr_write_b32 a210, v90
    v_accvgpr_write_b32 a211, v91
    s_waitcnt lgkmcnt(2)
    v_lshlrev_b32 v80, 16, v180
    v_and_b32 v81, s63, v180
    v_lshlrev_b32 v82, 16, v181
    v_and_b32 v83, s63, v181
    v_lshlrev_b32 v84, 16, v182
    v_and_b32 v85, s63, v182
    v_lshlrev_b32 v86, 16, v183
    v_and_b32 v87, s63, v183
    v_pk_mul_f32 v[80:81], v[80:81], s[94:95]
    v_pk_mul_f32 v[82:83], v[82:83], s[94:95]
    v_pk_mul_f32 v[84:85], v[84:85], s[94:95]
    v_pk_mul_f32 v[86:87], v[86:87], s[94:95]
    v_cvt_pk_bf16_f32 v88, v80, v81
    v_cvt_pk_bf16_f32 v89, v82, v83
    v_cvt_pk_bf16_f32 v90, v84, v85
    v_cvt_pk_bf16_f32 v91, v86, v87
    v_accvgpr_write_b32 a212, v88
    v_accvgpr_write_b32 a213, v89
    v_accvgpr_write_b32 a214, v90
    v_accvgpr_write_b32 a215, v91
    s_waitcnt lgkmcnt(1)
    v_lshlrev_b32 v80, 16, v184
    v_and_b32 v81, s63, v184
    v_lshlrev_b32 v82, 16, v185
    v_and_b32 v83, s63, v185
    v_lshlrev_b32 v84, 16, v186
    v_and_b32 v85, s63, v186
    v_lshlrev_b32 v86, 16, v187
    v_and_b32 v87, s63, v187
    v_pk_mul_f32 v[80:81], v[80:81], s[94:95]
    v_pk_mul_f32 v[82:83], v[82:83], s[94:95]
    v_pk_mul_f32 v[84:85], v[84:85], s[94:95]
    v_pk_mul_f32 v[86:87], v[86:87], s[94:95]
    v_cvt_pk_bf16_f32 v88, v80, v81
    v_cvt_pk_bf16_f32 v89, v82, v83
    v_cvt_pk_bf16_f32 v90, v84, v85
    v_cvt_pk_bf16_f32 v91, v86, v87
    v_accvgpr_write_b32 a216, v88
    v_accvgpr_write_b32 a217, v89
    v_accvgpr_write_b32 a218, v90
    v_accvgpr_write_b32 a219, v91
    s_waitcnt lgkmcnt(0)
    v_lshlrev_b32 v80, 16, v188
    v_and_b32 v81, s63, v188
    v_lshlrev_b32 v82, 16, v189
    v_and_b32 v83, s63, v189
    v_lshlrev_b32 v84, 16, v190
    v_and_b32 v85, s63, v190
    v_lshlrev_b32 v86, 16, v191
    v_and_b32 v87, s63, v191
    v_pk_mul_f32 v[80:81], v[80:81], s[94:95]
    v_pk_mul_f32 v[82:83], v[82:83], s[94:95]
    v_pk_mul_f32 v[84:85], v[84:85], s[94:95]
    v_pk_mul_f32 v[86:87], v[86:87], s[94:95]
    v_cvt_pk_bf16_f32 v88, v80, v81
    v_cvt_pk_bf16_f32 v89, v82, v83
    v_cvt_pk_bf16_f32 v90, v84, v85
    v_cvt_pk_bf16_f32 v91, v86, v87
    v_accvgpr_write_b32 a220, v88
    v_accvgpr_write_b32 a221, v89
    v_accvgpr_write_b32 a222, v90
    v_accvgpr_write_b32 a223, v91
    s_waitcnt lgkmcnt(0)
    s_barrier
    v_bfe_u32 v242, v255, 4, 5
    v_bfe_u32 v243, v255, 9, 1
    v_and_b32 v248, 7, v242
    v_xor_b32 v248, v248, v243
    v_lshlrev_b32 v242, 7, v242
    v_add_u32 v242, s34, v242
    v_xor_b32 v208, 0, v248
    v_lshl_add_u32 v208, v208, 4, v242
    v_xor_b32 v209, 2, v248
    v_lshl_add_u32 v209, v209, 4, v242
    v_xor_b32 v210, 4, v248
    v_lshl_add_u32 v210, v210, 4, v242
    v_xor_b32 v211, 6, v248
    v_lshl_add_u32 v211, v211, 4, v242
    v_bfe_u32 v242, v255, 7, 3
    v_bfe_u32 v243, v255, 4, 3
    v_xor_b32 v243, v243, v242
    v_lshlrev_b32 v242, 8, v242
    v_lshl_add_u32 v253, v243, 4, v242
    v_add_u32 v251, s34, v255
    v_accvgpr_read_b32 v160, a128
    v_accvgpr_read_b32 v161, a129
    v_accvgpr_read_b32 v162, a130
    v_accvgpr_read_b32 v163, a131
    v_accvgpr_read_b32 v164, a132
    v_accvgpr_read_b32 v165, a133
    v_accvgpr_read_b32 v166, a134
    v_accvgpr_read_b32 v167, a135
    v_pk_mul_f32 v[160:161], v[160:161], v[68:69]
    v_pk_mul_f32 v[162:163], v[162:163], v[68:69]
    v_pk_mul_f32 v[164:165], v[164:165], v[68:69]
    v_pk_mul_f32 v[166:167], v[166:167], v[68:69]
    v_pk_fma_f32 v[160:161], v[32:33], v[70:71], v[160:161]
    v_pk_fma_f32 v[162:163], v[34:35], v[70:71], v[162:163]
    v_pk_fma_f32 v[164:165], v[36:37], v[70:71], v[164:165]
    v_pk_fma_f32 v[166:167], v[38:39], v[70:71], v[166:167]
    v_cvt_pk_bf16_f32 v168, v160, v161
    v_cvt_pk_bf16_f32 v169, v162, v163
    v_cvt_pk_bf16_f32 v170, v164, v165
    v_cvt_pk_bf16_f32 v171, v166, v167
    s_nop 0
    v_permlane32_swap_b32 v168, v170
    v_permlane32_swap_b32 v169, v171
    ds_write_b128 v208, v[168:171] offset:0
    v_accvgpr_read_b32 v172, a136
    v_accvgpr_read_b32 v173, a137
    v_accvgpr_read_b32 v174, a138
    v_accvgpr_read_b32 v175, a139
    v_accvgpr_read_b32 v176, a140
    v_accvgpr_read_b32 v177, a141
    v_accvgpr_read_b32 v178, a142
    v_accvgpr_read_b32 v179, a143
    v_pk_mul_f32 v[172:173], v[172:173], v[68:69]
    v_pk_mul_f32 v[174:175], v[174:175], v[68:69]
    v_pk_mul_f32 v[176:177], v[176:177], v[68:69]
    v_pk_mul_f32 v[178:179], v[178:179], v[68:69]
    v_pk_fma_f32 v[172:173], v[40:41], v[70:71], v[172:173]
    v_pk_fma_f32 v[174:175], v[42:43], v[70:71], v[174:175]
    v_pk_fma_f32 v[176:177], v[44:45], v[70:71], v[176:177]
    v_pk_fma_f32 v[178:179], v[46:47], v[70:71], v[178:179]
    v_cvt_pk_bf16_f32 v180, v172, v173
    v_cvt_pk_bf16_f32 v181, v174, v175
    v_cvt_pk_bf16_f32 v182, v176, v177
    v_cvt_pk_bf16_f32 v183, v178, v179
    s_nop 0
    v_permlane32_swap_b32 v180, v182
    v_permlane32_swap_b32 v181, v183
    ds_write_b128 v209, v[180:183] offset:0
    v_accvgpr_read_b32 v184, a144
    v_accvgpr_read_b32 v185, a145
    v_accvgpr_read_b32 v186, a146
    v_accvgpr_read_b32 v187, a147
    v_accvgpr_read_b32 v188, a148
    v_accvgpr_read_b32 v189, a149
    v_accvgpr_read_b32 v190, a150
    v_accvgpr_read_b32 v191, a151
    v_pk_mul_f32 v[184:185], v[184:185], v[68:69]
    v_pk_mul_f32 v[186:187], v[186:187], v[68:69]
    v_pk_mul_f32 v[188:189], v[188:189], v[68:69]
    v_pk_mul_f32 v[190:191], v[190:191], v[68:69]
    v_pk_fma_f32 v[184:185], v[48:49], v[70:71], v[184:185]
    v_pk_fma_f32 v[186:187], v[50:51], v[70:71], v[186:187]
    v_pk_fma_f32 v[188:189], v[52:53], v[70:71], v[188:189]
    v_pk_fma_f32 v[190:191], v[54:55], v[70:71], v[190:191]
    v_cvt_pk_bf16_f32 v192, v184, v185
    v_cvt_pk_bf16_f32 v193, v186, v187
    v_cvt_pk_bf16_f32 v194, v188, v189
    v_cvt_pk_bf16_f32 v195, v190, v191
    s_nop 0
    v_permlane32_swap_b32 v192, v194
    v_permlane32_swap_b32 v193, v195
    ds_write_b128 v210, v[192:195] offset:0
    v_accvgpr_read_b32 v196, a152
    v_accvgpr_read_b32 v197, a153
    v_accvgpr_read_b32 v198, a154
    v_accvgpr_read_b32 v199, a155
    v_accvgpr_read_b32 v200, a156
    v_accvgpr_read_b32 v201, a157
    v_accvgpr_read_b32 v202, a158
    v_accvgpr_read_b32 v203, a159
    v_pk_mul_f32 v[196:197], v[196:197], v[68:69]
    v_pk_mul_f32 v[198:199], v[198:199], v[68:69]
    v_pk_mul_f32 v[200:201], v[200:201], v[68:69]
    v_pk_mul_f32 v[202:203], v[202:203], v[68:69]
    v_pk_fma_f32 v[196:197], v[56:57], v[70:71], v[196:197]
    v_pk_fma_f32 v[198:199], v[58:59], v[70:71], v[198:199]
    v_pk_fma_f32 v[200:201], v[60:61], v[70:71], v[200:201]
    v_pk_fma_f32 v[202:203], v[62:63], v[70:71], v[202:203]
    v_cvt_pk_bf16_f32 v204, v196, v197
    v_cvt_pk_bf16_f32 v205, v198, v199
    v_cvt_pk_bf16_f32 v206, v200, v201
    v_cvt_pk_bf16_f32 v207, v202, v203
    s_nop 0
    v_permlane32_swap_b32 v204, v206
    v_permlane32_swap_b32 v205, v207
    ds_write_b128 v211, v[204:207] offset:0
    s_waitcnt lgkmcnt(0)
    ds_read_b128 v[80:83], v251 offset:0
    ds_read_b128 v[84:87], v251 offset:1024
    ds_read_b128 v[88:91], v251 offset:2048
    ds_read_b128 v[92:95], v251 offset:3072
    s_add_u32 s98, s38, 0
    s_add_u32 s99, s38, 4096
    s_waitcnt lgkmcnt(0)
    s_sub_u32 s45, s34, s55
    v_add_u32 v251, s45, v240
    v_xor_b32 v208, 0, v241
    v_lshl_add_u32 v208, v208, 4, v251
    v_xor_b32 v209, 2, v241
    v_lshl_add_u32 v209, v209, 4, v251
    v_xor_b32 v210, 4, v241
    v_lshl_add_u32 v210, v210, 4, v251
    v_xor_b32 v211, 6, v241
    v_lshl_add_u32 v211, v211, 4, v251
    v_xor_b32 v212, 8, v241
    v_lshl_add_u32 v212, v212, 4, v251
    v_xor_b32 v213, 10, v241
    v_lshl_add_u32 v213, v213, 4, v251
    v_xor_b32 v214, 12, v241
    v_lshl_add_u32 v214, v214, 4, v251
    v_xor_b32 v215, 14, v241
    v_lshl_add_u32 v215, v215, 4, v251
    v_mov_b32 v242, v220
    v_mov_b32 v243, v220
    s_nop 1
    v_permlane32_swap_b32 v242, v243
    s_nop 1
    v_add_f32 v244, v242, v243
    v_rcp_f32 v244, v244
    s_nop 0
    v_mov_b32 v245, v244
    v_accvgpr_read_b32 v160, a64
    v_accvgpr_read_b32 v161, a65
    buffer_store_dwordx4 v[80:83], v253, s[24:27], s98 offen offset:0 sc1 nt
    v_accvgpr_read_b32 v162, a66
    v_accvgpr_read_b32 v163, a67
    v_accvgpr_read_b32 v164, a68
    v_accvgpr_read_b32 v165, a69
    v_accvgpr_read_b32 v166, a70
    v_accvgpr_read_b32 v167, a71
    v_pk_mul_f32 v[160:161], v[160:161], v[244:245]
    v_pk_mul_f32 v[162:163], v[162:163], v[244:245]
    v_pk_mul_f32 v[164:165], v[164:165], v[244:245]
    v_pk_mul_f32 v[166:167], v[166:167], v[244:245]
    v_cvt_pk_bf16_f32 v168, v160, v161
    v_cvt_pk_bf16_f32 v169, v162, v163
    v_cvt_pk_bf16_f32 v170, v164, v165
    v_cvt_pk_bf16_f32 v171, v166, v167
    s_nop 0
    v_permlane32_swap_b32 v168, v170
    v_permlane32_swap_b32 v169, v171
    ds_write_b128 v208, v[168:171] offset:0
    v_accvgpr_read_b32 v172, a72
    v_accvgpr_read_b32 v173, a73
    v_accvgpr_read_b32 v174, a74
    v_accvgpr_read_b32 v175, a75
    v_accvgpr_read_b32 v176, a76
    v_accvgpr_read_b32 v177, a77
    v_accvgpr_read_b32 v178, a78
    v_accvgpr_read_b32 v179, a79
    v_pk_mul_f32 v[172:173], v[172:173], v[244:245]
    v_pk_mul_f32 v[174:175], v[174:175], v[244:245]
    v_pk_mul_f32 v[176:177], v[176:177], v[244:245]
    v_pk_mul_f32 v[178:179], v[178:179], v[244:245]
    v_cvt_pk_bf16_f32 v180, v172, v173
    v_cvt_pk_bf16_f32 v181, v174, v175
    v_cvt_pk_bf16_f32 v182, v176, v177
    v_cvt_pk_bf16_f32 v183, v178, v179
    s_nop 0
    v_permlane32_swap_b32 v180, v182
    v_permlane32_swap_b32 v181, v183
    ds_write_b128 v209, v[180:183] offset:0
    buffer_store_dwordx4 v[84:87], v253, s[24:27], s98 offen offset:2048 sc1 nt
    v_accvgpr_read_b32 v184, a80
    v_accvgpr_read_b32 v185, a81
    v_accvgpr_read_b32 v186, a82
    v_accvgpr_read_b32 v187, a83
    v_accvgpr_read_b32 v188, a84
    v_accvgpr_read_b32 v189, a85
    v_accvgpr_read_b32 v190, a86
    v_accvgpr_read_b32 v191, a87
    v_pk_mul_f32 v[184:185], v[184:185], v[244:245]
    v_pk_mul_f32 v[186:187], v[186:187], v[244:245]
    v_pk_mul_f32 v[188:189], v[188:189], v[244:245]
    v_pk_mul_f32 v[190:191], v[190:191], v[244:245]
    v_cvt_pk_bf16_f32 v192, v184, v185
    v_cvt_pk_bf16_f32 v193, v186, v187
    v_cvt_pk_bf16_f32 v194, v188, v189
    v_cvt_pk_bf16_f32 v195, v190, v191
    s_nop 0
    v_permlane32_swap_b32 v192, v194
    v_permlane32_swap_b32 v193, v195
    ds_write_b128 v210, v[192:195] offset:0
    v_accvgpr_read_b32 v196, a88
    v_accvgpr_read_b32 v197, a89
    v_accvgpr_read_b32 v198, a90
    v_accvgpr_read_b32 v199, a91
    v_accvgpr_read_b32 v200, a92
    v_accvgpr_read_b32 v201, a93
    v_accvgpr_read_b32 v202, a94
    v_accvgpr_read_b32 v203, a95
    v_pk_mul_f32 v[196:197], v[196:197], v[244:245]
    v_pk_mul_f32 v[198:199], v[198:199], v[244:245]
    v_pk_mul_f32 v[200:201], v[200:201], v[244:245]
    v_pk_mul_f32 v[202:203], v[202:203], v[244:245]
    v_cvt_pk_bf16_f32 v204, v196, v197
    v_cvt_pk_bf16_f32 v205, v198, v199
    v_cvt_pk_bf16_f32 v206, v200, v201
    v_cvt_pk_bf16_f32 v207, v202, v203
    buffer_store_dwordx4 v[88:91], v253, s[24:27], s99 offen offset:0 sc1 nt
    v_permlane32_swap_b32 v204, v206
    v_permlane32_swap_b32 v205, v207
    ds_write_b128 v211, v[204:207] offset:0
    v_accvgpr_read_b32 v160, a96
    v_accvgpr_read_b32 v161, a97
    v_accvgpr_read_b32 v162, a98
    v_accvgpr_read_b32 v163, a99
    v_accvgpr_read_b32 v164, a100
    v_accvgpr_read_b32 v165, a101
    v_accvgpr_read_b32 v166, a102
    v_accvgpr_read_b32 v167, a103
    v_pk_mul_f32 v[160:161], v[160:161], v[244:245]
    v_pk_mul_f32 v[162:163], v[162:163], v[244:245]
    v_pk_mul_f32 v[164:165], v[164:165], v[244:245]
    v_pk_mul_f32 v[166:167], v[166:167], v[244:245]
    v_cvt_pk_bf16_f32 v168, v160, v161
    v_cvt_pk_bf16_f32 v169, v162, v163
    v_cvt_pk_bf16_f32 v170, v164, v165
    v_cvt_pk_bf16_f32 v171, v166, v167
    s_nop 0
    v_permlane32_swap_b32 v168, v170
    v_permlane32_swap_b32 v169, v171
    ds_write_b128 v212, v[168:171] offset:0
    v_accvgpr_read_b32 v172, a104
    v_accvgpr_read_b32 v173, a105
    v_accvgpr_read_b32 v174, a106
    v_accvgpr_read_b32 v175, a107
    v_accvgpr_read_b32 v176, a108
    v_accvgpr_read_b32 v177, a109
    v_accvgpr_read_b32 v178, a110
    v_accvgpr_read_b32 v179, a111
    v_pk_mul_f32 v[172:173], v[172:173], v[244:245]
    v_pk_mul_f32 v[174:175], v[174:175], v[244:245]
    v_pk_mul_f32 v[176:177], v[176:177], v[244:245]
    v_pk_mul_f32 v[178:179], v[178:179], v[244:245]
    v_cvt_pk_bf16_f32 v180, v172, v173
    buffer_store_dwordx4 v[92:95], v253, s[24:27], s99 offen offset:2048 sc1 nt
    v_cvt_pk_bf16_f32 v181, v174, v175
    v_cvt_pk_bf16_f32 v182, v176, v177
    v_cvt_pk_bf16_f32 v183, v178, v179
    s_nop 0
    v_permlane32_swap_b32 v180, v182
    v_permlane32_swap_b32 v181, v183
    ds_write_b128 v213, v[180:183] offset:0
    v_accvgpr_read_b32 v184, a112
    v_accvgpr_read_b32 v185, a113
    v_accvgpr_read_b32 v186, a114
    v_accvgpr_read_b32 v187, a115
    v_accvgpr_read_b32 v188, a116
    v_accvgpr_read_b32 v189, a117
    v_accvgpr_read_b32 v190, a118
    v_accvgpr_read_b32 v191, a119
    v_pk_mul_f32 v[184:185], v[184:185], v[244:245]
    v_pk_mul_f32 v[186:187], v[186:187], v[244:245]
    v_pk_mul_f32 v[188:189], v[188:189], v[244:245]
    v_pk_mul_f32 v[190:191], v[190:191], v[244:245]
    v_cvt_pk_bf16_f32 v192, v184, v185
    v_cvt_pk_bf16_f32 v193, v186, v187
    v_cvt_pk_bf16_f32 v194, v188, v189
    v_cvt_pk_bf16_f32 v195, v190, v191
    s_nop 0
    v_permlane32_swap_b32 v192, v194
    v_permlane32_swap_b32 v193, v195
    ds_write_b128 v214, v[192:195] offset:0
    v_accvgpr_read_b32 v196, a120
    v_accvgpr_read_b32 v197, a121
    v_accvgpr_read_b32 v198, a122
    v_accvgpr_read_b32 v199, a123
    v_accvgpr_read_b32 v200, a124
    v_accvgpr_read_b32 v201, a125
    v_accvgpr_read_b32 v202, a126
    v_accvgpr_read_b32 v203, a127
    v_pk_mul_f32 v[196:197], v[196:197], v[244:245]
    v_pk_mul_f32 v[198:199], v[198:199], v[244:245]
    v_pk_mul_f32 v[200:201], v[200:201], v[244:245]
    v_pk_mul_f32 v[202:203], v[202:203], v[244:245]
    v_cvt_pk_bf16_f32 v204, v196, v197
    v_cvt_pk_bf16_f32 v205, v198, v199
    v_cvt_pk_bf16_f32 v206, v200, v201
    v_cvt_pk_bf16_f32 v207, v202, v203
    s_nop 0
    v_permlane32_swap_b32 v204, v206
    v_permlane32_swap_b32 v205, v207
    ds_write_b128 v215, v[204:207] offset:0
    s_mov_b32 s41, 98304
    s_add_u32 s34, s55, 65536
    v_mov_b32 v200, 0
    v_mov_b32 v201, 0
    v_mov_b32 v202, 0
    v_mov_b32 v203, 0
    v_mov_b32 v204, 0
    v_mov_b32 v205, 0
    v_mov_b32 v206, 0
    v_mov_b32 v207, 0
    v_mfma_f32_32x32x16_bf16 a[0:15], v[128:131], v[200:203], 0
    v_mov_b32 v32, 0
    v_mov_b32 v33, 0
    v_mov_b32 v34, 0
    v_mov_b32 v35, 0
    v_mfma_f32_32x32x16_bf16 a[16:31], v[128:131], v[200:203], 0
    v_mov_b32 v36, 0
    v_mov_b32 v37, 0
    v_mov_b32 v38, 0
    v_mov_b32 v39, 0
    v_mfma_f32_32x32x16_bf16 a[32:47], v[128:131], v[200:203], 0
    v_mov_b32 v40, 0
    v_mov_b32 v41, 0
    v_mov_b32 v42, 0
    v_mov_b32 v43, 0
    v_mfma_f32_32x32x16_bf16 a[48:63], v[128:131], v[200:203], 0
    v_mov_b32 v44, 0
    v_mov_b32 v45, 0
    v_mov_b32 v46, 0
    v_mov_b32 v47, 0
    v_mov_b32 v219, 0
    v_mfma_f32_32x32x16_bf16 a[64:79], v[128:131], v[200:203], 0
    v_mov_b32 v48, 0
    v_mov_b32 v49, 0
    v_mov_b32 v50, 0
    v_mov_b32 v51, 0
    v_mfma_f32_32x32x16_bf16 a[80:95], v[128:131], v[200:203], 0
    v_mov_b32 v52, 0
    v_mov_b32 v53, 0
    v_mov_b32 v54, 0
    v_mov_b32 v55, 0
    v_mfma_f32_32x32x16_bf16 a[96:111], v[128:131], v[200:203], 0
    v_mov_b32 v56, 0
    v_mov_b32 v57, 0
    v_mov_b32 v58, 0
    v_mov_b32 v59, 0
    v_mfma_f32_32x32x16_bf16 a[112:127], v[128:131], v[200:203], 0
    v_mov_b32 v60, 0
    v_mov_b32 v61, 0
    v_mov_b32 v62, 0
    v_mov_b32 v63, 0
    v_mov_b32 v220, 0
    s_waitcnt lgkmcnt(0)
    v_add_u32 v252, s42, v255
    ds_read_b128 v[80:83], v252 offset:0
    ds_read_b128 v[84:87], v252 offset:1024
    ds_read_b128 v[88:91], v252 offset:2048
    ds_read_b128 v[92:95], v252 offset:3072
    s_mov_b32 s44, 1
    s_mov_b32 s43, 14
    s_branch L_go_B
L_last_A0:
    ds_read_b64_tr_b16 v[128:129], v231 offset:0
    ds_read_b64_tr_b16 v[130:131], v231 offset:2048
    v_mfma_f32_32x32x16_bf16 a[80:95], v[136:139], v[200:203], a[80:95]
    s_mov_b32 s51, s35
    s_add_u32 s35, s35, 32768
    s_cmp_ge_u32 s35, s40
    s_cselect_b32 s46, s41, 0
    s_sub_u32 s35, s35, s46
    s_sub_u32 s36, s35, s51
    s_sub_u32 s101, s51, s35
    s_mov_b32 s35, s51
    ds_read_b128 v[96:99], v223 offset:8192
    ds_read_b128 v[100:103], v224 offset:8192
    ds_read_b128 v[104:107], v225 offset:8192
    ds_read_b64_tr_b16 v[136:137], v232 offset:0
    ds_read_b64_tr_b16 v[138:139], v232 offset:2048
    v_mfma_f32_32x32x16_bf16 a[96:111], v[144:147], v[200:203], a[96:111]
    ds_read_b128 v[108:111], v226 offset:8192
    ds_read_b128 v[112:115], v227 offset:8192
    ds_read_b128 v[116:119], v228 offset:8192
    ds_read_b64_tr_b16 v[144:145], v233 offset:0
    ds_read_b64_tr_b16 v[146:147], v233 offset:2048
    v_mfma_f32_32x32x16_bf16 a[112:127], v[152:155], v[200:203], a[112:127]
    ds_read_b128 v[120:123], v229 offset:8192
    ds_read_b128 v[124:127], v230 offset:8192
    ds_read_b64_tr_b16 v[152:153], v234 offset:0
    ds_read_b64_tr_b16 v[154:155], v234 offset:2048
    v_exp_f32 v208, v160
    v_exp_f32 v209, v161
    v_mfma_f32_32x32x16_bf16 a[64:79], v[132:135], v[204:207], a[64:79]
    s_waitcnt vmcnt(0)
    s_barrier
    v_add_u32 v223, s36, v223
    v_add_u32 v224, s36, v224
    ds_read_b64_tr_b16 v[132:133], v231 offset:4096
    ds_read_b64_tr_b16 v[134:135], v231 offset:6144
    v_mfma_f32_32x32x16_bf16 a[80:95], v[140:143], v[204:207], a[80:95]
    v_add_u32 v225, s36, v225
    v_add_u32 v226, s36, v226
    ds_read_b64_tr_b16 v[140:141], v232 offset:4096
    ds_read_b64_tr_b16 v[142:143], v232 offset:6144
    v_exp_f32 v210, v162
    v_exp_f32 v211, v163
    v_mfma_f32_32x32x16_bf16 a[96:111], v[148:151], v[204:207], a[96:111]
    v_add_u32 v227, s36, v227
    v_add_u32 v228, s36, v228
    ds_read_b64_tr_b16 v[148:149], v233 offset:4096
    ds_read_b64_tr_b16 v[150:151], v233 offset:6144
    v_add_f32 v222, v208, v209
    v_cvt_pk_bf16_f32 v192, v208, v209
    v_exp_f32 v212, v164
    v_mfma_f32_32x32x16_bf16 a[112:127], v[156:159], v[204:207], a[112:127]
    v_add_u32 v229, s36, v229
    v_add_u32 v230, s36, v230
    ds_read_b64_tr_b16 v[156:157], v234 offset:4096
    ds_read_b64_tr_b16 v[158:159], v234 offset:6144
    v_add_f32 v222, v222, v210
    v_exp_f32 v213, v165
    s_waitcnt lgkmcnt(15)
    v_mfma_f32_32x32x16_bf16 v[176:191], v[96:99], v[0:3], v[32:47]
    ds_read_b128 v[96:99], v223 offset:0
    v_add_f32 v222, v222, v211
    v_cvt_pk_bf16_f32 v193, v210, v211
    v_exp_f32 v214, v166
    v_add_f32 v222, v222, v212
    v_mfma_f32_32x32x16_bf16 v[176:191], v[100:103], v[4:7], v[176:191]
    ds_read_b128 v[100:103], v224 offset:0
    v_exp_f32 v215, v167
    v_add_f32 v222, v222, v213
    v_cvt_pk_bf16_f32 v194, v212, v213
    v_exp_f32 v208, v168
    v_mfma_f32_32x32x16_bf16 v[176:191], v[104:107], v[8:11], v[176:191]
    ds_read_b128 v[104:107], v225 offset:0
    v_add_f32 v222, v222, v214
    v_exp_f32 v209, v169
    v_add_f32 v222, v222, v215
    v_cvt_pk_bf16_f32 v195, v214, v215
    v_mfma_f32_32x32x16_bf16 v[176:191], v[108:111], v[12:15], v[176:191]
    ds_read_b128 v[108:111], v226 offset:0
    v_exp_f32 v210, v170
    v_add_f32 v222, v222, v208
    v_exp_f32 v211, v171
    v_add_f32 v222, v222, v209
    v_cvt_pk_bf16_f32 v196, v208, v209
    v_mfma_f32_32x32x16_bf16 v[176:191], v[112:115], v[16:19], v[176:191]
    ds_read_b128 v[112:115], v227 offset:0
    v_exp_f32 v212, v172
    v_add_f32 v222, v222, v210
    v_exp_f32 v213, v173
    s_waitcnt lgkmcnt(15)
    v_mfma_f32_32x32x16_bf16 v[176:191], v[116:119], v[20:23], v[176:191]
    ds_read_b128 v[116:119], v228 offset:0
    v_add_f32 v222, v222, v211
    v_exp_f32 v214, v174
    v_add_f32 v222, v222, v212
    v_exp_f32 v215, v175
    v_mfma_f32_32x32x16_bf16 v[176:191], v[120:123], v[24:27], v[176:191]
    ds_read_b128 v[120:123], v229 offset:0
    v_add_f32 v222, v222, v213
    v_add_f32 v222, v222, v214
    v_add_f32 v222, v222, v215
    v_subrev_u32 v253, s29, v222
    v_cmp_lt_u32 vcc, s22, v253
    v_cvt_pk_bf16_f32 v197, v210, v211
    v_mfma_f32_32x32x16_bf16 v[176:191], v[124:127], v[28:31], v[176:191]
    ds_read_b128 v[124:127], v230 offset:0
    v_cvt_pk_bf16_f32 v198, v212, v213
    v_cvt_pk_bf16_f32 v199, v214, v215
    s_cbranch_vccnz L_stub10
L_ret10:
    v_add_f32 v219, v219, v222
    v_mfma_f32_32x32x16_bf16 a[0:15], v[128:131], v[192:195], a[0:15]
    ds_read_b64_tr_b16 v[128:129], v231 offset:8192
    ds_read_b64_tr_b16 v[130:131], v231 offset:10240
    v_mfma_f32_32x32x16_bf16 a[16:31], v[136:139], v[192:195], a[16:31]
    ds_read_b64_tr_b16 v[136:137], v232 offset:8192
    ds_read_b64_tr_b16 v[138:139], v232 offset:10240
    v_mfma_f32_32x32x16_bf16 a[32:47], v[144:147], v[192:195], a[32:47]
    ds_read_b64_tr_b16 v[144:145], v233 offset:8192
    ds_read_b64_tr_b16 v[146:147], v233 offset:10240
    v_exp_f32 v208, v176
    v_exp_f32 v209, v177
    s_waitcnt lgkmcnt(14)
    v_mfma_f32_32x32x16_bf16 a[48:63], v[152:155], v[192:195], a[48:63]
    ds_read_b64_tr_b16 v[152:153], v234 offset:8192
    ds_read_b64_tr_b16 v[154:155], v234 offset:10240
    v_exp_f32 v210, v178
    v_exp_f32 v211, v179
    v_mfma_f32_32x32x16_bf16 a[0:15], v[132:135], v[196:199], a[0:15]
    ds_read_b64_tr_b16 v[132:133], v231 offset:12288
    ds_read_b64_tr_b16 v[134:135], v231 offset:14336
    v_add_f32 v222, v208, v209
    v_cvt_pk_bf16_f32 v200, v208, v209
    v_exp_f32 v212, v180
    v_mfma_f32_32x32x16_bf16 a[16:31], v[140:143], v[196:199], a[16:31]
    ds_read_b64_tr_b16 v[140:141], v232 offset:12288
    ds_read_b64_tr_b16 v[142:143], v232 offset:14336
    v_add_f32 v222, v222, v210
    v_exp_f32 v213, v181
    v_add_f32 v222, v222, v211
    v_mfma_f32_32x32x16_bf16 a[32:47], v[148:151], v[196:199], a[32:47]
    ds_read_b64_tr_b16 v[148:149], v233 offset:12288
    ds_read_b64_tr_b16 v[150:151], v233 offset:14336
    v_cvt_pk_bf16_f32 v201, v210, v211
    v_exp_f32 v214, v182
    v_add_f32 v222, v222, v212
    v_mfma_f32_32x32x16_bf16 a[48:63], v[156:159], v[196:199], a[48:63]
    ds_read_b64_tr_b16 v[156:157], v234 offset:12288
    ds_read_b64_tr_b16 v[158:159], v234 offset:14336
    v_exp_f32 v215, v183
    v_add_f32 v222, v222, v213
    v_cvt_pk_bf16_f32 v202, v212, v213
    s_waitcnt lgkmcnt(15)
    v_mfma_f32_32x32x16_bf16 v[160:175], v[96:99], v[0:3], v[32:47]
    ds_read_b128 v[96:99], v223 offset:8192
    v_exp_f32 v208, v184
    v_add_f32 v222, v222, v214
    v_exp_f32 v209, v185
    v_mfma_f32_32x32x16_bf16 v[160:175], v[100:103], v[4:7], v[160:175]
    ds_read_b128 v[100:103], v224 offset:8192
    v_add_f32 v222, v222, v215
    v_cvt_pk_bf16_f32 v203, v214, v215
    v_exp_f32 v210, v186
    v_mfma_f32_32x32x16_bf16 v[160:175], v[104:107], v[8:11], v[160:175]
    ds_read_b128 v[104:107], v225 offset:8192
    v_add_f32 v222, v222, v208
    v_exp_f32 v211, v187
    v_add_f32 v222, v222, v209
    v_cvt_pk_bf16_f32 v204, v208, v209
    v_mfma_f32_32x32x16_bf16 v[160:175], v[108:111], v[12:15], v[160:175]
    ds_read_b128 v[108:111], v226 offset:8192
    v_exp_f32 v212, v188
    v_add_f32 v222, v222, v210
    v_exp_f32 v213, v189
    v_mfma_f32_32x32x16_bf16 v[160:175], v[112:115], v[16:19], v[160:175]
    ds_read_b128 v[112:115], v227 offset:8192
    v_add_f32 v222, v222, v211
    v_exp_f32 v214, v190
    v_add_f32 v222, v222, v212
    v_mfma_f32_32x32x16_bf16 v[160:175], v[116:119], v[20:23], v[160:175]
    ds_read_b128 v[116:119], v228 offset:8192
    v_exp_f32 v215, v191
    v_add_f32 v222, v222, v213
    v_add_f32 v222, v222, v214
    v_add_f32 v222, v222, v215
    v_mfma_f32_32x32x16_bf16 v[160:175], v[120:123], v[24:27], v[160:175]
    ds_read_b128 v[120:123], v229 offset:8192
    v_subrev_u32 v253, s29, v222
    v_cmp_lt_u32 vcc, s22, v253
    v_cvt_pk_bf16_f32 v205, v210, v211
    v_cvt_pk_bf16_f32 v206, v212, v213
    v_mfma_f32_32x32x16_bf16 v[160:175], v[124:127], v[28:31], v[160:175]
    ds_read_b128 v[124:127], v230 offset:8192
    v_cvt_pk_bf16_f32 v207, v214, v215
    s_cbranch_vccnz L_stub11
L_ret11:
    v_add_f32 v219, v219, v222
    v_add_u32 v231, s36, v231
    v_add_u32 v232, s36, v232
    v_add_u32 v233, s36, v233
    v_add_u32 v234, s36, v234
    s_waitcnt lgkmcnt(8)
    v_mfma_f32_32x32x16_bf16 a[0:15], v[128:131], v[200:203], a[0:15]
    ds_read_b64_tr_b16 v[128:129], v231 offset:0
    ds_read_b64_tr_b16 v[130:131], v231 offset:2048
    v_mfma_f32_32x32x16_bf16 a[16:31], v[136:139], v[200:203], a[16:31]
    ds_read_b64_tr_b16 v[136:137], v232 offset:0
    ds_read_b64_tr_b16 v[138:139], v232 offset:2048
    v_mfma_f32_32x32x16_bf16 a[32:47], v[144:147], v[200:203], a[32:47]
    ds_read_b64_tr_b16 v[144:145], v233 offset:0
    ds_read_b64_tr_b16 v[146:147], v233 offset:2048
    v_exp_f32 v208, v160
    v_exp_f32 v209, v161
    v_mfma_f32_32x32x16_bf16 a[48:63], v[152:155], v[200:203], a[48:63]
    ds_read_b64_tr_b16 v[152:153], v234 offset:0
    ds_read_b64_tr_b16 v[154:155], v234 offset:2048
    v_exp_f32 v210, v162
    v_exp_f32 v211, v163
    v_add_f32 v222, v208, v209
    v_mfma_f32_32x32x16_bf16 a[0:15], v[132:135], v[204:207], a[0:15]
    v_add_u32 v223, s101, v223
    v_add_u32 v224, s101, v224
    ds_read_b64_tr_b16 v[132:133], v231 offset:4096
    ds_read_b64_tr_b16 v[134:135], v231 offset:6144
    v_cvt_pk_bf16_f32 v192, v208, v209
    v_exp_f32 v212, v164
    v_mfma_f32_32x32x16_bf16 a[16:31], v[140:143], v[204:207], a[16:31]
    v_add_u32 v225, s101, v225
    v_add_u32 v226, s101, v226
    ds_read_b64_tr_b16 v[140:141], v232 offset:4096
    ds_read_b64_tr_b16 v[142:143], v232 offset:6144
    v_add_f32 v222, v222, v210
    v_exp_f32 v213, v165
    v_mfma_f32_32x32x16_bf16 a[32:47], v[148:151], v[204:207], a[32:47]
    v_add_u32 v227, s101, v227
    v_add_u32 v228, s101, v228
    ds_read_b64_tr_b16 v[148:149], v233 offset:4096
    ds_read_b64_tr_b16 v[150:151], v233 offset:6144
    v_add_f32 v222, v222, v211
    v_cvt_pk_bf16_f32 v193, v210, v211
    v_mfma_f32_32x32x16_bf16 a[48:63], v[156:159], v[204:207], a[48:63]
    v_add_u32 v229, s101, v229
    v_add_u32 v230, s101, v230
    ds_read_b64_tr_b16 v[156:157], v234 offset:4096
    ds_read_b64_tr_b16 v[158:159], v234 offset:6144
    v_exp_f32 v214, v166
    v_add_f32 v222, v222, v212
    s_waitcnt lgkmcnt(15)
    v_mfma_f32_32x32x16_bf16 v[176:191], v[96:99], v[0:3], v[32:47]
    ds_read_b128 v[96:99], v223 offset:0
    v_exp_f32 v215, v167
    v_add_f32 v222, v222, v213
    v_cvt_pk_bf16_f32 v194, v212, v213
    v_exp_f32 v208, v168
    v_mfma_f32_32x32x16_bf16 v[176:191], v[100:103], v[4:7], v[176:191]
    ds_read_b128 v[100:103], v224 offset:0
    v_add_f32 v222, v222, v214
    v_exp_f32 v209, v169
    v_add_f32 v222, v222, v215
    v_mfma_f32_32x32x16_bf16 v[176:191], v[104:107], v[8:11], v[176:191]
    ds_read_b128 v[104:107], v225 offset:0
    v_cvt_pk_bf16_f32 v195, v214, v215
    v_exp_f32 v210, v170
    v_add_f32 v222, v222, v208
    v_exp_f32 v211, v171
    v_mfma_f32_32x32x16_bf16 v[176:191], v[108:111], v[12:15], v[176:191]
    ds_read_b128 v[108:111], v226 offset:0
    v_add_f32 v222, v222, v209
    v_cvt_pk_bf16_f32 v196, v208, v209
    v_exp_f32 v212, v172
    v_mfma_f32_32x32x16_bf16 v[176:191], v[112:115], v[16:19], v[176:191]
    ds_read_b128 v[112:115], v227 offset:0
    v_add_f32 v222, v222, v210
    v_exp_f32 v213, v173
    v_add_f32 v222, v222, v211
    v_exp_f32 v214, v174
    v_mfma_f32_32x32x16_bf16 v[176:191], v[116:119], v[20:23], v[176:191]
    ds_read_b128 v[116:119], v228 offset:0
    v_add_f32 v222, v222, v212
    v_exp_f32 v215, v175
    v_add_f32 v222, v222, v213
    v_add_f32 v222, v222, v214
    v_mfma_f32_32x32x16_bf16 v[176:191], v[120:123], v[24:27], v[176:191]
    ds_read_b128 v[120:123], v229 offset:0
    v_add_f32 v222, v222, v215
    v_subrev_u32 v253, s29, v222
    v_cmp_lt_u32 vcc, s22, v253
    v_cvt_pk_bf16_f32 v197, v210, v211
    v_cvt_pk_bf16_f32 v198, v212, v213
    v_mfma_f32_32x32x16_bf16 v[176:191], v[124:127], v[28:31], v[176:191]
    ds_read_b128 v[124:127], v230 offset:0
    v_cvt_pk_bf16_f32 v199, v214, v215
    s_cbranch_vccnz L_stub12
L_ret12:
    v_add_f32 v219, v219, v222
    s_waitcnt lgkmcnt(8)
    v_mfma_f32_32x32x16_bf16 a[0:15], v[128:131], v[192:195], a[0:15]
    ds_read_b64_tr_b16 v[128:129], v231 offset:8192
    ds_read_b64_tr_b16 v[130:131], v231 offset:10240
    v_mfma_f32_32x32x16_bf16 a[16:31], v[136:139], v[192:195], a[16:31]
    ds_read_b64_tr_b16 v[136:137], v232 offset:8192
    ds_read_b64_tr_b16 v[138:139], v232 offset:10240
    v_mfma_f32_32x32x16_bf16 a[32:47], v[144:147], v[192:195], a[32:47]
    ds_read_b64_tr_b16 v[144:145], v233 offset:8192
    ds_read_b64_tr_b16 v[146:147], v233 offset:10240
    v_exp_f32 v208, v176
    v_exp_f32 v209, v177
    v_mfma_f32_32x32x16_bf16 a[48:63], v[152:155], v[192:195], a[48:63]
    ds_read_b64_tr_b16 v[152:153], v234 offset:8192
    ds_read_b64_tr_b16 v[154:155], v234 offset:10240
    v_exp_f32 v210, v178
    v_mfma_f32_32x32x16_bf16 a[0:15], v[132:135], v[196:199], a[0:15]
    ds_read_b64_tr_b16 v[132:133], v231 offset:12288
    ds_read_b64_tr_b16 v[134:135], v231 offset:14336
    v_exp_f32 v211, v179
    v_add_f32 v222, v208, v209
    v_cvt_pk_bf16_f32 v200, v208, v209
    v_mfma_f32_32x32x16_bf16 a[16:31], v[140:143], v[196:199], a[16:31]
    ds_read_b64_tr_b16 v[140:141], v232 offset:12288
    ds_read_b64_tr_b16 v[142:143], v232 offset:14336
    v_exp_f32 v212, v180
    v_add_f32 v222, v222, v210
    v_mfma_f32_32x32x16_bf16 a[32:47], v[148:151], v[196:199], a[32:47]
    ds_read_b64_tr_b16 v[148:149], v233 offset:12288
    ds_read_b64_tr_b16 v[150:151], v233 offset:14336
    v_exp_f32 v213, v181
    v_add_f32 v222, v222, v211
    v_mfma_f32_32x32x16_bf16 a[48:63], v[156:159], v[196:199], a[48:63]
    ds_read_b64_tr_b16 v[156:157], v234 offset:12288
    ds_read_b64_tr_b16 v[158:159], v234 offset:14336
    v_cvt_pk_bf16_f32 v201, v210, v211
    v_exp_f32 v214, v182
    s_waitcnt lgkmcnt(15)
    v_mfma_f32_32x32x16_bf16 v[160:175], v[96:99], a[192:195], v[48:63]
    v_add_f32 v222, v222, v212
    v_exp_f32 v215, v183
    v_add_f32 v222, v222, v213
    v_cvt_pk_bf16_f32 v202, v212, v213
    v_mfma_f32_32x32x16_bf16 v[160:175], v[100:103], a[196:199], v[160:175]
    v_exp_f32 v208, v184
    v_add_f32 v222, v222, v214
    v_exp_f32 v209, v185
    v_add_f32 v222, v222, v215
    v_mfma_f32_32x32x16_bf16 v[160:175], v[104:107], a[200:203], v[160:175]
    v_cvt_pk_bf16_f32 v203, v214, v215
    v_exp_f32 v210, v186
    v_add_f32 v222, v222, v208
    v_mfma_f32_32x32x16_bf16 v[160:175], v[108:111], a[204:207], v[160:175]
    v_exp_f32 v211, v187
    v_add_f32 v222, v222, v209
    v_cvt_pk_bf16_f32 v204, v208, v209
    v_exp_f32 v212, v188
    v_mfma_f32_32x32x16_bf16 v[160:175], v[112:115], a[208:211], v[160:175]
    v_add_f32 v222, v222, v210
    v_exp_f32 v213, v189
    v_add_f32 v222, v222, v211
    v_exp_f32 v214, v190
    v_mfma_f32_32x32x16_bf16 v[160:175], v[116:119], a[212:215], v[160:175]
    v_add_f32 v222, v222, v212
    v_exp_f32 v215, v191
    v_add_f32 v222, v222, v213
    v_add_f32 v222, v222, v214
    v_mfma_f32_32x32x16_bf16 v[160:175], v[120:123], a[216:219], v[160:175]
    v_add_f32 v222, v222, v215
    v_subrev_u32 v253, s29, v222
    v_cmp_lt_u32 vcc, s22, v253
    v_cvt_pk_bf16_f32 v205, v210, v211
    v_cvt_pk_bf16_f32 v206, v212, v213
    v_mfma_f32_32x32x16_bf16 v[160:175], v[124:127], a[220:223], v[160:175]
    v_cvt_pk_bf16_f32 v207, v214, v215
    s_cbranch_vccnz L_stub13
L_ret13:
    v_add_f32 v219, v219, v222
    v_add_u32 v231, s101, v231
    v_add_u32 v232, s101, v232
    v_add_u32 v233, s101, v233
    v_add_u32 v234, s101, v234
    s_waitcnt lgkmcnt(0)
    v_mfma_f32_32x32x16_bf16 a[0:15], v[128:131], v[200:203], a[0:15]
    ds_read_b64_tr_b16 v[128:129], v231 offset:0
    ds_read_b64_tr_b16 v[130:131], v231 offset:2048
    v_mfma_f32_32x32x16_bf16 a[16:31], v[136:139], v[200:203], a[16:31]
    ds_read_b64_tr_b16 v[136:137], v232 offset:0
    ds_read_b64_tr_b16 v[138:139], v232 offset:2048
    v_mfma_f32_32x32x16_bf16 a[32:47], v[144:147], v[200:203], a[32:47]
    ds_read_b64_tr_b16 v[144:145], v233 offset:0
    ds_read_b64_tr_b16 v[146:147], v233 offset:2048
    v_exp_f32 v208, v160
    v_exp_f32 v209, v161
    v_mfma_f32_32x32x16_bf16 a[48:63], v[152:155], v[200:203], a[48:63]
    ds_read_b64_tr_b16 v[152:153], v234 offset:0
    ds_read_b64_tr_b16 v[154:155], v234 offset:2048
    v_exp_f32 v210, v162
    v_exp_f32 v211, v163
    v_add_f32 v222, v208, v209
    v_mfma_f32_32x32x16_bf16 a[0:15], v[132:135], v[204:207], a[0:15]
    ds_read_b64_tr_b16 v[132:133], v231 offset:4096
    ds_read_b64_tr_b16 v[134:135], v231 offset:6144
    v_cvt_pk_bf16_f32 v192, v208, v209
    v_exp_f32 v212, v164
    v_add_f32 v222, v222, v210
    v_mfma_f32_32x32x16_bf16 a[16:31], v[140:143], v[204:207], a[16:31]
    ds_read_b64_tr_b16 v[140:141], v232 offset:4096
    ds_read_b64_tr_b16 v[142:143], v232 offset:6144
    v_exp_f32 v213, v165
    v_add_f32 v222, v222, v211
    v_cvt_pk_bf16_f32 v193, v210, v211
    v_mfma_f32_32x32x16_bf16 a[32:47], v[148:151], v[204:207], a[32:47]
    ds_read_b64_tr_b16 v[148:149], v233 offset:4096
    ds_read_b64_tr_b16 v[150:151], v233 offset:6144
    v_exp_f32 v214, v166
    v_add_f32 v222, v222, v212
    v_exp_f32 v215, v167
    v_mfma_f32_32x32x16_bf16 a[48:63], v[156:159], v[204:207], a[48:63]
    ds_read_b64_tr_b16 v[156:157], v234 offset:4096
    ds_read_b64_tr_b16 v[158:159], v234 offset:6144
    v_add_f32 v222, v222, v213
    v_cvt_pk_bf16_f32 v194, v212, v213
    v_exp_f32 v208, v168
    s_sub_u32 s45, s62, s55
    v_add_u32 v251, s45, v240
    v_xor_b32 v24, 0, v241
    v_lshl_add_u32 v24, v24, 4, v251
    v_xor_b32 v25, 2, v241
    v_lshl_add_u32 v25, v25, 4, v251
    v_xor_b32 v26, 4, v241
    v_lshl_add_u32 v26, v26, 4, v251
    v_xor_b32 v27, 6, v241
    v_lshl_add_u32 v27, v27, 4, v251
    v_xor_b32 v28, 8, v241
    v_lshl_add_u32 v28, v28, 4, v251
    v_xor_b32 v29, 10, v241
    v_lshl_add_u32 v29, v29, 4, v251
    v_xor_b32 v30, 12, v241
    v_lshl_add_u32 v30, v30, 4, v251
    v_xor_b32 v31, 14, v241
    v_lshl_add_u32 v31, v31, 4, v251
    v_mov_b32 v242, v219
    v_mov_b32 v243, v219
    s_nop 1
    v_permlane32_swap_b32 v242, v243
    s_nop 1
    v_add_f32 v244, v242, v243
    v_rcp_f32 v244, v244
    s_nop 0
    v_mov_b32 v245, v244
    v_accvgpr_read_b32 v0, a0
    v_accvgpr_read_b32 v1, a1
    v_accvgpr_read_b32 v2, a2
    v_accvgpr_read_b32 v3, a3
    v_accvgpr_read_b32 v4, a4
    v_accvgpr_read_b32 v5, a5
    v_accvgpr_read_b32 v6, a6
    v_accvgpr_read_b32 v7, a7
    v_pk_mul_f32 v[0:1], v[0:1], v[244:245]
    v_pk_mul_f32 v[2:3], v[2:3], v[244:245]
    v_pk_mul_f32 v[4:5], v[4:5], v[244:245]
    v_pk_mul_f32 v[6:7], v[6:7], v[244:245]
    v_cvt_pk_bf16_f32 v8, v0, v1
    v_cvt_pk_bf16_f32 v9, v2, v3
    v_cvt_pk_bf16_f32 v10, v4, v5
    v_cvt_pk_bf16_f32 v11, v6, v7
    s_nop 0
    v_permlane32_swap_b32 v8, v10
    v_permlane32_swap_b32 v9, v11
    ds_write_b128 v24, v[8:11] offset:0
    v_accvgpr_read_b32 v12, a8
    v_accvgpr_read_b32 v13, a9
    v_accvgpr_read_b32 v14, a10
    v_accvgpr_read_b32 v15, a11
    v_accvgpr_read_b32 v16, a12
    v_accvgpr_read_b32 v17, a13
    v_accvgpr_read_b32 v18, a14
    v_accvgpr_read_b32 v19, a15
    v_pk_mul_f32 v[12:13], v[12:13], v[244:245]
    v_pk_mul_f32 v[14:15], v[14:15], v[244:245]
    v_pk_mul_f32 v[16:17], v[16:17], v[244:245]
    v_pk_mul_f32 v[18:19], v[18:19], v[244:245]
    v_cvt_pk_bf16_f32 v20, v12, v13
    v_cvt_pk_bf16_f32 v21, v14, v15
    v_cvt_pk_bf16_f32 v22, v16, v17
    v_cvt_pk_bf16_f32 v23, v18, v19
    s_nop 0
    v_permlane32_swap_b32 v20, v22
    v_permlane32_swap_b32 v21, v23
    ds_write_b128 v25, v[20:23] offset:0
    v_accvgpr_read_b32 v0, a16
    v_accvgpr_read_b32 v1, a17
    v_accvgpr_read_b32 v2, a18
    v_accvgpr_read_b32 v3, a19
    v_accvgpr_read_b32 v4, a20
    v_accvgpr_read_b32 v5, a21
    v_accvgpr_read_b32 v6, a22
    v_accvgpr_read_b32 v7, a23
    v_pk_mul_f32 v[0:1], v[0:1], v[244:245]
    v_pk_mul_f32 v[2:3], v[2:3], v[244:245]
    v_pk_mul_f32 v[4:5], v[4:5], v[244:245]
    v_pk_mul_f32 v[6:7], v[6:7], v[244:245]
    v_cvt_pk_bf16_f32 v8, v0, v1
    v_cvt_pk_bf16_f32 v9, v2, v3
    v_cvt_pk_bf16_f32 v10, v4, v5
    v_cvt_pk_bf16_f32 v11, v6, v7
    s_nop 0
    v_permlane32_swap_b32 v8, v10
    v_permlane32_swap_b32 v9, v11
    ds_write_b128 v26, v[8:11] offset:0
    v_accvgpr_read_b32 v12, a24
    v_accvgpr_read_b32 v13, a25
    v_accvgpr_read_b32 v14, a26
    v_accvgpr_read_b32 v15, a27
    v_accvgpr_read_b32 v16, a28
    v_accvgpr_read_b32 v17, a29
    v_accvgpr_read_b32 v18, a30
    v_accvgpr_read_b32 v19, a31
    v_pk_mul_f32 v[12:13], v[12:13], v[244:245]
    v_pk_mul_f32 v[14:15], v[14:15], v[244:245]
    v_pk_mul_f32 v[16:17], v[16:17], v[244:245]
    v_pk_mul_f32 v[18:19], v[18:19], v[244:245]
    v_cvt_pk_bf16_f32 v20, v12, v13
    v_cvt_pk_bf16_f32 v21, v14, v15
    v_cvt_pk_bf16_f32 v22, v16, v17
    v_cvt_pk_bf16_f32 v23, v18, v19
    s_nop 0
    v_permlane32_swap_b32 v20, v22
    v_permlane32_swap_b32 v21, v23
    ds_write_b128 v27, v[20:23] offset:0
    v_accvgpr_read_b32 v0, a32
    v_accvgpr_read_b32 v1, a33
    v_accvgpr_read_b32 v2, a34
    v_accvgpr_read_b32 v3, a35
    v_accvgpr_read_b32 v4, a36
    v_accvgpr_read_b32 v5, a37
    v_accvgpr_read_b32 v6, a38
    v_accvgpr_read_b32 v7, a39
    v_pk_mul_f32 v[0:1], v[0:1], v[244:245]
    v_pk_mul_f32 v[2:3], v[2:3], v[244:245]
    v_pk_mul_f32 v[4:5], v[4:5], v[244:245]
    v_pk_mul_f32 v[6:7], v[6:7], v[244:245]
    v_cvt_pk_bf16_f32 v8, v0, v1
    v_cvt_pk_bf16_f32 v9, v2, v3
    v_cvt_pk_bf16_f32 v10, v4, v5
    v_cvt_pk_bf16_f32 v11, v6, v7
    s_nop 0
    v_permlane32_swap_b32 v8, v10
    v_permlane32_swap_b32 v9, v11
    ds_write_b128 v28, v[8:11] offset:0
    v_accvgpr_read_b32 v12, a40
    v_accvgpr_read_b32 v13, a41
    v_accvgpr_read_b32 v14, a42
    v_accvgpr_read_b32 v15, a43
    v_accvgpr_read_b32 v16, a44
    v_accvgpr_read_b32 v17, a45
    v_accvgpr_read_b32 v18, a46
    v_accvgpr_read_b32 v19, a47
    v_pk_mul_f32 v[12:13], v[12:13], v[244:245]
    v_pk_mul_f32 v[14:15], v[14:15], v[244:245]
    v_pk_mul_f32 v[16:17], v[16:17], v[244:245]
    v_pk_mul_f32 v[18:19], v[18:19], v[244:245]
    v_cvt_pk_bf16_f32 v20, v12, v13
    v_cvt_pk_bf16_f32 v21, v14, v15
    v_cvt_pk_bf16_f32 v22, v16, v17
    v_cvt_pk_bf16_f32 v23, v18, v19
    s_nop 0
    v_permlane32_swap_b32 v20, v22
    v_permlane32_swap_b32 v21, v23
    ds_write_b128 v29, v[20:23] offset:0
    v_accvgpr_read_b32 v0, a48
    v_accvgpr_read_b32 v1, a49
    v_accvgpr_read_b32 v2, a50
    v_accvgpr_read_b32 v3, a51
    v_accvgpr_read_b32 v4, a52
    v_accvgpr_read_b32 v5, a53
    v_accvgpr_read_b32 v6, a54
    v_accvgpr_read_b32 v7, a55
    v_pk_mul_f32 v[0:1], v[0:1], v[244:245]
    v_pk_mul_f32 v[2:3], v[2:3], v[244:245]
    v_pk_mul_f32 v[4:5], v[4:5], v[244:245]
    v_pk_mul_f32 v[6:7], v[6:7], v[244:245]
    v_cvt_pk_bf16_f32 v8, v0, v1
    v_cvt_pk_bf16_f32 v9, v2, v3
    v_cvt_pk_bf16_f32 v10, v4, v5
    v_cvt_pk_bf16_f32 v11, v6, v7
    s_nop 0
    v_permlane32_swap_b32 v8, v10
    v_permlane32_swap_b32 v9, v11
    ds_write_b128 v30, v[8:11] offset:0
    v_accvgpr_read_b32 v12, a56
    v_accvgpr_read_b32 v13, a57
    v_accvgpr_read_b32 v14, a58
    v_accvgpr_read_b32 v15, a59
    v_accvgpr_read_b32 v16, a60
    v_accvgpr_read_b32 v17, a61
    v_accvgpr_read_b32 v18, a62
    v_accvgpr_read_b32 v19, a63
    v_pk_mul_f32 v[12:13], v[12:13], v[244:245]
    v_pk_mul_f32 v[14:15], v[14:15], v[244:245]
    v_pk_mul_f32 v[16:17], v[16:17], v[244:245]
    v_pk_mul_f32 v[18:19], v[18:19], v[244:245]
    v_cvt_pk_bf16_f32 v20, v12, v13
    v_cvt_pk_bf16_f32 v21, v14, v15
    v_cvt_pk_bf16_f32 v22, v16, v17
    v_cvt_pk_bf16_f32 v23, v18, v19
    s_nop 0
    v_permlane32_swap_b32 v20, v22
    v_permlane32_swap_b32 v21, v23
    ds_write_b128 v31, v[20:23] offset:0
    v_add_u32 v250, s62, v255
    s_waitcnt lgkmcnt(0)
    ds_read_b128 v[0:3], v250 offset:0
    ds_read_b128 v[4:7], v250 offset:1024
    ds_read_b128 v[8:11], v250 offset:2048
    ds_read_b128 v[12:15], v250 offset:3072
    ds_read_b128 v[16:19], v250 offset:16384
    ds_read_b128 v[20:23], v250 offset:17408
    ds_read_b128 v[24:27], v250 offset:18432
    ds_read_b128 v[28:31], v250 offset:19456
    s_mov_b32 s96, s37
    s_add_u32 s97, s37, 4096
    v_mfma_f32_32x32x16_bf16 v[176:191], v[96:99], a[224:227], v[64:79]
    ds_read_b128 v[96:99], v223 offset:8192
    v_add_f32 v222, v222, v214
    v_exp_f32 v209, v169
    v_add_f32 v222, v222, v215
    v_cvt_pk_bf16_f32 v195, v214, v215
    v_mfma_f32_32x32x16_bf16 v[176:191], v[100:103], a[228:231], v[176:191]
    ds_read_b128 v[100:103], v224 offset:8192
    v_exp_f32 v210, v170
    v_add_f32 v222, v222, v208
    v_exp_f32 v211, v171
    v_mfma_f32_32x32x16_bf16 v[176:191], v[104:107], a[232:235], v[176:191]
    ds_read_b128 v[104:107], v225 offset:8192
    v_add_f32 v222, v222, v209
    v_cvt_pk_bf16_f32 v196, v208, v209
    v_exp_f32 v212, v172
    v_mfma_f32_32x32x16_bf16 v[176:191], v[108:111], a[236:239], v[176:191]
    ds_read_b128 v[108:111], v226 offset:8192
    s_waitcnt lgkmcnt(11)
    buffer_store_dwordx4 v[0:3], v235, s[24:27], s96 offen offset:0 sc1 nt
    v_add_f32 v222, v222, v210
    v_exp_f32 v213, v173
    v_mfma_f32_32x32x16_bf16 v[176:191], v[112:115], a[240:243], v[176:191]
    ds_read_b128 v[112:115], v227 offset:8192
    v_add_f32 v222, v222, v211
    v_exp_f32 v214, v174
    v_add_f32 v222, v222, v212
    v_exp_f32 v215, v175
    v_mfma_f32_32x32x16_bf16 v[176:191], v[116:119], a[244:247], v[176:191]
    ds_read_b128 v[116:119], v228 offset:8192
    v_add_f32 v222, v222, v213
    v_add_f32 v222, v222, v214
    v_add_f32 v222, v222, v215
    v_subrev_u32 v253, s29, v222
    v_mfma_f32_32x32x16_bf16 v[176:191], v[120:123], a[248:251], v[176:191]
    ds_read_b128 v[120:123], v229 offset:8192
    s_waitcnt lgkmcnt(13)
    buffer_store_dwordx4 v[4:7], v236, s[24:27], s96 offen offset:1024 sc1 nt
    v_cmp_lt_u32 vcc, s22, v253
    v_cvt_pk_bf16_f32 v197, v210, v211
    v_cvt_pk_bf16_f32 v198, v212, v213
    v_mfma_f32_32x32x16_bf16 v[176:191], v[124:127], a[252:255], v[176:191]
    ds_read_b128 v[124:127], v230 offset:8192
    v_cvt_pk_bf16_f32 v199, v214, v215
    s_cbranch_vccnz L_stub14
L_ret14:
    v_add_f32 v220, v220, v222
    v_mfma_f32_32x32x16_bf16 a[64:79], v[128:131], v[192:195], a[64:79]
    s_waitcnt lgkmcnt(13)
    buffer_store_dwordx4 v[8:11], v237, s[24:27], s96 offen offset:2048 sc1 nt
    v_mfma_f32_32x32x16_bf16 a[80:95], v[136:139], v[192:195], a[80:95]
    s_waitcnt lgkmcnt(12)
    buffer_store_dwordx4 v[12:15], v238, s[24:27], s96 offen offset:3072 sc1 nt
    v_mfma_f32_32x32x16_bf16 a[96:111], v[144:147], v[192:195], a[96:111]
    s_nop 0
    v_exp_f32 v208, v176
    v_exp_f32 v209, v177
    v_exp_f32 v210, v178
    v_mfma_f32_32x32x16_bf16 a[112:127], v[152:155], v[192:195], a[112:127]
    v_exp_f32 v211, v179
    v_add_f32 v222, v208, v209
    v_cvt_pk_bf16_f32 v200, v208, v209
    v_exp_f32 v212, v180
    v_mfma_f32_32x32x16_bf16 a[64:79], v[132:135], v[196:199], a[64:79]
    v_add_u32 v223, s36, v223
    v_add_u32 v224, s36, v224
    v_add_f32 v222, v222, v210
    v_exp_f32 v213, v181
    v_add_f32 v222, v222, v211
    v_mfma_f32_32x32x16_bf16 a[80:95], v[140:143], v[196:199], a[80:95]
    v_add_u32 v225, s36, v225
    v_add_u32 v226, s36, v226
    v_cvt_pk_bf16_f32 v201, v210, v211
    v_exp_f32 v214, v182
    v_add_f32 v222, v222, v212
    v_mfma_f32_32x32x16_bf16 a[96:111], v[148:151], v[196:199], a[96:111]
    v_add_u32 v227, s36, v227
    v_add_u32 v228, s36, v228
    v_exp_f32 v215, v183
    v_add_f32 v222, v222, v213
    v_cvt_pk_bf16_f32 v202, v212, v213
    v_mfma_f32_32x32x16_bf16 a[112:127], v[156:159], v[196:199], a[112:127]
    v_add_u32 v229, s36, v229
    v_add_u32 v230, s36, v230
    v_exp_f32 v208, v184
    v_add_f32 v222, v222, v214
    v_exp_f32 v209, v185
    s_waitcnt lgkmcnt(0)
    v_mfma_f32_32x32x16_bf16 v[160:175], v[96:99], a[192:195], v[48:63]
    ds_read_b128 v[96:99], v223 offset:0
    v_add_f32 v222, v222, v215
    v_cvt_pk_bf16_f32 v203, v214, v215
    v_exp_f32 v210, v186
    v_mfma_f32_32x32x16_bf16 v[160:175], v[100:103], a[196:199], v[160:175]
    ds_read_b128 v[100:103], v224 offset:0
    v_add_f32 v222, v222, v208
    v_exp_f32 v211, v187
    v_add_f32 v222, v222, v209
    v_mfma_f32_32x32x16_bf16 v[160:175], v[104:107], a[200:203], v[160:175]
    ds_read_b128 v[104:107], v225 offset:0
    v_cvt_pk_bf16_f32 v204, v208, v209
    v_exp_f32 v212, v188
    v_add_f32 v222, v222, v210
    v_mfma_f32_32x32x16_bf16 v[160:175], v[108:111], a[204:207], v[160:175]
    ds_read_b128 v[108:111], v226 offset:0
    buffer_store_dwordx4 v[16:19], v239, s[24:27], s97 offen offset:0 sc1 nt
    v_exp_f32 v213, v189
    v_add_f32 v222, v222, v211
    v_mfma_f32_32x32x16_bf16 v[160:175], v[112:115], a[208:211], v[160:175]
    ds_read_b128 v[112:115], v227 offset:0
    v_exp_f32 v214, v190
    v_add_f32 v222, v222, v212
    v_exp_f32 v215, v191
    v_mfma_f32_32x32x16_bf16 v[160:175], v[116:119], a[212:215], v[160:175]
    ds_read_b128 v[116:119], v228 offset:0
    v_add_f32 v222, v222, v213
    v_add_f32 v222, v222, v214
    v_add_f32 v222, v222, v215
    v_subrev_u32 v253, s29, v222
    v_cmp_lt_u32 vcc, s22, v253
    v_mfma_f32_32x32x16_bf16 v[160:175], v[120:123], a[216:219], v[160:175]
    ds_read_b128 v[120:123], v229 offset:0
    buffer_store_dwordx4 v[20:23], v239, s[24:27], s97 offen offset:1024 sc1 nt
    v_cvt_pk_bf16_f32 v205, v210, v211
    v_cvt_pk_bf16_f32 v206, v212, v213
    v_mfma_f32_32x32x16_bf16 v[160:175], v[124:127], a[220:223], v[160:175]
    ds_read_b128 v[124:127], v230 offset:0
    v_cvt_pk_bf16_f32 v207, v214, v215
    s_cbranch_vccnz L_stub15
L_ret15:
    v_add_f32 v221, v221, v222
    v_mfma_f32_32x32x16_bf16 a[128:143], v[128:131], v[200:203], a[128:143]
    ds_read_b64_tr_b16 v[128:129], v231 offset:8192
    ds_read_b64_tr_b16 v[130:131], v231 offset:10240
    buffer_store_dwordx4 v[24:27], v239, s[24:27], s97 offen offset:2048 sc1 nt
    v_mfma_f32_32x32x16_bf16 a[144:159], v[136:139], v[200:203], a[144:159]
    ds_read_b64_tr_b16 v[136:137], v232 offset:8192
    ds_read_b64_tr_b16 v[138:139], v232 offset:10240
    buffer_store_dwordx4 v[28:31], v239, s[24:27], s97 offen offset:3072 sc1 nt
    v_mfma_f32_32x32x16_bf16 a[160:175], v[144:147], v[200:203], a[160:175]
    ds_read_b64_tr_b16 v[144:145], v233 offset:8192
    ds_read_b64_tr_b16 v[146:147], v233 offset:10240
    v_exp_f32 v208, v160
    v_exp_f32 v209, v161
    v_mfma_f32_32x32x16_bf16 a[176:191], v[152:155], v[200:203], a[176:191]
    ds_read_b64_tr_b16 v[152:153], v234 offset:8192
    ds_read_b64_tr_b16 v[154:155], v234 offset:10240
    v_exp_f32 v210, v162
    v_mfma_f32_32x32x16_bf16 a[128:143], v[132:135], v[204:207], a[128:143]
    ds_read_b64_tr_b16 v[132:133], v231 offset:12288
    ds_read_b64_tr_b16 v[134:135], v231 offset:14336
    v_exp_f32 v211, v163
    v_add_f32 v222, v208, v209
    v_cvt_pk_bf16_f32 v192, v208, v209
    v_mfma_f32_32x32x16_bf16 a[144:159], v[140:143], v[204:207], a[144:159]
    ds_read_b64_tr_b16 v[140:141], v232 offset:12288
    ds_read_b64_tr_b16 v[142:143], v232 offset:14336
    v_exp_f32 v212, v164
    v_add_f32 v222, v222, v210
    v_mfma_f32_32x32x16_bf16 a[160:175], v[148:151], v[204:207], a[160:175]
    ds_read_b64_tr_b16 v[148:149], v233 offset:12288
    ds_read_b64_tr_b16 v[150:151], v233 offset:14336
    v_exp_f32 v213, v165
    v_add_f32 v222, v222, v211
    v_mfma_f32_32x32x16_bf16 a[176:191], v[156:159], v[204:207], a[176:191]
    ds_read_b64_tr_b16 v[156:157], v234 offset:12288
    ds_read_b64_tr_b16 v[158:159], v234 offset:14336
    v_cvt_pk_bf16_f32 v193, v210, v211
    v_exp_f32 v214, v166
    s_waitcnt lgkmcnt(15)
    v_mfma_f32_32x32x16_bf16 v[176:191], v[96:99], a[192:195], v[48:63]
    v_add_f32 v222, v222, v212
    v_exp_f32 v215, v167
    v_add_f32 v222, v222, v213
    v_cvt_pk_bf16_f32 v194, v212, v213
    v_mfma_f32_32x32x16_bf16 v[176:191], v[100:103], a[196:199], v[176:191]
    v_exp_f32 v208, v168
    v_add_f32 v222, v222, v214
    v_exp_f32 v209, v169
    v_add_f32 v222, v222, v215
    v_mfma_f32_32x32x16_bf16 v[176:191], v[104:107], a[200:203], v[176:191]
    v_cvt_pk_bf16_f32 v195, v214, v215
    v_exp_f32 v210, v170
    v_add_f32 v222, v222, v208
    v_mfma_f32_32x32x16_bf16 v[176:191], v[108:111], a[204:207], v[176:191]
    v_exp_f32 v211, v171
    v_add_f32 v222, v222, v209
    v_cvt_pk_bf16_f32 v196, v208, v209
    v_exp_f32 v212, v172
    v_mfma_f32_32x32x16_bf16 v[176:191], v[112:115], a[208:211], v[176:191]
    v_add_f32 v222, v222, v210
    v_exp_f32 v213, v173
    v_add_f32 v222, v222, v211
    v_exp_f32 v214, v174
    v_mfma_f32_32x32x16_bf16 v[176:191], v[116:119], a[212:215], v[176:191]
    v_add_f32 v222, v222, v212
    v_exp_f32 v215, v175
    v_add_f32 v222, v222, v213
    v_add_f32 v222, v222, v214
    v_mfma_f32_32x32x16_bf16 v[176:191], v[120:123], a[216:219], v[176:191]
    v_add_f32 v222, v222, v215
    v_subrev_u32 v253, s29, v222
    v_cmp_lt_u32 vcc, s22, v253
    v_cvt_pk_bf16_f32 v197, v210, v211
    v_cvt_pk_bf16_f32 v198, v212, v213
    v_mfma_f32_32x32x16_bf16 v[176:191], v[124:127], a[220:223], v[176:191]
    v_cvt_pk_bf16_f32 v199, v214, v215
    s_cbranch_vccnz L_stub16
L_ret16:
    v_add_f32 v220, v220, v222
    v_add_u32 v231, s36, v231
    v_add_u32 v232, s36, v232
    v_add_u32 v233, s36, v233
    v_add_u32 v234, s36, v234
    s_waitcnt lgkmcnt(0)
    v_mfma_f32_32x32x16_bf16 a[64:79], v[128:131], v[192:195], a[64:79]
    ds_read_b64_tr_b16 v[128:129], v231 offset:0
    ds_read_b64_tr_b16 v[130:131], v231 offset:2048
    v_mfma_f32_32x32x16_bf16 a[80:95], v[136:139], v[192:195], a[80:95]
    ds_read_b64_tr_b16 v[136:137], v232 offset:0
    ds_read_b64_tr_b16 v[138:139], v232 offset:2048
    v_mfma_f32_32x32x16_bf16 a[96:111], v[144:147], v[192:195], a[96:111]
    ds_read_b64_tr_b16 v[144:145], v233 offset:0
    ds_read_b64_tr_b16 v[146:147], v233 offset:2048
    v_exp_f32 v208, v176
    v_exp_f32 v209, v177
    v_mfma_f32_32x32x16_bf16 a[112:127], v[152:155], v[192:195], a[112:127]
    ds_read_b64_tr_b16 v[152:153], v234 offset:0
    ds_read_b64_tr_b16 v[154:155], v234 offset:2048
    v_exp_f32 v210, v178
    v_exp_f32 v211, v179
    v_mfma_f32_32x32x16_bf16 a[64:79], v[132:135], v[196:199], a[64:79]
    ds_read_b64_tr_b16 v[132:133], v231 offset:4096
    ds_read_b64_tr_b16 v[134:135], v231 offset:6144
    v_add_f32 v222, v208, v209
    v_cvt_pk_bf16_f32 v200, v208, v209
    v_exp_f32 v212, v180
    v_mfma_f32_32x32x16_bf16 a[80:95], v[140:143], v[196:199], a[80:95]
    ds_read_b64_tr_b16 v[140:141], v232 offset:4096
    ds_read_b64_tr_b16 v[142:143], v232 offset:6144
    v_add_f32 v222, v222, v210
    v_exp_f32 v213, v181
    v_add_f32 v222, v222, v211
    v_mfma_f32_32x32x16_bf16 a[96:111], v[148:151], v[196:199], a[96:111]
    ds_read_b64_tr_b16 v[148:149], v233 offset:4096
    ds_read_b64_tr_b16 v[150:151], v233 offset:6144
    v_cvt_pk_bf16_f32 v201, v210, v211
    v_exp_f32 v214, v182
    v_add_f32 v222, v222, v212
    v_mfma_f32_32x32x16_bf16 a[112:127], v[156:159], v[196:199], a[112:127]
    ds_read_b64_tr_b16 v[156:157], v234 offset:4096
    ds_read_b64_tr_b16 v[158:159], v234 offset:6144
    v_exp_f32 v215, v183
    v_add_f32 v222, v222, v213
    v_cvt_pk_bf16_f32 v202, v212, v213
    v_mfma_f32_32x32x16_bf16 v[160:175], v[96:99], a[224:227], v[64:79]
    ds_read_b128 v[96:99], v223 offset:8192
    v_exp_f32 v208, v184
    v_add_f32 v222, v222, v214
    v_exp_f32 v209, v185
    v_mfma_f32_32x32x16_bf16 v[160:175], v[100:103], a[228:231], v[160:175]
    ds_read_b128 v[100:103], v224 offset:8192
    v_add_f32 v222, v222, v215
    v_cvt_pk_bf16_f32 v203, v214, v215
    v_exp_f32 v210, v186
    v_mfma_f32_32x32x16_bf16 v[160:175], v[104:107], a[232:235], v[160:175]
    ds_read_b128 v[104:107], v225 offset:8192
    v_add_f32 v222, v222, v208
    v_exp_f32 v211, v187
    v_add_f32 v222, v222, v209
    v_cvt_pk_bf16_f32 v204, v208, v209
    v_mfma_f32_32x32x16_bf16 v[160:175], v[108:111], a[236:239], v[160:175]
    ds_read_b128 v[108:111], v226 offset:8192
    v_exp_f32 v212, v188
    v_add_f32 v222, v222, v210
    v_exp_f32 v213, v189
    v_mfma_f32_32x32x16_bf16 v[160:175], v[112:115], a[240:243], v[160:175]
    ds_read_b128 v[112:115], v227 offset:8192
    v_add_f32 v222, v222, v211
    v_exp_f32 v214, v190
    v_add_f32 v222, v222, v212
    v_mfma_f32_32x32x16_bf16 v[160:175], v[116:119], a[244:247], v[160:175]
    ds_read_b128 v[116:119], v228 offset:8192
    v_exp_f32 v215, v191
    v_add_f32 v222, v222, v213
    v_add_f32 v222, v222, v214
    v_add_f32 v222, v222, v215
    v_mfma_f32_32x32x16_bf16 v[160:175], v[120:123], a[248:251], v[160:175]
    ds_read_b128 v[120:123], v229 offset:8192
    v_subrev_u32 v253, s29, v222
    v_cmp_lt_u32 vcc, s22, v253
    v_cvt_pk_bf16_f32 v205, v210, v211
    v_cvt_pk_bf16_f32 v206, v212, v213
    v_mfma_f32_32x32x16_bf16 v[160:175], v[124:127], a[252:255], v[160:175]
    ds_read_b128 v[124:127], v230 offset:8192
    v_cvt_pk_bf16_f32 v207, v214, v215
    s_cbranch_vccnz L_stub17
L_ret17:
    v_add_f32 v220, v220, v222
    s_waitcnt lgkmcnt(8)
    v_mfma_f32_32x32x16_bf16 a[64:79], v[128:131], v[200:203], a[64:79]
    v_mfma_f32_32x32x16_bf16 a[80:95], v[136:139], v[200:203], a[80:95]
    v_mfma_f32_32x32x16_bf16 a[96:111], v[144:147], v[200:203], a[96:111]
    s_nop 3
    v_exp_f32 v208, v160
    v_exp_f32 v209, v161
    v_mfma_f32_32x32x16_bf16 a[112:127], v[152:155], v[200:203], a[112:127]
    v_exp_f32 v210, v162
    v_exp_f32 v211, v163
    v_add_f32 v222, v208, v209
    v_mfma_f32_32x32x16_bf16 a[64:79], v[132:135], v[204:207], a[64:79]
    v_cvt_pk_bf16_f32 v192, v208, v209
    v_exp_f32 v212, v164
    v_add_f32 v222, v222, v210
    v_mfma_f32_32x32x16_bf16 a[80:95], v[140:143], v[204:207], a[80:95]
    v_exp_f32 v213, v165
    v_add_f32 v222, v222, v211
    v_cvt_pk_bf16_f32 v193, v210, v211
    v_mfma_f32_32x32x16_bf16 a[96:111], v[148:151], v[204:207], a[96:111]
    v_exp_f32 v214, v166
    v_add_f32 v222, v222, v212
    v_exp_f32 v215, v167
    v_mfma_f32_32x32x16_bf16 a[112:127], v[156:159], v[204:207], a[112:127]
    v_add_f32 v222, v222, v213
    v_cvt_pk_bf16_f32 v194, v212, v213
    v_exp_f32 v208, v168
    s_waitcnt lgkmcnt(0)
    v_mfma_f32_32x32x16_bf16 v[176:191], v[96:99], a[192:195], v[48:63]
    v_add_f32 v222, v222, v214
    v_exp_f32 v209, v169
    v_add_f32 v222, v222, v215
    v_mfma_f32_32x32x16_bf16 v[176:191], v[100:103], a[196:199], v[176:191]
    v_cvt_pk_bf16_f32 v195, v214, v215
    v_exp_f32 v210, v170
    v_add_f32 v222, v222, v208
    v_mfma_f32_32x32x16_bf16 v[176:191], v[104:107], a[200:203], v[176:191]
    v_exp_f32 v211, v171
    v_add_f32 v222, v222, v209
    v_cvt_pk_bf16_f32 v196, v208, v209
    v_mfma_f32_32x32x16_bf16 v[176:191], v[108:111], a[204:207], v[176:191]
    v_exp_f32 v212, v172
    v_add_f32 v222, v222, v210
    v_exp_f32 v213, v173
    v_mfma_f32_32x32x16_bf16 v[176:191], v[112:115], a[208:211], v[176:191]
    v_add_f32 v222, v222, v211
    v_exp_f32 v214, v174
    v_add_f32 v222, v222, v212
    v_mfma_f32_32x32x16_bf16 v[176:191], v[116:119], a[212:215], v[176:191]
    v_exp_f32 v215, v175
    v_add_f32 v222, v222, v213
    v_add_f32 v222, v222, v214
    v_add_f32 v222, v222, v215
    v_mfma_f32_32x32x16_bf16 v[176:191], v[120:123], a[216:219], v[176:191]
    v_subrev_u32 v253, s29, v222
    v_cmp_lt_u32 vcc, s22, v253
    v_cvt_pk_bf16_f32 v197, v210, v211
    v_cvt_pk_bf16_f32 v198, v212, v213
    v_mfma_f32_32x32x16_bf16 v[176:191], v[124:127], a[220:223], v[176:191]
    v_cvt_pk_bf16_f32 v199, v214, v215
    s_cbranch_vccnz L_stub18
L_ret18:
    v_add_f32 v221, v221, v222
    v_mfma_f32_32x32x16_bf16 a[128:143], v[128:131], v[192:195], a[128:143]
    ds_read_b64_tr_b16 v[128:129], v231 offset:8192
    ds_read_b64_tr_b16 v[130:131], v231 offset:10240
    v_mfma_f32_32x32x16_bf16 a[144:159], v[136:139], v[192:195], a[144:159]
    ds_read_b64_tr_b16 v[136:137], v232 offset:8192
    ds_read_b64_tr_b16 v[138:139], v232 offset:10240
    v_mfma_f32_32x32x16_bf16 a[160:175], v[144:147], v[192:195], a[160:175]
    ds_read_b64_tr_b16 v[144:145], v233 offset:8192
    ds_read_b64_tr_b16 v[146:147], v233 offset:10240
    v_exp_f32 v208, v176
    v_exp_f32 v209, v177
    v_mfma_f32_32x32x16_bf16 a[176:191], v[152:155], v[192:195], a[176:191]
    ds_read_b64_tr_b16 v[152:153], v234 offset:8192
    ds_read_b64_tr_b16 v[154:155], v234 offset:10240
    v_exp_f32 v210, v178
    v_exp_f32 v211, v179
    v_mfma_f32_32x32x16_bf16 a[128:143], v[132:135], v[196:199], a[128:143]
    ds_read_b64_tr_b16 v[132:133], v231 offset:12288
    ds_read_b64_tr_b16 v[134:135], v231 offset:14336
    v_add_f32 v222, v208, v209
    v_cvt_pk_bf16_f32 v200, v208, v209
    v_exp_f32 v212, v180
    v_mfma_f32_32x32x16_bf16 a[144:159], v[140:143], v[196:199], a[144:159]
    ds_read_b64_tr_b16 v[140:141], v232 offset:12288
    ds_read_b64_tr_b16 v[142:143], v232 offset:14336
    v_add_f32 v222, v222, v210
    v_exp_f32 v213, v181
    v_add_f32 v222, v222, v211
    v_mfma_f32_32x32x16_bf16 a[160:175], v[148:151], v[196:199], a[160:175]
    ds_read_b64_tr_b16 v[148:149], v233 offset:12288
    ds_read_b64_tr_b16 v[150:151], v233 offset:14336
    v_cvt_pk_bf16_f32 v201, v210, v211
    v_exp_f32 v214, v182
    v_add_f32 v222, v222, v212
    v_mfma_f32_32x32x16_bf16 a[176:191], v[156:159], v[196:199], a[176:191]
    ds_read_b64_tr_b16 v[156:157], v234 offset:12288
    ds_read_b64_tr_b16 v[158:159], v234 offset:14336
    v_exp_f32 v215, v183
    v_add_f32 v222, v222, v213
    v_cvt_pk_bf16_f32 v202, v212, v213
    v_exp_f32 v208, v184
    v_add_f32 v222, v222, v214
    v_exp_f32 v209, v185
    v_add_f32 v222, v222, v215
    v_cvt_pk_bf16_f32 v203, v214, v215
    v_exp_f32 v210, v186
    v_add_f32 v222, v222, v208
    v_exp_f32 v211, v187
    v_add_f32 v222, v222, v209
    v_cvt_pk_bf16_f32 v204, v208, v209
    v_exp_f32 v212, v188
    v_add_f32 v222, v222, v210
    v_exp_f32 v213, v189
    v_add_f32 v222, v222, v211
    v_exp_f32 v214, v190
    v_add_f32 v222, v222, v212
    v_exp_f32 v215, v191
    v_add_f32 v222, v222, v213
    v_add_f32 v222, v222, v214
    v_add_f32 v222, v222, v215
    v_subrev_u32 v253, s29, v222
    v_cmp_lt_u32 vcc, s22, v253
    v_cvt_pk_bf16_f32 v205, v210, v211
    v_cvt_pk_bf16_f32 v206, v212, v213
    v_cvt_pk_bf16_f32 v207, v214, v215
    s_cbranch_vccnz L_stub19
L_ret19:
    v_add_f32 v220, v220, v222
    s_waitcnt lgkmcnt(0)
    v_mfma_f32_32x32x16_bf16 a[64:79], v[128:131], v[200:203], a[64:79]
    v_mfma_f32_32x32x16_bf16 a[80:95], v[136:139], v[200:203], a[80:95]
    v_mfma_f32_32x32x16_bf16 a[96:111], v[144:147], v[200:203], a[96:111]
    v_mfma_f32_32x32x16_bf16 a[112:127], v[152:155], v[200:203], a[112:127]
    v_mfma_f32_32x32x16_bf16 a[64:79], v[132:135], v[204:207], a[64:79]
    v_mfma_f32_32x32x16_bf16 a[80:95], v[140:143], v[204:207], a[80:95]
    v_mfma_f32_32x32x16_bf16 a[96:111], v[148:151], v[204:207], a[96:111]
    v_mfma_f32_32x32x16_bf16 a[112:127], v[156:159], v[204:207], a[112:127]
    s_waitcnt lgkmcnt(0)
    s_xor_b32 s54, s34, 4096
    v_mov_b32 v74, v64
    v_mov_b32 v242, v221
    v_mov_b32 v243, v221
    s_nop 1
    v_permlane32_swap_b32 v242, v243
    s_nop 1
    v_add_f32 v75, v242, v243
    v_add_u32 v246, s54, v254
    ds_write_b64 v246, v[74:75]
    v_add_u32 v72, s54, v255
    v_add_u32 v73, s34, v255
    ds_write_b128 v73, a[164:167] offset:1024
    ds_write_b128 v73, a[168:171] offset:2048
    ds_write_b128 v73, a[172:175] offset:3072
    ds_write_b128 v73, a[176:179] offset:16384
    ds_write_b128 v73, a[180:183] offset:17408
    ds_write_b128 v73, a[184:187] offset:18432
    ds_write_b128 v73, a[188:191] offset:19456
    s_add_u32 s42, s35, s55
    v_add_u32 v251, s35, v240
    v_xor_b32 v208, 0, v241
    v_lshl_add_u32 v208, v208, 4, v251
    v_xor_b32 v209, 2, v241
    v_lshl_add_u32 v209, v209, 4, v251
    v_xor_b32 v210, 4, v241
    v_lshl_add_u32 v210, v210, 4, v251
    v_xor_b32 v211, 6, v241
    v_lshl_add_u32 v211, v211, 4, v251
    v_xor_b32 v212, 8, v241
    v_lshl_add_u32 v212, v212, 4, v251
    v_xor_b32 v213, 10, v241
    v_lshl_add_u32 v213, v213, 4, v251
    v_xor_b32 v214, 12, v241
    v_lshl_add_u32 v214, v214, 4, v251
    v_xor_b32 v215, 14, v241
    v_lshl_add_u32 v215, v215, 4, v251
    s_waitcnt lgkmcnt(0)
    s_barrier
    v_add_u32 v247, s34, v254
    ds_read_b64 v[248:249], v247
    s_waitcnt lgkmcnt(0)
    ds_write_b128 v73, a[160:163] offset:0
    v_min_f32 v242, v74, v248
    v_sub_f32 v243, v242, v74
    v_sub_f32 v242, v242, v248
    v_exp_f32 v243, v243
    v_exp_f32 v242, v242
    v_mul_f32 v245, v75, v243
    v_fma_f32 v245, v249, v242, v245
    v_rcp_f32 v245, v245
    s_nop 0
    v_mul_f32 v70, v245, v242
    v_mul_f32 v68, v245, v243
    v_mov_b32 v71, v70
    v_mov_b32 v69, v68
    v_mov_b32 v242, v220
    v_mov_b32 v243, v220
    s_nop 1
    v_permlane32_swap_b32 v242, v243
    s_nop 1
    v_add_f32 v244, v242, v243
    v_rcp_f32 v244, v244
    s_nop 0
    v_mov_b32 v245, v244
    v_accvgpr_read_b32 v160, a64
    v_accvgpr_read_b32 v161, a65
    v_accvgpr_read_b32 v162, a66
    v_accvgpr_read_b32 v163, a67
    v_accvgpr_read_b32 v164, a68
    v_accvgpr_read_b32 v165, a69
    v_accvgpr_read_b32 v166, a70
    v_accvgpr_read_b32 v167, a71
    v_pk_mul_f32 v[160:161], v[160:161], v[244:245]
    v_pk_mul_f32 v[162:163], v[162:163], v[244:245]
    v_pk_mul_f32 v[164:165], v[164:165], v[244:245]
    v_pk_mul_f32 v[166:167], v[166:167], v[244:245]
    v_cvt_pk_bf16_f32 v168, v160, v161
    v_cvt_pk_bf16_f32 v169, v162, v163
    v_cvt_pk_bf16_f32 v170, v164, v165
    v_cvt_pk_bf16_f32 v171, v166, v167
    s_nop 0
    v_permlane32_swap_b32 v168, v170
    v_permlane32_swap_b32 v169, v171
    ds_write_b128 v208, v[168:171] offset:0
    v_accvgpr_read_b32 v172, a72
    v_accvgpr_read_b32 v173, a73
    v_accvgpr_read_b32 v174, a74
    v_accvgpr_read_b32 v175, a75
    v_accvgpr_read_b32 v176, a76
    v_accvgpr_read_b32 v177, a77
    v_accvgpr_read_b32 v178, a78
    v_accvgpr_read_b32 v179, a79
    v_pk_mul_f32 v[172:173], v[172:173], v[244:245]
    v_pk_mul_f32 v[174:175], v[174:175], v[244:245]
    v_pk_mul_f32 v[176:177], v[176:177], v[244:245]
    v_pk_mul_f32 v[178:179], v[178:179], v[244:245]
    v_cvt_pk_bf16_f32 v180, v172, v173
    v_cvt_pk_bf16_f32 v181, v174, v175
    v_cvt_pk_bf16_f32 v182, v176, v177
    v_cvt_pk_bf16_f32 v183, v178, v179
    s_nop 0
    v_permlane32_swap_b32 v180, v182
    v_permlane32_swap_b32 v181, v183
    ds_write_b128 v209, v[180:183] offset:0
    v_accvgpr_read_b32 v184, a80
    v_accvgpr_read_b32 v185, a81
    v_accvgpr_read_b32 v186, a82
    v_accvgpr_read_b32 v187, a83
    v_accvgpr_read_b32 v188, a84
    v_accvgpr_read_b32 v189, a85
    v_accvgpr_read_b32 v190, a86
    v_accvgpr_read_b32 v191, a87
    v_pk_mul_f32 v[184:185], v[184:185], v[244:245]
    v_pk_mul_f32 v[186:187], v[186:187], v[244:245]
    v_pk_mul_f32 v[188:189], v[188:189], v[244:245]
    v_pk_mul_f32 v[190:191], v[190:191], v[244:245]
    v_cvt_pk_bf16_f32 v192, v184, v185
    v_cvt_pk_bf16_f32 v193, v186, v187
    v_cvt_pk_bf16_f32 v194, v188, v189
    v_cvt_pk_bf16_f32 v195, v190, v191
    s_nop 0
    v_permlane32_swap_b32 v192, v194
    v_permlane32_swap_b32 v193, v195
    ds_write_b128 v210, v[192:195] offset:0
    v_accvgpr_read_b32 v196, a88
    v_accvgpr_read_b32 v197, a89
    v_accvgpr_read_b32 v198, a90
    v_accvgpr_read_b32 v199, a91
    v_accvgpr_read_b32 v200, a92
    v_accvgpr_read_b32 v201, a93
    v_accvgpr_read_b32 v202, a94
    v_accvgpr_read_b32 v203, a95
    v_pk_mul_f32 v[196:197], v[196:197], v[244:245]
    v_pk_mul_f32 v[198:199], v[198:199], v[244:245]
    v_pk_mul_f32 v[200:201], v[200:201], v[244:245]
    v_pk_mul_f32 v[202:203], v[202:203], v[244:245]
    v_cvt_pk_bf16_f32 v204, v196, v197
    v_cvt_pk_bf16_f32 v205, v198, v199
    v_cvt_pk_bf16_f32 v206, v200, v201
    v_cvt_pk_bf16_f32 v207, v202, v203
    s_nop 0
    v_permlane32_swap_b32 v204, v206
    v_permlane32_swap_b32 v205, v207
    ds_write_b128 v211, v[204:207] offset:0
    v_accvgpr_read_b32 v160, a96
    v_accvgpr_read_b32 v161, a97
    v_accvgpr_read_b32 v162, a98
    v_accvgpr_read_b32 v163, a99
    v_accvgpr_read_b32 v164, a100
    v_accvgpr_read_b32 v165, a101
    v_accvgpr_read_b32 v166, a102
    v_accvgpr_read_b32 v167, a103
    v_pk_mul_f32 v[160:161], v[160:161], v[244:245]
    v_pk_mul_f32 v[162:163], v[162:163], v[244:245]
    v_pk_mul_f32 v[164:165], v[164:165], v[244:245]
    v_pk_mul_f32 v[166:167], v[166:167], v[244:245]
    v_cvt_pk_bf16_f32 v168, v160, v161
    v_cvt_pk_bf16_f32 v169, v162, v163
    v_cvt_pk_bf16_f32 v170, v164, v165
    v_cvt_pk_bf16_f32 v171, v166, v167
    s_nop 0
    v_permlane32_swap_b32 v168, v170
    v_permlane32_swap_b32 v169, v171
    ds_write_b128 v212, v[168:171] offset:0
    v_accvgpr_read_b32 v172, a104
    v_accvgpr_read_b32 v173, a105
    v_accvgpr_read_b32 v174, a106
    v_accvgpr_read_b32 v175, a107
    v_accvgpr_read_b32 v176, a108
    v_accvgpr_read_b32 v177, a109
    v_accvgpr_read_b32 v178, a110
    v_accvgpr_read_b32 v179, a111
    v_pk_mul_f32 v[172:173], v[172:173], v[244:245]
    v_pk_mul_f32 v[174:175], v[174:175], v[244:245]
    v_pk_mul_f32 v[176:177], v[176:177], v[244:245]
    v_pk_mul_f32 v[178:179], v[178:179], v[244:245]
    v_cvt_pk_bf16_f32 v180, v172, v173
    v_cvt_pk_bf16_f32 v181, v174, v175
    v_cvt_pk_bf16_f32 v182, v176, v177
    v_cvt_pk_bf16_f32 v183, v178, v179
    s_nop 0
    v_permlane32_swap_b32 v180, v182
    v_permlane32_swap_b32 v181, v183
    ds_write_b128 v213, v[180:183] offset:0
    v_accvgpr_read_b32 v184, a112
    v_accvgpr_read_b32 v185, a113
    v_accvgpr_read_b32 v186, a114
    v_accvgpr_read_b32 v187, a115
    v_accvgpr_read_b32 v188, a116
    v_accvgpr_read_b32 v189, a117
    v_accvgpr_read_b32 v190, a118
    v_accvgpr_read_b32 v191, a119
    v_pk_mul_f32 v[184:185], v[184:185], v[244:245]
    v_pk_mul_f32 v[186:187], v[186:187], v[244:245]
    v_pk_mul_f32 v[188:189], v[188:189], v[244:245]
    v_pk_mul_f32 v[190:191], v[190:191], v[244:245]
    v_cvt_pk_bf16_f32 v192, v184, v185
    v_cvt_pk_bf16_f32 v193, v186, v187
    v_cvt_pk_bf16_f32 v194, v188, v189
    v_cvt_pk_bf16_f32 v195, v190, v191
    s_nop 0
    v_permlane32_swap_b32 v192, v194
    v_permlane32_swap_b32 v193, v195
    ds_write_b128 v214, v[192:195] offset:0
    v_accvgpr_read_b32 v196, a120
    v_accvgpr_read_b32 v197, a121
    v_accvgpr_read_b32 v198, a122
    v_accvgpr_read_b32 v199, a123
    v_accvgpr_read_b32 v200, a124
    v_accvgpr_read_b32 v201, a125
    v_accvgpr_read_b32 v202, a126
    v_accvgpr_read_b32 v203, a127
    v_pk_mul_f32 v[196:197], v[196:197], v[244:245]
    v_pk_mul_f32 v[198:199], v[198:199], v[244:245]
    v_pk_mul_f32 v[200:201], v[200:201], v[244:245]
    v_pk_mul_f32 v[202:203], v[202:203], v[244:245]
    v_cvt_pk_bf16_f32 v204, v196, v197
    v_cvt_pk_bf16_f32 v205, v198, v199
    v_cvt_pk_bf16_f32 v206, v200, v201
    v_cvt_pk_bf16_f32 v207, v202, v203
    s_nop 0
    v_permlane32_swap_b32 v204, v206
    v_permlane32_swap_b32 v205, v207
    ds_write_b128 v215, v[204:207] offset:0
    v_add_u32 v250, s42, v255
    s_waitcnt lgkmcnt(0)
    ds_read_b128 v[128:131], v250 offset:0
    ds_read_b128 v[132:135], v250 offset:1024
    ds_read_b128 v[136:139], v250 offset:2048
    ds_read_b128 v[140:143], v250 offset:3072
    ds_read_b128 v[144:147], v250 offset:16384
    ds_read_b128 v[148:151], v250 offset:17408
    ds_read_b128 v[152:155], v250 offset:18432
    ds_read_b128 v[156:159], v250 offset:19456
    s_add_u32 s96, s37, 8192
    s_add_u32 s97, s37, 12288
    s_waitcnt lgkmcnt(0)
    s_barrier
    ds_read_b128 v[32:35], v72 offset:0
    ds_read_b128 v[36:39], v72 offset:1024
    ds_read_b128 v[40:43], v72 offset:2048
    ds_read_b128 v[44:47], v72 offset:3072
    ds_read_b128 v[48:51], v72 offset:16384
    ds_read_b128 v[52:55], v72 offset:17408
    ds_read_b128 v[56:59], v72 offset:18432
    ds_read_b128 v[60:63], v72 offset:19456
    buffer_store_dwordx4 v[128:131], v235, s[24:27], s96 offen offset:0 sc1 nt
    v_bfe_u32 v242, v255, 4, 5
    v_bfe_u32 v243, v255, 9, 1
    v_and_b32 v248, 7, v242
    v_xor_b32 v248, v248, v243
    v_lshlrev_b32 v242, 7, v242
    v_add_u32 v242, s42, v242
    v_xor_b32 v208, 0, v248
    v_lshl_add_u32 v208, v208, 4, v242
    v_xor_b32 v209, 2, v248
    v_lshl_add_u32 v209, v209, 4, v242
    v_xor_b32 v210, 4, v248
    v_lshl_add_u32 v210, v210, 4, v242
    v_xor_b32 v211, 6, v248
    v_lshl_add_u32 v211, v211, 4, v242
    buffer_store_dwordx4 v[132:135], v236, s[24:27], s96 offen offset:1024 sc1 nt
    v_bfe_u32 v242, v255, 7, 3
    v_bfe_u32 v243, v255, 4, 3
    v_xor_b32 v243, v243, v242
    v_lshlrev_b32 v242, 8, v242
    v_lshl_add_u32 v253, v243, 4, v242
    v_add_u32 v251, s42, v255
    v_accvgpr_read_b32 v160, a128
    v_accvgpr_read_b32 v161, a129
    v_accvgpr_read_b32 v162, a130
    v_accvgpr_read_b32 v163, a131
    v_accvgpr_read_b32 v164, a132
    v_accvgpr_read_b32 v165, a133
    v_accvgpr_read_b32 v166, a134
    v_accvgpr_read_b32 v167, a135
    buffer_store_dwordx4 v[136:139], v237, s[24:27], s96 offen offset:2048 sc1 nt
    v_pk_mul_f32 v[160:161], v[160:161], v[68:69]
    v_pk_mul_f32 v[162:163], v[162:163], v[68:69]
    v_pk_mul_f32 v[164:165], v[164:165], v[68:69]
    v_pk_mul_f32 v[166:167], v[166:167], v[68:69]
    s_waitcnt lgkmcnt(7)
    v_pk_fma_f32 v[160:161], v[32:33], v[70:71], v[160:161]
    v_pk_fma_f32 v[162:163], v[34:35], v[70:71], v[162:163]
    s_waitcnt lgkmcnt(6)
    v_pk_fma_f32 v[164:165], v[36:37], v[70:71], v[164:165]
    v_pk_fma_f32 v[166:167], v[38:39], v[70:71], v[166:167]
    v_cvt_pk_bf16_f32 v168, v160, v161
    buffer_store_dwordx4 v[140:143], v238, s[24:27], s96 offen offset:3072 sc1 nt
    v_cvt_pk_bf16_f32 v169, v162, v163
    v_cvt_pk_bf16_f32 v170, v164, v165
    v_cvt_pk_bf16_f32 v171, v166, v167
    s_nop 0
    v_permlane32_swap_b32 v168, v170
    v_permlane32_swap_b32 v169, v171
    ds_write_b128 v208, v[168:171] offset:0
    v_accvgpr_read_b32 v172, a136
    v_accvgpr_read_b32 v173, a137
    v_accvgpr_read_b32 v174, a138
    v_accvgpr_read_b32 v175, a139
    v_accvgpr_read_b32 v176, a140
    v_accvgpr_read_b32 v177, a141
    v_accvgpr_read_b32 v178, a142
    v_accvgpr_read_b32 v179, a143
    buffer_store_dwordx4 v[144:147], v239, s[24:27], s97 offen offset:0 sc1 nt
    v_pk_mul_f32 v[172:173], v[172:173], v[68:69]
    v_pk_mul_f32 v[174:175], v[174:175], v[68:69]
    v_pk_mul_f32 v[176:177], v[176:177], v[68:69]
    v_pk_mul_f32 v[178:179], v[178:179], v[68:69]
    s_waitcnt lgkmcnt(6)
    v_pk_fma_f32 v[172:173], v[40:41], v[70:71], v[172:173]
    v_pk_fma_f32 v[174:175], v[42:43], v[70:71], v[174:175]
    s_waitcnt lgkmcnt(5)
    v_pk_fma_f32 v[176:177], v[44:45], v[70:71], v[176:177]
    v_pk_fma_f32 v[178:179], v[46:47], v[70:71], v[178:179]
    v_cvt_pk_bf16_f32 v180, v172, v173
    buffer_store_dwordx4 v[148:151], v239, s[24:27], s97 offen offset:1024 sc1 nt
    v_cvt_pk_bf16_f32 v181, v174, v175
    v_cvt_pk_bf16_f32 v182, v176, v177
    v_cvt_pk_bf16_f32 v183, v178, v179
    s_nop 0
    v_permlane32_swap_b32 v180, v182
    v_permlane32_swap_b32 v181, v183
    ds_write_b128 v209, v[180:183] offset:0
    v_accvgpr_read_b32 v184, a144
    v_accvgpr_read_b32 v185, a145
    v_accvgpr_read_b32 v186, a146
    v_accvgpr_read_b32 v187, a147
    v_accvgpr_read_b32 v188, a148
    v_accvgpr_read_b32 v189, a149
    v_accvgpr_read_b32 v190, a150
    v_accvgpr_read_b32 v191, a151
    buffer_store_dwordx4 v[152:155], v239, s[24:27], s97 offen offset:2048 sc1 nt
    v_pk_mul_f32 v[184:185], v[184:185], v[68:69]
    v_pk_mul_f32 v[186:187], v[186:187], v[68:69]
    v_pk_mul_f32 v[188:189], v[188:189], v[68:69]
    v_pk_mul_f32 v[190:191], v[190:191], v[68:69]
    s_waitcnt lgkmcnt(5)
    v_pk_fma_f32 v[184:185], v[48:49], v[70:71], v[184:185]
    v_pk_fma_f32 v[186:187], v[50:51], v[70:71], v[186:187]
    s_waitcnt lgkmcnt(4)
    v_pk_fma_f32 v[188:189], v[52:53], v[70:71], v[188:189]
    v_pk_fma_f32 v[190:191], v[54:55], v[70:71], v[190:191]
    v_cvt_pk_bf16_f32 v192, v184, v185
    v_cvt_pk_bf16_f32 v193, v186, v187
    buffer_store_dwordx4 v[156:159], v239, s[24:27], s97 offen offset:3072 sc1 nt
    v_cvt_pk_bf16_f32 v194, v188, v189
    v_cvt_pk_bf16_f32 v195, v190, v191
    s_nop 0
    v_permlane32_swap_b32 v192, v194
    v_permlane32_swap_b32 v193, v195
    ds_write_b128 v210, v[192:195] offset:0
    v_accvgpr_read_b32 v196, a152
    v_accvgpr_read_b32 v197, a153
    v_accvgpr_read_b32 v198, a154
    v_accvgpr_read_b32 v199, a155
    v_accvgpr_read_b32 v200, a156
    v_accvgpr_read_b32 v201, a157
    v_accvgpr_read_b32 v202, a158
    v_accvgpr_read_b32 v203, a159
    v_pk_mul_f32 v[196:197], v[196:197], v[68:69]
    v_pk_mul_f32 v[198:199], v[198:199], v[68:69]
    v_pk_mul_f32 v[200:201], v[200:201], v[68:69]
    v_pk_mul_f32 v[202:203], v[202:203], v[68:69]
    s_waitcnt lgkmcnt(4)
    v_pk_fma_f32 v[196:197], v[56:57], v[70:71], v[196:197]
    v_pk_fma_f32 v[198:199], v[58:59], v[70:71], v[198:199]
    s_waitcnt lgkmcnt(3)
    v_pk_fma_f32 v[200:201], v[60:61], v[70:71], v[200:201]
    v_pk_fma_f32 v[202:203], v[62:63], v[70:71], v[202:203]
    v_cvt_pk_bf16_f32 v204, v196, v197
    v_cvt_pk_bf16_f32 v205, v198, v199
    v_cvt_pk_bf16_f32 v206, v200, v201
    v_cvt_pk_bf16_f32 v207, v202, v203
    s_nop 0
    v_permlane32_swap_b32 v204, v206
    v_permlane32_swap_b32 v205, v207
    ds_write_b128 v211, v[204:207] offset:0
    s_waitcnt lgkmcnt(0)
    ds_read_b128 v[80:83], v251 offset:0
    ds_read_b128 v[84:87], v251 offset:1024
    ds_read_b128 v[88:91], v251 offset:2048
    ds_read_b128 v[92:95], v251 offset:3072
    s_add_u32 s98, s38, 0
    s_add_u32 s99, s38, 4096
    s_waitcnt lgkmcnt(0)
    buffer_store_dwordx4 v[80:83], v253, s[24:27], s98 offen offset:0 sc1 nt
    buffer_store_dwordx4 v[84:87], v253, s[24:27], s98 offen offset:2048 sc1 nt
    buffer_store_dwordx4 v[88:91], v253, s[24:27], s99 offen offset:0 sc1 nt
    buffer_store_dwordx4 v[92:95], v253, s[24:27], s99 offen offset:2048 sc1 nt
    s_branch L_fin
L_item_A1:
    s_sub_u32 s36, s35, s51
    s_mov_b32 s51, s35
    v_add_u32 v223, s36, v223
    v_add_u32 v224, s36, v224
    v_add_u32 v225, s36, v225
    v_add_u32 v226, s36, v226
    v_add_u32 v227, s36, v227
    v_add_u32 v228, s36, v228
    v_add_u32 v229, s36, v229
    v_add_u32 v230, s36, v230
    ds_read_b128 v[96:99], v223 offset:0
    ds_read_b128 v[100:103], v224 offset:0
    ds_read_b128 v[104:107], v225 offset:0
    ds_read_b128 v[108:111], v226 offset:0
    ds_read_b128 v[112:115], v227 offset:0
    ds_read_b128 v[116:119], v228 offset:0
    ds_read_b128 v[120:123], v229 offset:0
    ds_read_b128 v[124:127], v230 offset:0
    s_sub_u32 s36, s35, s52
    s_mov_b32 s52, s35
    s_mov_b32 s29, 0x35800000
    s_mov_b32 s22, 0x12000000
    s_waitcnt lgkmcnt(0)
    v_mfma_f32_32x32x16_bf16 v[160:175], v[96:99], v[0:3], v[32:47]
    v_mfma_f32_32x32x16_bf16 v[160:175], v[100:103], v[4:7], v[160:175]
    v_mfma_f32_32x32x16_bf16 v[160:175], v[104:107], v[8:11], v[160:175]
    v_mfma_f32_32x32x16_bf16 v[160:175], v[108:111], v[12:15], v[160:175]
    v_mfma_f32_32x32x16_bf16 v[160:175], v[112:115], v[16:19], v[160:175]
    v_mfma_f32_32x32x16_bf16 v[160:175], v[116:119], v[20:23], v[160:175]
    v_mfma_f32_32x32x16_bf16 v[160:175], v[120:123], v[24:27], v[160:175]
    v_mfma_f32_32x32x16_bf16 v[160:175], v[124:127], v[28:31], v[160:175]
    v_add_u32 v231, s36, v231
    v_add_u32 v232, s36, v232
    v_add_u32 v233, s36, v233
    v_add_u32 v234, s36, v234
    v_mfma_f32_32x32x16_bf16 a[128:143], v[128:131], v[200:203], a[128:143]
L_loop_A1:
    ds_read_b64_tr_b16 v[128:129], v231 offset:0
    ds_read_b64_tr_b16 v[130:131], v231 offset:2048
    s_bitcmp1_b32 s23, s32
    s_cbranch_scc1 L_ex49
L_exr50:
    v_mfma_f32_32x32x16_bf16 a[144:159], v[136:139], v[200:203], a[144:159]
    ds_read_b64_tr_b16 v[136:137], v232 offset:0
    ds_read_b64_tr_b16 v[138:139], v232 offset:2048
    s_mov_b32 m0, s34
    s_nop 0
    buffer_load_dwordx4 v235, s[12:15], s20 offen offset:0 nt lds
    buffer_load_dwordx4 v236, s[12:15], s20 offen offset:1024 nt lds
    v_mfma_f32_32x32x16_bf16 a[160:175], v[144:147], v[200:203], a[160:175]
    ds_read_b64_tr_b16 v[144:145], v233 offset:0
    ds_read_b64_tr_b16 v[146:147], v233 offset:2048
    v_exp_f32 v208, v160
    v_exp_f32 v209, v161
    v_mfma_f32_32x32x16_bf16 a[176:191], v[152:155], v[200:203], a[176:191]
    ds_read_b64_tr_b16 v[152:153], v234 offset:0
    ds_read_b64_tr_b16 v[154:155], v234 offset:2048
    v_exp_f32 v210, v162
    v_exp_f32 v211, v163
    v_mfma_f32_32x32x16_bf16 a[128:143], v[132:135], v[204:207], a[128:143]
    ds_read_b64_tr_b16 v[132:133], v231 offset:4096
    ds_read_b64_tr_b16 v[134:135], v231 offset:6144
    v_add_f32 v222, v208, v209
    v_cvt_pk_bf16_f32 v192, v208, v209
    v_exp_f32 v212, v164
    v_mfma_f32_32x32x16_bf16 a[144:159], v[140:143], v[204:207], a[144:159]
    ds_read_b64_tr_b16 v[140:141], v232 offset:4096
    ds_read_b64_tr_b16 v[142:143], v232 offset:6144
    v_add_f32 v222, v222, v210
    v_exp_f32 v213, v165
    v_add_f32 v222, v222, v211
    v_mfma_f32_32x32x16_bf16 a[160:175], v[148:151], v[204:207], a[160:175]
    ds_read_b64_tr_b16 v[148:149], v233 offset:4096
    ds_read_b64_tr_b16 v[150:151], v233 offset:6144
    v_cvt_pk_bf16_f32 v193, v210, v211
    v_exp_f32 v214, v166
    v_add_f32 v222, v222, v212
    v_mfma_f32_32x32x16_bf16 a[176:191], v[156:159], v[204:207], a[176:191]
    ds_read_b64_tr_b16 v[156:157], v234 offset:4096
    ds_read_b64_tr_b16 v[158:159], v234 offset:6144
    v_exp_f32 v215, v167
    v_add_f32 v222, v222, v213
    v_cvt_pk_bf16_f32 v194, v212, v213
    v_mfma_f32_32x32x16_bf16 v[176:191], v[96:99], a[192:195], v[48:63]
    ds_read_b128 v[96:99], v223 offset:8192
    v_exp_f32 v208, v168
    v_add_f32 v222, v222, v214
    v_exp_f32 v209, v169
    v_mfma_f32_32x32x16_bf16 v[176:191], v[100:103], a[196:199], v[176:191]
    ds_read_b128 v[100:103], v224 offset:8192
    v_add_f32 v222, v222, v215
    v_cvt_pk_bf16_f32 v195, v214, v215
    v_exp_f32 v210, v170
    v_mfma_f32_32x32x16_bf16 v[176:191], v[104:107], a[200:203], v[176:191]
    ds_read_b128 v[104:107], v225 offset:8192
    v_add_f32 v222, v222, v208
    v_exp_f32 v211, v171
    v_add_f32 v222, v222, v209
    v_cvt_pk_bf16_f32 v196, v208, v209
    v_mfma_f32_32x32x16_bf16 v[176:191], v[108:111], a[204:207], v[176:191]
    ds_read_b128 v[108:111], v226 offset:8192
    v_exp_f32 v212, v172
    v_add_f32 v222, v222, v210
    v_exp_f32 v213, v173
    v_mfma_f32_32x32x16_bf16 v[176:191], v[112:115], a[208:211], v[176:191]
    ds_read_b128 v[112:115], v227 offset:8192
    v_add_f32 v222, v222, v211
    v_exp_f32 v214, v174
    v_add_f32 v222, v222, v212
    v_mfma_f32_32x32x16_bf16 v[176:191], v[116:119], a[212:215], v[176:191]
    ds_read_b128 v[116:119], v228 offset:8192
    v_exp_f32 v215, v175
    v_add_f32 v222, v222, v213
    v_add_f32 v222, v222, v214
    v_add_f32 v222, v222, v215
    v_mfma_f32_32x32x16_bf16 v[176:191], v[120:123], a[216:219], v[176:191]
    ds_read_b128 v[120:123], v229 offset:8192
    v_subrev_u32 v253, s29, v222
    v_cmp_lt_u32 vcc, s22, v253
    v_cvt_pk_bf16_f32 v197, v210, v211
    v_cvt_pk_bf16_f32 v198, v212, v213
    v_mfma_f32_32x32x16_bf16 v[176:191], v[124:127], a[220:223], v[176:191]
    ds_read_b128 v[124:127], v230 offset:8192
    v_cvt_pk_bf16_f32 v199, v214, v215
    s_cbranch_vccnz L_stub20
L_ret20:
    v_add_f32 v219, v219, v222
    s_waitcnt lgkmcnt(8)
    v_mfma_f32_32x32x16_bf16 a[0:15], v[128:131], v[192:195], a[0:15]
    buffer_load_dwordx4 v237, s[12:15], s20 offen offset:2048 nt lds
    buffer_load_dwordx4 v238, s[12:15], s20 offen offset:3072 nt lds
    v_mfma_f32_32x32x16_bf16 a[16:31], v[136:139], v[192:195], a[16:31]
    s_add_u32 m0, s34, 16384
    s_nop 0
    buffer_load_dwordx4 v239, s[16:19], s21 offen offset:0 nt lds
    buffer_load_dwordx4 v239, s[16:19], s21 offen offset:1024 nt lds
    v_mfma_f32_32x32x16_bf16 a[32:47], v[144:147], v[192:195], a[32:47]
    v_exp_f32 v208, v176
    v_exp_f32 v209, v177
    v_mfma_f32_32x32x16_bf16 a[48:63], v[152:155], v[192:195], a[48:63]
    v_exp_f32 v210, v178
    v_exp_f32 v211, v179
    v_add_f32 v222, v208, v209
    v_mfma_f32_32x32x16_bf16 a[0:15], v[132:135], v[196:199], a[0:15]
    v_cvt_pk_bf16_f32 v200, v208, v209
    v_exp_f32 v212, v180
    v_add_f32 v222, v222, v210
    v_mfma_f32_32x32x16_bf16 a[16:31], v[140:143], v[196:199], a[16:31]
    v_exp_f32 v213, v181
    v_add_f32 v222, v222, v211
    v_cvt_pk_bf16_f32 v201, v210, v211
    v_mfma_f32_32x32x16_bf16 a[32:47], v[148:151], v[196:199], a[32:47]
    v_exp_f32 v214, v182
    v_add_f32 v222, v222, v212
    v_exp_f32 v215, v183
    v_mfma_f32_32x32x16_bf16 a[48:63], v[156:159], v[196:199], a[48:63]
    v_add_f32 v222, v222, v213
    v_cvt_pk_bf16_f32 v202, v212, v213
    v_exp_f32 v208, v184
    s_waitcnt lgkmcnt(0)
    v_mfma_f32_32x32x16_bf16 v[160:175], v[96:99], v[0:3], v[32:47]
    v_add_f32 v222, v222, v214
    v_exp_f32 v209, v185
    v_add_f32 v222, v222, v215
    v_mfma_f32_32x32x16_bf16 v[160:175], v[100:103], v[4:7], v[160:175]
    v_cvt_pk_bf16_f32 v203, v214, v215
    v_exp_f32 v210, v186
    v_add_f32 v222, v222, v208
    v_mfma_f32_32x32x16_bf16 v[160:175], v[104:107], v[8:11], v[160:175]
    v_exp_f32 v211, v187
    v_add_f32 v222, v222, v209
    v_cvt_pk_bf16_f32 v204, v208, v209
    v_mfma_f32_32x32x16_bf16 v[160:175], v[108:111], v[12:15], v[160:175]
    v_exp_f32 v212, v188
    v_add_f32 v222, v222, v210
    v_exp_f32 v213, v189
    v_mfma_f32_32x32x16_bf16 v[160:175], v[112:115], v[16:19], v[160:175]
    v_add_f32 v222, v222, v211
    v_exp_f32 v214, v190
    v_add_f32 v222, v222, v212
    v_mfma_f32_32x32x16_bf16 v[160:175], v[116:119], v[20:23], v[160:175]
    v_exp_f32 v215, v191
    v_add_f32 v222, v222, v213
    v_add_f32 v222, v222, v214
    v_add_f32 v222, v222, v215
    v_mfma_f32_32x32x16_bf16 v[160:175], v[120:123], v[24:27], v[160:175]
    v_subrev_u32 v253, s29, v222
    v_cmp_lt_u32 vcc, s22, v253
    v_cvt_pk_bf16_f32 v205, v210, v211
    v_cvt_pk_bf16_f32 v206, v212, v213
    v_mfma_f32_32x32x16_bf16 v[160:175], v[124:127], v[28:31], v[160:175]
    v_cvt_pk_bf16_f32 v207, v214, v215
    s_cbranch_vccnz L_stub21
L_ret21:
    v_add_f32 v220, v220, v222
    v_mfma_f32_32x32x16_bf16 a[64:79], v[128:131], v[200:203], a[64:79]
    ds_read_b64_tr_b16 v[128:129], v231 offset:8192
    ds_read_b64_tr_b16 v[130:131], v231 offset:10240
    buffer_load_dwordx4 v239, s[16:19], s21 offen offset:2048 nt lds
    buffer_load_dwordx4 v239, s[16:19], s21 offen offset:3072 nt lds
    v_mfma_f32_32x32x16_bf16 a[80:95], v[136:139], v[200:203], a[80:95]
    ds_read_b64_tr_b16 v[136:137], v232 offset:8192
    ds_read_b64_tr_b16 v[138:139], v232 offset:10240
    s_add_u32 s34, s34, 32768
    s_cmp_ge_u32 s34, s40
    s_cselect_b32 s60, s41, 0
    s_sub_u32 s34, s34, s60
    v_mfma_f32_32x32x16_bf16 a[96:111], v[144:147], v[200:203], a[96:111]
    ds_read_b64_tr_b16 v[144:145], v233 offset:8192
    ds_read_b64_tr_b16 v[146:147], v233 offset:10240
    v_exp_f32 v208, v160
    v_exp_f32 v209, v161
    v_mfma_f32_32x32x16_bf16 a[112:127], v[152:155], v[200:203], a[112:127]
    ds_read_b64_tr_b16 v[152:153], v234 offset:8192
    ds_read_b64_tr_b16 v[154:155], v234 offset:10240
    v_exp_f32 v210, v162
    v_mfma_f32_32x32x16_bf16 a[64:79], v[132:135], v[204:207], a[64:79]
    ds_read_b64_tr_b16 v[132:133], v231 offset:12288
    ds_read_b64_tr_b16 v[134:135], v231 offset:14336
    v_exp_f32 v211, v163
    v_add_f32 v222, v208, v209
    v_cvt_pk_bf16_f32 v192, v208, v209
    v_mfma_f32_32x32x16_bf16 a[80:95], v[140:143], v[204:207], a[80:95]
    ds_read_b64_tr_b16 v[140:141], v232 offset:12288
    ds_read_b64_tr_b16 v[142:143], v232 offset:14336
    v_exp_f32 v212, v164
    v_add_f32 v222, v222, v210
    v_mfma_f32_32x32x16_bf16 a[96:111], v[148:151], v[204:207], a[96:111]
    ds_read_b64_tr_b16 v[148:149], v233 offset:12288
    ds_read_b64_tr_b16 v[150:151], v233 offset:14336
    v_exp_f32 v213, v165
    v_add_f32 v222, v222, v211
    v_mfma_f32_32x32x16_bf16 a[112:127], v[156:159], v[204:207], a[112:127]
    ds_read_b64_tr_b16 v[156:157], v234 offset:12288
    ds_read_b64_tr_b16 v[158:159], v234 offset:14336
    v_cvt_pk_bf16_f32 v193, v210, v211
    v_exp_f32 v214, v166
    v_mfma_f32_32x32x16_bf16 v[176:191], v[96:99], a[192:195], v[48:63]
    v_add_f32 v222, v222, v212
    v_exp_f32 v215, v167
    v_add_f32 v222, v222, v213
    v_cvt_pk_bf16_f32 v194, v212, v213
    v_mfma_f32_32x32x16_bf16 v[176:191], v[100:103], a[196:199], v[176:191]
    v_exp_f32 v208, v168
    v_add_f32 v222, v222, v214
    v_exp_f32 v209, v169
    v_add_f32 v222, v222, v215
    v_mfma_f32_32x32x16_bf16 v[176:191], v[104:107], a[200:203], v[176:191]
    v_cvt_pk_bf16_f32 v195, v214, v215
    v_exp_f32 v210, v170
    v_add_f32 v222, v222, v208
    v_mfma_f32_32x32x16_bf16 v[176:191], v[108:111], a[204:207], v[176:191]
    v_exp_f32 v211, v171
    v_add_f32 v222, v222, v209
    v_cvt_pk_bf16_f32 v196, v208, v209
    v_exp_f32 v212, v172
    v_mfma_f32_32x32x16_bf16 v[176:191], v[112:115], a[208:211], v[176:191]
    v_add_f32 v222, v222, v210
    v_exp_f32 v213, v173
    v_add_f32 v222, v222, v211
    v_exp_f32 v214, v174
    v_mfma_f32_32x32x16_bf16 v[176:191], v[116:119], a[212:215], v[176:191]
    v_add_f32 v222, v222, v212
    v_exp_f32 v215, v175
    v_add_f32 v222, v222, v213
    v_add_f32 v222, v222, v214
    v_mfma_f32_32x32x16_bf16 v[176:191], v[120:123], a[216:219], v[176:191]
    v_add_f32 v222, v222, v215
    v_subrev_u32 v253, s29, v222
    v_cmp_lt_u32 vcc, s22, v253
    v_cvt_pk_bf16_f32 v197, v210, v211
    v_cvt_pk_bf16_f32 v198, v212, v213
    v_mfma_f32_32x32x16_bf16 v[176:191], v[124:127], a[220:223], v[176:191]
    v_cvt_pk_bf16_f32 v199, v214, v215
    s_cbranch_vccnz L_stub22
L_ret22:
    v_add_f32 v219, v219, v222
    s_waitcnt lgkmcnt(0)
    v_mfma_f32_32x32x16_bf16 a[0:15], v[128:131], v[192:195], a[0:15]
    s_add_u32 s20, s20, 16384
    s_add_u32 s21, s21, 16384
    s_bitcmp1_b32 s58, s32
    s_cbranch_scc1 L_sp42
L_spr43:
    v_mfma_f32_32x32x16_bf16 a[16:31], v[136:139], v[192:195], a[16:31]
    v_mfma_f32_32x32x16_bf16 a[32:47], v[144:147], v[192:195], a[32:47]
    s_nop 0
    v_exp_f32 v208, v176
    v_exp_f32 v209, v177
    v_exp_f32 v210, v178
    v_mfma_f32_32x32x16_bf16 a[48:63], v[152:155], v[192:195], a[48:63]
    v_exp_f32 v211, v179
    v_add_f32 v222, v208, v209
    v_cvt_pk_bf16_f32 v200, v208, v209
    v_mfma_f32_32x32x16_bf16 a[0:15], v[132:135], v[196:199], a[0:15]
    v_exp_f32 v212, v180
    v_add_f32 v222, v222, v210
    v_exp_f32 v213, v181
    v_add_f32 v222, v222, v211
    v_mfma_f32_32x32x16_bf16 a[16:31], v[140:143], v[196:199], a[16:31]
    v_cvt_pk_bf16_f32 v201, v210, v211
    v_exp_f32 v214, v182
    v_add_f32 v222, v222, v212
    v_exp_f32 v215, v183
    v_mfma_f32_32x32x16_bf16 a[32:47], v[148:151], v[196:199], a[32:47]
    v_add_f32 v222, v222, v213
    v_cvt_pk_bf16_f32 v202, v212, v213
    v_exp_f32 v208, v184
    v_add_f32 v222, v222, v214
    v_mfma_f32_32x32x16_bf16 a[48:63], v[156:159], v[196:199], a[48:63]
    v_exp_f32 v209, v185
    v_add_f32 v222, v222, v215
    v_cvt_pk_bf16_f32 v203, v214, v215
    v_exp_f32 v210, v186
    v_mfma_f32_32x32x16_bf16 v[160:175], v[96:99], a[224:227], v[64:79]
    s_add_u32 s35, s35, 32768
    s_cmp_ge_u32 s35, s40
    s_cselect_b32 s46, s41, 0
    s_sub_u32 s35, s35, s46
    v_add_f32 v222, v222, v208
    v_mfma_f32_32x32x16_bf16 v[160:175], v[100:103], a[228:231], v[160:175]
    s_sub_u32 s36, s35, s51
    s_mov_b32 s51, s35
    s_mov_b32 s52, s35
    s_add_u32 s32, s32, 1
    v_exp_f32 v211, v187
    v_mfma_f32_32x32x16_bf16 v[160:175], v[104:107], a[232:235], v[160:175]
    v_add_u32 v223, s36, v223
    v_add_u32 v224, s36, v224
    v_add_f32 v222, v222, v209
    v_cvt_pk_bf16_f32 v204, v208, v209
    v_exp_f32 v212, v188
    v_mfma_f32_32x32x16_bf16 v[160:175], v[108:111], a[236:239], v[160:175]
    v_add_u32 v225, s36, v225
    v_add_f32 v222, v222, v210
    v_exp_f32 v213, v189
    v_add_f32 v222, v222, v211
    v_mfma_f32_32x32x16_bf16 v[160:175], v[112:115], a[240:243], v[160:175]
    v_add_u32 v226, s36, v226
    v_exp_f32 v214, v190
    v_add_f32 v222, v222, v212
    v_exp_f32 v215, v191
    v_mfma_f32_32x32x16_bf16 v[160:175], v[116:119], a[244:247], v[160:175]
    v_add_u32 v227, s36, v227
    v_add_u32 v228, s36, v228
    v_add_f32 v222, v222, v213
    v_add_f32 v222, v222, v214
    v_add_f32 v222, v222, v215
    v_mfma_f32_32x32x16_bf16 v[160:175], v[120:123], a[248:251], v[160:175]
    v_add_u32 v229, s36, v229
    v_subrev_u32 v253, s29, v222
    v_cmp_lt_u32 vcc, s22, v253
    v_cvt_pk_bf16_f32 v205, v210, v211
    v_cvt_pk_bf16_f32 v206, v212, v213
    v_mfma_f32_32x32x16_bf16 v[160:175], v[124:127], a[252:255], v[160:175]
    v_add_u32 v230, s36, v230
    v_cvt_pk_bf16_f32 v207, v214, v215
    s_cbranch_vccnz L_stub23
L_ret23:
    v_add_f32 v220, v220, v222
    v_mfma_f32_32x32x16_bf16 a[64:79], v[128:131], v[200:203], a[64:79]
    s_waitcnt lgkmcnt(0)
    s_bitcmp1_b32 s59, s32
    s_cbranch_scc1 L_bw27
    s_waitcnt vmcnt(24)
L_bwr28:
    s_barrier
    v_mfma_f32_32x32x16_bf16 a[80:95], v[136:139], v[200:203], a[80:95]
    ds_read_b128 v[96:99], v223 offset:0
    ds_read_b128 v[100:103], v224 offset:0
    ds_read_b128 v[104:107], v225 offset:0
    v_mfma_f32_32x32x16_bf16 a[96:111], v[144:147], v[200:203], a[96:111]
    ds_read_b128 v[108:111], v226 offset:0
    ds_read_b128 v[112:115], v227 offset:0
    ds_read_b128 v[116:119], v228 offset:0
    v_exp_f32 v208, v160
    v_mfma_f32_32x32x16_bf16 a[112:127], v[152:155], v[200:203], a[112:127]
    ds_read_b128 v[120:123], v229 offset:0
    ds_read_b128 v[124:127], v230 offset:0
    v_exp_f32 v209, v161
    v_mfma_f32_32x32x16_bf16 a[64:79], v[132:135], v[204:207], a[64:79]
    s_bitcmp1_b32 s23, s32
    s_cbranch_scc1 L_ex36
L_exr37:
    v_exp_f32 v210, v162
    v_mfma_f32_32x32x16_bf16 a[80:95], v[140:143], v[204:207], a[80:95]
    v_exp_f32 v211, v163
    v_add_f32 v222, v208, v209
    v_cvt_pk_bf16_f32 v192, v208, v209
    v_exp_f32 v212, v164
    v_mfma_f32_32x32x16_bf16 a[96:111], v[148:151], v[204:207], a[96:111]
    v_add_f32 v222, v222, v210
    v_exp_f32 v213, v165
    v_add_f32 v222, v222, v211
    v_cvt_pk_bf16_f32 v193, v210, v211
    v_mfma_f32_32x32x16_bf16 a[112:127], v[156:159], v[204:207], a[112:127]
    v_exp_f32 v214, v166
    v_add_f32 v222, v222, v212
    v_exp_f32 v215, v167
    s_waitcnt lgkmcnt(0)
    v_mfma_f32_32x32x16_bf16 v[176:191], v[96:99], v[0:3], v[32:47]
    v_add_f32 v222, v222, v213
    v_cvt_pk_bf16_f32 v194, v212, v213
    v_exp_f32 v208, v168
    v_add_f32 v222, v222, v214
    v_mfma_f32_32x32x16_bf16 v[176:191], v[100:103], v[4:7], v[176:191]
    v_exp_f32 v209, v169
    v_add_f32 v222, v222, v215
    v_cvt_pk_bf16_f32 v195, v214, v215
    v_exp_f32 v210, v170
    v_mfma_f32_32x32x16_bf16 v[176:191], v[104:107], v[8:11], v[176:191]
    v_add_f32 v222, v222, v208
    v_exp_f32 v211, v171
    v_add_f32 v222, v222, v209
    v_cvt_pk_bf16_f32 v196, v208, v209
    v_mfma_f32_32x32x16_bf16 v[176:191], v[108:111], v[12:15], v[176:191]
    s_mov_b32 m0, s34
    s_nop 0
    buffer_load_dwordx4 v235, s[12:15], s20 offen offset:0 nt lds
    buffer_load_dwordx4 v236, s[12:15], s20 offen offset:1024 nt lds
    v_mfma_f32_32x32x16_bf16 v[176:191], v[112:115], v[16:19], v[176:191]
    v_exp_f32 v212, v172
    v_add_f32 v222, v222, v210
    v_exp_f32 v213, v173
    v_add_f32 v222, v222, v211
    v_mfma_f32_32x32x16_bf16 v[176:191], v[116:119], v[20:23], v[176:191]
    v_exp_f32 v214, v174
    v_add_f32 v222, v222, v212
    v_exp_f32 v215, v175
    v_add_f32 v222, v222, v213
    v_mfma_f32_32x32x16_bf16 v[176:191], v[120:123], v[24:27], v[176:191]
    v_add_f32 v222, v222, v214
    v_add_f32 v222, v222, v215
    v_subrev_u32 v253, s29, v222
    v_cmp_lt_u32 vcc, s22, v253
    v_cvt_pk_bf16_f32 v197, v210, v211
    v_mfma_f32_32x32x16_bf16 v[176:191], v[124:127], v[28:31], v[176:191]
    v_cvt_pk_bf16_f32 v198, v212, v213
    v_cvt_pk_bf16_f32 v199, v214, v215
    s_cbranch_vccnz L_stub24
L_ret24:
    v_add_f32 v221, v221, v222
    v_add_u32 v231, s36, v231
    v_add_u32 v232, s36, v232
    v_add_u32 v233, s36, v233
    v_add_u32 v234, s36, v234
    v_mfma_f32_32x32x16_bf16 a[128:143], v[128:131], v[192:195], a[128:143]
    ds_read_b64_tr_b16 v[128:129], v231 offset:0
    ds_read_b64_tr_b16 v[130:131], v231 offset:2048
    v_mfma_f32_32x32x16_bf16 a[144:159], v[136:139], v[192:195], a[144:159]
    ds_read_b64_tr_b16 v[136:137], v232 offset:0
    ds_read_b64_tr_b16 v[138:139], v232 offset:2048
    buffer_load_dwordx4 v237, s[12:15], s20 offen offset:2048 nt lds
    buffer_load_dwordx4 v238, s[12:15], s20 offen offset:3072 nt lds
    v_mfma_f32_32x32x16_bf16 a[160:175], v[144:147], v[192:195], a[160:175]
    ds_read_b64_tr_b16 v[144:145], v233 offset:0
    ds_read_b64_tr_b16 v[146:147], v233 offset:2048
    v_exp_f32 v208, v176
    v_exp_f32 v209, v177
    v_mfma_f32_32x32x16_bf16 a[176:191], v[152:155], v[192:195], a[176:191]
    ds_read_b64_tr_b16 v[152:153], v234 offset:0
    ds_read_b64_tr_b16 v[154:155], v234 offset:2048
    v_exp_f32 v210, v178
    v_exp_f32 v211, v179
    v_mfma_f32_32x32x16_bf16 a[128:143], v[132:135], v[196:199], a[128:143]
    ds_read_b64_tr_b16 v[132:133], v231 offset:4096
    ds_read_b64_tr_b16 v[134:135], v231 offset:6144
    v_add_f32 v222, v208, v209
    v_cvt_pk_bf16_f32 v200, v208, v209
    v_exp_f32 v212, v180
    v_mfma_f32_32x32x16_bf16 a[144:159], v[140:143], v[196:199], a[144:159]
    ds_read_b64_tr_b16 v[140:141], v232 offset:4096
    ds_read_b64_tr_b16 v[142:143], v232 offset:6144
    v_add_f32 v222, v222, v210
    v_exp_f32 v213, v181
    v_add_f32 v222, v222, v211
    v_mfma_f32_32x32x16_bf16 a[160:175], v[148:151], v[196:199], a[160:175]
    ds_read_b64_tr_b16 v[148:149], v233 offset:4096
    ds_read_b64_tr_b16 v[150:151], v233 offset:6144
    v_cvt_pk_bf16_f32 v201, v210, v211
    v_exp_f32 v214, v182
    v_add_f32 v222, v222, v212
    v_mfma_f32_32x32x16_bf16 a[176:191], v[156:159], v[196:199], a[176:191]
    ds_read_b64_tr_b16 v[156:157], v234 offset:4096
    ds_read_b64_tr_b16 v[158:159], v234 offset:6144
    v_exp_f32 v215, v183
    v_add_f32 v222, v222, v213
    v_cvt_pk_bf16_f32 v202, v212, v213
    v_mfma_f32_32x32x16_bf16 v[160:175], v[96:99], a[192:195], v[48:63]
    ds_read_b128 v[96:99], v223 offset:8192
    v_exp_f32 v208, v184
    v_add_f32 v222, v222, v214
    v_exp_f32 v209, v185
    v_mfma_f32_32x32x16_bf16 v[160:175], v[100:103], a[196:199], v[160:175]
    ds_read_b128 v[100:103], v224 offset:8192
    v_add_f32 v222, v222, v215
    v_cvt_pk_bf16_f32 v203, v214, v215
    v_exp_f32 v210, v186
    v_mfma_f32_32x32x16_bf16 v[160:175], v[104:107], a[200:203], v[160:175]
    ds_read_b128 v[104:107], v225 offset:8192
    v_add_f32 v222, v222, v208
    v_exp_f32 v211, v187
    v_add_f32 v222, v222, v209
    v_cvt_pk_bf16_f32 v204, v208, v209
    v_mfma_f32_32x32x16_bf16 v[160:175], v[108:111], a[204:207], v[160:175]
    ds_read_b128 v[108:111], v226 offset:8192
    v_exp_f32 v212, v188
    v_add_f32 v222, v222, v210
    v_exp_f32 v213, v189
    v_mfma_f32_32x32x16_bf16 v[160:175], v[112:115], a[208:211], v[160:175]
    ds_read_b128 v[112:115], v227 offset:8192
    v_add_f32 v222, v222, v211
    v_exp_f32 v214, v190
    v_add_f32 v222, v222, v212
    v_mfma_f32_32x32x16_bf16 v[160:175], v[116:119], a[212:215], v[160:175]
    ds_read_b128 v[116:119], v228 offset:8192
    v_exp_f32 v215, v191
    v_add_f32 v222, v222, v213
    v_add_f32 v222, v222, v214
    v_add_f32 v222, v222, v215
    v_mfma_f32_32x32x16_bf16 v[160:175], v[120:123], a[216:219], v[160:175]
    ds_read_b128 v[120:123], v229 offset:8192
    v_subrev_u32 v253, s29, v222
    v_cmp_lt_u32 vcc, s22, v253
    v_cvt_pk_bf16_f32 v205, v210, v211
    v_cvt_pk_bf16_f32 v206, v212, v213
    v_mfma_f32_32x32x16_bf16 v[160:175], v[124:127], a[220:223], v[160:175]
    ds_read_b128 v[124:127], v230 offset:8192
    v_cvt_pk_bf16_f32 v207, v214, v215
    s_cbranch_vccnz L_stub25
L_ret25:
    v_add_f32 v219, v219, v222
    s_waitcnt lgkmcnt(8)
    v_mfma_f32_32x32x16_bf16 a[0:15], v[128:131], v[200:203], a[0:15]
    s_add_u32 m0, s34, 16384
    s_nop 0
    buffer_load_dwordx4 v239, s[16:19], s21 offen offset:0 nt lds
    buffer_load_dwordx4 v239, s[16:19], s21 offen offset:1024 nt lds
    v_mfma_f32_32x32x16_bf16 a[16:31], v[136:139], v[200:203], a[16:31]
    v_mfma_f32_32x32x16_bf16 a[32:47], v[144:147], v[200:203], a[32:47]
    v_exp_f32 v208, v160
    v_exp_f32 v209, v161
    v_mfma_f32_32x32x16_bf16 a[48:63], v[152:155], v[200:203], a[48:63]
    v_exp_f32 v210, v162
    v_exp_f32 v211, v163
    v_add_f32 v222, v208, v209
    v_mfma_f32_32x32x16_bf16 a[0:15], v[132:135], v[204:207], a[0:15]
    v_cvt_pk_bf16_f32 v192, v208, v209
    v_exp_f32 v212, v164
    v_add_f32 v222, v222, v210
    v_exp_f32 v213, v165
    v_mfma_f32_32x32x16_bf16 a[16:31], v[140:143], v[204:207], a[16:31]
    v_add_f32 v222, v222, v211
    v_cvt_pk_bf16_f32 v193, v210, v211
    v_exp_f32 v214, v166
    v_mfma_f32_32x32x16_bf16 a[32:47], v[148:151], v[204:207], a[32:47]
    v_add_f32 v222, v222, v212
    v_exp_f32 v215, v167
    v_add_f32 v222, v222, v213
    v_mfma_f32_32x32x16_bf16 a[48:63], v[156:159], v[204:207], a[48:63]
    v_cvt_pk_bf16_f32 v194, v212, v213
    v_exp_f32 v208, v168
    v_add_f32 v222, v222, v214
    s_waitcnt lgkmcnt(0)
    v_mfma_f32_32x32x16_bf16 v[176:191], v[96:99], v[0:3], v[32:47]
    v_exp_f32 v209, v169
    v_add_f32 v222, v222, v215
    v_cvt_pk_bf16_f32 v195, v214, v215
    v_exp_f32 v210, v170
    v_mfma_f32_32x32x16_bf16 v[176:191], v[100:103], v[4:7], v[176:191]
    v_add_f32 v222, v222, v208
    v_exp_f32 v211, v171
    v_add_f32 v222, v222, v209
    v_mfma_f32_32x32x16_bf16 v[176:191], v[104:107], v[8:11], v[176:191]
    v_cvt_pk_bf16_f32 v196, v208, v209
    v_exp_f32 v212, v172
    v_add_f32 v222, v222, v210
    v_mfma_f32_32x32x16_bf16 v[176:191], v[108:111], v[12:15], v[176:191]
    buffer_load_dwordx4 v239, s[16:19], s21 offen offset:2048 nt lds
    buffer_load_dwordx4 v239, s[16:19], s21 offen offset:3072 nt lds
    v_exp_f32 v213, v173
    v_mfma_f32_32x32x16_bf16 v[176:191], v[112:115], v[16:19], v[176:191]
    v_add_f32 v222, v222, v211
    v_exp_f32 v214, v174
    v_add_f32 v222, v222, v212
    v_mfma_f32_32x32x16_bf16 v[176:191], v[116:119], v[20:23], v[176:191]
    v_exp_f32 v215, v175
    v_add_f32 v222, v222, v213
    v_add_f32 v222, v222, v214
    v_add_f32 v222, v222, v215
    v_mfma_f32_32x32x16_bf16 v[176:191], v[120:123], v[24:27], v[176:191]
    v_subrev_u32 v253, s29, v222
    v_cmp_lt_u32 vcc, s22, v253
    v_cvt_pk_bf16_f32 v197, v210, v211
    v_cvt_pk_bf16_f32 v198, v212, v213
    v_mfma_f32_32x32x16_bf16 v[176:191], v[124:127], v[28:31], v[176:191]
    v_cvt_pk_bf16_f32 v199, v214, v215
    s_cbranch_vccnz L_stub26
L_ret26:
    v_add_f32 v220, v220, v222
    v_mfma_f32_32x32x16_bf16 a[64:79], v[128:131], v[192:195], a[64:79]
    ds_read_b64_tr_b16 v[128:129], v231 offset:8192
    ds_read_b64_tr_b16 v[130:131], v231 offset:10240
    v_mfma_f32_32x32x16_bf16 a[80:95], v[136:139], v[192:195], a[80:95]
    ds_read_b64_tr_b16 v[136:137], v232 offset:8192
    ds_read_b64_tr_b16 v[138:139], v232 offset:10240
    s_add_u32 s34, s34, 32768
    s_cmp_ge_u32 s34, s40
    s_cselect_b32 s60, s41, 0
    s_sub_u32 s34, s34, s60
    v_mfma_f32_32x32x16_bf16 a[96:111], v[144:147], v[192:195], a[96:111]
    ds_read_b64_tr_b16 v[144:145], v233 offset:8192
    ds_read_b64_tr_b16 v[146:147], v233 offset:10240
    v_exp_f32 v208, v176
    v_exp_f32 v209, v177
    v_mfma_f32_32x32x16_bf16 a[112:127], v[152:155], v[192:195], a[112:127]
    ds_read_b64_tr_b16 v[152:153], v234 offset:8192
    ds_read_b64_tr_b16 v[154:155], v234 offset:10240
    v_exp_f32 v210, v178
    v_mfma_f32_32x32x16_bf16 a[64:79], v[132:135], v[196:199], a[64:79]
    ds_read_b64_tr_b16 v[132:133], v231 offset:12288
    ds_read_b64_tr_b16 v[134:135], v231 offset:14336
    v_exp_f32 v211, v179
    v_add_f32 v222, v208, v209
    v_cvt_pk_bf16_f32 v200, v208, v209
    v_mfma_f32_32x32x16_bf16 a[80:95], v[140:143], v[196:199], a[80:95]
    ds_read_b64_tr_b16 v[140:141], v232 offset:12288
    ds_read_b64_tr_b16 v[142:143], v232 offset:14336
    v_exp_f32 v212, v180
    v_add_f32 v222, v222, v210
    v_mfma_f32_32x32x16_bf16 a[96:111], v[148:151], v[196:199], a[96:111]
    ds_read_b64_tr_b16 v[148:149], v233 offset:12288
    ds_read_b64_tr_b16 v[150:151], v233 offset:14336
    v_exp_f32 v213, v181
    v_add_f32 v222, v222, v211
    v_mfma_f32_32x32x16_bf16 a[112:127], v[156:159], v[196:199], a[112:127]
    ds_read_b64_tr_b16 v[156:157], v234 offset:12288
    ds_read_b64_tr_b16 v[158:159], v234 offset:14336
    v_cvt_pk_bf16_f32 v201, v210, v211
    v_exp_f32 v214, v182
    v_mfma_f32_32x32x16_bf16 v[160:175], v[96:99], a[192:195], v[48:63]
    v_add_f32 v222, v222, v212
    v_exp_f32 v215, v183
    v_add_f32 v222, v222, v213
    v_cvt_pk_bf16_f32 v202, v212, v213
    v_mfma_f32_32x32x16_bf16 v[160:175], v[100:103], a[196:199], v[160:175]
    v_exp_f32 v208, v184
    v_add_f32 v222, v222, v214
    v_exp_f32 v209, v185
    v_add_f32 v222, v222, v215
    v_mfma_f32_32x32x16_bf16 v[160:175], v[104:107], a[200:203], v[160:175]
    v_cvt_pk_bf16_f32 v203, v214, v215
    v_exp_f32 v210, v186
    v_add_f32 v222, v222, v208
    v_mfma_f32_32x32x16_bf16 v[160:175], v[108:111], a[204:207], v[160:175]
    v_exp_f32 v211, v187
    v_add_f32 v222, v222, v209
    v_cvt_pk_bf16_f32 v204, v208, v209
    v_exp_f32 v212, v188
    v_mfma_f32_32x32x16_bf16 v[160:175], v[112:115], a[208:211], v[160:175]
    v_add_f32 v222, v222, v210
    v_exp_f32 v213, v189
    v_add_f32 v222, v222, v211
    v_exp_f32 v214, v190
    v_mfma_f32_32x32x16_bf16 v[160:175], v[116:119], a[212:215], v[160:175]
    v_add_f32 v222, v222, v212
    v_exp_f32 v215, v191
    v_add_f32 v222, v222, v213
    v_add_f32 v222, v222, v214
    v_mfma_f32_32x32x16_bf16 v[160:175], v[120:123], a[216:219], v[160:175]
    v_add_f32 v222, v222, v215
    v_subrev_u32 v253, s29, v222
    v_cmp_lt_u32 vcc, s22, v253
    v_cvt_pk_bf16_f32 v205, v210, v211
    v_cvt_pk_bf16_f32 v206, v212, v213
    v_mfma_f32_32x32x16_bf16 v[160:175], v[124:127], a[220:223], v[160:175]
    v_cvt_pk_bf16_f32 v207, v214, v215
    s_cbranch_vccnz L_stub27
L_ret27:
    v_add_f32 v219, v219, v222
    s_waitcnt lgkmcnt(0)
    v_mfma_f32_32x32x16_bf16 a[0:15], v[128:131], v[200:203], a[0:15]
    s_add_u32 s20, s20, 16384
    s_add_u32 s21, s21, 16384
    s_bitcmp1_b32 s58, s32
    s_cbranch_scc1 L_sp29
L_spr30:
    v_mfma_f32_32x32x16_bf16 a[16:31], v[136:139], v[200:203], a[16:31]
    v_mfma_f32_32x32x16_bf16 a[32:47], v[144:147], v[200:203], a[32:47]
    s_nop 0
    v_exp_f32 v208, v160
    v_exp_f32 v209, v161
    v_exp_f32 v210, v162
    v_mfma_f32_32x32x16_bf16 a[48:63], v[152:155], v[200:203], a[48:63]
    v_exp_f32 v211, v163
    v_add_f32 v222, v208, v209
    v_cvt_pk_bf16_f32 v192, v208, v209
    v_mfma_f32_32x32x16_bf16 a[0:15], v[132:135], v[204:207], a[0:15]
    v_exp_f32 v212, v164
    v_add_f32 v222, v222, v210
    v_exp_f32 v213, v165
    v_add_f32 v222, v222, v211
    v_mfma_f32_32x32x16_bf16 a[16:31], v[140:143], v[204:207], a[16:31]
    v_cvt_pk_bf16_f32 v193, v210, v211
    v_exp_f32 v214, v166
    v_add_f32 v222, v222, v212
    v_exp_f32 v215, v167
    v_mfma_f32_32x32x16_bf16 a[32:47], v[148:151], v[204:207], a[32:47]
    v_add_f32 v222, v222, v213
    v_cvt_pk_bf16_f32 v194, v212, v213
    v_exp_f32 v208, v168
    v_add_f32 v222, v222, v214
    v_mfma_f32_32x32x16_bf16 a[48:63], v[156:159], v[204:207], a[48:63]
    v_exp_f32 v209, v169
    v_add_f32 v222, v222, v215
    v_cvt_pk_bf16_f32 v195, v214, v215
    v_exp_f32 v210, v170
    v_mfma_f32_32x32x16_bf16 v[176:191], v[96:99], a[224:227], v[64:79]
    s_add_u32 s35, s35, 32768
    s_cmp_ge_u32 s35, s40
    s_cselect_b32 s46, s41, 0
    s_sub_u32 s35, s35, s46
    v_add_f32 v222, v222, v208
    v_mfma_f32_32x32x16_bf16 v[176:191], v[100:103], a[228:231], v[176:191]
    s_sub_u32 s36, s35, s51
    s_mov_b32 s51, s35
    s_mov_b32 s52, s35
    s_add_u32 s32, s32, 1
    v_exp_f32 v211, v171
    v_mfma_f32_32x32x16_bf16 v[176:191], v[104:107], a[232:235], v[176:191]
    v_add_u32 v223, s36, v223
    v_add_u32 v224, s36, v224
    v_add_f32 v222, v222, v209
    v_cvt_pk_bf16_f32 v196, v208, v209
    v_exp_f32 v212, v172
    v_mfma_f32_32x32x16_bf16 v[176:191], v[108:111], a[236:239], v[176:191]
    v_add_u32 v225, s36, v225
    v_add_f32 v222, v222, v210
    v_exp_f32 v213, v173
    v_add_f32 v222, v222, v211
    v_mfma_f32_32x32x16_bf16 v[176:191], v[112:115], a[240:243], v[176:191]
    v_add_u32 v226, s36, v226
    v_exp_f32 v214, v174
    v_add_f32 v222, v222, v212
    v_exp_f32 v215, v175
    v_mfma_f32_32x32x16_bf16 v[176:191], v[116:119], a[244:247], v[176:191]
    v_add_u32 v227, s36, v227
    v_add_u32 v228, s36, v228
    v_add_f32 v222, v222, v213
    v_add_f32 v222, v222, v214
    v_add_f32 v222, v222, v215
    v_mfma_f32_32x32x16_bf16 v[176:191], v[120:123], a[248:251], v[176:191]
    v_add_u32 v229, s36, v229
    v_subrev_u32 v253, s29, v222
    v_cmp_lt_u32 vcc, s22, v253
    v_cvt_pk_bf16_f32 v197, v210, v211
    v_cvt_pk_bf16_f32 v198, v212, v213
    v_mfma_f32_32x32x16_bf16 v[176:191], v[124:127], a[252:255], v[176:191]
    v_add_u32 v230, s36, v230
    v_cvt_pk_bf16_f32 v199, v214, v215
    s_cbranch_vccnz L_stub28
L_ret28:
    v_add_f32 v220, v220, v222
    v_mfma_f32_32x32x16_bf16 a[64:79], v[128:131], v[192:195], a[64:79]
    s_waitcnt lgkmcnt(0)
    s_bitcmp1_b32 s59, s32
    s_cbranch_scc1 L_bw40
    s_waitcnt vmcnt(24)
L_bwr41:
    s_barrier
    v_mfma_f32_32x32x16_bf16 a[80:95], v[136:139], v[192:195], a[80:95]
    ds_read_b128 v[96:99], v223 offset:0
    ds_read_b128 v[100:103], v224 offset:0
    ds_read_b128 v[104:107], v225 offset:0
    v_mfma_f32_32x32x16_bf16 a[96:111], v[144:147], v[192:195], a[96:111]
    ds_read_b128 v[108:111], v226 offset:0
    ds_read_b128 v[112:115], v227 offset:0
    ds_read_b128 v[116:119], v228 offset:0
    v_mfma_f32_32x32x16_bf16 a[112:127], v[152:155], v[192:195], a[112:127]
    ds_read_b128 v[120:123], v229 offset:0
    ds_read_b128 v[124:127], v230 offset:0
    v_exp_f32 v208, v176
    v_mfma_f32_32x32x16_bf16 a[64:79], v[132:135], v[196:199], a[64:79]
    v_exp_f32 v209, v177
    v_exp_f32 v210, v178
    v_exp_f32 v211, v179
    v_mfma_f32_32x32x16_bf16 a[80:95], v[140:143], v[196:199], a[80:95]
    v_add_f32 v222, v208, v209
    v_cvt_pk_bf16_f32 v200, v208, v209
    v_exp_f32 v212, v180
    v_mfma_f32_32x32x16_bf16 a[96:111], v[148:151], v[196:199], a[96:111]
    v_add_f32 v222, v222, v210
    v_exp_f32 v213, v181
    v_add_f32 v222, v222, v211
    v_cvt_pk_bf16_f32 v201, v210, v211
    v_mfma_f32_32x32x16_bf16 a[112:127], v[156:159], v[196:199], a[112:127]
    v_exp_f32 v214, v182
    v_add_f32 v222, v222, v212
    v_exp_f32 v215, v183
    s_waitcnt lgkmcnt(0)
    v_mfma_f32_32x32x16_bf16 v[160:175], v[96:99], v[0:3], v[32:47]
    v_add_f32 v222, v222, v213
    v_cvt_pk_bf16_f32 v202, v212, v213
    v_exp_f32 v208, v184
    v_add_f32 v222, v222, v214
    v_mfma_f32_32x32x16_bf16 v[160:175], v[100:103], v[4:7], v[160:175]
    v_exp_f32 v209, v185
    v_add_f32 v222, v222, v215
    v_cvt_pk_bf16_f32 v203, v214, v215
    v_mfma_f32_32x32x16_bf16 v[160:175], v[104:107], v[8:11], v[160:175]
    v_exp_f32 v210, v186
    v_add_f32 v222, v222, v208
    v_exp_f32 v211, v187
    v_add_f32 v222, v222, v209
    v_mfma_f32_32x32x16_bf16 v[160:175], v[108:111], v[12:15], v[160:175]
    v_cvt_pk_bf16_f32 v204, v208, v209
    v_exp_f32 v212, v188
    v_add_f32 v222, v222, v210
    v_mfma_f32_32x32x16_bf16 v[160:175], v[112:115], v[16:19], v[160:175]
    v_exp_f32 v213, v189
    v_add_f32 v222, v222, v211
    v_exp_f32 v214, v190
    v_mfma_f32_32x32x16_bf16 v[160:175], v[116:119], v[20:23], v[160:175]
    v_add_f32 v222, v222, v212
    v_exp_f32 v215, v191
    v_add_f32 v222, v222, v213
    v_add_f32 v222, v222, v214
    v_mfma_f32_32x32x16_bf16 v[160:175], v[120:123], v[24:27], v[160:175]
    v_add_f32 v222, v222, v215
    v_subrev_u32 v253, s29, v222
    v_cmp_lt_u32 vcc, s22, v253
    v_cvt_pk_bf16_f32 v205, v210, v211
    v_cvt_pk_bf16_f32 v206, v212, v213
    v_mfma_f32_32x32x16_bf16 v[160:175], v[124:127], v[28:31], v[160:175]
    v_cvt_pk_bf16_f32 v207, v214, v215
    s_cbranch_vccnz L_stub29
L_ret29:
    v_add_f32 v221, v221, v222
    v_add_u32 v231, s36, v231
    v_add_u32 v232, s36, v232
    v_add_u32 v233, s36, v233
    v_add_u32 v234, s36, v234
    v_mfma_f32_32x32x16_bf16 a[128:143], v[128:131], v[200:203], a[128:143]
    s_cmp_lg_u32 s32, s43
    s_cbranch_scc1 L_loop_A1
    s_cmp_lg_u32 s44, 0
    s_cbranch_scc1 L_last_A1
    v_mfma_f32_32x32x16_bf16 a[144:159], v[136:139], v[200:203], a[144:159]
    v_mfma_f32_32x32x16_bf16 a[160:175], v[144:147], v[200:203], a[160:175]
    v_mfma_f32_32x32x16_bf16 a[176:191], v[152:155], v[200:203], a[176:191]
    v_mfma_f32_32x32x16_bf16 a[128:143], v[132:135], v[204:207], a[128:143]
    v_mfma_f32_32x32x16_bf16 a[144:159], v[140:143], v[204:207], a[144:159]
    v_mfma_f32_32x32x16_bf16 a[160:175], v[148:151], v[204:207], a[160:175]
    v_mfma_f32_32x32x16_bf16 a[176:191], v[156:159], v[204:207], a[176:191]
    s_waitcnt vmcnt(8)
    s_waitcnt lgkmcnt(0)
    s_xor_b32 s54, s34, 4096
    v_mov_b32 v74, v64
    v_mov_b32 v242, v221
    v_mov_b32 v243, v221
    s_nop 1
    v_permlane32_swap_b32 v242, v243
    s_nop 1
    v_add_f32 v75, v242, v243
    v_add_u32 v246, s54, v254
    ds_write_b64 v246, v[74:75]
    v_add_u32 v72, s54, v255
    v_add_u32 v73, s34, v255
    ds_write_b128 v73, a[132:135] offset:1024
    ds_write_b128 v73, a[136:139] offset:2048
    ds_write_b128 v73, a[140:143] offset:3072
    ds_write_b128 v73, a[144:147] offset:16384
    ds_write_b128 v73, a[148:151] offset:17408
    ds_write_b128 v73, a[152:155] offset:18432
    ds_write_b128 v73, a[156:159] offset:19456
    s_add_u32 s42, s35, s55
    s_mov_b32 s62, s34
    s_mov_b32 s53, s37
    s_mov_b32 s61, 0
    v_add_u32 v251, s35, v240
    v_xor_b32 v208, 0, v241
    v_lshl_add_u32 v208, v208, 4, v251
    v_xor_b32 v209, 2, v241
    v_lshl_add_u32 v209, v209, 4, v251
    v_xor_b32 v210, 4, v241
    v_lshl_add_u32 v210, v210, 4, v251
    v_xor_b32 v211, 6, v241
    v_lshl_add_u32 v211, v211, 4, v251
    v_xor_b32 v212, 8, v241
    v_lshl_add_u32 v212, v212, 4, v251
    v_xor_b32 v213, 10, v241
    v_lshl_add_u32 v213, v213, 4, v251
    v_xor_b32 v214, 12, v241
    v_lshl_add_u32 v214, v214, 4, v251
    v_xor_b32 v215, 14, v241
    v_lshl_add_u32 v215, v215, 4, v251
    ds_read_b128 v[160:163], v208
    ds_read_b128 v[164:167], v209
    ds_read_b128 v[168:171], v210
    ds_read_b128 v[172:175], v211
    ds_read_b128 v[176:179], v212
    ds_read_b128 v[180:183], v213
    ds_read_b128 v[184:187], v214
    ds_read_b128 v[188:191], v215
    s_add_u32 s35, s35, 32768
    s_cmp_ge_u32 s35, s40
    s_cselect_b32 s46, s41, 0
    s_sub_u32 s35, s35, s46
    s_waitcnt lgkmcnt(7)
    v_lshlrev_b32 v80, 16, v160
    v_and_b32 v81, s63, v160
    v_lshlrev_b32 v82, 16, v161
    v_and_b32 v83, s63, v161
    v_lshlrev_b32 v84, 16, v162
    v_and_b32 v85, s63, v162
    v_lshlrev_b32 v86, 16, v163
    v_and_b32 v87, s63, v163
    v_pk_mul_f32 v[80:81], v[80:81], s[94:95]
    v_pk_mul_f32 v[82:83], v[82:83], s[94:95]
    v_pk_mul_f32 v[84:85], v[84:85], s[94:95]
    v_pk_mul_f32 v[86:87], v[86:87], s[94:95]
    v_cvt_pk_bf16_f32 v0, v80, v81
    v_cvt_pk_bf16_f32 v1, v82, v83
    v_cvt_pk_bf16_f32 v2, v84, v85
    v_cvt_pk_bf16_f32 v3, v86, v87
    s_waitcnt lgkmcnt(6)
    v_lshlrev_b32 v80, 16, v164
    v_and_b32 v81, s63, v164
    v_lshlrev_b32 v82, 16, v165
    v_and_b32 v83, s63, v165
    v_lshlrev_b32 v84, 16, v166
    v_and_b32 v85, s63, v166
    v_lshlrev_b32 v86, 16, v167
    v_and_b32 v87, s63, v167
    v_pk_mul_f32 v[80:81], v[80:81], s[94:95]
    v_pk_mul_f32 v[82:83], v[82:83], s[94:95]
    v_pk_mul_f32 v[84:85], v[84:85], s[94:95]
    v_pk_mul_f32 v[86:87], v[86:87], s[94:95]
    v_cvt_pk_bf16_f32 v4, v80, v81
    v_cvt_pk_bf16_f32 v5, v82, v83
    v_cvt_pk_bf16_f32 v6, v84, v85
    v_cvt_pk_bf16_f32 v7, v86, v87
    s_waitcnt lgkmcnt(5)
    v_lshlrev_b32 v80, 16, v168
    v_and_b32 v81, s63, v168
    v_lshlrev_b32 v82, 16, v169
    v_and_b32 v83, s63, v169
    v_lshlrev_b32 v84, 16, v170
    v_and_b32 v85, s63, v170
    v_lshlrev_b32 v86, 16, v171
    v_and_b32 v87, s63, v171
    v_pk_mul_f32 v[80:81], v[80:81], s[94:95]
    v_pk_mul_f32 v[82:83], v[82:83], s[94:95]
    v_pk_mul_f32 v[84:85], v[84:85], s[94:95]
    v_pk_mul_f32 v[86:87], v[86:87], s[94:95]
    v_cvt_pk_bf16_f32 v8, v80, v81
    v_cvt_pk_bf16_f32 v9, v82, v83
    v_cvt_pk_bf16_f32 v10, v84, v85
    v_cvt_pk_bf16_f32 v11, v86, v87
    s_waitcnt lgkmcnt(4)
    v_lshlrev_b32 v80, 16, v172
    v_and_b32 v81, s63, v172
    v_lshlrev_b32 v82, 16, v173
    v_and_b32 v83, s63, v173
    v_lshlrev_b32 v84, 16, v174
    v_and_b32 v85, s63, v174
    v_lshlrev_b32 v86, 16, v175
    v_and_b32 v87, s63, v175
    v_pk_mul_f32 v[80:81], v[80:81], s[94:95]
    v_pk_mul_f32 v[82:83], v[82:83], s[94:95]
    v_pk_mul_f32 v[84:85], v[84:85], s[94:95]
    v_pk_mul_f32 v[86:87], v[86:87], s[94:95]
    v_cvt_pk_bf16_f32 v12, v80, v81
    v_cvt_pk_bf16_f32 v13, v82, v83
    v_cvt_pk_bf16_f32 v14, v84, v85
    v_cvt_pk_bf16_f32 v15, v86, v87
    s_waitcnt lgkmcnt(3)
    v_lshlrev_b32 v80, 16, v176
    v_and_b32 v81, s63, v176
    v_lshlrev_b32 v82, 16, v177
    v_and_b32 v83, s63, v177
    v_lshlrev_b32 v84, 16, v178
    v_and_b32 v85, s63, v178
    v_lshlrev_b32 v86, 16, v179
    v_and_b32 v87, s63, v179
    v_pk_mul_f32 v[80:81], v[80:81], s[94:95]
    v_pk_mul_f32 v[82:83], v[82:83], s[94:95]
    v_pk_mul_f32 v[84:85], v[84:85], s[94:95]
    v_pk_mul_f32 v[86:87], v[86:87], s[94:95]
    v_cvt_pk_bf16_f32 v16, v80, v81
    v_cvt_pk_bf16_f32 v17, v82, v83
    v_cvt_pk_bf16_f32 v18, v84, v85
    v_cvt_pk_bf16_f32 v19, v86, v87
    s_waitcnt lgkmcnt(2)
    v_lshlrev_b32 v80, 16, v180
    v_and_b32 v81, s63, v180
    v_lshlrev_b32 v82, 16, v181
    v_and_b32 v83, s63, v181
    v_lshlrev_b32 v84, 16, v182
    v_and_b32 v85, s63, v182
    v_lshlrev_b32 v86, 16, v183
    v_and_b32 v87, s63, v183
    v_pk_mul_f32 v[80:81], v[80:81], s[94:95]
    v_pk_mul_f32 v[82:83], v[82:83], s[94:95]
    v_pk_mul_f32 v[84:85], v[84:85], s[94:95]
    v_pk_mul_f32 v[86:87], v[86:87], s[94:95]
    v_cvt_pk_bf16_f32 v20, v80, v81
    v_cvt_pk_bf16_f32 v21, v82, v83
    v_cvt_pk_bf16_f32 v22, v84, v85
    v_cvt_pk_bf16_f32 v23, v86, v87
    s_waitcnt lgkmcnt(1)
    v_lshlrev_b32 v80, 16, v184
    v_and_b32 v81, s63, v184
    v_lshlrev_b32 v82, 16, v185
    v_and_b32 v83, s63, v185
    v_lshlrev_b32 v84, 16, v186
    v_and_b32 v85, s63, v186
    v_lshlrev_b32 v86, 16, v187
    v_and_b32 v87, s63, v187
    v_pk_mul_f32 v[80:81], v[80:81], s[94:95]
    v_pk_mul_f32 v[82:83], v[82:83], s[94:95]
    v_pk_mul_f32 v[84:85], v[84:85], s[94:95]
    v_pk_mul_f32 v[86:87], v[86:87], s[94:95]
    v_cvt_pk_bf16_f32 v24, v80, v81
    v_cvt_pk_bf16_f32 v25, v82, v83
    v_cvt_pk_bf16_f32 v26, v84, v85
    v_cvt_pk_bf16_f32 v27, v86, v87
    s_waitcnt lgkmcnt(0)
    v_lshlrev_b32 v80, 16, v188
    v_and_b32 v81, s63, v188
    v_lshlrev_b32 v82, 16, v189
    v_and_b32 v83, s63, v189
    v_lshlrev_b32 v84, 16, v190
    v_and_b32 v85, s63, v190
    v_lshlrev_b32 v86, 16, v191
    v_and_b32 v87, s63, v191
    v_pk_mul_f32 v[80:81], v[80:81], s[94:95]
    v_pk_mul_f32 v[82:83], v[82:83], s[94:95]
    v_pk_mul_f32 v[84:85], v[84:85], s[94:95]
    v_pk_mul_f32 v[86:87], v[86:87], s[94:95]
    v_cvt_pk_bf16_f32 v28, v80, v81
    v_cvt_pk_bf16_f32 v29, v82, v83
    v_cvt_pk_bf16_f32 v30, v84, v85
    v_cvt_pk_bf16_f32 v31, v86, v87
    s_waitcnt lgkmcnt(0)
    s_barrier
    v_add_u32 v247, s34, v254
    ds_read_b64 v[248:249], v247
    s_waitcnt lgkmcnt(0)
    ds_write_b128 v73, a[128:131] offset:0
    v_min_f32 v242, v74, v248
    v_sub_f32 v243, v242, v74
    v_sub_f32 v242, v242, v248
    v_exp_f32 v243, v243
    v_exp_f32 v242, v242
    v_mul_f32 v245, v75, v243
    v_fma_f32 v245, v249, v242, v245
    v_rcp_f32 v245, v245
    s_nop 0
    v_mul_f32 v70, v245, v242
    v_mul_f32 v68, v245, v243
    v_mov_b32 v71, v70
    v_mov_b32 v69, v68
    v_mov_b32 v242, v219
    v_mov_b32 v243, v219
    s_nop 1
    v_permlane32_swap_b32 v242, v243
    s_nop 1
    v_add_f32 v244, v242, v243
    v_rcp_f32 v244, v244
    s_nop 0
    v_mov_b32 v245, v244
    v_accvgpr_read_b32 v160, a0
    v_accvgpr_read_b32 v161, a1
    v_accvgpr_read_b32 v162, a2
    v_accvgpr_read_b32 v163, a3
    v_accvgpr_read_b32 v164, a4
    v_accvgpr_read_b32 v165, a5
    v_accvgpr_read_b32 v166, a6
    v_accvgpr_read_b32 v167, a7
    v_pk_mul_f32 v[160:161], v[160:161], v[244:245]
    v_pk_mul_f32 v[162:163], v[162:163], v[244:245]
    v_pk_mul_f32 v[164:165], v[164:165], v[244:245]
    v_pk_mul_f32 v[166:167], v[166:167], v[244:245]
    v_cvt_pk_bf16_f32 v168, v160, v161
    v_cvt_pk_bf16_f32 v169, v162, v163
    v_cvt_pk_bf16_f32 v170, v164, v165
    v_cvt_pk_bf16_f32 v171, v166, v167
    s_nop 0
    v_permlane32_swap_b32 v168, v170
    v_permlane32_swap_b32 v169, v171
    ds_write_b128 v208, v[168:171] offset:0
    v_accvgpr_read_b32 v172, a8
    v_accvgpr_read_b32 v173, a9
    v_accvgpr_read_b32 v174, a10
    v_accvgpr_read_b32 v175, a11
    v_accvgpr_read_b32 v176, a12
    v_accvgpr_read_b32 v177, a13
    v_accvgpr_read_b32 v178, a14
    v_accvgpr_read_b32 v179, a15
    v_pk_mul_f32 v[172:173], v[172:173], v[244:245]
    v_pk_mul_f32 v[174:175], v[174:175], v[244:245]
    v_pk_mul_f32 v[176:177], v[176:177], v[244:245]
    v_pk_mul_f32 v[178:179], v[178:179], v[244:245]
    v_cvt_pk_bf16_f32 v180, v172, v173
    v_cvt_pk_bf16_f32 v181, v174, v175
    v_cvt_pk_bf16_f32 v182, v176, v177
    v_cvt_pk_bf16_f32 v183, v178, v179
    s_nop 0
    v_permlane32_swap_b32 v180, v182
    v_permlane32_swap_b32 v181, v183
    ds_write_b128 v209, v[180:183] offset:0
    v_accvgpr_read_b32 v184, a16
    v_accvgpr_read_b32 v185, a17
    v_accvgpr_read_b32 v186, a18
    v_accvgpr_read_b32 v187, a19
    v_accvgpr_read_b32 v188, a20
    v_accvgpr_read_b32 v189, a21
    v_accvgpr_read_b32 v190, a22
    v_accvgpr_read_b32 v191, a23
    v_pk_mul_f32 v[184:185], v[184:185], v[244:245]
    v_pk_mul_f32 v[186:187], v[186:187], v[244:245]
    v_pk_mul_f32 v[188:189], v[188:189], v[244:245]
    v_pk_mul_f32 v[190:191], v[190:191], v[244:245]
    v_cvt_pk_bf16_f32 v192, v184, v185
    v_cvt_pk_bf16_f32 v193, v186, v187
    v_cvt_pk_bf16_f32 v194, v188, v189
    v_cvt_pk_bf16_f32 v195, v190, v191
    s_nop 0
    v_permlane32_swap_b32 v192, v194
    v_permlane32_swap_b32 v193, v195
    ds_write_b128 v210, v[192:195] offset:0
    v_accvgpr_read_b32 v196, a24
    v_accvgpr_read_b32 v197, a25
    v_accvgpr_read_b32 v198, a26
    v_accvgpr_read_b32 v199, a27
    v_accvgpr_read_b32 v200, a28
    v_accvgpr_read_b32 v201, a29
    v_accvgpr_read_b32 v202, a30
    v_accvgpr_read_b32 v203, a31
    v_pk_mul_f32 v[196:197], v[196:197], v[244:245]
    v_pk_mul_f32 v[198:199], v[198:199], v[244:245]
    v_pk_mul_f32 v[200:201], v[200:201], v[244:245]
    v_pk_mul_f32 v[202:203], v[202:203], v[244:245]
    v_cvt_pk_bf16_f32 v204, v196, v197
    v_cvt_pk_bf16_f32 v205, v198, v199
    v_cvt_pk_bf16_f32 v206, v200, v201
    v_cvt_pk_bf16_f32 v207, v202, v203
    s_nop 0
    v_permlane32_swap_b32 v204, v206
    v_permlane32_swap_b32 v205, v207
    ds_write_b128 v211, v[204:207] offset:0
    v_accvgpr_read_b32 v160, a32
    v_accvgpr_read_b32 v161, a33
    v_accvgpr_read_b32 v162, a34
    v_accvgpr_read_b32 v163, a35
    v_accvgpr_read_b32 v164, a36
    v_accvgpr_read_b32 v165, a37
    v_accvgpr_read_b32 v166, a38
    v_accvgpr_read_b32 v167, a39
    v_pk_mul_f32 v[160:161], v[160:161], v[244:245]
    v_pk_mul_f32 v[162:163], v[162:163], v[244:245]
    v_pk_mul_f32 v[164:165], v[164:165], v[244:245]
    v_pk_mul_f32 v[166:167], v[166:167], v[244:245]
    v_cvt_pk_bf16_f32 v168, v160, v161
    v_cvt_pk_bf16_f32 v169, v162, v163
    v_cvt_pk_bf16_f32 v170, v164, v165
    v_cvt_pk_bf16_f32 v171, v166, v167
    s_nop 0
    v_permlane32_swap_b32 v168, v170
    v_permlane32_swap_b32 v169, v171
    ds_write_b128 v212, v[168:171] offset:0
    v_accvgpr_read_b32 v172, a40
    v_accvgpr_read_b32 v173, a41
    v_accvgpr_read_b32 v174, a42
    v_accvgpr_read_b32 v175, a43
    v_accvgpr_read_b32 v176, a44
    v_accvgpr_read_b32 v177, a45
    v_accvgpr_read_b32 v178, a46
    v_accvgpr_read_b32 v179, a47
    v_pk_mul_f32 v[172:173], v[172:173], v[244:245]
    v_pk_mul_f32 v[174:175], v[174:175], v[244:245]
    v_pk_mul_f32 v[176:177], v[176:177], v[244:245]
    v_pk_mul_f32 v[178:179], v[178:179], v[244:245]
    v_cvt_pk_bf16_f32 v180, v172, v173
    v_cvt_pk_bf16_f32 v181, v174, v175
    v_cvt_pk_bf16_f32 v182, v176, v177
    v_cvt_pk_bf16_f32 v183, v178, v179
    s_nop 0
    v_permlane32_swap_b32 v180, v182
    v_permlane32_swap_b32 v181, v183
    ds_write_b128 v213, v[180:183] offset:0
    v_accvgpr_read_b32 v184, a48
    v_accvgpr_read_b32 v185, a49
    v_accvgpr_read_b32 v186, a50
    v_accvgpr_read_b32 v187, a51
    v_accvgpr_read_b32 v188, a52
    v_accvgpr_read_b32 v189, a53
    v_accvgpr_read_b32 v190, a54
    v_accvgpr_read_b32 v191, a55
    v_pk_mul_f32 v[184:185], v[184:185], v[244:245]
    v_pk_mul_f32 v[186:187], v[186:187], v[244:245]
    v_pk_mul_f32 v[188:189], v[188:189], v[244:245]
    v_pk_mul_f32 v[190:191], v[190:191], v[244:245]
    v_cvt_pk_bf16_f32 v192, v184, v185
    v_cvt_pk_bf16_f32 v193, v186, v187
    v_cvt_pk_bf16_f32 v194, v188, v189
    v_cvt_pk_bf16_f32 v195, v190, v191
    s_nop 0
    v_permlane32_swap_b32 v192, v194
    v_permlane32_swap_b32 v193, v195
    ds_write_b128 v214, v[192:195] offset:0
    v_accvgpr_read_b32 v196, a56
    v_accvgpr_read_b32 v197, a57
    v_accvgpr_read_b32 v198, a58
    v_accvgpr_read_b32 v199, a59
    v_accvgpr_read_b32 v200, a60
    v_accvgpr_read_b32 v201, a61
    v_accvgpr_read_b32 v202, a62
    v_accvgpr_read_b32 v203, a63
    v_pk_mul_f32 v[196:197], v[196:197], v[244:245]
    v_pk_mul_f32 v[198:199], v[198:199], v[244:245]
    v_pk_mul_f32 v[200:201], v[200:201], v[244:245]
    v_pk_mul_f32 v[202:203], v[202:203], v[244:245]
    v_cvt_pk_bf16_f32 v204, v196, v197
    v_cvt_pk_bf16_f32 v205, v198, v199
    v_cvt_pk_bf16_f32 v206, v200, v201
    v_cvt_pk_bf16_f32 v207, v202, v203
    s_nop 0
    v_permlane32_swap_b32 v204, v206
    v_permlane32_swap_b32 v205, v207
    ds_write_b128 v215, v[204:207] offset:0
    s_waitcnt lgkmcnt(0)
    s_barrier
    ds_read_b128 v[32:35], v72 offset:0
    ds_read_b128 v[36:39], v72 offset:1024
    ds_read_b128 v[40:43], v72 offset:2048
    ds_read_b128 v[44:47], v72 offset:3072
    ds_read_b128 v[48:51], v72 offset:16384
    ds_read_b128 v[52:55], v72 offset:17408
    ds_read_b128 v[56:59], v72 offset:18432
    ds_read_b128 v[60:63], v72 offset:19456
    v_add_u32 v251, s35, v240
    v_xor_b32 v208, 0, v241
    v_lshl_add_u32 v208, v208, 4, v251
    v_xor_b32 v209, 2, v241
    v_lshl_add_u32 v209, v209, 4, v251
    v_xor_b32 v210, 4, v241
    v_lshl_add_u32 v210, v210, 4, v251
    v_xor_b32 v211, 6, v241
    v_lshl_add_u32 v211, v211, 4, v251
    v_xor_b32 v212, 8, v241
    v_lshl_add_u32 v212, v212, 4, v251
    v_xor_b32 v213, 10, v241
    v_lshl_add_u32 v213, v213, 4, v251
    v_xor_b32 v214, 12, v241
    v_lshl_add_u32 v214, v214, 4, v251
    v_xor_b32 v215, 14, v241
    v_lshl_add_u32 v215, v215, 4, v251
    ds_read_b128 v[160:163], v208
    ds_read_b128 v[164:167], v209
    ds_read_b128 v[168:171], v210
    ds_read_b128 v[172:175], v211
    ds_read_b128 v[176:179], v212
    ds_read_b128 v[180:183], v213
    ds_read_b128 v[184:187], v214
    ds_read_b128 v[188:191], v215
    s_add_u32 s35, s35, 32768
    s_cmp_ge_u32 s35, s40
    s_cselect_b32 s46, s41, 0
    s_sub_u32 s35, s35, s46
    s_waitcnt lgkmcnt(7)
    v_lshlrev_b32 v80, 16, v160
    v_and_b32 v81, s63, v160
    v_lshlrev_b32 v82, 16, v161
    v_and_b32 v83, s63, v161
    v_lshlrev_b32 v84, 16, v162
    v_and_b32 v85, s63, v162
    v_lshlrev_b32 v86, 16, v163
    v_and_b32 v87, s63, v163
    v_pk_mul_f32 v[80:81], v[80:81], s[94:95]
    v_pk_mul_f32 v[82:83], v[82:83], s[94:95]
    v_pk_mul_f32 v[84:85], v[84:85], s[94:95]
    v_pk_mul_f32 v[86:87], v[86:87], s[94:95]
    v_cvt_pk_bf16_f32 v88, v80, v81
    v_cvt_pk_bf16_f32 v89, v82, v83
    v_cvt_pk_bf16_f32 v90, v84, v85
    v_cvt_pk_bf16_f32 v91, v86, v87
    v_accvgpr_write_b32 a192, v88
    v_accvgpr_write_b32 a193, v89
    v_accvgpr_write_b32 a194, v90
    v_accvgpr_write_b32 a195, v91
    s_waitcnt lgkmcnt(6)
    v_lshlrev_b32 v80, 16, v164
    v_and_b32 v81, s63, v164
    v_lshlrev_b32 v82, 16, v165
    v_and_b32 v83, s63, v165
    v_lshlrev_b32 v84, 16, v166
    v_and_b32 v85, s63, v166
    v_lshlrev_b32 v86, 16, v167
    v_and_b32 v87, s63, v167
    v_pk_mul_f32 v[80:81], v[80:81], s[94:95]
    v_pk_mul_f32 v[82:83], v[82:83], s[94:95]
    v_pk_mul_f32 v[84:85], v[84:85], s[94:95]
    v_pk_mul_f32 v[86:87], v[86:87], s[94:95]
    v_cvt_pk_bf16_f32 v88, v80, v81
    v_cvt_pk_bf16_f32 v89, v82, v83
    v_cvt_pk_bf16_f32 v90, v84, v85
    v_cvt_pk_bf16_f32 v91, v86, v87
    v_accvgpr_write_b32 a196, v88
    v_accvgpr_write_b32 a197, v89
    v_accvgpr_write_b32 a198, v90
    v_accvgpr_write_b32 a199, v91
    s_waitcnt lgkmcnt(5)
    v_lshlrev_b32 v80, 16, v168
    v_and_b32 v81, s63, v168
    v_lshlrev_b32 v82, 16, v169
    v_and_b32 v83, s63, v169
    v_lshlrev_b32 v84, 16, v170
    v_and_b32 v85, s63, v170
    v_lshlrev_b32 v86, 16, v171
    v_and_b32 v87, s63, v171
    v_pk_mul_f32 v[80:81], v[80:81], s[94:95]
    v_pk_mul_f32 v[82:83], v[82:83], s[94:95]
    v_pk_mul_f32 v[84:85], v[84:85], s[94:95]
    v_pk_mul_f32 v[86:87], v[86:87], s[94:95]
    v_cvt_pk_bf16_f32 v88, v80, v81
    v_cvt_pk_bf16_f32 v89, v82, v83
    v_cvt_pk_bf16_f32 v90, v84, v85
    v_cvt_pk_bf16_f32 v91, v86, v87
    v_accvgpr_write_b32 a200, v88
    v_accvgpr_write_b32 a201, v89
    v_accvgpr_write_b32 a202, v90
    v_accvgpr_write_b32 a203, v91
    s_waitcnt lgkmcnt(4)
    v_lshlrev_b32 v80, 16, v172
    v_and_b32 v81, s63, v172
    v_lshlrev_b32 v82, 16, v173
    v_and_b32 v83, s63, v173
    v_lshlrev_b32 v84, 16, v174
    v_and_b32 v85, s63, v174
    v_lshlrev_b32 v86, 16, v175
    v_and_b32 v87, s63, v175
    v_pk_mul_f32 v[80:81], v[80:81], s[94:95]
    v_pk_mul_f32 v[82:83], v[82:83], s[94:95]
    v_pk_mul_f32 v[84:85], v[84:85], s[94:95]
    v_pk_mul_f32 v[86:87], v[86:87], s[94:95]
    v_cvt_pk_bf16_f32 v88, v80, v81
    v_cvt_pk_bf16_f32 v89, v82, v83
    v_cvt_pk_bf16_f32 v90, v84, v85
    v_cvt_pk_bf16_f32 v91, v86, v87
    v_accvgpr_write_b32 a204, v88
    v_accvgpr_write_b32 a205, v89
    v_accvgpr_write_b32 a206, v90
    v_accvgpr_write_b32 a207, v91
    s_waitcnt lgkmcnt(3)
    v_lshlrev_b32 v80, 16, v176
    v_and_b32 v81, s63, v176
    v_lshlrev_b32 v82, 16, v177
    v_and_b32 v83, s63, v177
    v_lshlrev_b32 v84, 16, v178
    v_and_b32 v85, s63, v178
    v_lshlrev_b32 v86, 16, v179
    v_and_b32 v87, s63, v179
    v_pk_mul_f32 v[80:81], v[80:81], s[94:95]
    v_pk_mul_f32 v[82:83], v[82:83], s[94:95]
    v_pk_mul_f32 v[84:85], v[84:85], s[94:95]
    v_pk_mul_f32 v[86:87], v[86:87], s[94:95]
    v_cvt_pk_bf16_f32 v88, v80, v81
    v_cvt_pk_bf16_f32 v89, v82, v83
    v_cvt_pk_bf16_f32 v90, v84, v85
    v_cvt_pk_bf16_f32 v91, v86, v87
    v_accvgpr_write_b32 a208, v88
    v_accvgpr_write_b32 a209, v89
    v_accvgpr_write_b32 a210, v90
    v_accvgpr_write_b32 a211, v91
    s_waitcnt lgkmcnt(2)
    v_lshlrev_b32 v80, 16, v180
    v_and_b32 v81, s63, v180
    v_lshlrev_b32 v82, 16, v181
    v_and_b32 v83, s63, v181
    v_lshlrev_b32 v84, 16, v182
    v_and_b32 v85, s63, v182
    v_lshlrev_b32 v86, 16, v183
    v_and_b32 v87, s63, v183
    v_pk_mul_f32 v[80:81], v[80:81], s[94:95]
    v_pk_mul_f32 v[82:83], v[82:83], s[94:95]
    v_pk_mul_f32 v[84:85], v[84:85], s[94:95]
    v_pk_mul_f32 v[86:87], v[86:87], s[94:95]
    v_cvt_pk_bf16_f32 v88, v80, v81
    v_cvt_pk_bf16_f32 v89, v82, v83
    v_cvt_pk_bf16_f32 v90, v84, v85
    v_cvt_pk_bf16_f32 v91, v86, v87
    v_accvgpr_write_b32 a212, v88
    v_accvgpr_write_b32 a213, v89
    v_accvgpr_write_b32 a214, v90
    v_accvgpr_write_b32 a215, v91
    s_waitcnt lgkmcnt(1)
    v_lshlrev_b32 v80, 16, v184
    v_and_b32 v81, s63, v184
    v_lshlrev_b32 v82, 16, v185
    v_and_b32 v83, s63, v185
    v_lshlrev_b32 v84, 16, v186
    v_and_b32 v85, s63, v186
    v_lshlrev_b32 v86, 16, v187
    v_and_b32 v87, s63, v187
    v_pk_mul_f32 v[80:81], v[80:81], s[94:95]
    v_pk_mul_f32 v[82:83], v[82:83], s[94:95]
    v_pk_mul_f32 v[84:85], v[84:85], s[94:95]
    v_pk_mul_f32 v[86:87], v[86:87], s[94:95]
    v_cvt_pk_bf16_f32 v88, v80, v81
    v_cvt_pk_bf16_f32 v89, v82, v83
    v_cvt_pk_bf16_f32 v90, v84, v85
    v_cvt_pk_bf16_f32 v91, v86, v87
    v_accvgpr_write_b32 a216, v88
    v_accvgpr_write_b32 a217, v89
    v_accvgpr_write_b32 a218, v90
    v_accvgpr_write_b32 a219, v91
    s_waitcnt lgkmcnt(0)
    v_lshlrev_b32 v80, 16, v188
    v_and_b32 v81, s63, v188
    v_lshlrev_b32 v82, 16, v189
    v_and_b32 v83, s63, v189
    v_lshlrev_b32 v84, 16, v190
    v_and_b32 v85, s63, v190
    v_lshlrev_b32 v86, 16, v191
    v_and_b32 v87, s63, v191
    v_pk_mul_f32 v[80:81], v[80:81], s[94:95]
    v_pk_mul_f32 v[82:83], v[82:83], s[94:95]
    v_pk_mul_f32 v[84:85], v[84:85], s[94:95]
    v_pk_mul_f32 v[86:87], v[86:87], s[94:95]
    v_cvt_pk_bf16_f32 v88, v80, v81
    v_cvt_pk_bf16_f32 v89, v82, v83
    v_cvt_pk_bf16_f32 v90, v84, v85
    v_cvt_pk_bf16_f32 v91, v86, v87
    v_accvgpr_write_b32 a220, v88
    v_accvgpr_write_b32 a221, v89
    v_accvgpr_write_b32 a222, v90
    v_accvgpr_write_b32 a223, v91
    s_waitcnt lgkmcnt(0)
    s_barrier
    v_bfe_u32 v242, v255, 4, 5
    v_bfe_u32 v243, v255, 9, 1
    v_and_b32 v248, 7, v242
    v_xor_b32 v248, v248, v243
    v_lshlrev_b32 v242, 7, v242
    v_add_u32 v242, s34, v242
    v_xor_b32 v208, 0, v248
    v_lshl_add_u32 v208, v208, 4, v242
    v_xor_b32 v209, 2, v248
    v_lshl_add_u32 v209, v209, 4, v242
    v_xor_b32 v210, 4, v248
    v_lshl_add_u32 v210, v210, 4, v242
    v_xor_b32 v211, 6, v248
    v_lshl_add_u32 v211, v211, 4, v242
    v_bfe_u32 v242, v255, 7, 3
    v_bfe_u32 v243, v255, 4, 3
    v_xor_b32 v243, v243, v242
    v_lshlrev_b32 v242, 8, v242
    v_lshl_add_u32 v253, v243, 4, v242
    v_add_u32 v251, s34, v255
    v_accvgpr_read_b32 v160, a160
    v_accvgpr_read_b32 v161, a161
    v_accvgpr_read_b32 v162, a162
    v_accvgpr_read_b32 v163, a163
    v_accvgpr_read_b32 v164, a164
    v_accvgpr_read_b32 v165, a165
    v_accvgpr_read_b32 v166, a166
    v_accvgpr_read_b32 v167, a167
    v_pk_mul_f32 v[160:161], v[160:161], v[68:69]
    v_pk_mul_f32 v[162:163], v[162:163], v[68:69]
    v_pk_mul_f32 v[164:165], v[164:165], v[68:69]
    v_pk_mul_f32 v[166:167], v[166:167], v[68:69]
    v_pk_fma_f32 v[160:161], v[32:33], v[70:71], v[160:161]
    v_pk_fma_f32 v[162:163], v[34:35], v[70:71], v[162:163]
    v_pk_fma_f32 v[164:165], v[36:37], v[70:71], v[164:165]
    v_pk_fma_f32 v[166:167], v[38:39], v[70:71], v[166:167]
    v_cvt_pk_bf16_f32 v168, v160, v161
    v_cvt_pk_bf16_f32 v169, v162, v163
    v_cvt_pk_bf16_f32 v170, v164, v165
    v_cvt_pk_bf16_f32 v171, v166, v167
    s_nop 0
    v_permlane32_swap_b32 v168, v170
    v_permlane32_swap_b32 v169, v171
    ds_write_b128 v208, v[168:171] offset:0
    v_accvgpr_read_b32 v172, a168
    v_accvgpr_read_b32 v173, a169
    v_accvgpr_read_b32 v174, a170
    v_accvgpr_read_b32 v175, a171
    v_accvgpr_read_b32 v176, a172
    v_accvgpr_read_b32 v177, a173
    v_accvgpr_read_b32 v178, a174
    v_accvgpr_read_b32 v179, a175
    v_pk_mul_f32 v[172:173], v[172:173], v[68:69]
    v_pk_mul_f32 v[174:175], v[174:175], v[68:69]
    v_pk_mul_f32 v[176:177], v[176:177], v[68:69]
    v_pk_mul_f32 v[178:179], v[178:179], v[68:69]
    v_pk_fma_f32 v[172:173], v[40:41], v[70:71], v[172:173]
    v_pk_fma_f32 v[174:175], v[42:43], v[70:71], v[174:175]
    v_pk_fma_f32 v[176:177], v[44:45], v[70:71], v[176:177]
    v_pk_fma_f32 v[178:179], v[46:47], v[70:71], v[178:179]
    v_cvt_pk_bf16_f32 v180, v172, v173
    v_cvt_pk_bf16_f32 v181, v174, v175
    v_cvt_pk_bf16_f32 v182, v176, v177
    v_cvt_pk_bf16_f32 v183, v178, v179
    s_nop 0
    v_permlane32_swap_b32 v180, v182
    v_permlane32_swap_b32 v181, v183
    ds_write_b128 v209, v[180:183] offset:0
    v_accvgpr_read_b32 v184, a176
    v_accvgpr_read_b32 v185, a177
    v_accvgpr_read_b32 v186, a178
    v_accvgpr_read_b32 v187, a179
    v_accvgpr_read_b32 v188, a180
    v_accvgpr_read_b32 v189, a181
    v_accvgpr_read_b32 v190, a182
    v_accvgpr_read_b32 v191, a183
    v_pk_mul_f32 v[184:185], v[184:185], v[68:69]
    v_pk_mul_f32 v[186:187], v[186:187], v[68:69]
    v_pk_mul_f32 v[188:189], v[188:189], v[68:69]
    v_pk_mul_f32 v[190:191], v[190:191], v[68:69]
    v_pk_fma_f32 v[184:185], v[48:49], v[70:71], v[184:185]
    v_pk_fma_f32 v[186:187], v[50:51], v[70:71], v[186:187]
    v_pk_fma_f32 v[188:189], v[52:53], v[70:71], v[188:189]
    v_pk_fma_f32 v[190:191], v[54:55], v[70:71], v[190:191]
    v_cvt_pk_bf16_f32 v192, v184, v185
    v_cvt_pk_bf16_f32 v193, v186, v187
    v_cvt_pk_bf16_f32 v194, v188, v189
    v_cvt_pk_bf16_f32 v195, v190, v191
    s_nop 0
    v_permlane32_swap_b32 v192, v194
    v_permlane32_swap_b32 v193, v195
    ds_write_b128 v210, v[192:195] offset:0
    v_accvgpr_read_b32 v196, a184
    v_accvgpr_read_b32 v197, a185
    v_accvgpr_read_b32 v198, a186
    v_accvgpr_read_b32 v199, a187
    v_accvgpr_read_b32 v200, a188
    v_accvgpr_read_b32 v201, a189
    v_accvgpr_read_b32 v202, a190
    v_accvgpr_read_b32 v203, a191
    v_pk_mul_f32 v[196:197], v[196:197], v[68:69]
    v_pk_mul_f32 v[198:199], v[198:199], v[68:69]
    v_pk_mul_f32 v[200:201], v[200:201], v[68:69]
    v_pk_mul_f32 v[202:203], v[202:203], v[68:69]
    v_pk_fma_f32 v[196:197], v[56:57], v[70:71], v[196:197]
    v_pk_fma_f32 v[198:199], v[58:59], v[70:71], v[198:199]
    v_pk_fma_f32 v[200:201], v[60:61], v[70:71], v[200:201]
    v_pk_fma_f32 v[202:203], v[62:63], v[70:71], v[202:203]
    v_cvt_pk_bf16_f32 v204, v196, v197
    v_cvt_pk_bf16_f32 v205, v198, v199
    v_cvt_pk_bf16_f32 v206, v200, v201
    v_cvt_pk_bf16_f32 v207, v202, v203
    s_nop 0
    v_permlane32_swap_b32 v204, v206
    v_permlane32_swap_b32 v205, v207
    ds_write_b128 v211, v[204:207] offset:0
    s_waitcnt lgkmcnt(0)
    ds_read_b128 v[80:83], v251 offset:0
    ds_read_b128 v[84:87], v251 offset:1024
    ds_read_b128 v[88:91], v251 offset:2048
    ds_read_b128 v[92:95], v251 offset:3072
    s_add_u32 s98, s38, 128
    s_add_u32 s99, s38, 4224
    s_waitcnt lgkmcnt(0)
    s_sub_u32 s45, s34, s55
    v_add_u32 v251, s45, v240
    v_xor_b32 v208, 0, v241
    v_lshl_add_u32 v208, v208, 4, v251
    v_xor_b32 v209, 2, v241
    v_lshl_add_u32 v209, v209, 4, v251
    v_xor_b32 v210, 4, v241
    v_lshl_add_u32 v210, v210, 4, v251
    v_xor_b32 v211, 6, v241
    v_lshl_add_u32 v211, v211, 4, v251
    v_xor_b32 v212, 8, v241
    v_lshl_add_u32 v212, v212, 4, v251
    v_xor_b32 v213, 10, v241
    v_lshl_add_u32 v213, v213, 4, v251
    v_xor_b32 v214, 12, v241
    v_lshl_add_u32 v214, v214, 4, v251
    v_xor_b32 v215, 14, v241
    v_lshl_add_u32 v215, v215, 4, v251
    v_mov_b32 v242, v220
    v_mov_b32 v243, v220
    s_nop 1
    v_permlane32_swap_b32 v242, v243
    s_nop 1
    v_add_f32 v244, v242, v243
    v_rcp_f32 v244, v244
    s_nop 0
    v_mov_b32 v245, v244
    v_accvgpr_read_b32 v160, a64
    v_accvgpr_read_b32 v161, a65
    buffer_store_dwordx4 v[80:83], v253, s[24:27], s98 offen offset:0 sc1 nt
    v_accvgpr_read_b32 v162, a66
    v_accvgpr_read_b32 v163, a67
    v_accvgpr_read_b32 v164, a68
    v_accvgpr_read_b32 v165, a69
    v_accvgpr_read_b32 v166, a70
    v_accvgpr_read_b32 v167, a71
    v_pk_mul_f32 v[160:161], v[160:161], v[244:245]
    v_pk_mul_f32 v[162:163], v[162:163], v[244:245]
    v_pk_mul_f32 v[164:165], v[164:165], v[244:245]
    v_pk_mul_f32 v[166:167], v[166:167], v[244:245]
    v_cvt_pk_bf16_f32 v168, v160, v161
    v_cvt_pk_bf16_f32 v169, v162, v163
    v_cvt_pk_bf16_f32 v170, v164, v165
    v_cvt_pk_bf16_f32 v171, v166, v167
    s_nop 0
    v_permlane32_swap_b32 v168, v170
    v_permlane32_swap_b32 v169, v171
    ds_write_b128 v208, v[168:171] offset:0
    v_accvgpr_read_b32 v172, a72
    v_accvgpr_read_b32 v173, a73
    v_accvgpr_read_b32 v174, a74
    v_accvgpr_read_b32 v175, a75
    v_accvgpr_read_b32 v176, a76
    v_accvgpr_read_b32 v177, a77
    v_accvgpr_read_b32 v178, a78
    v_accvgpr_read_b32 v179, a79
    v_pk_mul_f32 v[172:173], v[172:173], v[244:245]
    v_pk_mul_f32 v[174:175], v[174:175], v[244:245]
    v_pk_mul_f32 v[176:177], v[176:177], v[244:245]
    v_pk_mul_f32 v[178:179], v[178:179], v[244:245]
    v_cvt_pk_bf16_f32 v180, v172, v173
    v_cvt_pk_bf16_f32 v181, v174, v175
    v_cvt_pk_bf16_f32 v182, v176, v177
    v_cvt_pk_bf16_f32 v183, v178, v179
    s_nop 0
    v_permlane32_swap_b32 v180, v182
    v_permlane32_swap_b32 v181, v183
    ds_write_b128 v209, v[180:183] offset:0
    buffer_store_dwordx4 v[84:87], v253, s[24:27], s98 offen offset:2048 sc1 nt
    v_accvgpr_read_b32 v184, a80
    v_accvgpr_read_b32 v185, a81
    v_accvgpr_read_b32 v186, a82
    v_accvgpr_read_b32 v187, a83
    v_accvgpr_read_b32 v188, a84
    v_accvgpr_read_b32 v189, a85
    v_accvgpr_read_b32 v190, a86
    v_accvgpr_read_b32 v191, a87
    v_pk_mul_f32 v[184:185], v[184:185], v[244:245]
    v_pk_mul_f32 v[186:187], v[186:187], v[244:245]
    v_pk_mul_f32 v[188:189], v[188:189], v[244:245]
    v_pk_mul_f32 v[190:191], v[190:191], v[244:245]
    v_cvt_pk_bf16_f32 v192, v184, v185
    v_cvt_pk_bf16_f32 v193, v186, v187
    v_cvt_pk_bf16_f32 v194, v188, v189
    v_cvt_pk_bf16_f32 v195, v190, v191
    s_nop 0
    v_permlane32_swap_b32 v192, v194
    v_permlane32_swap_b32 v193, v195
    ds_write_b128 v210, v[192:195] offset:0
    v_accvgpr_read_b32 v196, a88
    v_accvgpr_read_b32 v197, a89
    v_accvgpr_read_b32 v198, a90
    v_accvgpr_read_b32 v199, a91
    v_accvgpr_read_b32 v200, a92
    v_accvgpr_read_b32 v201, a93
    v_accvgpr_read_b32 v202, a94
    v_accvgpr_read_b32 v203, a95
    v_pk_mul_f32 v[196:197], v[196:197], v[244:245]
    v_pk_mul_f32 v[198:199], v[198:199], v[244:245]
    v_pk_mul_f32 v[200:201], v[200:201], v[244:245]
    v_pk_mul_f32 v[202:203], v[202:203], v[244:245]
    v_cvt_pk_bf16_f32 v204, v196, v197
    v_cvt_pk_bf16_f32 v205, v198, v199
    v_cvt_pk_bf16_f32 v206, v200, v201
    v_cvt_pk_bf16_f32 v207, v202, v203
    buffer_store_dwordx4 v[88:91], v253, s[24:27], s99 offen offset:0 sc1 nt
    v_permlane32_swap_b32 v204, v206
    v_permlane32_swap_b32 v205, v207
    ds_write_b128 v211, v[204:207] offset:0
    v_accvgpr_read_b32 v160, a96
    v_accvgpr_read_b32 v161, a97
    v_accvgpr_read_b32 v162, a98
    v_accvgpr_read_b32 v163, a99
    v_accvgpr_read_b32 v164, a100
    v_accvgpr_read_b32 v165, a101
    v_accvgpr_read_b32 v166, a102
    v_accvgpr_read_b32 v167, a103
    v_pk_mul_f32 v[160:161], v[160:161], v[244:245]
    v_pk_mul_f32 v[162:163], v[162:163], v[244:245]
    v_pk_mul_f32 v[164:165], v[164:165], v[244:245]
    v_pk_mul_f32 v[166:167], v[166:167], v[244:245]
    v_cvt_pk_bf16_f32 v168, v160, v161
    v_cvt_pk_bf16_f32 v169, v162, v163
    v_cvt_pk_bf16_f32 v170, v164, v165
    v_cvt_pk_bf16_f32 v171, v166, v167
    s_nop 0
    v_permlane32_swap_b32 v168, v170
    v_permlane32_swap_b32 v169, v171
    ds_write_b128 v212, v[168:171] offset:0
    v_accvgpr_read_b32 v172, a104
    v_accvgpr_read_b32 v173, a105
    v_accvgpr_read_b32 v174, a106
    v_accvgpr_read_b32 v175, a107
    v_accvgpr_read_b32 v176, a108
    v_accvgpr_read_b32 v177, a109
    v_accvgpr_read_b32 v178, a110
    v_accvgpr_read_b32 v179, a111
    v_pk_mul_f32 v[172:173], v[172:173], v[244:245]
    v_pk_mul_f32 v[174:175], v[174:175], v[244:245]
    v_pk_mul_f32 v[176:177], v[176:177], v[244:245]
    v_pk_mul_f32 v[178:179], v[178:179], v[244:245]
    v_cvt_pk_bf16_f32 v180, v172, v173
    buffer_store_dwordx4 v[92:95], v253, s[24:27], s99 offen offset:2048 sc1 nt
    v_cvt_pk_bf16_f32 v181, v174, v175
    v_cvt_pk_bf16_f32 v182, v176, v177
    v_cvt_pk_bf16_f32 v183, v178, v179
    s_nop 0
    v_permlane32_swap_b32 v180, v182
    v_permlane32_swap_b32 v181, v183
    ds_write_b128 v213, v[180:183] offset:0
    v_accvgpr_read_b32 v184, a112
    v_accvgpr_read_b32 v185, a113
    v_accvgpr_read_b32 v186, a114
    v_accvgpr_read_b32 v187, a115
    v_accvgpr_read_b32 v188, a116
    v_accvgpr_read_b32 v189, a117
    v_accvgpr_read_b32 v190, a118
    v_accvgpr_read_b32 v191, a119
    v_pk_mul_f32 v[184:185], v[184:185], v[244:245]
    v_pk_mul_f32 v[186:187], v[186:187], v[244:245]
    v_pk_mul_f32 v[188:189], v[188:189], v[244:245]
    v_pk_mul_f32 v[190:191], v[190:191], v[244:245]
    v_cvt_pk_bf16_f32 v192, v184, v185
    v_cvt_pk_bf16_f32 v193, v186, v187
    v_cvt_pk_bf16_f32 v194, v188, v189
    v_cvt_pk_bf16_f32 v195, v190, v191
    s_nop 0
    v_permlane32_swap_b32 v192, v194
    v_permlane32_swap_b32 v193, v195
    ds_write_b128 v214, v[192:195] offset:0
    v_accvgpr_read_b32 v196, a120
    v_accvgpr_read_b32 v197, a121
    v_accvgpr_read_b32 v198, a122
    v_accvgpr_read_b32 v199, a123
    v_accvgpr_read_b32 v200, a124
    v_accvgpr_read_b32 v201, a125
    v_accvgpr_read_b32 v202, a126
    v_accvgpr_read_b32 v203, a127
    v_pk_mul_f32 v[196:197], v[196:197], v[244:245]
    v_pk_mul_f32 v[198:199], v[198:199], v[244:245]
    v_pk_mul_f32 v[200:201], v[200:201], v[244:245]
    v_pk_mul_f32 v[202:203], v[202:203], v[244:245]
    v_cvt_pk_bf16_f32 v204, v196, v197
    v_cvt_pk_bf16_f32 v205, v198, v199
    v_cvt_pk_bf16_f32 v206, v200, v201
    v_cvt_pk_bf16_f32 v207, v202, v203
    s_nop 0
    v_permlane32_swap_b32 v204, v206
    v_permlane32_swap_b32 v205, v207
    ds_write_b128 v215, v[204:207] offset:0
    s_mov_b32 s41, 98304
    s_add_u32 s34, s55, 65536
    v_mov_b32 v200, 0
    v_mov_b32 v201, 0
    v_mov_b32 v202, 0
    v_mov_b32 v203, 0
    v_mov_b32 v204, 0
    v_mov_b32 v205, 0
    v_mov_b32 v206, 0
    v_mov_b32 v207, 0
    v_mfma_f32_32x32x16_bf16 a[0:15], v[128:131], v[200:203], 0
    v_mov_b32 v32, 0
    v_mov_b32 v33, 0
    v_mov_b32 v34, 0
    v_mov_b32 v35, 0
    v_mfma_f32_32x32x16_bf16 a[16:31], v[128:131], v[200:203], 0
    v_mov_b32 v36, 0
    v_mov_b32 v37, 0
    v_mov_b32 v38, 0
    v_mov_b32 v39, 0
    v_mfma_f32_32x32x16_bf16 a[32:47], v[128:131], v[200:203], 0
    v_mov_b32 v40, 0
    v_mov_b32 v41, 0
    v_mov_b32 v42, 0
    v_mov_b32 v43, 0
    v_mfma_f32_32x32x16_bf16 a[48:63], v[128:131], v[200:203], 0
    v_mov_b32 v44, 0
    v_mov_b32 v45, 0
    v_mov_b32 v46, 0
    v_mov_b32 v47, 0
    v_mov_b32 v219, 0
    v_mfma_f32_32x32x16_bf16 a[64:79], v[128:131], v[200:203], 0
    v_mov_b32 v48, 0
    v_mov_b32 v49, 0
    v_mov_b32 v50, 0
    v_mov_b32 v51, 0
    v_mfma_f32_32x32x16_bf16 a[80:95], v[128:131], v[200:203], 0
    v_mov_b32 v52, 0
    v_mov_b32 v53, 0
    v_mov_b32 v54, 0
    v_mov_b32 v55, 0
    v_mfma_f32_32x32x16_bf16 a[96:111], v[128:131], v[200:203], 0
    v_mov_b32 v56, 0
    v_mov_b32 v57, 0
    v_mov_b32 v58, 0
    v_mov_b32 v59, 0
    v_mfma_f32_32x32x16_bf16 a[112:127], v[128:131], v[200:203], 0
    v_mov_b32 v60, 0
    v_mov_b32 v61, 0
    v_mov_b32 v62, 0
    v_mov_b32 v63, 0
    v_mov_b32 v220, 0
    s_waitcnt lgkmcnt(0)
    v_add_u32 v252, s42, v255
    ds_read_b128 v[80:83], v252 offset:0
    ds_read_b128 v[84:87], v252 offset:1024
    ds_read_b128 v[88:91], v252 offset:2048
    ds_read_b128 v[92:95], v252 offset:3072
    s_mov_b32 s44, 1
    s_mov_b32 s43, 14
    s_branch L_go_B
L_last_A1:
    ds_read_b64_tr_b16 v[128:129], v231 offset:0
    ds_read_b64_tr_b16 v[130:131], v231 offset:2048
    v_mfma_f32_32x32x16_bf16 a[144:159], v[136:139], v[200:203], a[144:159]
    s_mov_b32 s51, s35
    s_add_u32 s35, s35, 32768
    s_cmp_ge_u32 s35, s40
    s_cselect_b32 s46, s41, 0
    s_sub_u32 s35, s35, s46
    s_sub_u32 s36, s35, s51
    s_sub_u32 s101, s51, s35
    s_mov_b32 s35, s51
    ds_read_b128 v[96:99], v223 offset:8192
    ds_read_b128 v[100:103], v224 offset:8192
    ds_read_b128 v[104:107], v225 offset:8192
    ds_read_b64_tr_b16 v[136:137], v232 offset:0
    ds_read_b64_tr_b16 v[138:139], v232 offset:2048
    v_mfma_f32_32x32x16_bf16 a[160:175], v[144:147], v[200:203], a[160:175]
    ds_read_b128 v[108:111], v226 offset:8192
    ds_read_b128 v[112:115], v227 offset:8192
    ds_read_b128 v[116:119], v228 offset:8192
    ds_read_b64_tr_b16 v[144:145], v233 offset:0
    ds_read_b64_tr_b16 v[146:147], v233 offset:2048
    v_mfma_f32_32x32x16_bf16 a[176:191], v[152:155], v[200:203], a[176:191]
    ds_read_b128 v[120:123], v229 offset:8192
    ds_read_b128 v[124:127], v230 offset:8192
    ds_read_b64_tr_b16 v[152:153], v234 offset:0
    ds_read_b64_tr_b16 v[154:155], v234 offset:2048
    v_exp_f32 v208, v160
    v_exp_f32 v209, v161
    v_mfma_f32_32x32x16_bf16 a[128:143], v[132:135], v[204:207], a[128:143]
    s_waitcnt vmcnt(0)
    s_barrier
    v_add_u32 v223, s36, v223
    v_add_u32 v224, s36, v224
    ds_read_b64_tr_b16 v[132:133], v231 offset:4096
    ds_read_b64_tr_b16 v[134:135], v231 offset:6144
    v_mfma_f32_32x32x16_bf16 a[144:159], v[140:143], v[204:207], a[144:159]
    v_add_u32 v225, s36, v225
    v_add_u32 v226, s36, v226
    ds_read_b64_tr_b16 v[140:141], v232 offset:4096
    ds_read_b64_tr_b16 v[142:143], v232 offset:6144
    v_exp_f32 v210, v162
    v_exp_f32 v211, v163
    v_mfma_f32_32x32x16_bf16 a[160:175], v[148:151], v[204:207], a[160:175]
    v_add_u32 v227, s36, v227
    v_add_u32 v228, s36, v228
    ds_read_b64_tr_b16 v[148:149], v233 offset:4096
    ds_read_b64_tr_b16 v[150:151], v233 offset:6144
    v_add_f32 v222, v208, v209
    v_cvt_pk_bf16_f32 v192, v208, v209
    v_exp_f32 v212, v164
    v_mfma_f32_32x32x16_bf16 a[176:191], v[156:159], v[204:207], a[176:191]
    v_add_u32 v229, s36, v229
    v_add_u32 v230, s36, v230
    ds_read_b64_tr_b16 v[156:157], v234 offset:4096
    ds_read_b64_tr_b16 v[158:159], v234 offset:6144
    v_add_f32 v222, v222, v210
    v_exp_f32 v213, v165
    s_waitcnt lgkmcnt(15)
    v_mfma_f32_32x32x16_bf16 v[176:191], v[96:99], v[0:3], v[32:47]
    ds_read_b128 v[96:99], v223 offset:0
    v_add_f32 v222, v222, v211
    v_cvt_pk_bf16_f32 v193, v210, v211
    v_exp_f32 v214, v166
    v_add_f32 v222, v222, v212
    v_mfma_f32_32x32x16_bf16 v[176:191], v[100:103], v[4:7], v[176:191]
    ds_read_b128 v[100:103], v224 offset:0
    v_exp_f32 v215, v167
    v_add_f32 v222, v222, v213
    v_cvt_pk_bf16_f32 v194, v212, v213
    v_exp_f32 v208, v168
    v_mfma_f32_32x32x16_bf16 v[176:191], v[104:107], v[8:11], v[176:191]
    ds_read_b128 v[104:107], v225 offset:0
    v_add_f32 v222, v222, v214
    v_exp_f32 v209, v169
    v_add_f32 v222, v222, v215
    v_cvt_pk_bf16_f32 v195, v214, v215
    v_mfma_f32_32x32x16_bf16 v[176:191], v[108:111], v[12:15], v[176:191]
    ds_read_b128 v[108:111], v226 offset:0
    v_exp_f32 v210, v170
    v_add_f32 v222, v222, v208
    v_exp_f32 v211, v171
    v_add_f32 v222, v222, v209
    v_cvt_pk_bf16_f32 v196, v208, v209
    v_mfma_f32_32x32x16_bf16 v[176:191], v[112:115], v[16:19], v[176:191]
    ds_read_b128 v[112:115], v227 offset:0
    v_exp_f32 v212, v172
    v_add_f32 v222, v222, v210
    v_exp_f32 v213, v173
    s_waitcnt lgkmcnt(15)
    v_mfma_f32_32x32x16_bf16 v[176:191], v[116:119], v[20:23], v[176:191]
    ds_read_b128 v[116:119], v228 offset:0
    v_add_f32 v222, v222, v211
    v_exp_f32 v214, v174
    v_add_f32 v222, v222, v212
    v_exp_f32 v215, v175
    v_mfma_f32_32x32x16_bf16 v[176:191], v[120:123], v[24:27], v[176:191]
    ds_read_b128 v[120:123], v229 offset:0
    v_add_f32 v222, v222, v213
    v_add_f32 v222, v222, v214
    v_add_f32 v222, v222, v215
    v_subrev_u32 v253, s29, v222
    v_cmp_lt_u32 vcc, s22, v253
    v_cvt_pk_bf16_f32 v197, v210, v211
    v_mfma_f32_32x32x16_bf16 v[176:191], v[124:127], v[28:31], v[176:191]
    ds_read_b128 v[124:127], v230 offset:0
    v_cvt_pk_bf16_f32 v198, v212, v213
    v_cvt_pk_bf16_f32 v199, v214, v215
    s_cbranch_vccnz L_stub30
L_ret30:
    v_add_f32 v219, v219, v222
    v_mfma_f32_32x32x16_bf16 a[0:15], v[128:131], v[192:195], a[0:15]
    ds_read_b64_tr_b16 v[128:129], v231 offset:8192
    ds_read_b64_tr_b16 v[130:131], v231 offset:10240
    v_mfma_f32_32x32x16_bf16 a[16:31], v[136:139], v[192:195], a[16:31]
    ds_read_b64_tr_b16 v[136:137], v232 offset:8192
    ds_read_b64_tr_b16 v[138:139], v232 offset:10240
    v_mfma_f32_32x32x16_bf16 a[32:47], v[144:147], v[192:195], a[32:47]
    ds_read_b64_tr_b16 v[144:145], v233 offset:8192
    ds_read_b64_tr_b16 v[146:147], v233 offset:10240
    v_exp_f32 v208, v176
    v_exp_f32 v209, v177
    s_waitcnt lgkmcnt(14)
    v_mfma_f32_32x32x16_bf16 a[48:63], v[152:155], v[192:195], a[48:63]
    ds_read_b64_tr_b16 v[152:153], v234 offset:8192
    ds_read_b64_tr_b16 v[154:155], v234 offset:10240
    v_exp_f32 v210, v178
    v_exp_f32 v211, v179
    v_mfma_f32_32x32x16_bf16 a[0:15], v[132:135], v[196:199], a[0:15]
    ds_read_b64_tr_b16 v[132:133], v231 offset:12288
    ds_read_b64_tr_b16 v[134:135], v231 offset:14336
    v_add_f32 v222, v208, v209
    v_cvt_pk_bf16_f32 v200, v208, v209
    v_exp_f32 v212, v180
    v_mfma_f32_32x32x16_bf16 a[16:31], v[140:143], v[196:199], a[16:31]
    ds_read_b64_tr_b16 v[140:141], v232 offset:12288
    ds_read_b64_tr_b16 v[142:143], v232 offset:14336
    v_add_f32 v222, v222, v210
    v_exp_f32 v213, v181
    v_add_f32 v222, v222, v211
    v_mfma_f32_32x32x16_bf16 a[32:47], v[148:151], v[196:199], a[32:47]
    ds_read_b64_tr_b16 v[148:149], v233 offset:12288
    ds_read_b64_tr_b16 v[150:151], v233 offset:14336
    v_cvt_pk_bf16_f32 v201, v210, v211
    v_exp_f32 v214, v182
    v_add_f32 v222, v222, v212
    v_mfma_f32_32x32x16_bf16 a[48:63], v[156:159], v[196:199], a[48:63]
    ds_read_b64_tr_b16 v[156:157], v234 offset:12288
    ds_read_b64_tr_b16 v[158:159], v234 offset:14336
    v_exp_f32 v215, v183
    v_add_f32 v222, v222, v213
    v_cvt_pk_bf16_f32 v202, v212, v213
    s_waitcnt lgkmcnt(15)
    v_mfma_f32_32x32x16_bf16 v[160:175], v[96:99], v[0:3], v[32:47]
    ds_read_b128 v[96:99], v223 offset:8192
    v_exp_f32 v208, v184
    v_add_f32 v222, v222, v214
    v_exp_f32 v209, v185
    v_mfma_f32_32x32x16_bf16 v[160:175], v[100:103], v[4:7], v[160:175]
    ds_read_b128 v[100:103], v224 offset:8192
    v_add_f32 v222, v222, v215
    v_cvt_pk_bf16_f32 v203, v214, v215
    v_exp_f32 v210, v186
    v_mfma_f32_32x32x16_bf16 v[160:175], v[104:107], v[8:11], v[160:175]
    ds_read_b128 v[104:107], v225 offset:8192
    v_add_f32 v222, v222, v208
    v_exp_f32 v211, v187
    v_add_f32 v222, v222, v209
    v_cvt_pk_bf16_f32 v204, v208, v209
    v_mfma_f32_32x32x16_bf16 v[160:175], v[108:111], v[12:15], v[160:175]
    ds_read_b128 v[108:111], v226 offset:8192
    v_exp_f32 v212, v188
    v_add_f32 v222, v222, v210
    v_exp_f32 v213, v189
    v_mfma_f32_32x32x16_bf16 v[160:175], v[112:115], v[16:19], v[160:175]
    ds_read_b128 v[112:115], v227 offset:8192
    v_add_f32 v222, v222, v211
    v_exp_f32 v214, v190
    v_add_f32 v222, v222, v212
    v_mfma_f32_32x32x16_bf16 v[160:175], v[116:119], v[20:23], v[160:175]
    ds_read_b128 v[116:119], v228 offset:8192
    v_exp_f32 v215, v191
    v_add_f32 v222, v222, v213
    v_add_f32 v222, v222, v214
    v_add_f32 v222, v222, v215
    v_mfma_f32_32x32x16_bf16 v[160:175], v[120:123], v[24:27], v[160:175]
    ds_read_b128 v[120:123], v229 offset:8192
    v_subrev_u32 v253, s29, v222
    v_cmp_lt_u32 vcc, s22, v253
    v_cvt_pk_bf16_f32 v205, v210, v211
    v_cvt_pk_bf16_f32 v206, v212, v213
    v_mfma_f32_32x32x16_bf16 v[160:175], v[124:127], v[28:31], v[160:175]
    ds_read_b128 v[124:127], v230 offset:8192
    v_cvt_pk_bf16_f32 v207, v214, v215
    s_cbranch_vccnz L_stub31
L_ret31:
    v_add_f32 v219, v219, v222
    v_add_u32 v231, s36, v231
    v_add_u32 v232, s36, v232
    v_add_u32 v233, s36, v233
    v_add_u32 v234, s36, v234
    s_waitcnt lgkmcnt(8)
    v_mfma_f32_32x32x16_bf16 a[0:15], v[128:131], v[200:203], a[0:15]
    ds_read_b64_tr_b16 v[128:129], v231 offset:0
    ds_read_b64_tr_b16 v[130:131], v231 offset:2048
    v_mfma_f32_32x32x16_bf16 a[16:31], v[136:139], v[200:203], a[16:31]
    ds_read_b64_tr_b16 v[136:137], v232 offset:0
    ds_read_b64_tr_b16 v[138:139], v232 offset:2048
    v_mfma_f32_32x32x16_bf16 a[32:47], v[144:147], v[200:203], a[32:47]
    ds_read_b64_tr_b16 v[144:145], v233 offset:0
    ds_read_b64_tr_b16 v[146:147], v233 offset:2048
    v_exp_f32 v208, v160
    v_exp_f32 v209, v161
    v_mfma_f32_32x32x16_bf16 a[48:63], v[152:155], v[200:203], a[48:63]
    ds_read_b64_tr_b16 v[152:153], v234 offset:0
    ds_read_b64_tr_b16 v[154:155], v234 offset:2048
    v_exp_f32 v210, v162
    v_exp_f32 v211, v163
    v_add_f32 v222, v208, v209
    v_mfma_f32_32x32x16_bf16 a[0:15], v[132:135], v[204:207], a[0:15]
    v_add_u32 v223, s101, v223
    v_add_u32 v224, s101, v224
    ds_read_b64_tr_b16 v[132:133], v231 offset:4096
    ds_read_b64_tr_b16 v[134:135], v231 offset:6144
    v_cvt_pk_bf16_f32 v192, v208, v209
    v_exp_f32 v212, v164
    v_mfma_f32_32x32x16_bf16 a[16:31], v[140:143], v[204:207], a[16:31]
    v_add_u32 v225, s101, v225
    v_add_u32 v226, s101, v226
    ds_read_b64_tr_b16 v[140:141], v232 offset:4096
    ds_read_b64_tr_b16 v[142:143], v232 offset:6144
    v_add_f32 v222, v222, v210
    v_exp_f32 v213, v165
    v_mfma_f32_32x32x16_bf16 a[32:47], v[148:151], v[204:207], a[32:47]
    v_add_u32 v227, s101, v227
    v_add_u32 v228, s101, v228
    ds_read_b64_tr_b16 v[148:149], v233 offset:4096
    ds_read_b64_tr_b16 v[150:151], v233 offset:6144
    v_add_f32 v222, v222, v211
    v_cvt_pk_bf16_f32 v193, v210, v211
    v_mfma_f32_32x32x16_bf16 a[48:63], v[156:159], v[204:207], a[48:63]
    v_add_u32 v229, s101, v229
    v_add_u32 v230, s101, v230
    ds_read_b64_tr_b16 v[156:157], v234 offset:4096
    ds_read_b64_tr_b16 v[158:159], v234 offset:6144
    v_exp_f32 v214, v166
    v_add_f32 v222, v222, v212
    s_waitcnt lgkmcnt(15)
    v_mfma_f32_32x32x16_bf16 v[176:191], v[96:99], v[0:3], v[32:47]
    ds_read_b128 v[96:99], v223 offset:0
    v_exp_f32 v215, v167
    v_add_f32 v222, v222, v213
    v_cvt_pk_bf16_f32 v194, v212, v213
    v_exp_f32 v208, v168
    v_mfma_f32_32x32x16_bf16 v[176:191], v[100:103], v[4:7], v[176:191]
    ds_read_b128 v[100:103], v224 offset:0
    v_add_f32 v222, v222, v214
    v_exp_f32 v209, v169
    v_add_f32 v222, v222, v215
    v_mfma_f32_32x32x16_bf16 v[176:191], v[104:107], v[8:11], v[176:191]
    ds_read_b128 v[104:107], v225 offset:0
    v_cvt_pk_bf16_f32 v195, v214, v215
    v_exp_f32 v210, v170
    v_add_f32 v222, v222, v208
    v_exp_f32 v211, v171
    v_mfma_f32_32x32x16_bf16 v[176:191], v[108:111], v[12:15], v[176:191]
    ds_read_b128 v[108:111], v226 offset:0
    v_add_f32 v222, v222, v209
    v_cvt_pk_bf16_f32 v196, v208, v209
    v_exp_f32 v212, v172
    v_mfma_f32_32x32x16_bf16 v[176:191], v[112:115], v[16:19], v[176:191]
    ds_read_b128 v[112:115], v227 offset:0
    v_add_f32 v222, v222, v210
    v_exp_f32 v213, v173
    v_add_f32 v222, v222, v211
    v_exp_f32 v214, v174
    v_mfma_f32_32x32x16_bf16 v[176:191], v[116:119], v[20:23], v[176:191]
    ds_read_b128 v[116:119], v228 offset:0
    v_add_f32 v222, v222, v212
    v_exp_f32 v215, v175
    v_add_f32 v222, v222, v213
    v_add_f32 v222, v222, v214
    v_mfma_f32_32x32x16_bf16 v[176:191], v[120:123], v[24:27], v[176:191]
    ds_read_b128 v[120:123], v229 offset:0
    v_add_f32 v222, v222, v215
    v_subrev_u32 v253, s29, v222
    v_cmp_lt_u32 vcc, s22, v253
    v_cvt_pk_bf16_f32 v197, v210, v211
    v_cvt_pk_bf16_f32 v198, v212, v213
    v_mfma_f32_32x32x16_bf16 v[176:191], v[124:127], v[28:31], v[176:191]
    ds_read_b128 v[124:127], v230 offset:0
    v_cvt_pk_bf16_f32 v199, v214, v215
    s_cbranch_vccnz L_stub32
L_ret32:
    v_add_f32 v219, v219, v222
    s_waitcnt lgkmcnt(8)
    v_mfma_f32_32x32x16_bf16 a[0:15], v[128:131], v[192:195], a[0:15]
    ds_read_b64_tr_b16 v[128:129], v231 offset:8192
    ds_read_b64_tr_b16 v[130:131], v231 offset:10240
    v_mfma_f32_32x32x16_bf16 a[16:31], v[136:139], v[192:195], a[16:31]
    ds_read_b64_tr_b16 v[136:137], v232 offset:8192
    ds_read_b64_tr_b16 v[138:139], v232 offset:10240
    v_mfma_f32_32x32x16_bf16 a[32:47], v[144:147], v[192:195], a[32:47]
    ds_read_b64_tr_b16 v[144:145], v233 offset:8192
    ds_read_b64_tr_b16 v[146:147], v233 offset:10240
    v_exp_f32 v208, v176
    v_exp_f32 v209, v177
    v_mfma_f32_32x32x16_bf16 a[48:63], v[152:155], v[192:195], a[48:63]
    ds_read_b64_tr_b16 v[152:153], v234 offset:8192
    ds_read_b64_tr_b16 v[154:155], v234 offset:10240
    v_exp_f32 v210, v178
    v_exp_f32 v211, v179
    v_mfma_f32_32x32x16_bf16 a[0:15], v[132:135], v[196:199], a[0:15]
    ds_read_b64_tr_b16 v[132:133], v231 offset:12288
    ds_read_b64_tr_b16 v[134:135], v231 offset:14336
    v_add_f32 v222, v208, v209
    v_cvt_pk_bf16_f32 v200, v208, v209
    v_exp_f32 v212, v180
    v_mfma_f32_32x32x16_bf16 a[16:31], v[140:143], v[196:199], a[16:31]
    ds_read_b64_tr_b16 v[140:141], v232 offset:12288
    ds_read_b64_tr_b16 v[142:143], v232 offset:14336
    v_add_f32 v222, v222, v210
    v_exp_f32 v213, v181
    v_add_f32 v222, v222, v211
    v_mfma_f32_32x32x16_bf16 a[32:47], v[148:151], v[196:199], a[32:47]
    ds_read_b64_tr_b16 v[148:149], v233 offset:12288
    ds_read_b64_tr_b16 v[150:151], v233 offset:14336
    v_cvt_pk_bf16_f32 v201, v210, v211
    v_exp_f32 v214, v182
    v_add_f32 v222, v222, v212
    v_mfma_f32_32x32x16_bf16 a[48:63], v[156:159], v[196:199], a[48:63]
    ds_read_b64_tr_b16 v[156:157], v234 offset:12288
    ds_read_b64_tr_b16 v[158:159], v234 offset:14336
    v_exp_f32 v215, v183
    v_add_f32 v222, v222, v213
    v_cvt_pk_bf16_f32 v202, v212, v213
    s_waitcnt lgkmcnt(15)
    v_mfma_f32_32x32x16_bf16 v[160:175], v[96:99], a[192:195], v[48:63]
    ds_read_b128 v[96:99], v223 offset:8192
    v_exp_f32 v208, v184
    v_add_f32 v222, v222, v214
    v_exp_f32 v209, v185
    v_mfma_f32_32x32x16_bf16 v[160:175], v[100:103], a[196:199], v[160:175]
    ds_read_b128 v[100:103], v224 offset:8192
    v_add_f32 v222, v222, v215
    v_cvt_pk_bf16_f32 v203, v214, v215
    v_exp_f32 v210, v186
    v_mfma_f32_32x32x16_bf16 v[160:175], v[104:107], a[200:203], v[160:175]
    ds_read_b128 v[104:107], v225 offset:8192
    v_add_f32 v222, v222, v208
    v_exp_f32 v211, v187
    v_add_f32 v222, v222, v209
    v_cvt_pk_bf16_f32 v204, v208, v209
    v_mfma_f32_32x32x16_bf16 v[160:175], v[108:111], a[204:207], v[160:175]
    ds_read_b128 v[108:111], v226 offset:8192
    v_exp_f32 v212, v188
    v_add_f32 v222, v222, v210
    v_exp_f32 v213, v189
    v_mfma_f32_32x32x16_bf16 v[160:175], v[112:115], a[208:211], v[160:175]
    ds_read_b128 v[112:115], v227 offset:8192
    v_add_f32 v222, v222, v211
    v_exp_f32 v214, v190
    v_add_f32 v222, v222, v212
    v_mfma_f32_32x32x16_bf16 v[160:175], v[116:119], a[212:215], v[160:175]
    ds_read_b128 v[116:119], v228 offset:8192
    v_exp_f32 v215, v191
    v_add_f32 v222, v222, v213
    v_add_f32 v222, v222, v214
    v_add_f32 v222, v222, v215
    v_mfma_f32_32x32x16_bf16 v[160:175], v[120:123], a[216:219], v[160:175]
    ds_read_b128 v[120:123], v229 offset:8192
    v_subrev_u32 v253, s29, v222
    v_cmp_lt_u32 vcc, s22, v253
    v_cvt_pk_bf16_f32 v205, v210, v211
    v_cvt_pk_bf16_f32 v206, v212, v213
    v_mfma_f32_32x32x16_bf16 v[160:175], v[124:127], a[220:223], v[160:175]
    ds_read_b128 v[124:127], v230 offset:8192
    v_cvt_pk_bf16_f32 v207, v214, v215
    s_cbranch_vccnz L_stub33
L_ret33:
    v_add_f32 v219, v219, v222
    v_add_u32 v231, s101, v231
    v_add_u32 v232, s101, v232
    v_add_u32 v233, s101, v233
    v_add_u32 v234, s101, v234
    s_waitcnt lgkmcnt(8)
    v_mfma_f32_32x32x16_bf16 a[0:15], v[128:131], v[200:203], a[0:15]
    ds_read_b64_tr_b16 v[128:129], v231 offset:0
    ds_read_b64_tr_b16 v[130:131], v231 offset:2048
    v_mfma_f32_32x32x16_bf16 a[16:31], v[136:139], v[200:203], a[16:31]
    ds_read_b64_tr_b16 v[136:137], v232 offset:0
    ds_read_b64_tr_b16 v[138:139], v232 offset:2048
    v_mfma_f32_32x32x16_bf16 a[32:47], v[144:147], v[200:203], a[32:47]
    ds_read_b64_tr_b16 v[144:145], v233 offset:0
    ds_read_b64_tr_b16 v[146:147], v233 offset:2048
    v_exp_f32 v208, v160
    v_exp_f32 v209, v161
    v_mfma_f32_32x32x16_bf16 a[48:63], v[152:155], v[200:203], a[48:63]
    ds_read_b64_tr_b16 v[152:153], v234 offset:0
    ds_read_b64_tr_b16 v[154:155], v234 offset:2048
    v_exp_f32 v210, v162
    v_exp_f32 v211, v163
    v_mfma_f32_32x32x16_bf16 a[0:15], v[132:135], v[204:207], a[0:15]
    ds_read_b64_tr_b16 v[132:133], v231 offset:4096
    ds_read_b64_tr_b16 v[134:135], v231 offset:6144
    v_add_f32 v222, v208, v209
    v_cvt_pk_bf16_f32 v192, v208, v209
    v_mfma_f32_32x32x16_bf16 a[16:31], v[140:143], v[204:207], a[16:31]
    ds_read_b64_tr_b16 v[140:141], v232 offset:4096
    ds_read_b64_tr_b16 v[142:143], v232 offset:6144
    v_exp_f32 v212, v164
    v_add_f32 v222, v222, v210
    v_exp_f32 v213, v165
    v_mfma_f32_32x32x16_bf16 a[32:47], v[148:151], v[204:207], a[32:47]
    ds_read_b64_tr_b16 v[148:149], v233 offset:4096
    ds_read_b64_tr_b16 v[150:151], v233 offset:6144
    v_add_f32 v222, v222, v211
    v_cvt_pk_bf16_f32 v193, v210, v211
    v_mfma_f32_32x32x16_bf16 a[48:63], v[156:159], v[204:207], a[48:63]
    ds_read_b64_tr_b16 v[156:157], v234 offset:4096
    ds_read_b64_tr_b16 v[158:159], v234 offset:6144
    v_exp_f32 v214, v166
    v_add_f32 v222, v222, v212
    v_exp_f32 v215, v167
    s_sub_u32 s45, s62, s55
    v_add_u32 v251, s45, v240
    v_xor_b32 v24, 0, v241
    v_lshl_add_u32 v24, v24, 4, v251
    v_xor_b32 v25, 2, v241
    v_lshl_add_u32 v25, v25, 4, v251
    v_xor_b32 v26, 4, v241
    v_lshl_add_u32 v26, v26, 4, v251
    v_xor_b32 v27, 6, v241
    v_lshl_add_u32 v27, v27, 4, v251
    v_xor_b32 v28, 8, v241
    v_lshl_add_u32 v28, v28, 4, v251
    v_xor_b32 v29, 10, v241
    v_lshl_add_u32 v29, v29, 4, v251
    v_xor_b32 v30, 12, v241
    v_lshl_add_u32 v30, v30, 4, v251
    v_xor_b32 v31, 14, v241
    v_lshl_add_u32 v31, v31, 4, v251
    v_mov_b32 v242, v219
    v_mov_b32 v243, v219
    s_nop 1
    v_permlane32_swap_b32 v242, v243
    s_nop 1
    v_add_f32 v244, v242, v243
    v_rcp_f32 v244, v244
    s_nop 0
    v_mov_b32 v245, v244
    v_accvgpr_read_b32 v0, a0
    v_accvgpr_read_b32 v1, a1
    v_accvgpr_read_b32 v2, a2
    v_accvgpr_read_b32 v3, a3
    v_accvgpr_read_b32 v4, a4
    v_accvgpr_read_b32 v5, a5
    v_accvgpr_read_b32 v6, a6
    v_accvgpr_read_b32 v7, a7
    v_pk_mul_f32 v[0:1], v[0:1], v[244:245]
    v_pk_mul_f32 v[2:3], v[2:3], v[244:245]
    v_pk_mul_f32 v[4:5], v[4:5], v[244:245]
    v_pk_mul_f32 v[6:7], v[6:7], v[244:245]
    v_cvt_pk_bf16_f32 v8, v0, v1
    v_cvt_pk_bf16_f32 v9, v2, v3
    v_cvt_pk_bf16_f32 v10, v4, v5
    v_cvt_pk_bf16_f32 v11, v6, v7
    s_nop 0
    v_permlane32_swap_b32 v8, v10
    v_permlane32_swap_b32 v9, v11
    ds_write_b128 v24, v[8:11] offset:0
    v_accvgpr_read_b32 v12, a8
    v_accvgpr_read_b32 v13, a9
    v_accvgpr_read_b32 v14, a10
    v_accvgpr_read_b32 v15, a11
    v_accvgpr_read_b32 v16, a12
    v_accvgpr_read_b32 v17, a13
    v_accvgpr_read_b32 v18, a14
    v_accvgpr_read_b32 v19, a15
    v_pk_mul_f32 v[12:13], v[12:13], v[244:245]
    v_pk_mul_f32 v[14:15], v[14:15], v[244:245]
    v_pk_mul_f32 v[16:17], v[16:17], v[244:245]
    v_pk_mul_f32 v[18:19], v[18:19], v[244:245]
    v_cvt_pk_bf16_f32 v20, v12, v13
    v_cvt_pk_bf16_f32 v21, v14, v15
    v_cvt_pk_bf16_f32 v22, v16, v17
    v_cvt_pk_bf16_f32 v23, v18, v19
    s_nop 0
    v_permlane32_swap_b32 v20, v22
    v_permlane32_swap_b32 v21, v23
    ds_write_b128 v25, v[20:23] offset:0
    v_accvgpr_read_b32 v0, a16
    v_accvgpr_read_b32 v1, a17
    v_accvgpr_read_b32 v2, a18
    v_accvgpr_read_b32 v3, a19
    v_accvgpr_read_b32 v4, a20
    v_accvgpr_read_b32 v5, a21
    v_accvgpr_read_b32 v6, a22
    v_accvgpr_read_b32 v7, a23
    v_pk_mul_f32 v[0:1], v[0:1], v[244:245]
    v_pk_mul_f32 v[2:3], v[2:3], v[244:245]
    v_pk_mul_f32 v[4:5], v[4:5], v[244:245]
    v_pk_mul_f32 v[6:7], v[6:7], v[244:245]
    v_cvt_pk_bf16_f32 v8, v0, v1
    v_cvt_pk_bf16_f32 v9, v2, v3
    v_cvt_pk_bf16_f32 v10, v4, v5
    v_cvt_pk_bf16_f32 v11, v6, v7
    s_nop 0
    v_permlane32_swap_b32 v8, v10
    v_permlane32_swap_b32 v9, v11
    ds_write_b128 v26, v[8:11] offset:0
    v_accvgpr_read_b32 v12, a24
    v_accvgpr_read_b32 v13, a25
    v_accvgpr_read_b32 v14, a26
    v_accvgpr_read_b32 v15, a27
    v_accvgpr_read_b32 v16, a28
    v_accvgpr_read_b32 v17, a29
    v_accvgpr_read_b32 v18, a30
    v_accvgpr_read_b32 v19, a31
    v_pk_mul_f32 v[12:13], v[12:13], v[244:245]
    v_pk_mul_f32 v[14:15], v[14:15], v[244:245]
    v_pk_mul_f32 v[16:17], v[16:17], v[244:245]
    v_pk_mul_f32 v[18:19], v[18:19], v[244:245]
    v_cvt_pk_bf16_f32 v20, v12, v13
    v_cvt_pk_bf16_f32 v21, v14, v15
    v_cvt_pk_bf16_f32 v22, v16, v17
    v_cvt_pk_bf16_f32 v23, v18, v19
    s_nop 0
    v_permlane32_swap_b32 v20, v22
    v_permlane32_swap_b32 v21, v23
    ds_write_b128 v27, v[20:23] offset:0
    v_accvgpr_read_b32 v0, a32
    v_accvgpr_read_b32 v1, a33
    v_accvgpr_read_b32 v2, a34
    v_accvgpr_read_b32 v3, a35
    v_accvgpr_read_b32 v4, a36
    v_accvgpr_read_b32 v5, a37
    v_accvgpr_read_b32 v6, a38
    v_accvgpr_read_b32 v7, a39
    v_pk_mul_f32 v[0:1], v[0:1], v[244:245]
    v_pk_mul_f32 v[2:3], v[2:3], v[244:245]
    v_pk_mul_f32 v[4:5], v[4:5], v[244:245]
    v_pk_mul_f32 v[6:7], v[6:7], v[244:245]
    v_cvt_pk_bf16_f32 v8, v0, v1
    v_cvt_pk_bf16_f32 v9, v2, v3
    v_cvt_pk_bf16_f32 v10, v4, v5
    v_cvt_pk_bf16_f32 v11, v6, v7
    s_nop 0
    v_permlane32_swap_b32 v8, v10
    v_permlane32_swap_b32 v9, v11
    ds_write_b128 v28, v[8:11] offset:0
    v_accvgpr_read_b32 v12, a40
    v_accvgpr_read_b32 v13, a41
    v_accvgpr_read_b32 v14, a42
    v_accvgpr_read_b32 v15, a43
    v_accvgpr_read_b32 v16, a44
    v_accvgpr_read_b32 v17, a45
    v_accvgpr_read_b32 v18, a46
    v_accvgpr_read_b32 v19, a47
    v_pk_mul_f32 v[12:13], v[12:13], v[244:245]
    v_pk_mul_f32 v[14:15], v[14:15], v[244:245]
    v_pk_mul_f32 v[16:17], v[16:17], v[244:245]
    v_pk_mul_f32 v[18:19], v[18:19], v[244:245]
    v_cvt_pk_bf16_f32 v20, v12, v13
    v_cvt_pk_bf16_f32 v21, v14, v15
    v_cvt_pk_bf16_f32 v22, v16, v17
    v_cvt_pk_bf16_f32 v23, v18, v19
    s_nop 0
    v_permlane32_swap_b32 v20, v22
    v_permlane32_swap_b32 v21, v23
    ds_write_b128 v29, v[20:23] offset:0
    v_accvgpr_read_b32 v0, a48
    v_accvgpr_read_b32 v1, a49
    v_accvgpr_read_b32 v2, a50
    v_accvgpr_read_b32 v3, a51
    v_accvgpr_read_b32 v4, a52
    v_accvgpr_read_b32 v5, a53
    v_accvgpr_read_b32 v6, a54
    v_accvgpr_read_b32 v7, a55
    v_pk_mul_f32 v[0:1], v[0:1], v[244:245]
    v_pk_mul_f32 v[2:3], v[2:3], v[244:245]
    v_pk_mul_f32 v[4:5], v[4:5], v[244:245]
    v_pk_mul_f32 v[6:7], v[6:7], v[244:245]
    v_cvt_pk_bf16_f32 v8, v0, v1
    v_cvt_pk_bf16_f32 v9, v2, v3
    v_cvt_pk_bf16_f32 v10, v4, v5
    v_cvt_pk_bf16_f32 v11, v6, v7
    s_nop 0
    v_permlane32_swap_b32 v8, v10
    v_permlane32_swap_b32 v9, v11
    ds_write_b128 v30, v[8:11] offset:0
    v_accvgpr_read_b32 v12, a56
    v_accvgpr_read_b32 v13, a57
    v_accvgpr_read_b32 v14, a58
    v_accvgpr_read_b32 v15, a59
    v_accvgpr_read_b32 v16, a60
    v_accvgpr_read_b32 v17, a61
    v_accvgpr_read_b32 v18, a62
    v_accvgpr_read_b32 v19, a63
    v_pk_mul_f32 v[12:13], v[12:13], v[244:245]
    v_pk_mul_f32 v[14:15], v[14:15], v[244:245]
    v_pk_mul_f32 v[16:17], v[16:17], v[244:245]
    v_pk_mul_f32 v[18:19], v[18:19], v[244:245]
    v_cvt_pk_bf16_f32 v20, v12, v13
    v_cvt_pk_bf16_f32 v21, v14, v15
    v_cvt_pk_bf16_f32 v22, v16, v17
    v_cvt_pk_bf16_f32 v23, v18, v19
    s_nop 0
    v_permlane32_swap_b32 v20, v22
    v_permlane32_swap_b32 v21, v23
    ds_write_b128 v31, v[20:23] offset:0
    v_add_u32 v250, s62, v255
    s_waitcnt lgkmcnt(0)
    ds_read_b128 v[0:3], v250 offset:0
    ds_read_b128 v[4:7], v250 offset:1024
    ds_read_b128 v[8:11], v250 offset:2048
    ds_read_b128 v[12:15], v250 offset:3072
    ds_read_b128 v[16:19], v250 offset:16384
    ds_read_b128 v[20:23], v250 offset:17408
    ds_read_b128 v[24:27], v250 offset:18432
    ds_read_b128 v[28:31], v250 offset:19456
    s_mov_b32 s96, s37
    s_add_u32 s97, s37, 4096
    v_mfma_f32_32x32x16_bf16 v[176:191], v[96:99], a[192:195], v[48:63]
    v_add_f32 v222, v222, v213
    v_cvt_pk_bf16_f32 v194, v212, v213
    v_exp_f32 v208, v168
    v_mfma_f32_32x32x16_bf16 v[176:191], v[100:103], a[196:199], v[176:191]
    v_add_f32 v222, v222, v214
    v_exp_f32 v209, v169
    v_add_f32 v222, v222, v215
    v_cvt_pk_bf16_f32 v195, v214, v215
    v_mfma_f32_32x32x16_bf16 v[176:191], v[104:107], a[200:203], v[176:191]
    v_exp_f32 v210, v170
    v_add_f32 v222, v222, v208
    v_exp_f32 v211, v171
    v_add_f32 v222, v222, v209
    v_mfma_f32_32x32x16_bf16 v[176:191], v[108:111], a[204:207], v[176:191]
    s_waitcnt lgkmcnt(7)
    buffer_store_dwordx4 v[0:3], v235, s[24:27], s96 offen offset:0 sc1 nt
    v_cvt_pk_bf16_f32 v196, v208, v209
    v_exp_f32 v212, v172
    v_add_f32 v222, v222, v210
    v_mfma_f32_32x32x16_bf16 v[176:191], v[112:115], a[208:211], v[176:191]
    v_exp_f32 v213, v173
    v_add_f32 v222, v222, v211
    v_exp_f32 v214, v174
    v_mfma_f32_32x32x16_bf16 v[176:191], v[116:119], a[212:215], v[176:191]
    v_add_f32 v222, v222, v212
    v_exp_f32 v215, v175
    v_add_f32 v222, v222, v213
    v_add_f32 v222, v222, v214
    v_add_f32 v222, v222, v215
    v_mfma_f32_32x32x16_bf16 v[176:191], v[120:123], a[216:219], v[176:191]
    s_waitcnt lgkmcnt(6)
    buffer_store_dwordx4 v[4:7], v236, s[24:27], s96 offen offset:1024 sc1 nt
    v_subrev_u32 v253, s29, v222
    v_cmp_lt_u32 vcc, s22, v253
    v_cvt_pk_bf16_f32 v197, v210, v211
    v_mfma_f32_32x32x16_bf16 v[176:191], v[124:127], a[220:223], v[176:191]
    v_cvt_pk_bf16_f32 v198, v212, v213
    v_cvt_pk_bf16_f32 v199, v214, v215
    s_cbranch_vccnz L_stub34
L_ret34:
    v_add_f32 v220, v220, v222
    v_mfma_f32_32x32x16_bf16 a[64:79], v[128:131], v[192:195], a[64:79]
    ds_read_b64_tr_b16 v[128:129], v231 offset:8192
    ds_read_b64_tr_b16 v[130:131], v231 offset:10240
    s_waitcnt lgkmcnt(7)
    buffer_store_dwordx4 v[8:11], v237, s[24:27], s96 offen offset:2048 sc1 nt
    v_mfma_f32_32x32x16_bf16 a[80:95], v[136:139], v[192:195], a[80:95]
    ds_read_b64_tr_b16 v[136:137], v232 offset:8192
    ds_read_b64_tr_b16 v[138:139], v232 offset:10240
    s_waitcnt lgkmcnt(8)
    buffer_store_dwordx4 v[12:15], v238, s[24:27], s96 offen offset:3072 sc1 nt
    v_mfma_f32_32x32x16_bf16 a[96:111], v[144:147], v[192:195], a[96:111]
    ds_read_b64_tr_b16 v[144:145], v233 offset:8192
    ds_read_b64_tr_b16 v[146:147], v233 offset:10240
    v_exp_f32 v208, v176
    v_exp_f32 v209, v177
    v_exp_f32 v210, v178
    v_mfma_f32_32x32x16_bf16 a[112:127], v[152:155], v[192:195], a[112:127]
    ds_read_b64_tr_b16 v[152:153], v234 offset:8192
    ds_read_b64_tr_b16 v[154:155], v234 offset:10240
    v_exp_f32 v211, v179
    v_add_f32 v222, v208, v209
    v_cvt_pk_bf16_f32 v200, v208, v209
    v_mfma_f32_32x32x16_bf16 a[64:79], v[132:135], v[196:199], a[64:79]
    v_add_u32 v223, s36, v223
    v_add_u32 v224, s36, v224
    ds_read_b64_tr_b16 v[132:133], v231 offset:12288
    ds_read_b64_tr_b16 v[134:135], v231 offset:14336
    v_exp_f32 v212, v180
    v_add_f32 v222, v222, v210
    v_mfma_f32_32x32x16_bf16 a[80:95], v[140:143], v[196:199], a[80:95]
    v_add_u32 v225, s36, v225
    v_add_u32 v226, s36, v226
    ds_read_b64_tr_b16 v[140:141], v232 offset:12288
    ds_read_b64_tr_b16 v[142:143], v232 offset:14336
    v_exp_f32 v213, v181
    v_add_f32 v222, v222, v211
    v_mfma_f32_32x32x16_bf16 a[96:111], v[148:151], v[196:199], a[96:111]
    v_add_u32 v227, s36, v227
    v_add_u32 v228, s36, v228
    ds_read_b64_tr_b16 v[148:149], v233 offset:12288
    ds_read_b64_tr_b16 v[150:151], v233 offset:14336
    v_cvt_pk_bf16_f32 v201, v210, v211
    v_exp_f32 v214, v182
    v_mfma_f32_32x32x16_bf16 a[112:127], v[156:159], v[196:199], a[112:127]
    v_add_u32 v229, s36, v229
    v_add_u32 v230, s36, v230
    ds_read_b64_tr_b16 v[156:157], v234 offset:12288
    ds_read_b64_tr_b16 v[158:159], v234 offset:14336
    v_add_f32 v222, v222, v212
    v_exp_f32 v215, v183
    v_mfma_f32_32x32x16_bf16 v[160:175], v[96:99], a[224:227], v[64:79]
    ds_read_b128 v[96:99], v223 offset:0
    v_add_f32 v222, v222, v213
    v_cvt_pk_bf16_f32 v202, v212, v213
    v_exp_f32 v208, v184
    v_add_f32 v222, v222, v214
    v_mfma_f32_32x32x16_bf16 v[160:175], v[100:103], a[228:231], v[160:175]
    ds_read_b128 v[100:103], v224 offset:0
    v_exp_f32 v209, v185
    v_add_f32 v222, v222, v215
    v_cvt_pk_bf16_f32 v203, v214, v215
    v_exp_f32 v210, v186
    v_mfma_f32_32x32x16_bf16 v[160:175], v[104:107], a[232:235], v[160:175]
    ds_read_b128 v[104:107], v225 offset:0
    v_add_f32 v222, v222, v208
    v_exp_f32 v211, v187
    v_add_f32 v222, v222, v209
    v_cvt_pk_bf16_f32 v204, v208, v209
    v_mfma_f32_32x32x16_bf16 v[160:175], v[108:111], a[236:239], v[160:175]
    ds_read_b128 v[108:111], v226 offset:0
    s_waitcnt lgkmcnt(15)
    buffer_store_dwordx4 v[16:19], v239, s[24:27], s97 offen offset:0 sc1 nt
    v_exp_f32 v212, v188
    v_add_f32 v222, v222, v210
    v_mfma_f32_32x32x16_bf16 v[160:175], v[112:115], a[240:243], v[160:175]
    ds_read_b128 v[112:115], v227 offset:0
    v_exp_f32 v213, v189
    v_add_f32 v222, v222, v211
    v_exp_f32 v214, v190
    v_add_f32 v222, v222, v212
    v_mfma_f32_32x32x16_bf16 v[160:175], v[116:119], a[244:247], v[160:175]
    ds_read_b128 v[116:119], v228 offset:0
    v_exp_f32 v215, v191
    v_add_f32 v222, v222, v213
    v_add_f32 v222, v222, v214
    v_add_f32 v222, v222, v215
    v_mfma_f32_32x32x16_bf16 v[160:175], v[120:123], a[248:251], v[160:175]
    ds_read_b128 v[120:123], v229 offset:0
    buffer_store_dwordx4 v[20:23], v239, s[24:27], s97 offen offset:1024 sc1 nt
    v_subrev_u32 v253, s29, v222
    v_cmp_lt_u32 vcc, s22, v253
    v_cvt_pk_bf16_f32 v205, v210, v211
    v_mfma_f32_32x32x16_bf16 v[160:175], v[124:127], a[252:255], v[160:175]
    ds_read_b128 v[124:127], v230 offset:0
    v_cvt_pk_bf16_f32 v206, v212, v213
    v_cvt_pk_bf16_f32 v207, v214, v215
    s_cbranch_vccnz L_stub35
L_ret35:
    v_add_f32 v220, v220, v222
    v_mfma_f32_32x32x16_bf16 a[64:79], v[128:131], v[200:203], a[64:79]
    buffer_store_dwordx4 v[24:27], v239, s[24:27], s97 offen offset:2048 sc1 nt
    v_mfma_f32_32x32x16_bf16 a[80:95], v[136:139], v[200:203], a[80:95]
    buffer_store_dwordx4 v[28:31], v239, s[24:27], s97 offen offset:3072 sc1 nt
    s_waitcnt lgkmcnt(8)
    v_mfma_f32_32x32x16_bf16 a[96:111], v[144:147], v[200:203], a[96:111]
    s_nop 0
    v_exp_f32 v208, v160
    v_exp_f32 v209, v161
    v_exp_f32 v210, v162
    v_mfma_f32_32x32x16_bf16 a[112:127], v[152:155], v[200:203], a[112:127]
    v_exp_f32 v211, v163
    v_add_f32 v222, v208, v209
    v_cvt_pk_bf16_f32 v192, v208, v209
    v_mfma_f32_32x32x16_bf16 a[64:79], v[132:135], v[204:207], a[64:79]
    v_exp_f32 v212, v164
    v_add_f32 v222, v222, v210
    v_exp_f32 v213, v165
    v_add_f32 v222, v222, v211
    v_mfma_f32_32x32x16_bf16 a[80:95], v[140:143], v[204:207], a[80:95]
    v_cvt_pk_bf16_f32 v193, v210, v211
    v_exp_f32 v214, v166
    v_add_f32 v222, v222, v212
    v_mfma_f32_32x32x16_bf16 a[96:111], v[148:151], v[204:207], a[96:111]
    v_exp_f32 v215, v167
    v_add_f32 v222, v222, v213
    v_cvt_pk_bf16_f32 v194, v212, v213
    v_exp_f32 v208, v168
    v_mfma_f32_32x32x16_bf16 a[112:127], v[156:159], v[204:207], a[112:127]
    v_add_f32 v222, v222, v214
    v_exp_f32 v209, v169
    v_add_f32 v222, v222, v215
    v_cvt_pk_bf16_f32 v195, v214, v215
    s_waitcnt lgkmcnt(0)
    v_mfma_f32_32x32x16_bf16 v[176:191], v[96:99], a[192:195], v[48:63]
    ds_read_b128 v[96:99], v223 offset:8192
    v_exp_f32 v210, v170
    v_add_f32 v222, v222, v208
    v_mfma_f32_32x32x16_bf16 v[176:191], v[100:103], a[196:199], v[176:191]
    ds_read_b128 v[100:103], v224 offset:8192
    v_exp_f32 v211, v171
    v_add_f32 v222, v222, v209
    v_cvt_pk_bf16_f32 v196, v208, v209
    v_mfma_f32_32x32x16_bf16 v[176:191], v[104:107], a[200:203], v[176:191]
    ds_read_b128 v[104:107], v225 offset:8192
    v_exp_f32 v212, v172
    v_add_f32 v222, v222, v210
    v_exp_f32 v213, v173
    v_mfma_f32_32x32x16_bf16 v[176:191], v[108:111], a[204:207], v[176:191]
    ds_read_b128 v[108:111], v226 offset:8192
    v_add_f32 v222, v222, v211
    v_exp_f32 v214, v174
    v_mfma_f32_32x32x16_bf16 v[176:191], v[112:115], a[208:211], v[176:191]
    ds_read_b128 v[112:115], v227 offset:8192
    v_add_f32 v222, v222, v212
    v_exp_f32 v215, v175
    v_add_f32 v222, v222, v213
    v_mfma_f32_32x32x16_bf16 v[176:191], v[116:119], a[212:215], v[176:191]
    ds_read_b128 v[116:119], v228 offset:8192
    v_add_f32 v222, v222, v214
    v_add_f32 v222, v222, v215
    v_subrev_u32 v253, s29, v222
    v_cmp_lt_u32 vcc, s22, v253
    v_mfma_f32_32x32x16_bf16 v[176:191], v[120:123], a[216:219], v[176:191]
    ds_read_b128 v[120:123], v229 offset:8192
    v_cvt_pk_bf16_f32 v197, v210, v211
    v_cvt_pk_bf16_f32 v198, v212, v213
    v_cvt_pk_bf16_f32 v199, v214, v215
    v_mfma_f32_32x32x16_bf16 v[176:191], v[124:127], a[220:223], v[176:191]
    ds_read_b128 v[124:127], v230 offset:8192
    s_cbranch_vccnz L_stub36
L_ret36:
    v_add_f32 v221, v221, v222
    v_add_u32 v231, s36, v231
    v_add_u32 v232, s36, v232
    v_add_u32 v233, s36, v233
    v_add_u32 v234, s36, v234
    v_mfma_f32_32x32x16_bf16 a[128:143], v[128:131], v[192:195], a[128:143]
    ds_read_b64_tr_b16 v[128:129], v231 offset:0
    ds_read_b64_tr_b16 v[130:131], v231 offset:2048
    v_mfma_f32_32x32x16_bf16 a[144:159], v[136:139], v[192:195], a[144:159]
    ds_read_b64_tr_b16 v[136:137], v232 offset:0
    ds_read_b64_tr_b16 v[138:139], v232 offset:2048
    v_mfma_f32_32x32x16_bf16 a[160:175], v[144:147], v[192:195], a[160:175]
    ds_read_b64_tr_b16 v[144:145], v233 offset:0
    ds_read_b64_tr_b16 v[146:147], v233 offset:2048
    v_exp_f32 v208, v176
    v_exp_f32 v209, v177
    v_mfma_f32_32x32x16_bf16 a[176:191], v[152:155], v[192:195], a[176:191]
    ds_read_b64_tr_b16 v[152:153], v234 offset:0
    ds_read_b64_tr_b16 v[154:155], v234 offset:2048
    v_exp_f32 v210, v178
    v_mfma_f32_32x32x16_bf16 a[128:143], v[132:135], v[196:199], a[128:143]
    ds_read_b64_tr_b16 v[132:133], v231 offset:4096
    ds_read_b64_tr_b16 v[134:135], v231 offset:6144
    v_exp_f32 v211, v179
    v_add_f32 v222, v208, v209
    v_cvt_pk_bf16_f32 v200, v208, v209
    v_mfma_f32_32x32x16_bf16 a[144:159], v[140:143], v[196:199], a[144:159]
    ds_read_b64_tr_b16 v[140:141], v232 offset:4096
    ds_read_b64_tr_b16 v[142:143], v232 offset:6144
    v_exp_f32 v212, v180
    v_add_f32 v222, v222, v210
    v_mfma_f32_32x32x16_bf16 a[160:175], v[148:151], v[196:199], a[160:175]
    ds_read_b64_tr_b16 v[148:149], v233 offset:4096
    ds_read_b64_tr_b16 v[150:151], v233 offset:6144
    v_exp_f32 v213, v181
    v_add_f32 v222, v222, v211
    v_mfma_f32_32x32x16_bf16 a[176:191], v[156:159], v[196:199], a[176:191]
    ds_read_b64_tr_b16 v[156:157], v234 offset:4096
    ds_read_b64_tr_b16 v[158:159], v234 offset:6144
    v_cvt_pk_bf16_f32 v201, v210, v211
    v_exp_f32 v214, v182
    s_waitcnt lgkmcnt(15)
    v_mfma_f32_32x32x16_bf16 v[160:175], v[96:99], a[192:195], v[48:63]
    v_add_f32 v222, v222, v212
    v_exp_f32 v215, v183
    v_add_f32 v222, v222, v213
    v_cvt_pk_bf16_f32 v202, v212, v213
    v_mfma_f32_32x32x16_bf16 v[160:175], v[100:103], a[196:199], v[160:175]
    v_exp_f32 v208, v184
    v_add_f32 v222, v222, v214
    v_exp_f32 v209, v185
    v_add_f32 v222, v222, v215
    v_mfma_f32_32x32x16_bf16 v[160:175], v[104:107], a[200:203], v[160:175]
    v_cvt_pk_bf16_f32 v203, v214, v215
    v_exp_f32 v210, v186
    v_add_f32 v222, v222, v208
    v_mfma_f32_32x32x16_bf16 v[160:175], v[108:111], a[204:207], v[160:175]
    v_exp_f32 v211, v187
    v_add_f32 v222, v222, v209
    v_cvt_pk_bf16_f32 v204, v208, v209
    v_exp_f32 v212, v188
    v_mfma_f32_32x32x16_bf16 v[160:175], v[112:115], a[208:211], v[160:175]
    v_add_f32 v222, v222, v210
    v_exp_f32 v213, v189
    v_add_f32 v222, v222, v211
    v_exp_f32 v214, v190
    v_mfma_f32_32x32x16_bf16 v[160:175], v[116:119], a[212:215], v[160:175]
    v_add_f32 v222, v222, v212
    v_exp_f32 v215, v191
    v_add_f32 v222, v222, v213
    v_add_f32 v222, v222, v214
    v_mfma_f32_32x32x16_bf16 v[160:175], v[120:123], a[216:219], v[160:175]
    v_add_f32 v222, v222, v215
    v_subrev_u32 v253, s29, v222
    v_cmp_lt_u32 vcc, s22, v253
    v_cvt_pk_bf16_f32 v205, v210, v211
    v_cvt_pk_bf16_f32 v206, v212, v213
    v_mfma_f32_32x32x16_bf16 v[160:175], v[124:127], a[220:223], v[160:175]
    v_cvt_pk_bf16_f32 v207, v214, v215
    s_cbranch_vccnz L_stub37
L_ret37:
    v_add_f32 v220, v220, v222
    s_waitcnt lgkmcnt(0)
    v_mfma_f32_32x32x16_bf16 a[64:79], v[128:131], v[200:203], a[64:79]
    ds_read_b64_tr_b16 v[128:129], v231 offset:8192
    ds_read_b64_tr_b16 v[130:131], v231 offset:10240
    v_mfma_f32_32x32x16_bf16 a[80:95], v[136:139], v[200:203], a[80:95]
    ds_read_b64_tr_b16 v[136:137], v232 offset:8192
    ds_read_b64_tr_b16 v[138:139], v232 offset:10240
    v_mfma_f32_32x32x16_bf16 a[96:111], v[144:147], v[200:203], a[96:111]
    ds_read_b64_tr_b16 v[144:145], v233 offset:8192
    ds_read_b64_tr_b16 v[146:147], v233 offset:10240
    v_exp_f32 v208, v160
    v_exp_f32 v209, v161
    v_mfma_f32_32x32x16_bf16 a[112:127], v[152:155], v[200:203], a[112:127]
    ds_read_b64_tr_b16 v[152:153], v234 offset:8192
    ds_read_b64_tr_b16 v[154:155], v234 offset:10240
    v_exp_f32 v210, v162
    v_mfma_f32_32x32x16_bf16 a[64:79], v[132:135], v[204:207], a[64:79]
    ds_read_b64_tr_b16 v[132:133], v231 offset:12288
    ds_read_b64_tr_b16 v[134:135], v231 offset:14336
    v_exp_f32 v211, v163
    v_add_f32 v222, v208, v209
    v_cvt_pk_bf16_f32 v192, v208, v209
    v_mfma_f32_32x32x16_bf16 a[80:95], v[140:143], v[204:207], a[80:95]
    ds_read_b64_tr_b16 v[140:141], v232 offset:12288
    ds_read_b64_tr_b16 v[142:143], v232 offset:14336
    v_exp_f32 v212, v164
    v_add_f32 v222, v222, v210
    v_mfma_f32_32x32x16_bf16 a[96:111], v[148:151], v[204:207], a[96:111]
    ds_read_b64_tr_b16 v[148:149], v233 offset:12288
    ds_read_b64_tr_b16 v[150:151], v233 offset:14336
    v_exp_f32 v213, v165
    v_add_f32 v222, v222, v211
    v_mfma_f32_32x32x16_bf16 a[112:127], v[156:159], v[204:207], a[112:127]
    ds_read_b64_tr_b16 v[156:157], v234 offset:12288
    ds_read_b64_tr_b16 v[158:159], v234 offset:14336
    v_cvt_pk_bf16_f32 v193, v210, v211
    v_exp_f32 v214, v166
    v_mfma_f32_32x32x16_bf16 v[176:191], v[96:99], a[224:227], v[64:79]
    v_add_f32 v222, v222, v212
    v_exp_f32 v215, v167
    v_add_f32 v222, v222, v213
    v_cvt_pk_bf16_f32 v194, v212, v213
    v_mfma_f32_32x32x16_bf16 v[176:191], v[100:103], a[228:231], v[176:191]
    v_exp_f32 v208, v168
    v_add_f32 v222, v222, v214
    v_exp_f32 v209, v169
    v_add_f32 v222, v222, v215
    v_mfma_f32_32x32x16_bf16 v[176:191], v[104:107], a[232:235], v[176:191]
    v_cvt_pk_bf16_f32 v195, v214, v215
    v_exp_f32 v210, v170
    v_add_f32 v222, v222, v208
    v_mfma_f32_32x32x16_bf16 v[176:191], v[108:111], a[236:239], v[176:191]
    v_exp_f32 v211, v171
    v_add_f32 v222, v222, v209
    v_cvt_pk_bf16_f32 v196, v208, v209
    v_exp_f32 v212, v172
    v_mfma_f32_32x32x16_bf16 v[176:191], v[112:115], a[240:243], v[176:191]
    v_add_f32 v222, v222, v210
    v_exp_f32 v213, v173
    v_add_f32 v222, v222, v211
    v_exp_f32 v214, v174
    v_mfma_f32_32x32x16_bf16 v[176:191], v[116:119], a[244:247], v[176:191]
    v_add_f32 v222, v222, v212
    v_exp_f32 v215, v175
    v_add_f32 v222, v222, v213
    v_add_f32 v222, v222, v214
    v_mfma_f32_32x32x16_bf16 v[176:191], v[120:123], a[248:251], v[176:191]
    v_add_f32 v222, v222, v215
    v_subrev_u32 v253, s29, v222
    v_cmp_lt_u32 vcc, s22, v253
    v_cvt_pk_bf16_f32 v197, v210, v211
    v_cvt_pk_bf16_f32 v198, v212, v213
    v_mfma_f32_32x32x16_bf16 v[176:191], v[124:127], a[252:255], v[176:191]
    v_cvt_pk_bf16_f32 v199, v214, v215
    s_cbranch_vccnz L_stub38
L_ret38:
    v_add_f32 v220, v220, v222
    s_waitcnt lgkmcnt(0)
    v_mfma_f32_32x32x16_bf16 a[64:79], v[128:131], v[192:195], a[64:79]
    v_mfma_f32_32x32x16_bf16 a[80:95], v[136:139], v[192:195], a[80:95]
    v_mfma_f32_32x32x16_bf16 a[96:111], v[144:147], v[192:195], a[96:111]
    s_nop 4
    v_exp_f32 v208, v176
    v_exp_f32 v209, v177
    v_exp_f32 v210, v178
    v_mfma_f32_32x32x16_bf16 a[112:127], v[152:155], v[192:195], a[112:127]
    v_exp_f32 v211, v179
    v_add_f32 v222, v208, v209
    v_cvt_pk_bf16_f32 v200, v208, v209
    v_exp_f32 v212, v180
    v_mfma_f32_32x32x16_bf16 a[64:79], v[132:135], v[196:199], a[64:79]
    v_add_f32 v222, v222, v210
    v_exp_f32 v213, v181
    v_add_f32 v222, v222, v211
    v_cvt_pk_bf16_f32 v201, v210, v211
    v_mfma_f32_32x32x16_bf16 a[80:95], v[140:143], v[196:199], a[80:95]
    v_exp_f32 v214, v182
    v_add_f32 v222, v222, v212
    v_exp_f32 v215, v183
    v_add_f32 v222, v222, v213
    v_mfma_f32_32x32x16_bf16 a[96:111], v[148:151], v[196:199], a[96:111]
    v_cvt_pk_bf16_f32 v202, v212, v213
    v_exp_f32 v208, v184
    v_add_f32 v222, v222, v214
    v_exp_f32 v209, v185
    v_mfma_f32_32x32x16_bf16 a[112:127], v[156:159], v[196:199], a[112:127]
    v_add_f32 v222, v222, v215
    v_cvt_pk_bf16_f32 v203, v214, v215
    v_exp_f32 v210, v186
    v_add_f32 v222, v222, v208
    v_exp_f32 v211, v187
    v_add_f32 v222, v222, v209
    v_cvt_pk_bf16_f32 v204, v208, v209
    v_exp_f32 v212, v188
    v_add_f32 v222, v222, v210
    v_exp_f32 v213, v189
    v_add_f32 v222, v222, v211
    v_exp_f32 v214, v190
    v_add_f32 v222, v222, v212
    v_exp_f32 v215, v191
    v_add_f32 v222, v222, v213
    v_add_f32 v222, v222, v214
    v_add_f32 v222, v222, v215
    v_subrev_u32 v253, s29, v222
    v_cmp_lt_u32 vcc, s22, v253
    v_cvt_pk_bf16_f32 v205, v210, v211
    v_cvt_pk_bf16_f32 v206, v212, v213
    v_cvt_pk_bf16_f32 v207, v214, v215
    s_cbranch_vccnz L_stub39
L_ret39:
    v_add_f32 v221, v221, v222
    v_mfma_f32_32x32x16_bf16 a[128:143], v[128:131], v[200:203], a[128:143]
    v_mfma_f32_32x32x16_bf16 a[144:159], v[136:139], v[200:203], a[144:159]
    v_mfma_f32_32x32x16_bf16 a[160:175], v[144:147], v[200:203], a[160:175]
    v_mfma_f32_32x32x16_bf16 a[176:191], v[152:155], v[200:203], a[176:191]
    v_mfma_f32_32x32x16_bf16 a[128:143], v[132:135], v[204:207], a[128:143]
    v_mfma_f32_32x32x16_bf16 a[144:159], v[140:143], v[204:207], a[144:159]
    v_mfma_f32_32x32x16_bf16 a[160:175], v[148:151], v[204:207], a[160:175]
    v_mfma_f32_32x32x16_bf16 a[176:191], v[156:159], v[204:207], a[176:191]
    s_waitcnt lgkmcnt(0)
    s_xor_b32 s54, s34, 4096
    v_mov_b32 v74, v64
    v_mov_b32 v242, v221
    v_mov_b32 v243, v221
    s_nop 1
    v_permlane32_swap_b32 v242, v243
    s_nop 1
    v_add_f32 v75, v242, v243
    v_add_u32 v246, s54, v254
    ds_write_b64 v246, v[74:75]
    v_add_u32 v72, s54, v255
    v_add_u32 v73, s34, v255
    ds_write_b128 v73, a[132:135] offset:1024
    ds_write_b128 v73, a[136:139] offset:2048
    ds_write_b128 v73, a[140:143] offset:3072
    ds_write_b128 v73, a[144:147] offset:16384
    ds_write_b128 v73, a[148:151] offset:17408
    ds_write_b128 v73, a[152:155] offset:18432
    ds_write_b128 v73, a[156:159] offset:19456
    s_add_u32 s42, s35, s55
    v_add_u32 v251, s35, v240
    v_xor_b32 v208, 0, v241
    v_lshl_add_u32 v208, v208, 4, v251
    v_xor_b32 v209, 2, v241
    v_lshl_add_u32 v209, v209, 4, v251
    v_xor_b32 v210, 4, v241
    v_lshl_add_u32 v210, v210, 4, v251
    v_xor_b32 v211, 6, v241
    v_lshl_add_u32 v211, v211, 4, v251
    v_xor_b32 v212, 8, v241
    v_lshl_add_u32 v212, v212, 4, v251
    v_xor_b32 v213, 10, v241
    v_lshl_add_u32 v213, v213, 4, v251
    v_xor_b32 v214, 12, v241
    v_lshl_add_u32 v214, v214, 4, v251
    v_xor_b32 v215, 14, v241
    v_lshl_add_u32 v215, v215, 4, v251
    s_waitcnt lgkmcnt(0)
    s_barrier
    v_add_u32 v247, s34, v254
    ds_read_b64 v[248:249], v247
    s_waitcnt lgkmcnt(0)
    ds_write_b128 v73, a[128:131] offset:0
    v_min_f32 v242, v74, v248
    v_sub_f32 v243, v242, v74
    v_sub_f32 v242, v242, v248
    v_exp_f32 v243, v243
    v_exp_f32 v242, v242
    v_mul_f32 v245, v75, v243
    v_fma_f32 v245, v249, v242, v245
    v_rcp_f32 v245, v245
    s_nop 0
    v_mul_f32 v70, v245, v242
    v_mul_f32 v68, v245, v243
    v_mov_b32 v71, v70
    v_mov_b32 v69, v68
    v_mov_b32 v242, v220
    v_mov_b32 v243, v220
    s_nop 1
    v_permlane32_swap_b32 v242, v243
    s_nop 1
    v_add_f32 v244, v242, v243
    v_rcp_f32 v244, v244
    s_nop 0
    v_mov_b32 v245, v244
    v_accvgpr_read_b32 v160, a64
    v_accvgpr_read_b32 v161, a65
    v_accvgpr_read_b32 v162, a66
    v_accvgpr_read_b32 v163, a67
    v_accvgpr_read_b32 v164, a68
    v_accvgpr_read_b32 v165, a69
    v_accvgpr_read_b32 v166, a70
    v_accvgpr_read_b32 v167, a71
    v_pk_mul_f32 v[160:161], v[160:161], v[244:245]
    v_pk_mul_f32 v[162:163], v[162:163], v[244:245]
    v_pk_mul_f32 v[164:165], v[164:165], v[244:245]
    v_pk_mul_f32 v[166:167], v[166:167], v[244:245]
    v_cvt_pk_bf16_f32 v168, v160, v161
    v_cvt_pk_bf16_f32 v169, v162, v163
    v_cvt_pk_bf16_f32 v170, v164, v165
    v_cvt_pk_bf16_f32 v171, v166, v167
    s_nop 0
    v_permlane32_swap_b32 v168, v170
    v_permlane32_swap_b32 v169, v171
    ds_write_b128 v208, v[168:171] offset:0
    v_accvgpr_read_b32 v172, a72
    v_accvgpr_read_b32 v173, a73
    v_accvgpr_read_b32 v174, a74
    v_accvgpr_read_b32 v175, a75
    v_accvgpr_read_b32 v176, a76
    v_accvgpr_read_b32 v177, a77
    v_accvgpr_read_b32 v178, a78
    v_accvgpr_read_b32 v179, a79
    v_pk_mul_f32 v[172:173], v[172:173], v[244:245]
    v_pk_mul_f32 v[174:175], v[174:175], v[244:245]
    v_pk_mul_f32 v[176:177], v[176:177], v[244:245]
    v_pk_mul_f32 v[178:179], v[178:179], v[244:245]
    v_cvt_pk_bf16_f32 v180, v172, v173
    v_cvt_pk_bf16_f32 v181, v174, v175
    v_cvt_pk_bf16_f32 v182, v176, v177
    v_cvt_pk_bf16_f32 v183, v178, v179
    s_nop 0
    v_permlane32_swap_b32 v180, v182
    v_permlane32_swap_b32 v181, v183
    ds_write_b128 v209, v[180:183] offset:0
    v_accvgpr_read_b32 v184, a80
    v_accvgpr_read_b32 v185, a81
    v_accvgpr_read_b32 v186, a82
    v_accvgpr_read_b32 v187, a83
    v_accvgpr_read_b32 v188, a84
    v_accvgpr_read_b32 v189, a85
    v_accvgpr_read_b32 v190, a86
    v_accvgpr_read_b32 v191, a87
    v_pk_mul_f32 v[184:185], v[184:185], v[244:245]
    v_pk_mul_f32 v[186:187], v[186:187], v[244:245]
    v_pk_mul_f32 v[188:189], v[188:189], v[244:245]
    v_pk_mul_f32 v[190:191], v[190:191], v[244:245]
    v_cvt_pk_bf16_f32 v192, v184, v185
    v_cvt_pk_bf16_f32 v193, v186, v187
    v_cvt_pk_bf16_f32 v194, v188, v189
    v_cvt_pk_bf16_f32 v195, v190, v191
    s_nop 0
    v_permlane32_swap_b32 v192, v194
    v_permlane32_swap_b32 v193, v195
    ds_write_b128 v210, v[192:195] offset:0
    v_accvgpr_read_b32 v196, a88
    v_accvgpr_read_b32 v197, a89
    v_accvgpr_read_b32 v198, a90
    v_accvgpr_read_b32 v199, a91
    v_accvgpr_read_b32 v200, a92
    v_accvgpr_read_b32 v201, a93
    v_accvgpr_read_b32 v202, a94
    v_accvgpr_read_b32 v203, a95
    v_pk_mul_f32 v[196:197], v[196:197], v[244:245]
    v_pk_mul_f32 v[198:199], v[198:199], v[244:245]
    v_pk_mul_f32 v[200:201], v[200:201], v[244:245]
    v_pk_mul_f32 v[202:203], v[202:203], v[244:245]
    v_cvt_pk_bf16_f32 v204, v196, v197
    v_cvt_pk_bf16_f32 v205, v198, v199
    v_cvt_pk_bf16_f32 v206, v200, v201
    v_cvt_pk_bf16_f32 v207, v202, v203
    s_nop 0
    v_permlane32_swap_b32 v204, v206
    v_permlane32_swap_b32 v205, v207
    ds_write_b128 v211, v[204:207] offset:0
    v_accvgpr_read_b32 v160, a96
    v_accvgpr_read_b32 v161, a97
    v_accvgpr_read_b32 v162, a98
    v_accvgpr_read_b32 v163, a99
    v_accvgpr_read_b32 v164, a100
    v_accvgpr_read_b32 v165, a101
    v_accvgpr_read_b32 v166, a102
    v_accvgpr_read_b32 v167, a103
    v_pk_mul_f32 v[160:161], v[160:161], v[244:245]
    v_pk_mul_f32 v[162:163], v[162:163], v[244:245]
    v_pk_mul_f32 v[164:165], v[164:165], v[244:245]
    v_pk_mul_f32 v[166:167], v[166:167], v[244:245]
    v_cvt_pk_bf16_f32 v168, v160, v161
    v_cvt_pk_bf16_f32 v169, v162, v163
    v_cvt_pk_bf16_f32 v170, v164, v165
    v_cvt_pk_bf16_f32 v171, v166, v167
    s_nop 0
    v_permlane32_swap_b32 v168, v170
    v_permlane32_swap_b32 v169, v171
    ds_write_b128 v212, v[168:171] offset:0
    v_accvgpr_read_b32 v172, a104
    v_accvgpr_read_b32 v173, a105
    v_accvgpr_read_b32 v174, a106
    v_accvgpr_read_b32 v175, a107
    v_accvgpr_read_b32 v176, a108
    v_accvgpr_read_b32 v177, a109
    v_accvgpr_read_b32 v178, a110
    v_accvgpr_read_b32 v179, a111
    v_pk_mul_f32 v[172:173], v[172:173], v[244:245]
    v_pk_mul_f32 v[174:175], v[174:175], v[244:245]
    v_pk_mul_f32 v[176:177], v[176:177], v[244:245]
    v_pk_mul_f32 v[178:179], v[178:179], v[244:245]
    v_cvt_pk_bf16_f32 v180, v172, v173
    v_cvt_pk_bf16_f32 v181, v174, v175
    v_cvt_pk_bf16_f32 v182, v176, v177
    v_cvt_pk_bf16_f32 v183, v178, v179
    s_nop 0
    v_permlane32_swap_b32 v180, v182
    v_permlane32_swap_b32 v181, v183
    ds_write_b128 v213, v[180:183] offset:0
    v_accvgpr_read_b32 v184, a112
    v_accvgpr_read_b32 v185, a113
    v_accvgpr_read_b32 v186, a114
    v_accvgpr_read_b32 v187, a115
    v_accvgpr_read_b32 v188, a116
    v_accvgpr_read_b32 v189, a117
    v_accvgpr_read_b32 v190, a118
    v_accvgpr_read_b32 v191, a119
    v_pk_mul_f32 v[184:185], v[184:185], v[244:245]
    v_pk_mul_f32 v[186:187], v[186:187], v[244:245]
    v_pk_mul_f32 v[188:189], v[188:189], v[244:245]
    v_pk_mul_f32 v[190:191], v[190:191], v[244:245]
    v_cvt_pk_bf16_f32 v192, v184, v185
    v_cvt_pk_bf16_f32 v193, v186, v187
    v_cvt_pk_bf16_f32 v194, v188, v189
    v_cvt_pk_bf16_f32 v195, v190, v191
    s_nop 0
    v_permlane32_swap_b32 v192, v194
    v_permlane32_swap_b32 v193, v195
    ds_write_b128 v214, v[192:195] offset:0
    v_accvgpr_read_b32 v196, a120
    v_accvgpr_read_b32 v197, a121
    v_accvgpr_read_b32 v198, a122
    v_accvgpr_read_b32 v199, a123
    v_accvgpr_read_b32 v200, a124
    v_accvgpr_read_b32 v201, a125
    v_accvgpr_read_b32 v202, a126
    v_accvgpr_read_b32 v203, a127
    v_pk_mul_f32 v[196:197], v[196:197], v[244:245]
    v_pk_mul_f32 v[198:199], v[198:199], v[244:245]
    v_pk_mul_f32 v[200:201], v[200:201], v[244:245]
    v_pk_mul_f32 v[202:203], v[202:203], v[244:245]
    v_cvt_pk_bf16_f32 v204, v196, v197
    v_cvt_pk_bf16_f32 v205, v198, v199
    v_cvt_pk_bf16_f32 v206, v200, v201
    v_cvt_pk_bf16_f32 v207, v202, v203
    s_nop 0
    v_permlane32_swap_b32 v204, v206
    v_permlane32_swap_b32 v205, v207
    ds_write_b128 v215, v[204:207] offset:0
    v_add_u32 v250, s42, v255
    s_waitcnt lgkmcnt(0)
    ds_read_b128 v[128:131], v250 offset:0
    ds_read_b128 v[132:135], v250 offset:1024
    ds_read_b128 v[136:139], v250 offset:2048
    ds_read_b128 v[140:143], v250 offset:3072
    ds_read_b128 v[144:147], v250 offset:16384
    ds_read_b128 v[148:151], v250 offset:17408
    ds_read_b128 v[152:155], v250 offset:18432
    ds_read_b128 v[156:159], v250 offset:19456
    s_add_u32 s96, s37, 8192
    s_add_u32 s97, s37, 12288
    s_waitcnt lgkmcnt(0)
    s_barrier
    ds_read_b128 v[32:35], v72 offset:0
    ds_read_b128 v[36:39], v72 offset:1024
    ds_read_b128 v[40:43], v72 offset:2048
    ds_read_b128 v[44:47], v72 offset:3072
    ds_read_b128 v[48:51], v72 offset:16384
    ds_read_b128 v[52:55], v72 offset:17408
    ds_read_b128 v[56:59], v72 offset:18432
    ds_read_b128 v[60:63], v72 offset:19456
    buffer_store_dwordx4 v[128:131], v235, s[24:27], s96 offen offset:0 sc1 nt
    v_bfe_u32 v242, v255, 4, 5
    v_bfe_u32 v243, v255, 9, 1
    v_and_b32 v248, 7, v242
    v_xor_b32 v248, v248, v243
    v_lshlrev_b32 v242, 7, v242
    v_add_u32 v242, s42, v242
    v_xor_b32 v208, 0, v248
    v_lshl_add_u32 v208, v208, 4, v242
    v_xor_b32 v209, 2, v248
    v_lshl_add_u32 v209, v209, 4, v242
    v_xor_b32 v210, 4, v248
    v_lshl_add_u32 v210, v210, 4, v242
    v_xor_b32 v211, 6, v248
    v_lshl_add_u32 v211, v211, 4, v242
    buffer_store_dwordx4 v[132:135], v236, s[24:27], s96 offen offset:1024 sc1 nt
    v_bfe_u32 v242, v255, 7, 3
    v_bfe_u32 v243, v255, 4, 3
    v_xor_b32 v243, v243, v242
    v_lshlrev_b32 v242, 8, v242
    v_lshl_add_u32 v253, v243, 4, v242
    v_add_u32 v251, s42, v255
    v_accvgpr_read_b32 v160, a160
    v_accvgpr_read_b32 v161, a161
    v_accvgpr_read_b32 v162, a162
    v_accvgpr_read_b32 v163, a163
    v_accvgpr_read_b32 v164, a164
    v_accvgpr_read_b32 v165, a165
    v_accvgpr_read_b32 v166, a166
    v_accvgpr_read_b32 v167, a167
    buffer_store_dwordx4 v[136:139], v237, s[24:27], s96 offen offset:2048 sc1 nt
    v_pk_mul_f32 v[160:161], v[160:161], v[68:69]
    v_pk_mul_f32 v[162:163], v[162:163], v[68:69]
    v_pk_mul_f32 v[164:165], v[164:165], v[68:69]
    v_pk_mul_f32 v[166:167], v[166:167], v[68:69]
    s_waitcnt lgkmcnt(7)
    v_pk_fma_f32 v[160:161], v[32:33], v[70:71], v[160:161]
    v_pk_fma_f32 v[162:163], v[34:35], v[70:71], v[162:163]
    s_waitcnt lgkmcnt(6)
    v_pk_fma_f32 v[164:165], v[36:37], v[70:71], v[164:165]
    v_pk_fma_f32 v[166:167], v[38:39], v[70:71], v[166:167]
    v_cvt_pk_bf16_f32 v168, v160, v161
    buffer_store_dwordx4 v[140:143], v238, s[24:27], s96 offen offset:3072 sc1 nt
    v_cvt_pk_bf16_f32 v169, v162, v163
    v_cvt_pk_bf16_f32 v170, v164, v165
    v_cvt_pk_bf16_f32 v171, v166, v167
    s_nop 0
    v_permlane32_swap_b32 v168, v170
    v_permlane32_swap_b32 v169, v171
    ds_write_b128 v208, v[168:171] offset:0
    v_accvgpr_read_b32 v172, a168
    v_accvgpr_read_b32 v173, a169
    v_accvgpr_read_b32 v174, a170
    v_accvgpr_read_b32 v175, a171
    v_accvgpr_read_b32 v176, a172
    v_accvgpr_read_b32 v177, a173
    v_accvgpr_read_b32 v178, a174
    v_accvgpr_read_b32 v179, a175
    buffer_store_dwordx4 v[144:147], v239, s[24:27], s97 offen offset:0 sc1 nt
    v_pk_mul_f32 v[172:173], v[172:173], v[68:69]
    v_pk_mul_f32 v[174:175], v[174:175], v[68:69]
    v_pk_mul_f32 v[176:177], v[176:177], v[68:69]
    v_pk_mul_f32 v[178:179], v[178:179], v[68:69]
    s_waitcnt lgkmcnt(6)
    v_pk_fma_f32 v[172:173], v[40:41], v[70:71], v[172:173]
    v_pk_fma_f32 v[174:175], v[42:43], v[70:71], v[174:175]
    s_waitcnt lgkmcnt(5)
    v_pk_fma_f32 v[176:177], v[44:45], v[70:71], v[176:177]
    v_pk_fma_f32 v[178:179], v[46:47], v[70:71], v[178:179]
    v_cvt_pk_bf16_f32 v180, v172, v173
    buffer_store_dwordx4 v[148:151], v239, s[24:27], s97 offen offset:1024 sc1 nt
    v_cvt_pk_bf16_f32 v181, v174, v175
    v_cvt_pk_bf16_f32 v182, v176, v177
    v_cvt_pk_bf16_f32 v183, v178, v179
    s_nop 0
    v_permlane32_swap_b32 v180, v182
    v_permlane32_swap_b32 v181, v183
    ds_write_b128 v209, v[180:183] offset:0
    v_accvgpr_read_b32 v184, a176
    v_accvgpr_read_b32 v185, a177
    v_accvgpr_read_b32 v186, a178
    v_accvgpr_read_b32 v187, a179
    v_accvgpr_read_b32 v188, a180
    v_accvgpr_read_b32 v189, a181
    v_accvgpr_read_b32 v190, a182
    v_accvgpr_read_b32 v191, a183
    buffer_store_dwordx4 v[152:155], v239, s[24:27], s97 offen offset:2048 sc1 nt
    v_pk_mul_f32 v[184:185], v[184:185], v[68:69]
    v_pk_mul_f32 v[186:187], v[186:187], v[68:69]
    v_pk_mul_f32 v[188:189], v[188:189], v[68:69]
    v_pk_mul_f32 v[190:191], v[190:191], v[68:69]
    s_waitcnt lgkmcnt(5)
    v_pk_fma_f32 v[184:185], v[48:49], v[70:71], v[184:185]
    v_pk_fma_f32 v[186:187], v[50:51], v[70:71], v[186:187]
    s_waitcnt lgkmcnt(4)
    v_pk_fma_f32 v[188:189], v[52:53], v[70:71], v[188:189]
    v_pk_fma_f32 v[190:191], v[54:55], v[70:71], v[190:191]
    v_cvt_pk_bf16_f32 v192, v184, v185
    v_cvt_pk_bf16_f32 v193, v186, v187
    buffer_store_dwordx4 v[156:159], v239, s[24:27], s97 offen offset:3072 sc1 nt
    v_cvt_pk_bf16_f32 v194, v188, v189
    v_cvt_pk_bf16_f32 v195, v190, v191
    s_nop 0
    v_permlane32_swap_b32 v192, v194
    v_permlane32_swap_b32 v193, v195
    ds_write_b128 v210, v[192:195] offset:0
    v_accvgpr_read_b32 v196, a184
    v_accvgpr_read_b32 v197, a185
    v_accvgpr_read_b32 v198, a186
    v_accvgpr_read_b32 v199, a187
    v_accvgpr_read_b32 v200, a188
    v_accvgpr_read_b32 v201, a189
    v_accvgpr_read_b32 v202, a190
    v_accvgpr_read_b32 v203, a191
    v_pk_mul_f32 v[196:197], v[196:197], v[68:69]
    v_pk_mul_f32 v[198:199], v[198:199], v[68:69]
    v_pk_mul_f32 v[200:201], v[200:201], v[68:69]
    v_pk_mul_f32 v[202:203], v[202:203], v[68:69]
    s_waitcnt lgkmcnt(4)
    v_pk_fma_f32 v[196:197], v[56:57], v[70:71], v[196:197]
    v_pk_fma_f32 v[198:199], v[58:59], v[70:71], v[198:199]
    s_waitcnt lgkmcnt(3)
    v_pk_fma_f32 v[200:201], v[60:61], v[70:71], v[200:201]
    v_pk_fma_f32 v[202:203], v[62:63], v[70:71], v[202:203]
    v_cvt_pk_bf16_f32 v204, v196, v197
    v_cvt_pk_bf16_f32 v205, v198, v199
    v_cvt_pk_bf16_f32 v206, v200, v201
    v_cvt_pk_bf16_f32 v207, v202, v203
    s_nop 0
    v_permlane32_swap_b32 v204, v206
    v_permlane32_swap_b32 v205, v207
    ds_write_b128 v211, v[204:207] offset:0
    s_waitcnt lgkmcnt(0)
    ds_read_b128 v[80:83], v251 offset:0
    ds_read_b128 v[84:87], v251 offset:1024
    ds_read_b128 v[88:91], v251 offset:2048
    ds_read_b128 v[92:95], v251 offset:3072
    s_add_u32 s98, s38, 128
    s_add_u32 s99, s38, 4224
    s_waitcnt lgkmcnt(0)
    buffer_store_dwordx4 v[80:83], v253, s[24:27], s98 offen offset:0 sc1 nt
    buffer_store_dwordx4 v[84:87], v253, s[24:27], s98 offen offset:2048 sc1 nt
    buffer_store_dwordx4 v[88:91], v253, s[24:27], s99 offen offset:0 sc1 nt
    buffer_store_dwordx4 v[92:95], v253, s[24:27], s99 offen offset:2048 sc1 nt
    s_branch L_fin
L_item_B:
    s_sub_u32 s36, s35, s51
    s_mov_b32 s51, s35
    v_add_u32 v223, s36, v223
    v_add_u32 v224, s36, v224
    v_add_u32 v225, s36, v225
    v_add_u32 v226, s36, v226
    v_add_u32 v227, s36, v227
    v_add_u32 v228, s36, v228
    v_add_u32 v229, s36, v229
    v_add_u32 v230, s36, v230
    ds_read_b128 v[96:99], v223 offset:0
    ds_read_b128 v[100:103], v224 offset:0
    ds_read_b128 v[104:107], v225 offset:0
    ds_read_b128 v[108:111], v226 offset:0
    ds_read_b128 v[112:115], v227 offset:0
    ds_read_b128 v[116:119], v228 offset:0
    ds_read_b128 v[120:123], v229 offset:0
    ds_read_b128 v[124:127], v230 offset:0
    s_sub_u32 s36, s35, s52
    s_mov_b32 s52, s35
    s_mov_b32 s29, 0x35800000
    s_mov_b32 s22, 0x12000000
    s_waitcnt lgkmcnt(0)
    v_mfma_f32_32x32x16_bf16 v[160:175], v[96:99], v[0:3], v[32:47]
    v_mfma_f32_32x32x16_bf16 v[160:175], v[100:103], v[4:7], v[160:175]
    v_mfma_f32_32x32x16_bf16 v[160:175], v[104:107], v[8:11], v[160:175]
    v_mfma_f32_32x32x16_bf16 v[160:175], v[108:111], v[12:15], v[160:175]
    v_mfma_f32_32x32x16_bf16 v[160:175], v[112:115], v[16:19], v[160:175]
    v_mfma_f32_32x32x16_bf16 v[160:175], v[116:119], v[20:23], v[160:175]
    v_mfma_f32_32x32x16_bf16 v[160:175], v[120:123], v[24:27], v[160:175]
    v_mfma_f32_32x32x16_bf16 v[160:175], v[124:127], v[28:31], v[160:175]
    v_add_u32 v231, s36, v231
    v_add_u32 v232, s36, v232
    v_add_u32 v233, s36, v233
    v_add_u32 v234, s36, v234
    v_mfma_f32_32x32x16_bf16 a[64:79], v[128:131], v[200:203], a[64:79]
L_loop_B:
    ds_read_b64_tr_b16 v[128:129], v231 offset:0
    ds_read_b64_tr_b16 v[130:131], v231 offset:2048
    s_bitcmp1_b32 s23, s32
    s_cbranch_scc1 L_ex63
L_exr64:
    v_mfma_f32_32x32x16_bf16 a[80:95], v[136:139], v[200:203], a[80:95]
    ds_read_b64_tr_b16 v[136:137], v232 offset:0
    ds_read_b64_tr_b16 v[138:139], v232 offset:2048
    s_mov_b32 m0, s34
    s_nop 0
    buffer_load_dwordx4 v235, s[12:15], s20 offen offset:0 nt lds
    buffer_load_dwordx4 v236, s[12:15], s20 offen offset:1024 nt lds
    v_mfma_f32_32x32x16_bf16 a[96:111], v[144:147], v[200:203], a[96:111]
    ds_read_b64_tr_b16 v[144:145], v233 offset:0
    ds_read_b64_tr_b16 v[146:147], v233 offset:2048
    v_exp_f32 v208, v160
    v_exp_f32 v209, v161
    v_mfma_f32_32x32x16_bf16 a[112:127], v[152:155], v[200:203], a[112:127]
    ds_read_b64_tr_b16 v[152:153], v234 offset:0
    ds_read_b64_tr_b16 v[154:155], v234 offset:2048
    v_exp_f32 v210, v162
    v_exp_f32 v211, v163
    v_add_f32 v222, v208, v209
    v_mfma_f32_32x32x16_bf16 a[64:79], v[132:135], v[204:207], a[64:79]
    ds_read_b64_tr_b16 v[132:133], v231 offset:4096
    ds_read_b64_tr_b16 v[134:135], v231 offset:6144
    v_cvt_pk_bf16_f32 v192, v208, v209
    v_exp_f32 v212, v164
    v_add_f32 v222, v222, v210
    v_mfma_f32_32x32x16_bf16 a[80:95], v[140:143], v[204:207], a[80:95]
    ds_read_b64_tr_b16 v[140:141], v232 offset:4096
    ds_read_b64_tr_b16 v[142:143], v232 offset:6144
    v_exp_f32 v213, v165
    v_add_f32 v222, v222, v211
    v_cvt_pk_bf16_f32 v193, v210, v211
    v_mfma_f32_32x32x16_bf16 a[96:111], v[148:151], v[204:207], a[96:111]
    ds_read_b64_tr_b16 v[148:149], v233 offset:4096
    ds_read_b64_tr_b16 v[150:151], v233 offset:6144
    v_exp_f32 v214, v166
    v_add_f32 v222, v222, v212
    v_exp_f32 v215, v167
    v_mfma_f32_32x32x16_bf16 a[112:127], v[156:159], v[204:207], a[112:127]
    ds_read_b64_tr_b16 v[156:157], v234 offset:4096
    ds_read_b64_tr_b16 v[158:159], v234 offset:6144
    v_add_f32 v222, v222, v213
    v_cvt_pk_bf16_f32 v194, v212, v213
    v_exp_f32 v208, v168
    v_mfma_f32_32x32x16_bf16 v[176:191], v[96:99], a[192:195], v[48:63]
    ds_read_b128 v[96:99], v223 offset:8192
    v_add_f32 v222, v222, v214
    v_exp_f32 v209, v169
    v_add_f32 v222, v222, v215
    v_cvt_pk_bf16_f32 v195, v214, v215
    v_mfma_f32_32x32x16_bf16 v[176:191], v[100:103], a[196:199], v[176:191]
    ds_read_b128 v[100:103], v224 offset:8192
    v_exp_f32 v210, v170
    v_add_f32 v222, v222, v208
    v_exp_f32 v211, v171
    v_mfma_f32_32x32x16_bf16 v[176:191], v[104:107], a[200:203], v[176:191]
    ds_read_b128 v[104:107], v225 offset:8192
    v_add_f32 v222, v222, v209
    v_cvt_pk_bf16_f32 v196, v208, v209
    v_exp_f32 v212, v172
    v_mfma_f32_32x32x16_bf16 v[176:191], v[108:111], a[204:207], v[176:191]
    ds_read_b128 v[108:111], v226 offset:8192
    buffer_load_dwordx4 v237, s[12:15], s20 offen offset:2048 nt lds
    buffer_load_dwordx4 v238, s[12:15], s20 offen offset:3072 nt lds
    v_add_f32 v222, v222, v210
    v_mfma_f32_32x32x16_bf16 v[176:191], v[112:115], a[208:211], v[176:191]
    ds_read_b128 v[112:115], v227 offset:8192
    v_exp_f32 v213, v173
    v_add_f32 v222, v222, v211
    v_exp_f32 v214, v174
    v_mfma_f32_32x32x16_bf16 v[176:191], v[116:119], a[212:215], v[176:191]
    ds_read_b128 v[116:119], v228 offset:8192
    v_add_f32 v222, v222, v212
    v_exp_f32 v215, v175
    v_add_f32 v222, v222, v213
    v_add_f32 v222, v222, v214
    v_mfma_f32_32x32x16_bf16 v[176:191], v[120:123], a[216:219], v[176:191]
    ds_read_b128 v[120:123], v229 offset:8192
    v_add_f32 v222, v222, v215
    v_subrev_u32 v253, s29, v222
    v_cmp_lt_u32 vcc, s22, v253
    v_cvt_pk_bf16_f32 v197, v210, v211
    v_cvt_pk_bf16_f32 v198, v212, v213
    v_mfma_f32_32x32x16_bf16 v[176:191], v[124:127], a[220:223], v[176:191]
    ds_read_b128 v[124:127], v230 offset:8192
    v_cvt_pk_bf16_f32 v199, v214, v215
    s_cbranch_vccnz L_stub40
L_ret40:
    v_add_f32 v219, v219, v222
    s_waitcnt lgkmcnt(8)
    v_mfma_f32_32x32x16_bf16 a[0:15], v[128:131], v[192:195], a[0:15]
    s_add_u32 m0, s34, 16384
    s_nop 0
    buffer_load_dwordx4 v239, s[16:19], s21 offen offset:0 nt lds
    buffer_load_dwordx4 v239, s[16:19], s21 offen offset:1024 nt lds
    v_mfma_f32_32x32x16_bf16 a[16:31], v[136:139], v[192:195], a[16:31]
    buffer_load_dwordx4 v239, s[16:19], s21 offen offset:2048 nt lds
    buffer_load_dwordx4 v239, s[16:19], s21 offen offset:3072 nt lds
    v_mfma_f32_32x32x16_bf16 a[32:47], v[144:147], v[192:195], a[32:47]
    v_exp_f32 v208, v176
    v_exp_f32 v209, v177
    v_mfma_f32_32x32x16_bf16 a[48:63], v[152:155], v[192:195], a[48:63]
    v_exp_f32 v210, v178
    v_exp_f32 v211, v179
    v_add_f32 v222, v208, v209
    v_mfma_f32_32x32x16_bf16 a[0:15], v[132:135], v[196:199], a[0:15]
    v_cvt_pk_bf16_f32 v200, v208, v209
    v_exp_f32 v212, v180
    v_add_f32 v222, v222, v210
    v_exp_f32 v213, v181
    v_mfma_f32_32x32x16_bf16 a[16:31], v[140:143], v[196:199], a[16:31]
    v_add_f32 v222, v222, v211
    v_cvt_pk_bf16_f32 v201, v210, v211
    v_exp_f32 v214, v182
    v_mfma_f32_32x32x16_bf16 a[32:47], v[148:151], v[196:199], a[32:47]
    v_add_f32 v222, v222, v212
    v_exp_f32 v215, v183
    v_add_f32 v222, v222, v213
    v_mfma_f32_32x32x16_bf16 a[48:63], v[156:159], v[196:199], a[48:63]
    v_cvt_pk_bf16_f32 v202, v212, v213
    v_exp_f32 v208, v184
    v_add_f32 v222, v222, v214
    s_waitcnt lgkmcnt(0)
    v_mfma_f32_32x32x16_bf16 v[160:175], v[96:99], v[0:3], v[32:47]
    v_exp_f32 v209, v185
    v_add_f32 v222, v222, v215
    v_cvt_pk_bf16_f32 v203, v214, v215
    v_exp_f32 v210, v186
    v_mfma_f32_32x32x16_bf16 v[160:175], v[100:103], v[4:7], v[160:175]
    v_add_f32 v222, v222, v208
    v_exp_f32 v211, v187
    v_add_f32 v222, v222, v209
    v_mfma_f32_32x32x16_bf16 v[160:175], v[104:107], v[8:11], v[160:175]
    v_cvt_pk_bf16_f32 v204, v208, v209
    v_exp_f32 v212, v188
    v_add_f32 v222, v222, v210
    v_mfma_f32_32x32x16_bf16 v[160:175], v[108:111], v[12:15], v[160:175]
    s_add_u32 s34, s34, 32768
    s_cmp_ge_u32 s34, s40
    s_cselect_b32 s60, s41, 0
    s_sub_u32 s34, s34, s60
    v_exp_f32 v213, v189
    v_mfma_f32_32x32x16_bf16 v[160:175], v[112:115], v[16:19], v[160:175]
    v_add_f32 v222, v222, v211
    v_exp_f32 v214, v190
    v_add_f32 v222, v222, v212
    v_mfma_f32_32x32x16_bf16 v[160:175], v[116:119], v[20:23], v[160:175]
    v_exp_f32 v215, v191
    v_add_f32 v222, v222, v213
    v_add_f32 v222, v222, v214
    v_add_f32 v222, v222, v215
    v_mfma_f32_32x32x16_bf16 v[160:175], v[120:123], v[24:27], v[160:175]
    v_subrev_u32 v253, s29, v222
    v_cmp_lt_u32 vcc, s22, v253
    v_cvt_pk_bf16_f32 v205, v210, v211
    v_cvt_pk_bf16_f32 v206, v212, v213
    v_mfma_f32_32x32x16_bf16 v[160:175], v[124:127], v[28:31], v[160:175]
    v_cvt_pk_bf16_f32 v207, v214, v215
    s_cbranch_vccnz L_stub41
L_ret41:
    v_add_f32 v220, v220, v222
    v_mfma_f32_32x32x16_bf16 a[64:79], v[128:131], v[200:203], a[64:79]
    ds_read_b64_tr_b16 v[128:129], v231 offset:8192
    ds_read_b64_tr_b16 v[130:131], v231 offset:10240
    s_add_u32 s20, s20, 16384
    s_add_u32 s21, s21, 16384
    s_bitcmp1_b32 s57, s32
    s_cbranch_scc1 L_sp55
L_spr56:
    v_mfma_f32_32x32x16_bf16 a[80:95], v[136:139], v[200:203], a[80:95]
    ds_read_b64_tr_b16 v[136:137], v232 offset:8192
    ds_read_b64_tr_b16 v[138:139], v232 offset:10240
    v_mfma_f32_32x32x16_bf16 a[96:111], v[144:147], v[200:203], a[96:111]
    ds_read_b64_tr_b16 v[144:145], v233 offset:8192
    ds_read_b64_tr_b16 v[146:147], v233 offset:10240
    v_exp_f32 v208, v160
    v_exp_f32 v209, v161
    v_mfma_f32_32x32x16_bf16 a[112:127], v[152:155], v[200:203], a[112:127]
    ds_read_b64_tr_b16 v[152:153], v234 offset:8192
    ds_read_b64_tr_b16 v[154:155], v234 offset:10240
    v_exp_f32 v210, v162
    v_exp_f32 v211, v163
    v_add_f32 v222, v208, v209
    v_mfma_f32_32x32x16_bf16 a[64:79], v[132:135], v[204:207], a[64:79]
    ds_read_b64_tr_b16 v[132:133], v231 offset:12288
    ds_read_b64_tr_b16 v[134:135], v231 offset:14336
    v_cvt_pk_bf16_f32 v192, v208, v209
    v_exp_f32 v212, v164
    v_add_f32 v222, v222, v210
    v_mfma_f32_32x32x16_bf16 a[80:95], v[140:143], v[204:207], a[80:95]
    ds_read_b64_tr_b16 v[140:141], v232 offset:12288
    ds_read_b64_tr_b16 v[142:143], v232 offset:14336
    v_exp_f32 v213, v165
    v_add_f32 v222, v222, v211
    v_cvt_pk_bf16_f32 v193, v210, v211
    v_mfma_f32_32x32x16_bf16 a[96:111], v[148:151], v[204:207], a[96:111]
    ds_read_b64_tr_b16 v[148:149], v233 offset:12288
    ds_read_b64_tr_b16 v[150:151], v233 offset:14336
    v_exp_f32 v214, v166
    v_add_f32 v222, v222, v212
    v_exp_f32 v215, v167
    v_mfma_f32_32x32x16_bf16 a[112:127], v[156:159], v[204:207], a[112:127]
    ds_read_b64_tr_b16 v[156:157], v234 offset:12288
    ds_read_b64_tr_b16 v[158:159], v234 offset:14336
    v_add_f32 v222, v222, v213
    v_cvt_pk_bf16_f32 v194, v212, v213
    v_exp_f32 v208, v168
    v_mfma_f32_32x32x16_bf16 v[176:191], v[96:99], a[192:195], v[48:63]
    s_add_u32 s35, s35, 32768
    s_cmp_ge_u32 s35, s40
    s_cselect_b32 s46, s41, 0
    s_sub_u32 s35, s35, s46
    v_add_f32 v222, v222, v214
    v_exp_f32 v209, v169
    v_mfma_f32_32x32x16_bf16 v[176:191], v[100:103], a[196:199], v[176:191]
    s_sub_u32 s36, s35, s51
    s_mov_b32 s51, s35
    s_mov_b32 s52, s35
    s_add_u32 s32, s32, 1
    v_add_f32 v222, v222, v215
    v_cvt_pk_bf16_f32 v195, v214, v215
    v_mfma_f32_32x32x16_bf16 v[176:191], v[104:107], a[200:203], v[176:191]
    v_add_u32 v223, s36, v223
    v_add_u32 v224, s36, v224
    v_exp_f32 v210, v170
    v_add_f32 v222, v222, v208
    v_exp_f32 v211, v171
    v_mfma_f32_32x32x16_bf16 v[176:191], v[108:111], a[204:207], v[176:191]
    v_add_u32 v225, s36, v225
    v_add_f32 v222, v222, v209
    v_cvt_pk_bf16_f32 v196, v208, v209
    v_exp_f32 v212, v172
    v_mfma_f32_32x32x16_bf16 v[176:191], v[112:115], a[208:211], v[176:191]
    v_add_u32 v226, s36, v226
    v_add_f32 v222, v222, v210
    v_exp_f32 v213, v173
    v_add_f32 v222, v222, v211
    v_exp_f32 v214, v174
    v_mfma_f32_32x32x16_bf16 v[176:191], v[116:119], a[212:215], v[176:191]
    v_add_u32 v227, s36, v227
    v_add_u32 v228, s36, v228
    v_add_f32 v222, v222, v212
    v_exp_f32 v215, v175
    v_add_f32 v222, v222, v213
    v_mfma_f32_32x32x16_bf16 v[176:191], v[120:123], a[216:219], v[176:191]
    v_add_u32 v229, s36, v229
    v_add_f32 v222, v222, v214
    v_add_f32 v222, v222, v215
    v_subrev_u32 v253, s29, v222
    v_cmp_lt_u32 vcc, s22, v253
    v_cvt_pk_bf16_f32 v197, v210, v211
    v_mfma_f32_32x32x16_bf16 v[176:191], v[124:127], a[220:223], v[176:191]
    v_add_u32 v230, s36, v230
    v_cvt_pk_bf16_f32 v198, v212, v213
    v_cvt_pk_bf16_f32 v199, v214, v215
    s_cbranch_vccnz L_stub42
L_ret42:
    v_add_f32 v219, v219, v222
    s_waitcnt lgkmcnt(0)
    v_mfma_f32_32x32x16_bf16 a[0:15], v[128:131], v[192:195], a[0:15]
    s_waitcnt lgkmcnt(0)
    s_bitcmp1_b32 s59, s32
    s_cbranch_scc1 L_bw53
    s_waitcnt vmcnt(24)
L_bwr54:
    s_barrier
    v_mfma_f32_32x32x16_bf16 a[16:31], v[136:139], v[192:195], a[16:31]
    ds_read_b128 v[96:99], v223 offset:0
    ds_read_b128 v[100:103], v224 offset:0
    ds_read_b128 v[104:107], v225 offset:0
    v_mfma_f32_32x32x16_bf16 a[32:47], v[144:147], v[192:195], a[32:47]
    ds_read_b128 v[108:111], v226 offset:0
    ds_read_b128 v[112:115], v227 offset:0
    ds_read_b128 v[116:119], v228 offset:0
    v_mfma_f32_32x32x16_bf16 a[48:63], v[152:155], v[192:195], a[48:63]
    ds_read_b128 v[120:123], v229 offset:0
    ds_read_b128 v[124:127], v230 offset:0
    v_exp_f32 v208, v176
    v_mfma_f32_32x32x16_bf16 a[0:15], v[132:135], v[196:199], a[0:15]
    v_exp_f32 v209, v177
    v_exp_f32 v210, v178
    v_exp_f32 v211, v179
    v_mfma_f32_32x32x16_bf16 a[16:31], v[140:143], v[196:199], a[16:31]
    v_add_f32 v222, v208, v209
    v_cvt_pk_bf16_f32 v200, v208, v209
    v_exp_f32 v212, v180
    v_mfma_f32_32x32x16_bf16 a[32:47], v[148:151], v[196:199], a[32:47]
    v_add_f32 v222, v222, v210
    v_exp_f32 v213, v181
    v_add_f32 v222, v222, v211
    v_cvt_pk_bf16_f32 v201, v210, v211
    v_mfma_f32_32x32x16_bf16 a[48:63], v[156:159], v[196:199], a[48:63]
    v_exp_f32 v214, v182
    v_add_f32 v222, v222, v212
    v_exp_f32 v215, v183
    s_waitcnt lgkmcnt(0)
    v_mfma_f32_32x32x16_bf16 v[160:175], v[96:99], v[0:3], v[32:47]
    v_add_f32 v222, v222, v213
    v_cvt_pk_bf16_f32 v202, v212, v213
    v_exp_f32 v208, v184
    v_add_f32 v222, v222, v214
    v_mfma_f32_32x32x16_bf16 v[160:175], v[100:103], v[4:7], v[160:175]
    v_exp_f32 v209, v185
    v_add_f32 v222, v222, v215
    v_cvt_pk_bf16_f32 v203, v214, v215
    v_mfma_f32_32x32x16_bf16 v[160:175], v[104:107], v[8:11], v[160:175]
    v_exp_f32 v210, v186
    v_add_f32 v222, v222, v208
    v_exp_f32 v211, v187
    v_add_f32 v222, v222, v209
    v_mfma_f32_32x32x16_bf16 v[160:175], v[108:111], v[12:15], v[160:175]
    v_cvt_pk_bf16_f32 v204, v208, v209
    v_exp_f32 v212, v188
    v_add_f32 v222, v222, v210
    v_mfma_f32_32x32x16_bf16 v[160:175], v[112:115], v[16:19], v[160:175]
    v_exp_f32 v213, v189
    v_add_f32 v222, v222, v211
    v_exp_f32 v214, v190
    v_mfma_f32_32x32x16_bf16 v[160:175], v[116:119], v[20:23], v[160:175]
    v_add_f32 v222, v222, v212
    v_exp_f32 v215, v191
    v_add_f32 v222, v222, v213
    v_add_f32 v222, v222, v214
    v_mfma_f32_32x32x16_bf16 v[160:175], v[120:123], v[24:27], v[160:175]
    v_add_f32 v222, v222, v215
    v_subrev_u32 v253, s29, v222
    v_cmp_lt_u32 vcc, s22, v253
    v_cvt_pk_bf16_f32 v205, v210, v211
    v_cvt_pk_bf16_f32 v206, v212, v213
    v_mfma_f32_32x32x16_bf16 v[160:175], v[124:127], v[28:31], v[160:175]
    v_cvt_pk_bf16_f32 v207, v214, v215
    s_cbranch_vccnz L_stub43
L_ret43:
    v_add_f32 v220, v220, v222
    v_add_u32 v231, s36, v231
    v_add_u32 v232, s36, v232
    v_add_u32 v233, s36, v233
    v_add_u32 v234, s36, v234
    v_mfma_f32_32x32x16_bf16 a[64:79], v[128:131], v[200:203], a[64:79]
    s_cmp_lg_u32 s32, s43
    s_cbranch_scc1 L_loop_B
    s_cmp_lg_u32 s44, 0
    s_cbranch_scc1 L_last_B
    v_mfma_f32_32x32x16_bf16 a[80:95], v[136:139], v[200:203], a[80:95]
    v_mfma_f32_32x32x16_bf16 a[96:111], v[144:147], v[200:203], a[96:111]
    v_mfma_f32_32x32x16_bf16 a[112:127], v[152:155], v[200:203], a[112:127]
    v_mfma_f32_32x32x16_bf16 a[64:79], v[132:135], v[204:207], a[64:79]
    v_mfma_f32_32x32x16_bf16 a[80:95], v[140:143], v[204:207], a[80:95]
    v_mfma_f32_32x32x16_bf16 a[96:111], v[148:151], v[204:207], a[96:111]
    v_mfma_f32_32x32x16_bf16 a[112:127], v[156:159], v[204:207], a[112:127]
    s_waitcnt vmcnt(0)
    s_waitcnt lgkmcnt(0)
    s_barrier
    s_sub_u32 s45, s34, s55
    v_add_u32 v251, s45, v240
    v_xor_b32 v208, 0, v241
    v_lshl_add_u32 v208, v208, 4, v251
    v_xor_b32 v209, 2, v241
    v_lshl_add_u32 v209, v209, 4, v251
    v_xor_b32 v210, 4, v241
    v_lshl_add_u32 v210, v210, 4, v251
    v_xor_b32 v211, 6, v241
    v_lshl_add_u32 v211, v211, 4, v251
    v_xor_b32 v212, 8, v241
    v_lshl_add_u32 v212, v212, 4, v251
    v_xor_b32 v213, 10, v241
    v_lshl_add_u32 v213, v213, 4, v251
    v_xor_b32 v214, 12, v241
    v_lshl_add_u32 v214, v214, 4, v251
    v_xor_b32 v215, 14, v241
    v_lshl_add_u32 v215, v215, 4, v251
    v_mov_b32 v242, v219
    v_mov_b32 v243, v219
    s_nop 1
    v_permlane32_swap_b32 v242, v243
    s_nop 1
    v_add_f32 v244, v242, v243
    v_rcp_f32 v244, v244
    s_nop 0
    v_mov_b32 v245, v244
    v_accvgpr_read_b32 v160, a0
    v_accvgpr_read_b32 v161, a1
    v_accvgpr_read_b32 v162, a2
    v_accvgpr_read_b32 v163, a3
    v_accvgpr_read_b32 v164, a4
    v_accvgpr_read_b32 v165, a5
    v_accvgpr_read_b32 v166, a6
    v_accvgpr_read_b32 v167, a7
    v_pk_mul_f32 v[160:161], v[160:161], v[244:245]
    v_pk_mul_f32 v[162:163], v[162:163], v[244:245]
    v_pk_mul_f32 v[164:165], v[164:165], v[244:245]
    v_pk_mul_f32 v[166:167], v[166:167], v[244:245]
    v_cvt_pk_bf16_f32 v168, v160, v161
    v_cvt_pk_bf16_f32 v169, v162, v163
    v_cvt_pk_bf16_f32 v170, v164, v165
    v_cvt_pk_bf16_f32 v171, v166, v167
    s_nop 0
    v_permlane32_swap_b32 v168, v170
    v_permlane32_swap_b32 v169, v171
    ds_write_b128 v208, v[168:171] offset:0
    v_accvgpr_read_b32 v172, a8
    v_accvgpr_read_b32 v173, a9
    v_accvgpr_read_b32 v174, a10
    v_accvgpr_read_b32 v175, a11
    v_accvgpr_read_b32 v176, a12
    v_accvgpr_read_b32 v177, a13
    v_accvgpr_read_b32 v178, a14
    v_accvgpr_read_b32 v179, a15
    v_pk_mul_f32 v[172:173], v[172:173], v[244:245]
    v_pk_mul_f32 v[174:175], v[174:175], v[244:245]
    v_pk_mul_f32 v[176:177], v[176:177], v[244:245]
    v_pk_mul_f32 v[178:179], v[178:179], v[244:245]
    v_cvt_pk_bf16_f32 v180, v172, v173
    v_cvt_pk_bf16_f32 v181, v174, v175
    v_cvt_pk_bf16_f32 v182, v176, v177
    v_cvt_pk_bf16_f32 v183, v178, v179
    s_nop 0
    v_permlane32_swap_b32 v180, v182
    v_permlane32_swap_b32 v181, v183
    ds_write_b128 v209, v[180:183] offset:0
    v_accvgpr_read_b32 v184, a16
    v_accvgpr_read_b32 v185, a17
    v_accvgpr_read_b32 v186, a18
    v_accvgpr_read_b32 v187, a19
    v_accvgpr_read_b32 v188, a20
    v_accvgpr_read_b32 v189, a21
    v_accvgpr_read_b32 v190, a22
    v_accvgpr_read_b32 v191, a23
    v_pk_mul_f32 v[184:185], v[184:185], v[244:245]
    v_pk_mul_f32 v[186:187], v[186:187], v[244:245]
    v_pk_mul_f32 v[188:189], v[188:189], v[244:245]
    v_pk_mul_f32 v[190:191], v[190:191], v[244:245]
    v_cvt_pk_bf16_f32 v192, v184, v185
    v_cvt_pk_bf16_f32 v193, v186, v187
    v_cvt_pk_bf16_f32 v194, v188, v189
    v_cvt_pk_bf16_f32 v195, v190, v191
    s_nop 0
    v_permlane32_swap_b32 v192, v194
    v_permlane32_swap_b32 v193, v195
    ds_write_b128 v210, v[192:195] offset:0
    v_accvgpr_read_b32 v196, a24
    v_accvgpr_read_b32 v197, a25
    v_accvgpr_read_b32 v198, a26
    v_accvgpr_read_b32 v199, a27
    v_accvgpr_read_b32 v200, a28
    v_accvgpr_read_b32 v201, a29
    v_accvgpr_read_b32 v202, a30
    v_accvgpr_read_b32 v203, a31
    v_pk_mul_f32 v[196:197], v[196:197], v[244:245]
    v_pk_mul_f32 v[198:199], v[198:199], v[244:245]
    v_pk_mul_f32 v[200:201], v[200:201], v[244:245]
    v_pk_mul_f32 v[202:203], v[202:203], v[244:245]
    v_cvt_pk_bf16_f32 v204, v196, v197
    v_cvt_pk_bf16_f32 v205, v198, v199
    v_cvt_pk_bf16_f32 v206, v200, v201
    v_cvt_pk_bf16_f32 v207, v202, v203
    s_nop 0
    v_permlane32_swap_b32 v204, v206
    v_permlane32_swap_b32 v205, v207
    ds_write_b128 v211, v[204:207] offset:0
    v_accvgpr_read_b32 v160, a32
    v_accvgpr_read_b32 v161, a33
    v_accvgpr_read_b32 v162, a34
    v_accvgpr_read_b32 v163, a35
    v_accvgpr_read_b32 v164, a36
    v_accvgpr_read_b32 v165, a37
    v_accvgpr_read_b32 v166, a38
    v_accvgpr_read_b32 v167, a39
    v_pk_mul_f32 v[160:161], v[160:161], v[244:245]
    v_pk_mul_f32 v[162:163], v[162:163], v[244:245]
    v_pk_mul_f32 v[164:165], v[164:165], v[244:245]
    v_pk_mul_f32 v[166:167], v[166:167], v[244:245]
    v_cvt_pk_bf16_f32 v168, v160, v161
    v_cvt_pk_bf16_f32 v169, v162, v163
    v_cvt_pk_bf16_f32 v170, v164, v165
    v_cvt_pk_bf16_f32 v171, v166, v167
    s_nop 0
    v_permlane32_swap_b32 v168, v170
    v_permlane32_swap_b32 v169, v171
    ds_write_b128 v212, v[168:171] offset:0
    v_accvgpr_read_b32 v172, a40
    v_accvgpr_read_b32 v173, a41
    v_accvgpr_read_b32 v174, a42
    v_accvgpr_read_b32 v175, a43
    v_accvgpr_read_b32 v176, a44
    v_accvgpr_read_b32 v177, a45
    v_accvgpr_read_b32 v178, a46
    v_accvgpr_read_b32 v179, a47
    v_pk_mul_f32 v[172:173], v[172:173], v[244:245]
    v_pk_mul_f32 v[174:175], v[174:175], v[244:245]
    v_pk_mul_f32 v[176:177], v[176:177], v[244:245]
    v_pk_mul_f32 v[178:179], v[178:179], v[244:245]
    v_cvt_pk_bf16_f32 v180, v172, v173
    v_cvt_pk_bf16_f32 v181, v174, v175
    v_cvt_pk_bf16_f32 v182, v176, v177
    v_cvt_pk_bf16_f32 v183, v178, v179
    s_nop 0
    v_permlane32_swap_b32 v180, v182
    v_permlane32_swap_b32 v181, v183
    ds_write_b128 v213, v[180:183] offset:0
    v_accvgpr_read_b32 v184, a48
    v_accvgpr_read_b32 v185, a49
    v_accvgpr_read_b32 v186, a50
    v_accvgpr_read_b32 v187, a51
    v_accvgpr_read_b32 v188, a52
    v_accvgpr_read_b32 v189, a53
    v_accvgpr_read_b32 v190, a54
    v_accvgpr_read_b32 v191, a55
    v_pk_mul_f32 v[184:185], v[184:185], v[244:245]
    v_pk_mul_f32 v[186:187], v[186:187], v[244:245]
    v_pk_mul_f32 v[188:189], v[188:189], v[244:245]
    v_pk_mul_f32 v[190:191], v[190:191], v[244:245]
    v_cvt_pk_bf16_f32 v192, v184, v185
    v_cvt_pk_bf16_f32 v193, v186, v187
    v_cvt_pk_bf16_f32 v194, v188, v189
    v_cvt_pk_bf16_f32 v195, v190, v191
    s_nop 0
    v_permlane32_swap_b32 v192, v194
    v_permlane32_swap_b32 v193, v195
    ds_write_b128 v214, v[192:195] offset:0
    v_accvgpr_read_b32 v196, a56
    v_accvgpr_read_b32 v197, a57
    v_accvgpr_read_b32 v198, a58
    v_accvgpr_read_b32 v199, a59
    v_accvgpr_read_b32 v200, a60
    v_accvgpr_read_b32 v201, a61
    v_accvgpr_read_b32 v202, a62
    v_accvgpr_read_b32 v203, a63
    v_pk_mul_f32 v[196:197], v[196:197], v[244:245]
    v_pk_mul_f32 v[198:199], v[198:199], v[244:245]
    v_pk_mul_f32 v[200:201], v[200:201], v[244:245]
    v_pk_mul_f32 v[202:203], v[202:203], v[244:245]
    v_cvt_pk_bf16_f32 v204, v196, v197
    v_cvt_pk_bf16_f32 v205, v198, v199
    v_cvt_pk_bf16_f32 v206, v200, v201
    v_cvt_pk_bf16_f32 v207, v202, v203
    s_nop 0
    v_permlane32_swap_b32 v204, v206
    v_permlane32_swap_b32 v205, v207
    ds_write_b128 v215, v[204:207] offset:0
    s_mov_b32 s42, s34
    s_mov_b32 s53, s39
    s_mov_b32 s61, 0
    s_add_u32 s62, s35, s55
    v_mov_b32 v96, 0
    v_mov_b32 v97, 0
    v_mov_b32 v98, 0
    v_mov_b32 v99, 0
    v_mov_b32 v100, 0
    v_mov_b32 v101, 0
    v_mov_b32 v102, 0
    v_mov_b32 v103, 0
    v_add_u32 v251, s35, v240
    v_xor_b32 v208, 0, v241
    v_lshl_add_u32 v208, v208, 4, v251
    v_xor_b32 v209, 2, v241
    v_lshl_add_u32 v209, v209, 4, v251
    v_xor_b32 v210, 4, v241
    v_lshl_add_u32 v210, v210, 4, v251
    v_xor_b32 v211, 6, v241
    v_lshl_add_u32 v211, v211, 4, v251
    v_xor_b32 v212, 8, v241
    v_lshl_add_u32 v212, v212, 4, v251
    v_xor_b32 v213, 10, v241
    v_lshl_add_u32 v213, v213, 4, v251
    v_xor_b32 v214, 12, v241
    v_lshl_add_u32 v214, v214, 4, v251
    v_xor_b32 v215, 14, v241
    v_lshl_add_u32 v215, v215, 4, v251
    ds_read_b128 v[160:163], v208
    ds_read_b128 v[164:167], v209
    ds_read_b128 v[168:171], v210
    ds_read_b128 v[172:175], v211
    ds_read_b128 v[176:179], v212
    ds_read_b128 v[180:183], v213
    ds_read_b128 v[184:187], v214
    ds_read_b128 v[188:191], v215
    s_add_u32 s35, s35, 32768
    s_cmp_ge_u32 s35, s40
    s_cselect_b32 s46, s41, 0
    s_sub_u32 s35, s35, s46
    v_mov_b32 v32, 0
    v_mov_b32 v33, 0
    v_mov_b32 v34, 0
    v_mov_b32 v35, 0
    v_mov_b32 v36, 0
    v_mov_b32 v37, 0
    v_mov_b32 v38, 0
    v_mov_b32 v39, 0
    v_mov_b32 v40, 0
    v_mov_b32 v41, 0
    v_mov_b32 v42, 0
    v_mov_b32 v43, 0
    v_mov_b32 v44, 0
    v_mov_b32 v45, 0
    v_mov_b32 v46, 0
    v_mov_b32 v47, 0
    v_mov_b32 v219, 0
    v_mfma_f32_32x32x16_bf16 a[0:15], v[128:131], v[96:99], 0
    s_waitcnt lgkmcnt(7)
    v_lshlrev_b32 v80, 16, v160
    v_and_b32 v81, s63, v160
    v_lshlrev_b32 v82, 16, v161
    v_and_b32 v83, s63, v161
    v_lshlrev_b32 v84, 16, v162
    v_and_b32 v85, s63, v162
    v_lshlrev_b32 v86, 16, v163
    v_and_b32 v87, s63, v163
    v_pk_mul_f32 v[80:81], v[80:81], s[94:95]
    v_pk_mul_f32 v[82:83], v[82:83], s[94:95]
    v_pk_mul_f32 v[84:85], v[84:85], s[94:95]
    v_pk_mul_f32 v[86:87], v[86:87], s[94:95]
    v_cvt_pk_bf16_f32 v0, v80, v81
    v_cvt_pk_bf16_f32 v1, v82, v83
    v_cvt_pk_bf16_f32 v2, v84, v85
    v_cvt_pk_bf16_f32 v3, v86, v87
    s_waitcnt lgkmcnt(6)
    v_lshlrev_b32 v80, 16, v164
    v_and_b32 v81, s63, v164
    v_lshlrev_b32 v82, 16, v165
    v_and_b32 v83, s63, v165
    v_lshlrev_b32 v84, 16, v166
    v_and_b32 v85, s63, v166
    v_lshlrev_b32 v86, 16, v167
    v_and_b32 v87, s63, v167
    v_pk_mul_f32 v[80:81], v[80:81], s[94:95]
    v_pk_mul_f32 v[82:83], v[82:83], s[94:95]
    v_pk_mul_f32 v[84:85], v[84:85], s[94:95]
    v_pk_mul_f32 v[86:87], v[86:87], s[94:95]
    v_cvt_pk_bf16_f32 v4, v80, v81
    v_cvt_pk_bf16_f32 v5, v82, v83
    v_cvt_pk_bf16_f32 v6, v84, v85
    v_cvt_pk_bf16_f32 v7, v86, v87
    v_mfma_f32_32x32x16_bf16 a[16:31], v[128:131], v[96:99], 0
    s_waitcnt lgkmcnt(5)
    v_lshlrev_b32 v80, 16, v168
    v_and_b32 v81, s63, v168
    v_lshlrev_b32 v82, 16, v169
    v_and_b32 v83, s63, v169
    v_lshlrev_b32 v84, 16, v170
    v_and_b32 v85, s63, v170
    v_lshlrev_b32 v86, 16, v171
    v_and_b32 v87, s63, v171
    v_pk_mul_f32 v[80:81], v[80:81], s[94:95]
    v_pk_mul_f32 v[82:83], v[82:83], s[94:95]
    v_pk_mul_f32 v[84:85], v[84:85], s[94:95]
    v_pk_mul_f32 v[86:87], v[86:87], s[94:95]
    v_cvt_pk_bf16_f32 v8, v80, v81
    v_cvt_pk_bf16_f32 v9, v82, v83
    v_cvt_pk_bf16_f32 v10, v84, v85
    v_cvt_pk_bf16_f32 v11, v86, v87
    s_waitcnt lgkmcnt(4)
    v_lshlrev_b32 v80, 16, v172
    v_and_b32 v81, s63, v172
    v_lshlrev_b32 v82, 16, v173
    v_and_b32 v83, s63, v173
    v_lshlrev_b32 v84, 16, v174
    v_and_b32 v85, s63, v174
    v_lshlrev_b32 v86, 16, v175
    v_and_b32 v87, s63, v175
    v_pk_mul_f32 v[80:81], v[80:81], s[94:95]
    v_pk_mul_f32 v[82:83], v[82:83], s[94:95]
    v_pk_mul_f32 v[84:85], v[84:85], s[94:95]
    v_pk_mul_f32 v[86:87], v[86:87], s[94:95]
    v_cvt_pk_bf16_f32 v12, v80, v81
    v_cvt_pk_bf16_f32 v13, v82, v83
    v_cvt_pk_bf16_f32 v14, v84, v85
    v_cvt_pk_bf16_f32 v15, v86, v87
    v_mfma_f32_32x32x16_bf16 a[32:47], v[128:131], v[96:99], 0
    s_waitcnt lgkmcnt(3)
    v_lshlrev_b32 v80, 16, v176
    v_and_b32 v81, s63, v176
    v_lshlrev_b32 v82, 16, v177
    v_and_b32 v83, s63, v177
    v_lshlrev_b32 v84, 16, v178
    v_and_b32 v85, s63, v178
    v_lshlrev_b32 v86, 16, v179
    v_and_b32 v87, s63, v179
    v_pk_mul_f32 v[80:81], v[80:81], s[94:95]
    v_pk_mul_f32 v[82:83], v[82:83], s[94:95]
    v_pk_mul_f32 v[84:85], v[84:85], s[94:95]
    v_pk_mul_f32 v[86:87], v[86:87], s[94:95]
    v_cvt_pk_bf16_f32 v16, v80, v81
    v_cvt_pk_bf16_f32 v17, v82, v83
    v_cvt_pk_bf16_f32 v18, v84, v85
    v_cvt_pk_bf16_f32 v19, v86, v87
    s_waitcnt lgkmcnt(2)
    v_lshlrev_b32 v80, 16, v180
    v_and_b32 v81, s63, v180
    v_lshlrev_b32 v82, 16, v181
    v_and_b32 v83, s63, v181
    v_lshlrev_b32 v84, 16, v182
    v_and_b32 v85, s63, v182
    v_lshlrev_b32 v86, 16, v183
    v_and_b32 v87, s63, v183
    v_pk_mul_f32 v[80:81], v[80:81], s[94:95]
    v_pk_mul_f32 v[82:83], v[82:83], s[94:95]
    v_pk_mul_f32 v[84:85], v[84:85], s[94:95]
    v_pk_mul_f32 v[86:87], v[86:87], s[94:95]
    v_cvt_pk_bf16_f32 v20, v80, v81
    v_cvt_pk_bf16_f32 v21, v82, v83
    v_cvt_pk_bf16_f32 v22, v84, v85
    v_cvt_pk_bf16_f32 v23, v86, v87
    v_mfma_f32_32x32x16_bf16 a[48:63], v[128:131], v[96:99], 0
    s_waitcnt lgkmcnt(1)
    v_lshlrev_b32 v80, 16, v184
    v_and_b32 v81, s63, v184
    v_lshlrev_b32 v82, 16, v185
    v_and_b32 v83, s63, v185
    v_lshlrev_b32 v84, 16, v186
    v_and_b32 v85, s63, v186
    v_lshlrev_b32 v86, 16, v187
    v_and_b32 v87, s63, v187
    v_pk_mul_f32 v[80:81], v[80:81], s[94:95]
    v_pk_mul_f32 v[82:83], v[82:83], s[94:95]
    v_pk_mul_f32 v[84:85], v[84:85], s[94:95]
    v_pk_mul_f32 v[86:87], v[86:87], s[94:95]
    v_cvt_pk_bf16_f32 v24, v80, v81
    v_cvt_pk_bf16_f32 v25, v82, v83
    v_cvt_pk_bf16_f32 v26, v84, v85
    v_cvt_pk_bf16_f32 v27, v86, v87
    s_waitcnt lgkmcnt(0)
    v_lshlrev_b32 v80, 16, v188
    v_and_b32 v81, s63, v188
    v_lshlrev_b32 v82, 16, v189
    v_and_b32 v83, s63, v189
    v_lshlrev_b32 v84, 16, v190
    v_and_b32 v85, s63, v190
    v_lshlrev_b32 v86, 16, v191
    v_and_b32 v87, s63, v191
    v_pk_mul_f32 v[80:81], v[80:81], s[94:95]
    v_pk_mul_f32 v[82:83], v[82:83], s[94:95]
    v_pk_mul_f32 v[84:85], v[84:85], s[94:95]
    v_pk_mul_f32 v[86:87], v[86:87], s[94:95]
    v_cvt_pk_bf16_f32 v28, v80, v81
    v_cvt_pk_bf16_f32 v29, v82, v83
    v_cvt_pk_bf16_f32 v30, v84, v85
    v_cvt_pk_bf16_f32 v31, v86, v87
    v_mov_b32 v242, v220
    v_mov_b32 v243, v220
    s_nop 1
    v_permlane32_swap_b32 v242, v243
    s_nop 1
    v_add_f32 v244, v242, v243
    v_rcp_f32 v244, v244
    s_nop 0
    v_mov_b32 v245, v244
    v_accvgpr_read_b32 v160, a64
    v_accvgpr_read_b32 v161, a65
    v_accvgpr_read_b32 v162, a66
    v_accvgpr_read_b32 v163, a67
    v_accvgpr_read_b32 v164, a68
    v_accvgpr_read_b32 v165, a69
    v_accvgpr_read_b32 v166, a70
    v_accvgpr_read_b32 v167, a71
    v_pk_mul_f32 v[160:161], v[160:161], v[244:245]
    v_pk_mul_f32 v[162:163], v[162:163], v[244:245]
    v_pk_mul_f32 v[164:165], v[164:165], v[244:245]
    v_pk_mul_f32 v[166:167], v[166:167], v[244:245]
    v_cvt_pk_bf16_f32 v168, v160, v161
    v_cvt_pk_bf16_f32 v169, v162, v163
    v_cvt_pk_bf16_f32 v170, v164, v165
    v_cvt_pk_bf16_f32 v171, v166, v167
    s_nop 0
    v_permlane32_swap_b32 v168, v170
    v_permlane32_swap_b32 v169, v171
    ds_write_b128 v208, v[168:171] offset:0
    v_accvgpr_read_b32 v172, a72
    v_accvgpr_read_b32 v173, a73
    v_accvgpr_read_b32 v174, a74
    v_accvgpr_read_b32 v175, a75
    v_accvgpr_read_b32 v176, a76
    v_accvgpr_read_b32 v177, a77
    v_accvgpr_read_b32 v178, a78
    v_accvgpr_read_b32 v179, a79
    v_pk_mul_f32 v[172:173], v[172:173], v[244:245]
    v_pk_mul_f32 v[174:175], v[174:175], v[244:245]
    v_pk_mul_f32 v[176:177], v[176:177], v[244:245]
    v_pk_mul_f32 v[178:179], v[178:179], v[244:245]
    v_cvt_pk_bf16_f32 v180, v172, v173
    v_cvt_pk_bf16_f32 v181, v174, v175
    v_cvt_pk_bf16_f32 v182, v176, v177
    v_cvt_pk_bf16_f32 v183, v178, v179
    s_nop 0
    v_permlane32_swap_b32 v180, v182
    v_permlane32_swap_b32 v181, v183
    ds_write_b128 v209, v[180:183] offset:0
    v_accvgpr_read_b32 v184, a80
    v_accvgpr_read_b32 v185, a81
    v_accvgpr_read_b32 v186, a82
    v_accvgpr_read_b32 v187, a83
    v_accvgpr_read_b32 v188, a84
    v_accvgpr_read_b32 v189, a85
    v_accvgpr_read_b32 v190, a86
    v_accvgpr_read_b32 v191, a87
    v_pk_mul_f32 v[184:185], v[184:185], v[244:245]
    v_pk_mul_f32 v[186:187], v[186:187], v[244:245]
    v_pk_mul_f32 v[188:189], v[188:189], v[244:245]
    v_pk_mul_f32 v[190:191], v[190:191], v[244:245]
    v_cvt_pk_bf16_f32 v192, v184, v185
    v_cvt_pk_bf16_f32 v193, v186, v187
    v_cvt_pk_bf16_f32 v194, v188, v189
    v_cvt_pk_bf16_f32 v195, v190, v191
    s_nop 0
    v_permlane32_swap_b32 v192, v194
    v_permlane32_swap_b32 v193, v195
    ds_write_b128 v210, v[192:195] offset:0
    v_accvgpr_read_b32 v196, a88
    v_accvgpr_read_b32 v197, a89
    v_accvgpr_read_b32 v198, a90
    v_accvgpr_read_b32 v199, a91
    v_accvgpr_read_b32 v200, a92
    v_accvgpr_read_b32 v201, a93
    v_accvgpr_read_b32 v202, a94
    v_accvgpr_read_b32 v203, a95
    v_pk_mul_f32 v[196:197], v[196:197], v[244:245]
    v_pk_mul_f32 v[198:199], v[198:199], v[244:245]
    v_pk_mul_f32 v[200:201], v[200:201], v[244:245]
    v_pk_mul_f32 v[202:203], v[202:203], v[244:245]
    v_cvt_pk_bf16_f32 v204, v196, v197
    v_cvt_pk_bf16_f32 v205, v198, v199
    v_cvt_pk_bf16_f32 v206, v200, v201
    v_cvt_pk_bf16_f32 v207, v202, v203
    s_nop 0
    v_permlane32_swap_b32 v204, v206
    v_permlane32_swap_b32 v205, v207
    ds_write_b128 v211, v[204:207] offset:0
    v_accvgpr_read_b32 v160, a96
    v_accvgpr_read_b32 v161, a97
    v_accvgpr_read_b32 v162, a98
    v_accvgpr_read_b32 v163, a99
    v_accvgpr_read_b32 v164, a100
    v_accvgpr_read_b32 v165, a101
    v_accvgpr_read_b32 v166, a102
    v_accvgpr_read_b32 v167, a103
    v_pk_mul_f32 v[160:161], v[160:161], v[244:245]
    v_pk_mul_f32 v[162:163], v[162:163], v[244:245]
    v_pk_mul_f32 v[164:165], v[164:165], v[244:245]
    v_pk_mul_f32 v[166:167], v[166:167], v[244:245]
    v_cvt_pk_bf16_f32 v168, v160, v161
    v_cvt_pk_bf16_f32 v169, v162, v163
    v_cvt_pk_bf16_f32 v170, v164, v165
    v_cvt_pk_bf16_f32 v171, v166, v167
    s_nop 0
    v_permlane32_swap_b32 v168, v170
    v_permlane32_swap_b32 v169, v171
    ds_write_b128 v212, v[168:171] offset:0
    v_accvgpr_read_b32 v172, a104
    v_accvgpr_read_b32 v173, a105
    v_accvgpr_read_b32 v174, a106
    v_accvgpr_read_b32 v175, a107
    v_accvgpr_read_b32 v176, a108
    v_accvgpr_read_b32 v177, a109
    v_accvgpr_read_b32 v178, a110
    v_accvgpr_read_b32 v179, a111
    v_pk_mul_f32 v[172:173], v[172:173], v[244:245]
    v_pk_mul_f32 v[174:175], v[174:175], v[244:245]
    v_pk_mul_f32 v[176:177], v[176:177], v[244:245]
    v_pk_mul_f32 v[178:179], v[178:179], v[244:245]
    v_cvt_pk_bf16_f32 v180, v172, v173
    v_cvt_pk_bf16_f32 v181, v174, v175
    v_cvt_pk_bf16_f32 v182, v176, v177
    v_cvt_pk_bf16_f32 v183, v178, v179
    s_nop 0
    v_permlane32_swap_b32 v180, v182
    v_permlane32_swap_b32 v181, v183
    ds_write_b128 v213, v[180:183] offset:0
    v_accvgpr_read_b32 v184, a112
    v_accvgpr_read_b32 v185, a113
    v_accvgpr_read_b32 v186, a114
    v_accvgpr_read_b32 v187, a115
    v_accvgpr_read_b32 v188, a116
    v_accvgpr_read_b32 v189, a117
    v_accvgpr_read_b32 v190, a118
    v_accvgpr_read_b32 v191, a119
    v_pk_mul_f32 v[184:185], v[184:185], v[244:245]
    v_pk_mul_f32 v[186:187], v[186:187], v[244:245]
    v_pk_mul_f32 v[188:189], v[188:189], v[244:245]
    v_pk_mul_f32 v[190:191], v[190:191], v[244:245]
    v_cvt_pk_bf16_f32 v192, v184, v185
    v_cvt_pk_bf16_f32 v193, v186, v187
    v_cvt_pk_bf16_f32 v194, v188, v189
    v_cvt_pk_bf16_f32 v195, v190, v191
    s_nop 0
    v_permlane32_swap_b32 v192, v194
    v_permlane32_swap_b32 v193, v195
    ds_write_b128 v214, v[192:195] offset:0
    v_accvgpr_read_b32 v196, a120
    v_accvgpr_read_b32 v197, a121
    v_accvgpr_read_b32 v198, a122
    v_accvgpr_read_b32 v199, a123
    v_accvgpr_read_b32 v200, a124
    v_accvgpr_read_b32 v201, a125
    v_accvgpr_read_b32 v202, a126
    v_accvgpr_read_b32 v203, a127
    v_pk_mul_f32 v[196:197], v[196:197], v[244:245]
    v_pk_mul_f32 v[198:199], v[198:199], v[244:245]
    v_pk_mul_f32 v[200:201], v[200:201], v[244:245]
    v_pk_mul_f32 v[202:203], v[202:203], v[244:245]
    v_cvt_pk_bf16_f32 v204, v196, v197
    v_cvt_pk_bf16_f32 v205, v198, v199
    v_cvt_pk_bf16_f32 v206, v200, v201
    v_cvt_pk_bf16_f32 v207, v202, v203
    s_nop 0
    v_permlane32_swap_b32 v204, v206
    v_permlane32_swap_b32 v205, v207
    ds_write_b128 v215, v[204:207] offset:0
    s_add_u32 s34, s55, 32768
    v_add_u32 v251, s35, v240
    v_xor_b32 v208, 0, v241
    v_lshl_add_u32 v208, v208, 4, v251
    v_xor_b32 v209, 2, v241
    v_lshl_add_u32 v209, v209, 4, v251
    v_xor_b32 v210, 4, v241
    v_lshl_add_u32 v210, v210, 4, v251
    v_xor_b32 v211, 6, v241
    v_lshl_add_u32 v211, v211, 4, v251
    v_xor_b32 v212, 8, v241
    v_lshl_add_u32 v212, v212, 4, v251
    v_xor_b32 v213, 10, v241
    v_lshl_add_u32 v213, v213, 4, v251
    v_xor_b32 v214, 12, v241
    v_lshl_add_u32 v214, v214, 4, v251
    v_xor_b32 v215, 14, v241
    v_lshl_add_u32 v215, v215, 4, v251
    ds_read_b128 v[160:163], v208
    ds_read_b128 v[164:167], v209
    ds_read_b128 v[168:171], v210
    ds_read_b128 v[172:175], v211
    ds_read_b128 v[176:179], v212
    ds_read_b128 v[180:183], v213
    ds_read_b128 v[184:187], v214
    ds_read_b128 v[188:191], v215
    s_add_u32 s35, s35, 32768
    s_cmp_ge_u32 s35, s40
    s_cselect_b32 s46, s41, 0
    s_sub_u32 s35, s35, s46
    v_mov_b32 v48, 0
    v_mov_b32 v49, 0
    v_mov_b32 v50, 0
    v_mov_b32 v51, 0
    v_mov_b32 v52, 0
    v_mov_b32 v53, 0
    v_mov_b32 v54, 0
    v_mov_b32 v55, 0
    v_mov_b32 v56, 0
    v_mov_b32 v57, 0
    v_mov_b32 v58, 0
    v_mov_b32 v59, 0
    v_mov_b32 v60, 0
    v_mov_b32 v61, 0
    v_mov_b32 v62, 0
    v_mov_b32 v63, 0
    v_mov_b32 v220, 0
    v_mfma_f32_32x32x16_bf16 a[64:79], v[128:131], v[96:99], 0
    s_waitcnt lgkmcnt(7)
    v_lshlrev_b32 v80, 16, v160
    v_and_b32 v81, s63, v160
    v_lshlrev_b32 v82, 16, v161
    v_and_b32 v83, s63, v161
    v_lshlrev_b32 v84, 16, v162
    v_and_b32 v85, s63, v162
    v_lshlrev_b32 v86, 16, v163
    v_and_b32 v87, s63, v163
    v_pk_mul_f32 v[80:81], v[80:81], s[94:95]
    v_pk_mul_f32 v[82:83], v[82:83], s[94:95]
    v_pk_mul_f32 v[84:85], v[84:85], s[94:95]
    v_pk_mul_f32 v[86:87], v[86:87], s[94:95]
    v_cvt_pk_bf16_f32 v88, v80, v81
    v_cvt_pk_bf16_f32 v89, v82, v83
    v_cvt_pk_bf16_f32 v90, v84, v85
    v_cvt_pk_bf16_f32 v91, v86, v87
    v_accvgpr_write_b32 a192, v88
    v_accvgpr_write_b32 a193, v89
    v_accvgpr_write_b32 a194, v90
    v_accvgpr_write_b32 a195, v91
    s_waitcnt lgkmcnt(6)
    v_lshlrev_b32 v80, 16, v164
    v_and_b32 v81, s63, v164
    v_lshlrev_b32 v82, 16, v165
    v_and_b32 v83, s63, v165
    v_lshlrev_b32 v84, 16, v166
    v_and_b32 v85, s63, v166
    v_lshlrev_b32 v86, 16, v167
    v_and_b32 v87, s63, v167
    v_pk_mul_f32 v[80:81], v[80:81], s[94:95]
    v_pk_mul_f32 v[82:83], v[82:83], s[94:95]
    v_pk_mul_f32 v[84:85], v[84:85], s[94:95]
    v_pk_mul_f32 v[86:87], v[86:87], s[94:95]
    v_cvt_pk_bf16_f32 v88, v80, v81
    v_cvt_pk_bf16_f32 v89, v82, v83
    v_cvt_pk_bf16_f32 v90, v84, v85
    v_cvt_pk_bf16_f32 v91, v86, v87
    v_accvgpr_write_b32 a196, v88
    v_accvgpr_write_b32 a197, v89
    v_accvgpr_write_b32 a198, v90
    v_accvgpr_write_b32 a199, v91
    v_mfma_f32_32x32x16_bf16 a[80:95], v[128:131], v[96:99], 0
    s_waitcnt lgkmcnt(5)
    v_lshlrev_b32 v80, 16, v168
    v_and_b32 v81, s63, v168
    v_lshlrev_b32 v82, 16, v169
    v_and_b32 v83, s63, v169
    v_lshlrev_b32 v84, 16, v170
    v_and_b32 v85, s63, v170
    v_lshlrev_b32 v86, 16, v171
    v_and_b32 v87, s63, v171
    v_pk_mul_f32 v[80:81], v[80:81], s[94:95]
    v_pk_mul_f32 v[82:83], v[82:83], s[94:95]
    v_pk_mul_f32 v[84:85], v[84:85], s[94:95]
    v_pk_mul_f32 v[86:87], v[86:87], s[94:95]
    v_cvt_pk_bf16_f32 v88, v80, v81
    v_cvt_pk_bf16_f32 v89, v82, v83
    v_cvt_pk_bf16_f32 v90, v84, v85
    v_cvt_pk_bf16_f32 v91, v86, v87
    v_accvgpr_write_b32 a200, v88
    v_accvgpr_write_b32 a201, v89
    v_accvgpr_write_b32 a202, v90
    v_accvgpr_write_b32 a203, v91
    s_waitcnt lgkmcnt(4)
    v_lshlrev_b32 v80, 16, v172
    v_and_b32 v81, s63, v172
    v_lshlrev_b32 v82, 16, v173
    v_and_b32 v83, s63, v173
    v_lshlrev_b32 v84, 16, v174
    v_and_b32 v85, s63, v174
    v_lshlrev_b32 v86, 16, v175
    v_and_b32 v87, s63, v175
    v_pk_mul_f32 v[80:81], v[80:81], s[94:95]
    v_pk_mul_f32 v[82:83], v[82:83], s[94:95]
    v_pk_mul_f32 v[84:85], v[84:85], s[94:95]
    v_pk_mul_f32 v[86:87], v[86:87], s[94:95]
    v_cvt_pk_bf16_f32 v88, v80, v81
    v_cvt_pk_bf16_f32 v89, v82, v83
    v_cvt_pk_bf16_f32 v90, v84, v85
    v_cvt_pk_bf16_f32 v91, v86, v87
    v_accvgpr_write_b32 a204, v88
    v_accvgpr_write_b32 a205, v89
    v_accvgpr_write_b32 a206, v90
    v_accvgpr_write_b32 a207, v91
    v_mfma_f32_32x32x16_bf16 a[96:111], v[128:131], v[96:99], 0
    s_waitcnt lgkmcnt(3)
    v_lshlrev_b32 v80, 16, v176
    v_and_b32 v81, s63, v176
    v_lshlrev_b32 v82, 16, v177
    v_and_b32 v83, s63, v177
    v_lshlrev_b32 v84, 16, v178
    v_and_b32 v85, s63, v178
    v_lshlrev_b32 v86, 16, v179
    v_and_b32 v87, s63, v179
    v_pk_mul_f32 v[80:81], v[80:81], s[94:95]
    v_pk_mul_f32 v[82:83], v[82:83], s[94:95]
    v_pk_mul_f32 v[84:85], v[84:85], s[94:95]
    v_pk_mul_f32 v[86:87], v[86:87], s[94:95]
    v_cvt_pk_bf16_f32 v88, v80, v81
    v_cvt_pk_bf16_f32 v89, v82, v83
    v_cvt_pk_bf16_f32 v90, v84, v85
    v_cvt_pk_bf16_f32 v91, v86, v87
    v_accvgpr_write_b32 a208, v88
    v_accvgpr_write_b32 a209, v89
    v_accvgpr_write_b32 a210, v90
    v_accvgpr_write_b32 a211, v91
    s_waitcnt lgkmcnt(2)
    v_lshlrev_b32 v80, 16, v180
    v_and_b32 v81, s63, v180
    v_lshlrev_b32 v82, 16, v181
    v_and_b32 v83, s63, v181
    v_lshlrev_b32 v84, 16, v182
    v_and_b32 v85, s63, v182
    v_lshlrev_b32 v86, 16, v183
    v_and_b32 v87, s63, v183
    v_pk_mul_f32 v[80:81], v[80:81], s[94:95]
    v_pk_mul_f32 v[82:83], v[82:83], s[94:95]
    v_pk_mul_f32 v[84:85], v[84:85], s[94:95]
    v_pk_mul_f32 v[86:87], v[86:87], s[94:95]
    v_cvt_pk_bf16_f32 v88, v80, v81
    v_cvt_pk_bf16_f32 v89, v82, v83
    v_cvt_pk_bf16_f32 v90, v84, v85
    v_cvt_pk_bf16_f32 v91, v86, v87
    v_accvgpr_write_b32 a212, v88
    v_accvgpr_write_b32 a213, v89
    v_accvgpr_write_b32 a214, v90
    v_accvgpr_write_b32 a215, v91
    v_mfma_f32_32x32x16_bf16 a[112:127], v[128:131], v[96:99], 0
    s_waitcnt lgkmcnt(1)
    v_lshlrev_b32 v80, 16, v184
    v_and_b32 v81, s63, v184
    v_lshlrev_b32 v82, 16, v185
    v_and_b32 v83, s63, v185
    v_lshlrev_b32 v84, 16, v186
    v_and_b32 v85, s63, v186
    v_lshlrev_b32 v86, 16, v187
    v_and_b32 v87, s63, v187
    v_pk_mul_f32 v[80:81], v[80:81], s[94:95]
    v_pk_mul_f32 v[82:83], v[82:83], s[94:95]
    v_pk_mul_f32 v[84:85], v[84:85], s[94:95]
    v_pk_mul_f32 v[86:87], v[86:87], s[94:95]
    v_cvt_pk_bf16_f32 v88, v80, v81
    v_cvt_pk_bf16_f32 v89, v82, v83
    v_cvt_pk_bf16_f32 v90, v84, v85
    v_cvt_pk_bf16_f32 v91, v86, v87
    v_accvgpr_write_b32 a216, v88
    v_accvgpr_write_b32 a217, v89
    v_accvgpr_write_b32 a218, v90
    v_accvgpr_write_b32 a219, v91
    s_waitcnt lgkmcnt(0)
    v_lshlrev_b32 v80, 16, v188
    v_and_b32 v81, s63, v188
    v_lshlrev_b32 v82, 16, v189
    v_and_b32 v83, s63, v189
    v_lshlrev_b32 v84, 16, v190
    v_and_b32 v85, s63, v190
    v_lshlrev_b32 v86, 16, v191
    v_and_b32 v87, s63, v191
    v_pk_mul_f32 v[80:81], v[80:81], s[94:95]
    v_pk_mul_f32 v[82:83], v[82:83], s[94:95]
    v_pk_mul_f32 v[84:85], v[84:85], s[94:95]
    v_pk_mul_f32 v[86:87], v[86:87], s[94:95]
    v_cvt_pk_bf16_f32 v88, v80, v81
    v_cvt_pk_bf16_f32 v89, v82, v83
    v_cvt_pk_bf16_f32 v90, v84, v85
    v_cvt_pk_bf16_f32 v91, v86, v87
    v_accvgpr_write_b32 a220, v88
    v_accvgpr_write_b32 a221, v89
    v_accvgpr_write_b32 a222, v90
    v_accvgpr_write_b32 a223, v91
    v_add_u32 v251, s35, v240
    v_xor_b32 v208, 0, v241
    v_lshl_add_u32 v208, v208, 4, v251
    v_xor_b32 v209, 2, v241
    v_lshl_add_u32 v209, v209, 4, v251
    v_xor_b32 v210, 4, v241
    v_lshl_add_u32 v210, v210, 4, v251
    v_xor_b32 v211, 6, v241
    v_lshl_add_u32 v211, v211, 4, v251
    v_xor_b32 v212, 8, v241
    v_lshl_add_u32 v212, v212, 4, v251
    v_xor_b32 v213, 10, v241
    v_lshl_add_u32 v213, v213, 4, v251
    v_xor_b32 v214, 12, v241
    v_lshl_add_u32 v214, v214, 4, v251
    v_xor_b32 v215, 14, v241
    v_lshl_add_u32 v215, v215, 4, v251
    ds_read_b128 v[160:163], v208
    ds_read_b128 v[164:167], v209
    ds_read_b128 v[168:171], v210
    ds_read_b128 v[172:175], v211
    ds_read_b128 v[176:179], v212
    ds_read_b128 v[180:183], v213
    ds_read_b128 v[184:187], v214
    ds_read_b128 v[188:191], v215
    s_add_u32 s35, s35, 32768
    s_cmp_ge_u32 s35, s40
    s_cselect_b32 s46, s41, 0
    s_sub_u32 s35, s35, s46
    s_mov_b32 s40, 131072
    s_mov_b32 s41, 98304
    s_mov_b32 m0, s34
    s_nop 0
    buffer_load_dwordx4 v235, s[12:15], s20 offen offset:0 nt lds
    v_mov_b32 v64, 0
    v_mov_b32 v65, 0
    v_mov_b32 v66, 0
    v_mov_b32 v67, 0
    v_mov_b32 v68, 0
    v_mov_b32 v69, 0
    v_mov_b32 v70, 0
    v_mov_b32 v71, 0
    v_mov_b32 v72, 0
    v_mov_b32 v73, 0
    v_mov_b32 v74, 0
    v_mov_b32 v75, 0
    v_mov_b32 v76, 0
    v_mov_b32 v77, 0
    v_mov_b32 v78, 0
    v_mov_b32 v79, 0
    v_mov_b32 v221, 0
    v_mfma_f32_32x32x16_bf16 a[128:143], v[128:131], v[96:99], 0
    s_waitcnt lgkmcnt(7)
    v_lshlrev_b32 v80, 16, v160
    v_and_b32 v81, s63, v160
    v_lshlrev_b32 v82, 16, v161
    v_and_b32 v83, s63, v161
    buffer_load_dwordx4 v236, s[12:15], s20 offen offset:1024 nt lds
    v_lshlrev_b32 v84, 16, v162
    v_and_b32 v85, s63, v162
    v_lshlrev_b32 v86, 16, v163
    v_and_b32 v87, s63, v163
    v_pk_mul_f32 v[80:81], v[80:81], s[94:95]
    v_pk_mul_f32 v[82:83], v[82:83], s[94:95]
    v_pk_mul_f32 v[84:85], v[84:85], s[94:95]
    v_pk_mul_f32 v[86:87], v[86:87], s[94:95]
    v_cvt_pk_bf16_f32 v88, v80, v81
    v_cvt_pk_bf16_f32 v89, v82, v83
    v_cvt_pk_bf16_f32 v90, v84, v85
    v_cvt_pk_bf16_f32 v91, v86, v87
    v_accvgpr_write_b32 a224, v88
    v_accvgpr_write_b32 a225, v89
    v_accvgpr_write_b32 a226, v90
    v_accvgpr_write_b32 a227, v91
    s_waitcnt lgkmcnt(6)
    v_lshlrev_b32 v80, 16, v164
    v_and_b32 v81, s63, v164
    v_lshlrev_b32 v82, 16, v165
    v_and_b32 v83, s63, v165
    v_lshlrev_b32 v84, 16, v166
    buffer_load_dwordx4 v237, s[12:15], s20 offen offset:2048 nt lds
    v_and_b32 v85, s63, v166
    v_lshlrev_b32 v86, 16, v167
    v_and_b32 v87, s63, v167
    v_pk_mul_f32 v[80:81], v[80:81], s[94:95]
    v_pk_mul_f32 v[82:83], v[82:83], s[94:95]
    v_pk_mul_f32 v[84:85], v[84:85], s[94:95]
    v_pk_mul_f32 v[86:87], v[86:87], s[94:95]
    v_cvt_pk_bf16_f32 v88, v80, v81
    v_cvt_pk_bf16_f32 v89, v82, v83
    v_cvt_pk_bf16_f32 v90, v84, v85
    v_cvt_pk_bf16_f32 v91, v86, v87
    v_accvgpr_write_b32 a228, v88
    v_accvgpr_write_b32 a229, v89
    v_accvgpr_write_b32 a230, v90
    v_accvgpr_write_b32 a231, v91
    v_mfma_f32_32x32x16_bf16 a[144:159], v[128:131], v[96:99], 0
    s_waitcnt lgkmcnt(5)
    v_lshlrev_b32 v80, 16, v168
    v_and_b32 v81, s63, v168
    v_lshlrev_b32 v82, 16, v169
    buffer_load_dwordx4 v238, s[12:15], s20 offen offset:3072 nt lds
    v_and_b32 v83, s63, v169
    v_lshlrev_b32 v84, 16, v170
    v_and_b32 v85, s63, v170
    v_lshlrev_b32 v86, 16, v171
    v_and_b32 v87, s63, v171
    v_pk_mul_f32 v[80:81], v[80:81], s[94:95]
    v_pk_mul_f32 v[82:83], v[82:83], s[94:95]
    v_pk_mul_f32 v[84:85], v[84:85], s[94:95]
    v_pk_mul_f32 v[86:87], v[86:87], s[94:95]
    v_cvt_pk_bf16_f32 v88, v80, v81
    v_cvt_pk_bf16_f32 v89, v82, v83
    v_cvt_pk_bf16_f32 v90, v84, v85
    v_cvt_pk_bf16_f32 v91, v86, v87
    v_accvgpr_write_b32 a232, v88
    v_accvgpr_write_b32 a233, v89
    v_accvgpr_write_b32 a234, v90
    v_accvgpr_write_b32 a235, v91
    s_waitcnt lgkmcnt(4)
    v_lshlrev_b32 v80, 16, v172
    v_and_b32 v81, s63, v172
    v_lshlrev_b32 v82, 16, v173
    v_and_b32 v83, s63, v173
    s_add_u32 m0, s34, 16384
    s_nop 0
    buffer_load_dwordx4 v239, s[16:19], s21 offen offset:0 nt lds
    v_lshlrev_b32 v84, 16, v174
    v_and_b32 v85, s63, v174
    v_lshlrev_b32 v86, 16, v175
    v_and_b32 v87, s63, v175
    v_pk_mul_f32 v[80:81], v[80:81], s[94:95]
    v_pk_mul_f32 v[82:83], v[82:83], s[94:95]
    v_pk_mul_f32 v[84:85], v[84:85], s[94:95]
    v_pk_mul_f32 v[86:87], v[86:87], s[94:95]
    v_cvt_pk_bf16_f32 v88, v80, v81
    v_cvt_pk_bf16_f32 v89, v82, v83
    v_cvt_pk_bf16_f32 v90, v84, v85
    v_cvt_pk_bf16_f32 v91, v86, v87
    v_accvgpr_write_b32 a236, v88
    v_accvgpr_write_b32 a237, v89
    v_accvgpr_write_b32 a238, v90
    v_accvgpr_write_b32 a239, v91
    v_mfma_f32_32x32x16_bf16 a[160:175], v[128:131], v[96:99], 0
    s_waitcnt lgkmcnt(3)
    v_lshlrev_b32 v80, 16, v176
    v_and_b32 v81, s63, v176
    v_lshlrev_b32 v82, 16, v177
    buffer_load_dwordx4 v239, s[16:19], s21 offen offset:1024 nt lds
    v_and_b32 v83, s63, v177
    v_lshlrev_b32 v84, 16, v178
    v_and_b32 v85, s63, v178
    v_lshlrev_b32 v86, 16, v179
    v_and_b32 v87, s63, v179
    v_pk_mul_f32 v[80:81], v[80:81], s[94:95]
    v_pk_mul_f32 v[82:83], v[82:83], s[94:95]
    v_pk_mul_f32 v[84:85], v[84:85], s[94:95]
    v_pk_mul_f32 v[86:87], v[86:87], s[94:95]
    v_cvt_pk_bf16_f32 v88, v80, v81
    v_cvt_pk_bf16_f32 v89, v82, v83
    v_cvt_pk_bf16_f32 v90, v84, v85
    v_cvt_pk_bf16_f32 v91, v86, v87
    v_accvgpr_write_b32 a240, v88
    v_accvgpr_write_b32 a241, v89
    v_accvgpr_write_b32 a242, v90
    v_accvgpr_write_b32 a243, v91
    s_waitcnt lgkmcnt(2)
    v_lshlrev_b32 v80, 16, v180
    v_and_b32 v81, s63, v180
    v_lshlrev_b32 v82, 16, v181
    buffer_load_dwordx4 v239, s[16:19], s21 offen offset:2048 nt lds
    v_and_b32 v83, s63, v181
    v_lshlrev_b32 v84, 16, v182
    v_and_b32 v85, s63, v182
    v_lshlrev_b32 v86, 16, v183
    v_and_b32 v87, s63, v183
    v_pk_mul_f32 v[80:81], v[80:81], s[94:95]
    v_pk_mul_f32 v[82:83], v[82:83], s[94:95]
    v_pk_mul_f32 v[84:85], v[84:85], s[94:95]
    v_pk_mul_f32 v[86:87], v[86:87], s[94:95]
    v_cvt_pk_bf16_f32 v88, v80, v81
    v_cvt_pk_bf16_f32 v89, v82, v83
    v_cvt_pk_bf16_f32 v90, v84, v85
    v_cvt_pk_bf16_f32 v91, v86, v87
    v_accvgpr_write_b32 a244, v88
    v_accvgpr_write_b32 a245, v89
    v_accvgpr_write_b32 a246, v90
    v_accvgpr_write_b32 a247, v91
    v_mfma_f32_32x32x16_bf16 a[176:191], v[128:131], v[96:99], 0
    s_waitcnt lgkmcnt(1)
    v_lshlrev_b32 v80, 16, v184
    v_and_b32 v81, s63, v184
    buffer_load_dwordx4 v239, s[16:19], s21 offen offset:3072 nt lds
    s_add_u32 s34, s34, 32768
    s_cmp_ge_u32 s34, s40
    s_cselect_b32 s60, s41, 0
    s_sub_u32 s34, s34, s60
    s_add_u32 s20, s20, 16384
    s_add_u32 s21, s21, 16384
    v_lshlrev_b32 v82, 16, v185
    v_and_b32 v83, s63, v185
    v_lshlrev_b32 v84, 16, v186
    v_and_b32 v85, s63, v186
    v_lshlrev_b32 v86, 16, v187
    v_and_b32 v87, s63, v187
    v_pk_mul_f32 v[80:81], v[80:81], s[94:95]
    v_pk_mul_f32 v[82:83], v[82:83], s[94:95]
    v_pk_mul_f32 v[84:85], v[84:85], s[94:95]
    v_pk_mul_f32 v[86:87], v[86:87], s[94:95]
    v_cvt_pk_bf16_f32 v88, v80, v81
    v_cvt_pk_bf16_f32 v89, v82, v83
    v_cvt_pk_bf16_f32 v90, v84, v85
    v_cvt_pk_bf16_f32 v91, v86, v87
    v_accvgpr_write_b32 a248, v88
    v_accvgpr_write_b32 a249, v89
    v_accvgpr_write_b32 a250, v90
    v_accvgpr_write_b32 a251, v91
    s_waitcnt lgkmcnt(0)
    v_lshlrev_b32 v80, 16, v188
    v_and_b32 v81, s63, v188
    v_lshlrev_b32 v82, 16, v189
    v_and_b32 v83, s63, v189
    v_lshlrev_b32 v84, 16, v190
    v_and_b32 v85, s63, v190
    v_lshlrev_b32 v86, 16, v191
    v_and_b32 v87, s63, v191
    v_pk_mul_f32 v[80:81], v[80:81], s[94:95]
    v_pk_mul_f32 v[82:83], v[82:83], s[94:95]
    v_pk_mul_f32 v[84:85], v[84:85], s[94:95]
    v_pk_mul_f32 v[86:87], v[86:87], s[94:95]
    v_cvt_pk_bf16_f32 v88, v80, v81
    v_cvt_pk_bf16_f32 v89, v82, v83
    v_cvt_pk_bf16_f32 v90, v84, v85
    v_cvt_pk_bf16_f32 v91, v86, v87
    v_accvgpr_write_b32 a252, v88
    v_accvgpr_write_b32 a253, v89
    v_accvgpr_write_b32 a254, v90
    v_accvgpr_write_b32 a255, v91
    v_mov_b32 v200, 0
    v_mov_b32 v201, 0
    v_mov_b32 v202, 0
    v_mov_b32 v203, 0
    v_mov_b32 v204, 0
    v_mov_b32 v205, 0
    v_mov_b32 v206, 0
    v_mov_b32 v207, 0
    s_waitcnt lgkmcnt(0)
    v_add_u32 v252, s42, v255
    ds_read_b128 v[80:83], v252 offset:0
    ds_read_b128 v[84:87], v252 offset:1024
    ds_read_b128 v[88:91], v252 offset:2048
    ds_read_b128 v[92:95], v252 offset:3072
    s_mov_b32 s44, 1
    s_mov_b32 s43, 14
    s_branch L_go_A
L_last_B:
    ds_read_b64_tr_b16 v[128:129], v231 offset:0
    ds_read_b64_tr_b16 v[130:131], v231 offset:2048
    v_mfma_f32_32x32x16_bf16 a[80:95], v[136:139], v[200:203], a[80:95]
    s_mov_b32 s51, s35
    s_add_u32 s35, s35, 32768
    s_cmp_ge_u32 s35, s40
    s_cselect_b32 s46, s41, 0
    s_sub_u32 s35, s35, s46
    s_sub_u32 s36, s35, s51
    s_sub_u32 s101, s51, s35
    s_mov_b32 s35, s51
    ds_read_b128 v[96:99], v223 offset:8192
    ds_read_b128 v[100:103], v224 offset:8192
    ds_read_b128 v[104:107], v225 offset:8192
    ds_read_b64_tr_b16 v[136:137], v232 offset:0
    ds_read_b64_tr_b16 v[138:139], v232 offset:2048
    v_mfma_f32_32x32x16_bf16 a[96:111], v[144:147], v[200:203], a[96:111]
    ds_read_b128 v[108:111], v226 offset:8192
    ds_read_b128 v[112:115], v227 offset:8192
    ds_read_b128 v[116:119], v228 offset:8192
    ds_read_b64_tr_b16 v[144:145], v233 offset:0
    ds_read_b64_tr_b16 v[146:147], v233 offset:2048
    v_mfma_f32_32x32x16_bf16 a[112:127], v[152:155], v[200:203], a[112:127]
    ds_read_b128 v[120:123], v229 offset:8192
    ds_read_b128 v[124:127], v230 offset:8192
    ds_read_b64_tr_b16 v[152:153], v234 offset:0
    ds_read_b64_tr_b16 v[154:155], v234 offset:2048
    v_exp_f32 v208, v160
    v_exp_f32 v209, v161
    v_mfma_f32_32x32x16_bf16 a[64:79], v[132:135], v[204:207], a[64:79]
    s_waitcnt vmcnt(0)
    s_barrier
    v_add_u32 v223, s36, v223
    v_add_u32 v224, s36, v224
    ds_read_b64_tr_b16 v[132:133], v231 offset:4096
    ds_read_b64_tr_b16 v[134:135], v231 offset:6144
    v_mfma_f32_32x32x16_bf16 a[80:95], v[140:143], v[204:207], a[80:95]
    v_add_u32 v225, s36, v225
    v_add_u32 v226, s36, v226
    ds_read_b64_tr_b16 v[140:141], v232 offset:4096
    ds_read_b64_tr_b16 v[142:143], v232 offset:6144
    v_exp_f32 v210, v162
    v_exp_f32 v211, v163
    v_mfma_f32_32x32x16_bf16 a[96:111], v[148:151], v[204:207], a[96:111]
    v_add_u32 v227, s36, v227
    v_add_u32 v228, s36, v228
    ds_read_b64_tr_b16 v[148:149], v233 offset:4096
    ds_read_b64_tr_b16 v[150:151], v233 offset:6144
    v_add_f32 v222, v208, v209
    v_cvt_pk_bf16_f32 v192, v208, v209
    v_exp_f32 v212, v164
    v_mfma_f32_32x32x16_bf16 a[112:127], v[156:159], v[204:207], a[112:127]
    v_add_u32 v229, s36, v229
    v_add_u32 v230, s36, v230
    ds_read_b64_tr_b16 v[156:157], v234 offset:4096
    ds_read_b64_tr_b16 v[158:159], v234 offset:6144
    v_add_f32 v222, v222, v210
    v_exp_f32 v213, v165
    s_waitcnt lgkmcnt(15)
    v_mfma_f32_32x32x16_bf16 v[176:191], v[96:99], v[0:3], v[32:47]
    ds_read_b128 v[96:99], v223 offset:0
    v_add_f32 v222, v222, v211
    v_cvt_pk_bf16_f32 v193, v210, v211
    v_exp_f32 v214, v166
    v_add_f32 v222, v222, v212
    v_mfma_f32_32x32x16_bf16 v[176:191], v[100:103], v[4:7], v[176:191]
    ds_read_b128 v[100:103], v224 offset:0
    v_exp_f32 v215, v167
    v_add_f32 v222, v222, v213
    v_cvt_pk_bf16_f32 v194, v212, v213
    v_exp_f32 v208, v168
    v_mfma_f32_32x32x16_bf16 v[176:191], v[104:107], v[8:11], v[176:191]
    ds_read_b128 v[104:107], v225 offset:0
    v_add_f32 v222, v222, v214
    v_exp_f32 v209, v169
    v_add_f32 v222, v222, v215
    v_cvt_pk_bf16_f32 v195, v214, v215
    v_mfma_f32_32x32x16_bf16 v[176:191], v[108:111], v[12:15], v[176:191]
    ds_read_b128 v[108:111], v226 offset:0
    v_exp_f32 v210, v170
    v_add_f32 v222, v222, v208
    v_exp_f32 v211, v171
    v_add_f32 v222, v222, v209
    v_cvt_pk_bf16_f32 v196, v208, v209
    v_mfma_f32_32x32x16_bf16 v[176:191], v[112:115], v[16:19], v[176:191]
    ds_read_b128 v[112:115], v227 offset:0
    v_exp_f32 v212, v172
    v_add_f32 v222, v222, v210
    v_exp_f32 v213, v173
    s_waitcnt lgkmcnt(15)
    v_mfma_f32_32x32x16_bf16 v[176:191], v[116:119], v[20:23], v[176:191]
    ds_read_b128 v[116:119], v228 offset:0
    v_add_f32 v222, v222, v211
    v_exp_f32 v214, v174
    v_add_f32 v222, v222, v212
    v_exp_f32 v215, v175
    v_mfma_f32_32x32x16_bf16 v[176:191], v[120:123], v[24:27], v[176:191]
    ds_read_b128 v[120:123], v229 offset:0
    v_add_f32 v222, v222, v213
    v_add_f32 v222, v222, v214
    v_add_f32 v222, v222, v215
    v_subrev_u32 v253, s29, v222
    v_cmp_lt_u32 vcc, s22, v253
    v_cvt_pk_bf16_f32 v197, v210, v211
    v_mfma_f32_32x32x16_bf16 v[176:191], v[124:127], v[28:31], v[176:191]
    ds_read_b128 v[124:127], v230 offset:0
    v_cvt_pk_bf16_f32 v198, v212, v213
    v_cvt_pk_bf16_f32 v199, v214, v215
    s_cbranch_vccnz L_stub44
L_ret44:
    v_add_f32 v219, v219, v222
    v_mfma_f32_32x32x16_bf16 a[0:15], v[128:131], v[192:195], a[0:15]
    ds_read_b64_tr_b16 v[128:129], v231 offset:8192
    ds_read_b64_tr_b16 v[130:131], v231 offset:10240
    v_mfma_f32_32x32x16_bf16 a[16:31], v[136:139], v[192:195], a[16:31]
    ds_read_b64_tr_b16 v[136:137], v232 offset:8192
    ds_read_b64_tr_b16 v[138:139], v232 offset:10240
    v_mfma_f32_32x32x16_bf16 a[32:47], v[144:147], v[192:195], a[32:47]
    ds_read_b64_tr_b16 v[144:145], v233 offset:8192
    ds_read_b64_tr_b16 v[146:147], v233 offset:10240
    v_exp_f32 v208, v176
    v_exp_f32 v209, v177
    s_waitcnt lgkmcnt(14)
    v_mfma_f32_32x32x16_bf16 a[48:63], v[152:155], v[192:195], a[48:63]
    ds_read_b64_tr_b16 v[152:153], v234 offset:8192
    ds_read_b64_tr_b16 v[154:155], v234 offset:10240
    v_exp_f32 v210, v178
    v_exp_f32 v211, v179
    v_mfma_f32_32x32x16_bf16 a[0:15], v[132:135], v[196:199], a[0:15]
    ds_read_b64_tr_b16 v[132:133], v231 offset:12288
    ds_read_b64_tr_b16 v[134:135], v231 offset:14336
    v_add_f32 v222, v208, v209
    v_cvt_pk_bf16_f32 v200, v208, v209
    v_exp_f32 v212, v180
    v_mfma_f32_32x32x16_bf16 a[16:31], v[140:143], v[196:199], a[16:31]
    ds_read_b64_tr_b16 v[140:141], v232 offset:12288
    ds_read_b64_tr_b16 v[142:143], v232 offset:14336
    v_add_f32 v222, v222, v210
    v_exp_f32 v213, v181
    v_add_f32 v222, v222, v211
    v_mfma_f32_32x32x16_bf16 a[32:47], v[148:151], v[196:199], a[32:47]
    ds_read_b64_tr_b16 v[148:149], v233 offset:12288
    ds_read_b64_tr_b16 v[150:151], v233 offset:14336
    v_cvt_pk_bf16_f32 v201, v210, v211
    v_exp_f32 v214, v182
    v_add_f32 v222, v222, v212
    v_mfma_f32_32x32x16_bf16 a[48:63], v[156:159], v[196:199], a[48:63]
    ds_read_b64_tr_b16 v[156:157], v234 offset:12288
    ds_read_b64_tr_b16 v[158:159], v234 offset:14336
    v_exp_f32 v215, v183
    v_add_f32 v222, v222, v213
    v_cvt_pk_bf16_f32 v202, v212, v213
    s_waitcnt lgkmcnt(15)
    v_mfma_f32_32x32x16_bf16 v[160:175], v[96:99], v[0:3], v[32:47]
    ds_read_b128 v[96:99], v223 offset:8192
    v_exp_f32 v208, v184
    v_add_f32 v222, v222, v214
    v_exp_f32 v209, v185
    v_mfma_f32_32x32x16_bf16 v[160:175], v[100:103], v[4:7], v[160:175]
    ds_read_b128 v[100:103], v224 offset:8192
    v_add_f32 v222, v222, v215
    v_cvt_pk_bf16_f32 v203, v214, v215
    v_exp_f32 v210, v186
    v_mfma_f32_32x32x16_bf16 v[160:175], v[104:107], v[8:11], v[160:175]
    ds_read_b128 v[104:107], v225 offset:8192
    v_add_f32 v222, v222, v208
    v_exp_f32 v211, v187
    v_add_f32 v222, v222, v209
    v_cvt_pk_bf16_f32 v204, v208, v209
    v_mfma_f32_32x32x16_bf16 v[160:175], v[108:111], v[12:15], v[160:175]
    ds_read_b128 v[108:111], v226 offset:8192
    v_exp_f32 v212, v188
    v_add_f32 v222, v222, v210
    v_exp_f32 v213, v189
    v_mfma_f32_32x32x16_bf16 v[160:175], v[112:115], v[16:19], v[160:175]
    ds_read_b128 v[112:115], v227 offset:8192
    v_add_f32 v222, v222, v211
    v_exp_f32 v214, v190
    v_add_f32 v222, v222, v212
    v_mfma_f32_32x32x16_bf16 v[160:175], v[116:119], v[20:23], v[160:175]
    ds_read_b128 v[116:119], v228 offset:8192
    v_exp_f32 v215, v191
    v_add_f32 v222, v222, v213
    v_add_f32 v222, v222, v214
    v_add_f32 v222, v222, v215
    v_mfma_f32_32x32x16_bf16 v[160:175], v[120:123], v[24:27], v[160:175]
    ds_read_b128 v[120:123], v229 offset:8192
    v_subrev_u32 v253, s29, v222
    v_cmp_lt_u32 vcc, s22, v253
    v_cvt_pk_bf16_f32 v205, v210, v211
    v_cvt_pk_bf16_f32 v206, v212, v213
    v_mfma_f32_32x32x16_bf16 v[160:175], v[124:127], v[28:31], v[160:175]
    ds_read_b128 v[124:127], v230 offset:8192
    v_cvt_pk_bf16_f32 v207, v214, v215
    s_cbranch_vccnz L_stub45
L_ret45:
    v_add_f32 v219, v219, v222
    v_add_u32 v231, s36, v231
    v_add_u32 v232, s36, v232
    v_add_u32 v233, s36, v233
    v_add_u32 v234, s36, v234
    s_waitcnt lgkmcnt(8)
    v_mfma_f32_32x32x16_bf16 a[0:15], v[128:131], v[200:203], a[0:15]
    ds_read_b64_tr_b16 v[128:129], v231 offset:0
    ds_read_b64_tr_b16 v[130:131], v231 offset:2048
    v_mfma_f32_32x32x16_bf16 a[16:31], v[136:139], v[200:203], a[16:31]
    ds_read_b64_tr_b16 v[136:137], v232 offset:0
    ds_read_b64_tr_b16 v[138:139], v232 offset:2048
    v_mfma_f32_32x32x16_bf16 a[32:47], v[144:147], v[200:203], a[32:47]
    ds_read_b64_tr_b16 v[144:145], v233 offset:0
    ds_read_b64_tr_b16 v[146:147], v233 offset:2048
    v_exp_f32 v208, v160
    v_exp_f32 v209, v161
    v_mfma_f32_32x32x16_bf16 a[48:63], v[152:155], v[200:203], a[48:63]
    ds_read_b64_tr_b16 v[152:153], v234 offset:0
    ds_read_b64_tr_b16 v[154:155], v234 offset:2048
    v_exp_f32 v210, v162
    v_exp_f32 v211, v163
    v_add_f32 v222, v208, v209
    v_mfma_f32_32x32x16_bf16 a[0:15], v[132:135], v[204:207], a[0:15]
    v_add_u32 v223, s101, v223
    v_add_u32 v224, s101, v224
    ds_read_b64_tr_b16 v[132:133], v231 offset:4096
    ds_read_b64_tr_b16 v[134:135], v231 offset:6144
    v_cvt_pk_bf16_f32 v192, v208, v209
    v_exp_f32 v212, v164
    v_mfma_f32_32x32x16_bf16 a[16:31], v[140:143], v[204:207], a[16:31]
    v_add_u32 v225, s101, v225
    v_add_u32 v226, s101, v226
    ds_read_b64_tr_b16 v[140:141], v232 offset:4096
    ds_read_b64_tr_b16 v[142:143], v232 offset:6144
    v_add_f32 v222, v222, v210
    v_exp_f32 v213, v165
    v_mfma_f32_32x32x16_bf16 a[32:47], v[148:151], v[204:207], a[32:47]
    v_add_u32 v227, s101, v227
    v_add_u32 v228, s101, v228
    ds_read_b64_tr_b16 v[148:149], v233 offset:4096
    ds_read_b64_tr_b16 v[150:151], v233 offset:6144
    v_add_f32 v222, v222, v211
    v_cvt_pk_bf16_f32 v193, v210, v211
    v_mfma_f32_32x32x16_bf16 a[48:63], v[156:159], v[204:207], a[48:63]
    v_add_u32 v229, s101, v229
    v_add_u32 v230, s101, v230
    ds_read_b64_tr_b16 v[156:157], v234 offset:4096
    ds_read_b64_tr_b16 v[158:159], v234 offset:6144
    v_exp_f32 v214, v166
    v_add_f32 v222, v222, v212
    s_waitcnt lgkmcnt(15)
    v_mfma_f32_32x32x16_bf16 v[176:191], v[96:99], v[0:3], v[32:47]
    ds_read_b128 v[96:99], v223 offset:0
    v_exp_f32 v215, v167
    v_add_f32 v222, v222, v213
    v_cvt_pk_bf16_f32 v194, v212, v213
    v_exp_f32 v208, v168
    v_mfma_f32_32x32x16_bf16 v[176:191], v[100:103], v[4:7], v[176:191]
    ds_read_b128 v[100:103], v224 offset:0
    v_add_f32 v222, v222, v214
    v_exp_f32 v209, v169
    v_add_f32 v222, v222, v215
    v_mfma_f32_32x32x16_bf16 v[176:191], v[104:107], v[8:11], v[176:191]
    ds_read_b128 v[104:107], v225 offset:0
    v_cvt_pk_bf16_f32 v195, v214, v215
    v_exp_f32 v210, v170
    v_add_f32 v222, v222, v208
    v_exp_f32 v211, v171
    v_mfma_f32_32x32x16_bf16 v[176:191], v[108:111], v[12:15], v[176:191]
    ds_read_b128 v[108:111], v226 offset:0
    v_add_f32 v222, v222, v209
    v_cvt_pk_bf16_f32 v196, v208, v209
    v_exp_f32 v212, v172
    v_mfma_f32_32x32x16_bf16 v[176:191], v[112:115], v[16:19], v[176:191]
    ds_read_b128 v[112:115], v227 offset:0
    v_add_f32 v222, v222, v210
    v_exp_f32 v213, v173
    v_add_f32 v222, v222, v211
    v_exp_f32 v214, v174
    v_mfma_f32_32x32x16_bf16 v[176:191], v[116:119], v[20:23], v[176:191]
    ds_read_b128 v[116:119], v228 offset:0
    v_add_f32 v222, v222, v212
    v_exp_f32 v215, v175
    v_add_f32 v222, v222, v213
    v_add_f32 v222, v222, v214
    v_mfma_f32_32x32x16_bf16 v[176:191], v[120:123], v[24:27], v[176:191]
    ds_read_b128 v[120:123], v229 offset:0
    v_add_f32 v222, v222, v215
    v_subrev_u32 v253, s29, v222
    v_cmp_lt_u32 vcc, s22, v253
    v_cvt_pk_bf16_f32 v197, v210, v211
    v_cvt_pk_bf16_f32 v198, v212, v213
    v_mfma_f32_32x32x16_bf16 v[176:191], v[124:127], v[28:31], v[176:191]
    ds_read_b128 v[124:127], v230 offset:0
    v_cvt_pk_bf16_f32 v199, v214, v215
    s_cbranch_vccnz L_stub46
L_ret46:
    v_add_f32 v219, v219, v222
    s_waitcnt lgkmcnt(8)
    v_mfma_f32_32x32x16_bf16 a[0:15], v[128:131], v[192:195], a[0:15]
    ds_read_b64_tr_b16 v[128:129], v231 offset:8192
    ds_read_b64_tr_b16 v[130:131], v231 offset:10240
    v_mfma_f32_32x32x16_bf16 a[16:31], v[136:139], v[192:195], a[16:31]
    ds_read_b64_tr_b16 v[136:137], v232 offset:8192
    ds_read_b64_tr_b16 v[138:139], v232 offset:10240
    v_mfma_f32_32x32x16_bf16 a[32:47], v[144:147], v[192:195], a[32:47]
    ds_read_b64_tr_b16 v[144:145], v233 offset:8192
    ds_read_b64_tr_b16 v[146:147], v233 offset:10240
    v_exp_f32 v208, v176
    v_exp_f32 v209, v177
    v_mfma_f32_32x32x16_bf16 a[48:63], v[152:155], v[192:195], a[48:63]
    ds_read_b64_tr_b16 v[152:153], v234 offset:8192
    ds_read_b64_tr_b16 v[154:155], v234 offset:10240
    v_exp_f32 v210, v178
    v_exp_f32 v211, v179
    v_mfma_f32_32x32x16_bf16 a[0:15], v[132:135], v[196:199], a[0:15]
    ds_read_b64_tr_b16 v[132:133], v231 offset:12288
    ds_read_b64_tr_b16 v[134:135], v231 offset:14336
    v_add_f32 v222, v208, v209
    v_cvt_pk_bf16_f32 v200, v208, v209
    v_exp_f32 v212, v180
    v_mfma_f32_32x32x16_bf16 a[16:31], v[140:143], v[196:199], a[16:31]
    ds_read_b64_tr_b16 v[140:141], v232 offset:12288
    ds_read_b64_tr_b16 v[142:143], v232 offset:14336
    v_add_f32 v222, v222, v210
    v_exp_f32 v213, v181
    v_add_f32 v222, v222, v211
    v_mfma_f32_32x32x16_bf16 a[32:47], v[148:151], v[196:199], a[32:47]
    ds_read_b64_tr_b16 v[148:149], v233 offset:12288
    ds_read_b64_tr_b16 v[150:151], v233 offset:14336
    v_cvt_pk_bf16_f32 v201, v210, v211
    v_exp_f32 v214, v182
    v_add_f32 v222, v222, v212
    v_mfma_f32_32x32x16_bf16 a[48:63], v[156:159], v[196:199], a[48:63]
    ds_read_b64_tr_b16 v[156:157], v234 offset:12288
    ds_read_b64_tr_b16 v[158:159], v234 offset:14336
    v_exp_f32 v215, v183
    v_add_f32 v222, v222, v213
    v_cvt_pk_bf16_f32 v202, v212, v213
    s_waitcnt lgkmcnt(15)
    v_mfma_f32_32x32x16_bf16 v[160:175], v[96:99], a[192:195], v[48:63]
    ds_read_b128 v[96:99], v223 offset:8192
    v_exp_f32 v208, v184
    v_add_f32 v222, v222, v214
    v_exp_f32 v209, v185
    v_mfma_f32_32x32x16_bf16 v[160:175], v[100:103], a[196:199], v[160:175]
    ds_read_b128 v[100:103], v224 offset:8192
    v_add_f32 v222, v222, v215
    v_cvt_pk_bf16_f32 v203, v214, v215
    v_exp_f32 v210, v186
    v_mfma_f32_32x32x16_bf16 v[160:175], v[104:107], a[200:203], v[160:175]
    ds_read_b128 v[104:107], v225 offset:8192
    v_add_f32 v222, v222, v208
    v_exp_f32 v211, v187
    v_add_f32 v222, v222, v209
    v_cvt_pk_bf16_f32 v204, v208, v209
    v_mfma_f32_32x32x16_bf16 v[160:175], v[108:111], a[204:207], v[160:175]
    ds_read_b128 v[108:111], v226 offset:8192
    v_exp_f32 v212, v188
    v_add_f32 v222, v222, v210
    v_exp_f32 v213, v189
    v_mfma_f32_32x32x16_bf16 v[160:175], v[112:115], a[208:211], v[160:175]
    ds_read_b128 v[112:115], v227 offset:8192
    v_add_f32 v222, v222, v211
    v_exp_f32 v214, v190
    v_add_f32 v222, v222, v212
    v_mfma_f32_32x32x16_bf16 v[160:175], v[116:119], a[212:215], v[160:175]
    ds_read_b128 v[116:119], v228 offset:8192
    v_exp_f32 v215, v191
    v_add_f32 v222, v222, v213
    v_add_f32 v222, v222, v214
    v_add_f32 v222, v222, v215
    v_mfma_f32_32x32x16_bf16 v[160:175], v[120:123], a[216:219], v[160:175]
    ds_read_b128 v[120:123], v229 offset:8192
    v_subrev_u32 v253, s29, v222
    v_cmp_lt_u32 vcc, s22, v253
    v_cvt_pk_bf16_f32 v205, v210, v211
    v_cvt_pk_bf16_f32 v206, v212, v213
    v_mfma_f32_32x32x16_bf16 v[160:175], v[124:127], a[220:223], v[160:175]
    ds_read_b128 v[124:127], v230 offset:8192
    v_cvt_pk_bf16_f32 v207, v214, v215
    s_cbranch_vccnz L_stub47
L_ret47:
    v_add_f32 v219, v219, v222
    v_add_u32 v231, s101, v231
    v_add_u32 v232, s101, v232
    v_add_u32 v233, s101, v233
    v_add_u32 v234, s101, v234
    s_waitcnt lgkmcnt(8)
    v_mfma_f32_32x32x16_bf16 a[0:15], v[128:131], v[200:203], a[0:15]
    ds_read_b64_tr_b16 v[128:129], v231 offset:0
    ds_read_b64_tr_b16 v[130:131], v231 offset:2048
    v_mfma_f32_32x32x16_bf16 a[16:31], v[136:139], v[200:203], a[16:31]
    ds_read_b64_tr_b16 v[136:137], v232 offset:0
    ds_read_b64_tr_b16 v[138:139], v232 offset:2048
    v_mfma_f32_32x32x16_bf16 a[32:47], v[144:147], v[200:203], a[32:47]
    ds_read_b64_tr_b16 v[144:145], v233 offset:0
    ds_read_b64_tr_b16 v[146:147], v233 offset:2048
    v_exp_f32 v208, v160
    v_exp_f32 v209, v161
    v_exp_f32 v210, v162
    v_mfma_f32_32x32x16_bf16 a[48:63], v[152:155], v[200:203], a[48:63]
    ds_read_b64_tr_b16 v[152:153], v234 offset:0
    ds_read_b64_tr_b16 v[154:155], v234 offset:2048
    v_exp_f32 v211, v163
    v_add_f32 v222, v208, v209
    v_cvt_pk_bf16_f32 v192, v208, v209
    v_mfma_f32_32x32x16_bf16 a[0:15], v[132:135], v[204:207], a[0:15]
    v_add_u32 v223, s36, v223
    v_add_u32 v224, s36, v224
    ds_read_b64_tr_b16 v[132:133], v231 offset:4096
    ds_read_b64_tr_b16 v[134:135], v231 offset:6144
    v_exp_f32 v212, v164
    v_add_f32 v222, v222, v210
    v_mfma_f32_32x32x16_bf16 a[16:31], v[140:143], v[204:207], a[16:31]
    v_add_u32 v225, s36, v225
    v_add_u32 v226, s36, v226
    ds_read_b64_tr_b16 v[140:141], v232 offset:4096
    ds_read_b64_tr_b16 v[142:143], v232 offset:6144
    v_exp_f32 v213, v165
    v_add_f32 v222, v222, v211
    v_mfma_f32_32x32x16_bf16 a[32:47], v[148:151], v[204:207], a[32:47]
    v_add_u32 v227, s36, v227
    v_add_u32 v228, s36, v228
    ds_read_b64_tr_b16 v[148:149], v233 offset:4096
    ds_read_b64_tr_b16 v[150:151], v233 offset:6144
    v_cvt_pk_bf16_f32 v193, v210, v211
    v_exp_f32 v214, v166
    v_mfma_f32_32x32x16_bf16 a[48:63], v[156:159], v[204:207], a[48:63]
    v_add_u32 v229, s36, v229
    v_add_u32 v230, s36, v230
    ds_read_b64_tr_b16 v[156:157], v234 offset:4096
    ds_read_b64_tr_b16 v[158:159], v234 offset:6144
    v_add_f32 v222, v222, v212
    v_exp_f32 v215, v167
    s_sub_u32 s45, s62, s55
    v_add_u32 v251, s45, v240
    v_xor_b32 v24, 0, v241
    v_lshl_add_u32 v24, v24, 4, v251
    v_xor_b32 v25, 2, v241
    v_lshl_add_u32 v25, v25, 4, v251
    v_xor_b32 v26, 4, v241
    v_lshl_add_u32 v26, v26, 4, v251
    v_xor_b32 v27, 6, v241
    v_lshl_add_u32 v27, v27, 4, v251
    v_xor_b32 v28, 8, v241
    v_lshl_add_u32 v28, v28, 4, v251
    v_xor_b32 v29, 10, v241
    v_lshl_add_u32 v29, v29, 4, v251
    v_xor_b32 v30, 12, v241
    v_lshl_add_u32 v30, v30, 4, v251
    v_xor_b32 v31, 14, v241
    v_lshl_add_u32 v31, v31, 4, v251
    v_mov_b32 v242, v219
    v_mov_b32 v243, v219
    s_nop 1
    v_permlane32_swap_b32 v242, v243
    s_nop 1
    v_add_f32 v244, v242, v243
    v_rcp_f32 v244, v244
    s_nop 0
    v_mov_b32 v245, v244
    v_accvgpr_read_b32 v0, a0
    v_accvgpr_read_b32 v1, a1
    v_accvgpr_read_b32 v2, a2
    v_accvgpr_read_b32 v3, a3
    v_accvgpr_read_b32 v4, a4
    v_accvgpr_read_b32 v5, a5
    v_accvgpr_read_b32 v6, a6
    v_accvgpr_read_b32 v7, a7
    v_pk_mul_f32 v[0:1], v[0:1], v[244:245]
    v_pk_mul_f32 v[2:3], v[2:3], v[244:245]
    v_pk_mul_f32 v[4:5], v[4:5], v[244:245]
    v_pk_mul_f32 v[6:7], v[6:7], v[244:245]
    v_cvt_pk_bf16_f32 v8, v0, v1
    v_cvt_pk_bf16_f32 v9, v2, v3
    v_cvt_pk_bf16_f32 v10, v4, v5
    v_cvt_pk_bf16_f32 v11, v6, v7
    s_nop 0
    v_permlane32_swap_b32 v8, v10
    v_permlane32_swap_b32 v9, v11
    ds_write_b128 v24, v[8:11] offset:0
    v_accvgpr_read_b32 v12, a8
    v_accvgpr_read_b32 v13, a9
    v_accvgpr_read_b32 v14, a10
    v_accvgpr_read_b32 v15, a11
    v_accvgpr_read_b32 v16, a12
    v_accvgpr_read_b32 v17, a13
    v_accvgpr_read_b32 v18, a14
    v_accvgpr_read_b32 v19, a15
    v_pk_mul_f32 v[12:13], v[12:13], v[244:245]
    v_pk_mul_f32 v[14:15], v[14:15], v[244:245]
    v_pk_mul_f32 v[16:17], v[16:17], v[244:245]
    v_pk_mul_f32 v[18:19], v[18:19], v[244:245]
    v_cvt_pk_bf16_f32 v20, v12, v13
    v_cvt_pk_bf16_f32 v21, v14, v15
    v_cvt_pk_bf16_f32 v22, v16, v17
    v_cvt_pk_bf16_f32 v23, v18, v19
    s_nop 0
    v_permlane32_swap_b32 v20, v22
    v_permlane32_swap_b32 v21, v23
    ds_write_b128 v25, v[20:23] offset:0
    v_accvgpr_read_b32 v0, a16
    v_accvgpr_read_b32 v1, a17
    v_accvgpr_read_b32 v2, a18
    v_accvgpr_read_b32 v3, a19
    v_accvgpr_read_b32 v4, a20
    v_accvgpr_read_b32 v5, a21
    v_accvgpr_read_b32 v6, a22
    v_accvgpr_read_b32 v7, a23
    v_pk_mul_f32 v[0:1], v[0:1], v[244:245]
    v_pk_mul_f32 v[2:3], v[2:3], v[244:245]
    v_pk_mul_f32 v[4:5], v[4:5], v[244:245]
    v_pk_mul_f32 v[6:7], v[6:7], v[244:245]
    v_cvt_pk_bf16_f32 v8, v0, v1
    v_cvt_pk_bf16_f32 v9, v2, v3
    v_cvt_pk_bf16_f32 v10, v4, v5
    v_cvt_pk_bf16_f32 v11, v6, v7
    s_nop 0
    v_permlane32_swap_b32 v8, v10
    v_permlane32_swap_b32 v9, v11
    ds_write_b128 v26, v[8:11] offset:0
    v_accvgpr_read_b32 v12, a24
    v_accvgpr_read_b32 v13, a25
    v_accvgpr_read_b32 v14, a26
    v_accvgpr_read_b32 v15, a27
    v_accvgpr_read_b32 v16, a28
    v_accvgpr_read_b32 v17, a29
    v_accvgpr_read_b32 v18, a30
    v_accvgpr_read_b32 v19, a31
    v_pk_mul_f32 v[12:13], v[12:13], v[244:245]
    v_pk_mul_f32 v[14:15], v[14:15], v[244:245]
    v_pk_mul_f32 v[16:17], v[16:17], v[244:245]
    v_pk_mul_f32 v[18:19], v[18:19], v[244:245]
    v_cvt_pk_bf16_f32 v20, v12, v13
    v_cvt_pk_bf16_f32 v21, v14, v15
    v_cvt_pk_bf16_f32 v22, v16, v17
    v_cvt_pk_bf16_f32 v23, v18, v19
    s_nop 0
    v_permlane32_swap_b32 v20, v22
    v_permlane32_swap_b32 v21, v23
    ds_write_b128 v27, v[20:23] offset:0
    v_accvgpr_read_b32 v0, a32
    v_accvgpr_read_b32 v1, a33
    v_accvgpr_read_b32 v2, a34
    v_accvgpr_read_b32 v3, a35
    v_accvgpr_read_b32 v4, a36
    v_accvgpr_read_b32 v5, a37
    v_accvgpr_read_b32 v6, a38
    v_accvgpr_read_b32 v7, a39
    v_pk_mul_f32 v[0:1], v[0:1], v[244:245]
    v_pk_mul_f32 v[2:3], v[2:3], v[244:245]
    v_pk_mul_f32 v[4:5], v[4:5], v[244:245]
    v_pk_mul_f32 v[6:7], v[6:7], v[244:245]
    v_cvt_pk_bf16_f32 v8, v0, v1
    v_cvt_pk_bf16_f32 v9, v2, v3
    v_cvt_pk_bf16_f32 v10, v4, v5
    v_cvt_pk_bf16_f32 v11, v6, v7
    s_nop 0
    v_permlane32_swap_b32 v8, v10
    v_permlane32_swap_b32 v9, v11
    ds_write_b128 v28, v[8:11] offset:0
    v_accvgpr_read_b32 v12, a40
    v_accvgpr_read_b32 v13, a41
    v_accvgpr_read_b32 v14, a42
    v_accvgpr_read_b32 v15, a43
    v_accvgpr_read_b32 v16, a44
    v_accvgpr_read_b32 v17, a45
    v_accvgpr_read_b32 v18, a46
    v_accvgpr_read_b32 v19, a47
    v_pk_mul_f32 v[12:13], v[12:13], v[244:245]
    v_pk_mul_f32 v[14:15], v[14:15], v[244:245]
    v_pk_mul_f32 v[16:17], v[16:17], v[244:245]
    v_pk_mul_f32 v[18:19], v[18:19], v[244:245]
    v_cvt_pk_bf16_f32 v20, v12, v13
    v_cvt_pk_bf16_f32 v21, v14, v15
    v_cvt_pk_bf16_f32 v22, v16, v17
    v_cvt_pk_bf16_f32 v23, v18, v19
    s_nop 0
    v_permlane32_swap_b32 v20, v22
    v_permlane32_swap_b32 v21, v23
    ds_write_b128 v29, v[20:23] offset:0
    v_accvgpr_read_b32 v0, a48
    v_accvgpr_read_b32 v1, a49
    v_accvgpr_read_b32 v2, a50
    v_accvgpr_read_b32 v3, a51
    v_accvgpr_read_b32 v4, a52
    v_accvgpr_read_b32 v5, a53
    v_accvgpr_read_b32 v6, a54
    v_accvgpr_read_b32 v7, a55
    v_pk_mul_f32 v[0:1], v[0:1], v[244:245]
    v_pk_mul_f32 v[2:3], v[2:3], v[244:245]
    v_pk_mul_f32 v[4:5], v[4:5], v[244:245]
    v_pk_mul_f32 v[6:7], v[6:7], v[244:245]
    v_cvt_pk_bf16_f32 v8, v0, v1
    v_cvt_pk_bf16_f32 v9, v2, v3
    v_cvt_pk_bf16_f32 v10, v4, v5
    v_cvt_pk_bf16_f32 v11, v6, v7
    s_nop 0
    v_permlane32_swap_b32 v8, v10
    v_permlane32_swap_b32 v9, v11
    ds_write_b128 v30, v[8:11] offset:0
    v_accvgpr_read_b32 v12, a56
    v_accvgpr_read_b32 v13, a57
    v_accvgpr_read_b32 v14, a58
    v_accvgpr_read_b32 v15, a59
    v_accvgpr_read_b32 v16, a60
    v_accvgpr_read_b32 v17, a61
    v_accvgpr_read_b32 v18, a62
    v_accvgpr_read_b32 v19, a63
    v_pk_mul_f32 v[12:13], v[12:13], v[244:245]
    v_pk_mul_f32 v[14:15], v[14:15], v[244:245]
    v_pk_mul_f32 v[16:17], v[16:17], v[244:245]
    v_pk_mul_f32 v[18:19], v[18:19], v[244:245]
    v_cvt_pk_bf16_f32 v20, v12, v13
    v_cvt_pk_bf16_f32 v21, v14, v15
    v_cvt_pk_bf16_f32 v22, v16, v17
    v_cvt_pk_bf16_f32 v23, v18, v19
    s_nop 0
    v_permlane32_swap_b32 v20, v22
    v_permlane32_swap_b32 v21, v23
    ds_write_b128 v31, v[20:23] offset:0
    v_add_u32 v250, s62, v255
    s_waitcnt lgkmcnt(0)
    ds_read_b128 v[0:3], v250 offset:0
    ds_read_b128 v[4:7], v250 offset:1024
    ds_read_b128 v[8:11], v250 offset:2048
    ds_read_b128 v[12:15], v250 offset:3072
    ds_read_b128 v[16:19], v250 offset:16384
    ds_read_b128 v[20:23], v250 offset:17408
    ds_read_b128 v[24:27], v250 offset:18432
    ds_read_b128 v[28:31], v250 offset:19456
    s_mov_b32 s96, s39
    s_add_u32 s97, s39, 4096
    v_mfma_f32_32x32x16_bf16 v[176:191], v[96:99], a[192:195], v[48:63]
    ds_read_b128 v[96:99], v223 offset:0
    v_add_f32 v222, v222, v213
    v_cvt_pk_bf16_f32 v194, v212, v213
    v_exp_f32 v208, v168
    v_add_f32 v222, v222, v214
    v_mfma_f32_32x32x16_bf16 v[176:191], v[100:103], a[196:199], v[176:191]
    ds_read_b128 v[100:103], v224 offset:0
    v_exp_f32 v209, v169
    v_add_f32 v222, v222, v215
    v_cvt_pk_bf16_f32 v195, v214, v215
    v_exp_f32 v210, v170
    v_mfma_f32_32x32x16_bf16 v[176:191], v[104:107], a[200:203], v[176:191]
    ds_read_b128 v[104:107], v225 offset:0
    v_add_f32 v222, v222, v208
    v_exp_f32 v211, v171
    v_add_f32 v222, v222, v209
    v_cvt_pk_bf16_f32 v196, v208, v209
    v_mfma_f32_32x32x16_bf16 v[176:191], v[108:111], a[204:207], v[176:191]
    ds_read_b128 v[108:111], v226 offset:0
    s_waitcnt lgkmcnt(11)
    buffer_store_dwordx4 v[0:3], v235, s[24:27], s96 offen offset:0 sc1 nt
    v_exp_f32 v212, v172
    v_add_f32 v222, v222, v210
    v_mfma_f32_32x32x16_bf16 v[176:191], v[112:115], a[208:211], v[176:191]
    ds_read_b128 v[112:115], v227 offset:0
    v_exp_f32 v213, v173
    v_add_f32 v222, v222, v211
    v_exp_f32 v214, v174
    v_add_f32 v222, v222, v212
    v_mfma_f32_32x32x16_bf16 v[176:191], v[116:119], a[212:215], v[176:191]
    ds_read_b128 v[116:119], v228 offset:0
    v_exp_f32 v215, v175
    v_add_f32 v222, v222, v213
    v_add_f32 v222, v222, v214
    v_add_f32 v222, v222, v215
    v_mfma_f32_32x32x16_bf16 v[176:191], v[120:123], a[216:219], v[176:191]
    ds_read_b128 v[120:123], v229 offset:0
    s_waitcnt lgkmcnt(13)
    buffer_store_dwordx4 v[4:7], v236, s[24:27], s96 offen offset:1024 sc1 nt
    v_subrev_u32 v253, s29, v222
    v_cmp_lt_u32 vcc, s22, v253
    v_cvt_pk_bf16_f32 v197, v210, v211
    v_mfma_f32_32x32x16_bf16 v[176:191], v[124:127], a[220:223], v[176:191]
    ds_read_b128 v[124:127], v230 offset:0
    v_cvt_pk_bf16_f32 v198, v212, v213
    v_cvt_pk_bf16_f32 v199, v214, v215
    s_cbranch_vccnz L_stub48
L_ret48:
    v_add_f32 v220, v220, v222
    v_mfma_f32_32x32x16_bf16 a[64:79], v[128:131], v[192:195], a[64:79]
    ds_read_b64_tr_b16 v[128:129], v231 offset:8192
    ds_read_b64_tr_b16 v[130:131], v231 offset:10240
    s_waitcnt lgkmcnt(15)
    buffer_store_dwordx4 v[8:11], v237, s[24:27], s96 offen offset:2048 sc1 nt
    v_mfma_f32_32x32x16_bf16 a[80:95], v[136:139], v[192:195], a[80:95]
    ds_read_b64_tr_b16 v[136:137], v232 offset:8192
    ds_read_b64_tr_b16 v[138:139], v232 offset:10240
    s_waitcnt lgkmcnt(15)
    buffer_store_dwordx4 v[12:15], v238, s[24:27], s96 offen offset:3072 sc1 nt
    v_mfma_f32_32x32x16_bf16 a[96:111], v[144:147], v[192:195], a[96:111]
    ds_read_b64_tr_b16 v[144:145], v233 offset:8192
    ds_read_b64_tr_b16 v[146:147], v233 offset:10240
    v_exp_f32 v208, v176
    v_exp_f32 v209, v177
    v_mfma_f32_32x32x16_bf16 a[112:127], v[152:155], v[192:195], a[112:127]
    ds_read_b64_tr_b16 v[152:153], v234 offset:8192
    ds_read_b64_tr_b16 v[154:155], v234 offset:10240
    v_exp_f32 v210, v178
    v_exp_f32 v211, v179
    v_add_f32 v222, v208, v209
    v_mfma_f32_32x32x16_bf16 a[64:79], v[132:135], v[196:199], a[64:79]
    ds_read_b64_tr_b16 v[132:133], v231 offset:12288
    ds_read_b64_tr_b16 v[134:135], v231 offset:14336
    v_cvt_pk_bf16_f32 v200, v208, v209
    v_exp_f32 v212, v180
    v_add_f32 v222, v222, v210
    v_mfma_f32_32x32x16_bf16 a[80:95], v[140:143], v[196:199], a[80:95]
    ds_read_b64_tr_b16 v[140:141], v232 offset:12288
    ds_read_b64_tr_b16 v[142:143], v232 offset:14336
    v_exp_f32 v213, v181
    v_add_f32 v222, v222, v211
    v_cvt_pk_bf16_f32 v201, v210, v211
    v_mfma_f32_32x32x16_bf16 a[96:111], v[148:151], v[196:199], a[96:111]
    ds_read_b64_tr_b16 v[148:149], v233 offset:12288
    ds_read_b64_tr_b16 v[150:151], v233 offset:14336
    v_exp_f32 v214, v182
    v_add_f32 v222, v222, v212
    v_exp_f32 v215, v183
    v_mfma_f32_32x32x16_bf16 a[112:127], v[156:159], v[196:199], a[112:127]
    ds_read_b64_tr_b16 v[156:157], v234 offset:12288
    ds_read_b64_tr_b16 v[158:159], v234 offset:14336
    v_add_f32 v222, v222, v213
    v_cvt_pk_bf16_f32 v202, v212, v213
    v_exp_f32 v208, v184
    s_waitcnt lgkmcnt(15)
    v_mfma_f32_32x32x16_bf16 v[160:175], v[96:99], a[192:195], v[48:63]
    ds_read_b128 v[96:99], v223 offset:8192
    v_add_f32 v222, v222, v214
    v_exp_f32 v209, v185
    v_add_f32 v222, v222, v215
    v_cvt_pk_bf16_f32 v203, v214, v215
    v_mfma_f32_32x32x16_bf16 v[160:175], v[100:103], a[196:199], v[160:175]
    ds_read_b128 v[100:103], v224 offset:8192
    v_exp_f32 v210, v186
    v_add_f32 v222, v222, v208
    v_exp_f32 v211, v187
    v_mfma_f32_32x32x16_bf16 v[160:175], v[104:107], a[200:203], v[160:175]
    ds_read_b128 v[104:107], v225 offset:8192
    v_add_f32 v222, v222, v209
    v_cvt_pk_bf16_f32 v204, v208, v209
    v_exp_f32 v212, v188
    v_mfma_f32_32x32x16_bf16 v[160:175], v[108:111], a[204:207], v[160:175]
    ds_read_b128 v[108:111], v226 offset:8192
    buffer_store_dwordx4 v[16:19], v239, s[24:27], s97 offen offset:0 sc1 nt
    v_add_f32 v222, v222, v210
    v_exp_f32 v213, v189
    v_mfma_f32_32x32x16_bf16 v[160:175], v[112:115], a[208:211], v[160:175]
    ds_read_b128 v[112:115], v227 offset:8192
    v_add_f32 v222, v222, v211
    v_exp_f32 v214, v190
    v_add_f32 v222, v222, v212
    v_exp_f32 v215, v191
    v_mfma_f32_32x32x16_bf16 v[160:175], v[116:119], a[212:215], v[160:175]
    ds_read_b128 v[116:119], v228 offset:8192
    v_add_f32 v222, v222, v213
    v_add_f32 v222, v222, v214
    v_add_f32 v222, v222, v215
    v_subrev_u32 v253, s29, v222
    v_mfma_f32_32x32x16_bf16 v[160:175], v[120:123], a[216:219], v[160:175]
    ds_read_b128 v[120:123], v229 offset:8192
    buffer_store_dwordx4 v[20:23], v239, s[24:27], s97 offen offset:1024 sc1 nt
    v_cmp_lt_u32 vcc, s22, v253
    v_cvt_pk_bf16_f32 v205, v210, v211
    v_cvt_pk_bf16_f32 v206, v212, v213
    v_mfma_f32_32x32x16_bf16 v[160:175], v[124:127], a[220:223], v[160:175]
    ds_read_b128 v[124:127], v230 offset:8192
    v_cvt_pk_bf16_f32 v207, v214, v215
    s_cbranch_vccnz L_stub49
L_ret49:
    v_add_f32 v220, v220, v222
    v_add_u32 v231, s36, v231
    v_add_u32 v232, s36, v232
    v_add_u32 v233, s36, v233
    v_add_u32 v234, s36, v234
    s_waitcnt lgkmcnt(8)
    v_mfma_f32_32x32x16_bf16 a[64:79], v[128:131], v[200:203], a[64:79]
    ds_read_b64_tr_b16 v[128:129], v231 offset:0
    ds_read_b64_tr_b16 v[130:131], v231 offset:2048
    buffer_store_dwordx4 v[24:27], v239, s[24:27], s97 offen offset:2048 sc1 nt
    v_mfma_f32_32x32x16_bf16 a[80:95], v[136:139], v[200:203], a[80:95]
    ds_read_b64_tr_b16 v[136:137], v232 offset:0
    ds_read_b64_tr_b16 v[138:139], v232 offset:2048
    buffer_store_dwordx4 v[28:31], v239, s[24:27], s97 offen offset:3072 sc1 nt
    v_mfma_f32_32x32x16_bf16 a[96:111], v[144:147], v[200:203], a[96:111]
    ds_read_b64_tr_b16 v[144:145], v233 offset:0
    ds_read_b64_tr_b16 v[146:147], v233 offset:2048
    v_exp_f32 v208, v160
    v_exp_f32 v209, v161
    v_mfma_f32_32x32x16_bf16 a[112:127], v[152:155], v[200:203], a[112:127]
    ds_read_b64_tr_b16 v[152:153], v234 offset:0
    ds_read_b64_tr_b16 v[154:155], v234 offset:2048
    v_exp_f32 v210, v162
    v_mfma_f32_32x32x16_bf16 a[64:79], v[132:135], v[204:207], a[64:79]
    ds_read_b64_tr_b16 v[132:133], v231 offset:4096
    ds_read_b64_tr_b16 v[134:135], v231 offset:6144
    v_exp_f32 v211, v163
    v_add_f32 v222, v208, v209
    v_cvt_pk_bf16_f32 v192, v208, v209
    v_mfma_f32_32x32x16_bf16 a[80:95], v[140:143], v[204:207], a[80:95]
    ds_read_b64_tr_b16 v[140:141], v232 offset:4096
    ds_read_b64_tr_b16 v[142:143], v232 offset:6144
    v_exp_f32 v212, v164
    v_add_f32 v222, v222, v210
    v_mfma_f32_32x32x16_bf16 a[96:111], v[148:151], v[204:207], a[96:111]
    ds_read_b64_tr_b16 v[148:149], v233 offset:4096
    ds_read_b64_tr_b16 v[150:151], v233 offset:6144
    v_exp_f32 v213, v165
    v_add_f32 v222, v222, v211
    v_mfma_f32_32x32x16_bf16 a[112:127], v[156:159], v[204:207], a[112:127]
    ds_read_b64_tr_b16 v[156:157], v234 offset:4096
    ds_read_b64_tr_b16 v[158:159], v234 offset:6144
    v_cvt_pk_bf16_f32 v193, v210, v211
    v_exp_f32 v214, v166
    s_waitcnt lgkmcnt(15)
    v_mfma_f32_32x32x16_bf16 v[176:191], v[96:99], a[192:195], v[48:63]
    v_add_f32 v222, v222, v212
    v_exp_f32 v215, v167
    v_add_f32 v222, v222, v213
    v_cvt_pk_bf16_f32 v194, v212, v213
    v_mfma_f32_32x32x16_bf16 v[176:191], v[100:103], a[196:199], v[176:191]
    v_exp_f32 v208, v168
    v_add_f32 v222, v222, v214
    v_exp_f32 v209, v169
    v_add_f32 v222, v222, v215
    v_mfma_f32_32x32x16_bf16 v[176:191], v[104:107], a[200:203], v[176:191]
    v_cvt_pk_bf16_f32 v195, v214, v215
    v_exp_f32 v210, v170
    v_add_f32 v222, v222, v208
    v_mfma_f32_32x32x16_bf16 v[176:191], v[108:111], a[204:207], v[176:191]
    v_exp_f32 v211, v171
    v_add_f32 v222, v222, v209
    v_cvt_pk_bf16_f32 v196, v208, v209
    v_exp_f32 v212, v172
    v_mfma_f32_32x32x16_bf16 v[176:191], v[112:115], a[208:211], v[176:191]
    v_add_f32 v222, v222, v210
    v_exp_f32 v213, v173
    v_add_f32 v222, v222, v211
    v_exp_f32 v214, v174
    v_mfma_f32_32x32x16_bf16 v[176:191], v[116:119], a[212:215], v[176:191]
    v_add_f32 v222, v222, v212
    v_exp_f32 v215, v175
    v_add_f32 v222, v222, v213
    v_add_f32 v222, v222, v214
    v_mfma_f32_32x32x16_bf16 v[176:191], v[120:123], a[216:219], v[176:191]
    v_add_f32 v222, v222, v215
    v_subrev_u32 v253, s29, v222
    v_cmp_lt_u32 vcc, s22, v253
    v_cvt_pk_bf16_f32 v197, v210, v211
    v_cvt_pk_bf16_f32 v198, v212, v213
    v_mfma_f32_32x32x16_bf16 v[176:191], v[124:127], a[220:223], v[176:191]
    v_cvt_pk_bf16_f32 v199, v214, v215
    s_cbranch_vccnz L_stub50
L_ret50:
    v_add_f32 v220, v220, v222
    s_waitcnt lgkmcnt(0)
    v_mfma_f32_32x32x16_bf16 a[64:79], v[128:131], v[192:195], a[64:79]
    ds_read_b64_tr_b16 v[128:129], v231 offset:8192
    ds_read_b64_tr_b16 v[130:131], v231 offset:10240
    v_mfma_f32_32x32x16_bf16 a[80:95], v[136:139], v[192:195], a[80:95]
    ds_read_b64_tr_b16 v[136:137], v232 offset:8192
    ds_read_b64_tr_b16 v[138:139], v232 offset:10240
    v_mfma_f32_32x32x16_bf16 a[96:111], v[144:147], v[192:195], a[96:111]
    ds_read_b64_tr_b16 v[144:145], v233 offset:8192
    ds_read_b64_tr_b16 v[146:147], v233 offset:10240
    v_exp_f32 v208, v176
    v_exp_f32 v209, v177
    v_mfma_f32_32x32x16_bf16 a[112:127], v[152:155], v[192:195], a[112:127]
    ds_read_b64_tr_b16 v[152:153], v234 offset:8192
    ds_read_b64_tr_b16 v[154:155], v234 offset:10240
    v_exp_f32 v210, v178
    v_exp_f32 v211, v179
    v_mfma_f32_32x32x16_bf16 a[64:79], v[132:135], v[196:199], a[64:79]
    ds_read_b64_tr_b16 v[132:133], v231 offset:12288
    ds_read_b64_tr_b16 v[134:135], v231 offset:14336
    v_add_f32 v222, v208, v209
    v_cvt_pk_bf16_f32 v200, v208, v209
    v_exp_f32 v212, v180
    v_mfma_f32_32x32x16_bf16 a[80:95], v[140:143], v[196:199], a[80:95]
    ds_read_b64_tr_b16 v[140:141], v232 offset:12288
    ds_read_b64_tr_b16 v[142:143], v232 offset:14336
    v_add_f32 v222, v222, v210
    v_exp_f32 v213, v181
    v_add_f32 v222, v222, v211
    v_mfma_f32_32x32x16_bf16 a[96:111], v[148:151], v[196:199], a[96:111]
    ds_read_b64_tr_b16 v[148:149], v233 offset:12288
    ds_read_b64_tr_b16 v[150:151], v233 offset:14336
    v_cvt_pk_bf16_f32 v201, v210, v211
    v_exp_f32 v214, v182
    v_add_f32 v222, v222, v212
    v_mfma_f32_32x32x16_bf16 a[112:127], v[156:159], v[196:199], a[112:127]
    ds_read_b64_tr_b16 v[156:157], v234 offset:12288
    ds_read_b64_tr_b16 v[158:159], v234 offset:14336
    v_exp_f32 v215, v183
    v_add_f32 v222, v222, v213
    v_cvt_pk_bf16_f32 v202, v212, v213
    v_exp_f32 v208, v184
    v_add_f32 v222, v222, v214
    v_exp_f32 v209, v185
    v_add_f32 v222, v222, v215
    v_cvt_pk_bf16_f32 v203, v214, v215
    v_exp_f32 v210, v186
    v_add_f32 v222, v222, v208
    v_exp_f32 v211, v187
    v_add_f32 v222, v222, v209
    v_cvt_pk_bf16_f32 v204, v208, v209
    v_exp_f32 v212, v188
    v_add_f32 v222, v222, v210
    v_exp_f32 v213, v189
    v_add_f32 v222, v222, v211
    v_exp_f32 v214, v190
    v_add_f32 v222, v222, v212
    v_exp_f32 v215, v191
    v_add_f32 v222, v222, v213
    v_add_f32 v222, v222, v214
    v_add_f32 v222, v222, v215
    v_subrev_u32 v253, s29, v222
    v_cmp_lt_u32 vcc, s22, v253
    v_cvt_pk_bf16_f32 v205, v210, v211
    v_cvt_pk_bf16_f32 v206, v212, v213
    v_cvt_pk_bf16_f32 v207, v214, v215
    s_cbranch_vccnz L_stub51
L_ret51:
    v_add_f32 v220, v220, v222
    s_waitcnt lgkmcnt(0)
    v_mfma_f32_32x32x16_bf16 a[64:79], v[128:131], v[200:203], a[64:79]
    v_mfma_f32_32x32x16_bf16 a[80:95], v[136:139], v[200:203], a[80:95]
    v_mfma_f32_32x32x16_bf16 a[96:111], v[144:147], v[200:203], a[96:111]
    v_mfma_f32_32x32x16_bf16 a[112:127], v[152:155], v[200:203], a[112:127]
    v_mfma_f32_32x32x16_bf16 a[64:79], v[132:135], v[204:207], a[64:79]
    v_mfma_f32_32x32x16_bf16 a[80:95], v[140:143], v[204:207], a[80:95]
    v_mfma_f32_32x32x16_bf16 a[96:111], v[148:151], v[204:207], a[96:111]
    v_mfma_f32_32x32x16_bf16 a[112:127], v[156:159], v[204:207], a[112:127]
    s_waitcnt lgkmcnt(0)
    s_sub_u32 s45, s34, s55
    v_add_u32 v251, s45, v240
    v_xor_b32 v208, 0, v241
    v_lshl_add_u32 v208, v208, 4, v251
    v_xor_b32 v209, 2, v241
    v_lshl_add_u32 v209, v209, 4, v251
    v_xor_b32 v210, 4, v241
    v_lshl_add_u32 v210, v210, 4, v251
    v_xor_b32 v211, 6, v241
    v_lshl_add_u32 v211, v211, 4, v251
    v_xor_b32 v212, 8, v241
    v_lshl_add_u32 v212, v212, 4, v251
    v_xor_b32 v213, 10, v241
    v_lshl_add_u32 v213, v213, 4, v251
    v_xor_b32 v214, 12, v241
    v_lshl_add_u32 v214, v214, 4, v251
    v_xor_b32 v215, 14, v241
    v_lshl_add_u32 v215, v215, 4, v251
    v_mov_b32 v242, v220
    v_mov_b32 v243, v220
    s_nop 1
    v_permlane32_swap_b32 v242, v243
    s_nop 1
    v_add_f32 v244, v242, v243
    v_rcp_f32 v244, v244
    s_nop 0
    v_mov_b32 v245, v244
    v_accvgpr_read_b32 v160, a64
    v_accvgpr_read_b32 v161, a65
    v_accvgpr_read_b32 v162, a66
    v_accvgpr_read_b32 v163, a67
    v_accvgpr_read_b32 v164, a68
    v_accvgpr_read_b32 v165, a69
    v_accvgpr_read_b32 v166, a70
    v_accvgpr_read_b32 v167, a71
    v_pk_mul_f32 v[160:161], v[160:161], v[244:245]
    v_pk_mul_f32 v[162:163], v[162:163], v[244:245]
    v_pk_mul_f32 v[164:165], v[164:165], v[244:245]
    v_pk_mul_f32 v[166:167], v[166:167], v[244:245]
    v_cvt_pk_bf16_f32 v168, v160, v161
    v_cvt_pk_bf16_f32 v169, v162, v163
    v_cvt_pk_bf16_f32 v170, v164, v165
    v_cvt_pk_bf16_f32 v171, v166, v167
    s_nop 0
    v_permlane32_swap_b32 v168, v170
    v_permlane32_swap_b32 v169, v171
    ds_write_b128 v208, v[168:171] offset:0
    v_accvgpr_read_b32 v172, a72
    v_accvgpr_read_b32 v173, a73
    v_accvgpr_read_b32 v174, a74
    v_accvgpr_read_b32 v175, a75
    v_accvgpr_read_b32 v176, a76
    v_accvgpr_read_b32 v177, a77
    v_accvgpr_read_b32 v178, a78
    v_accvgpr_read_b32 v179, a79
    v_pk_mul_f32 v[172:173], v[172:173], v[244:245]
    v_pk_mul_f32 v[174:175], v[174:175], v[244:245]
    v_pk_mul_f32 v[176:177], v[176:177], v[244:245]
    v_pk_mul_f32 v[178:179], v[178:179], v[244:245]
    v_cvt_pk_bf16_f32 v180, v172, v173
    v_cvt_pk_bf16_f32 v181, v174, v175
    v_cvt_pk_bf16_f32 v182, v176, v177
    v_cvt_pk_bf16_f32 v183, v178, v179
    s_nop 0
    v_permlane32_swap_b32 v180, v182
    v_permlane32_swap_b32 v181, v183
    ds_write_b128 v209, v[180:183] offset:0
    v_accvgpr_read_b32 v184, a80
    v_accvgpr_read_b32 v185, a81
    v_accvgpr_read_b32 v186, a82
    v_accvgpr_read_b32 v187, a83
    v_accvgpr_read_b32 v188, a84
    v_accvgpr_read_b32 v189, a85
    v_accvgpr_read_b32 v190, a86
    v_accvgpr_read_b32 v191, a87
    v_pk_mul_f32 v[184:185], v[184:185], v[244:245]
    v_pk_mul_f32 v[186:187], v[186:187], v[244:245]
    v_pk_mul_f32 v[188:189], v[188:189], v[244:245]
    v_pk_mul_f32 v[190:191], v[190:191], v[244:245]
    v_cvt_pk_bf16_f32 v192, v184, v185
    v_cvt_pk_bf16_f32 v193, v186, v187
    v_cvt_pk_bf16_f32 v194, v188, v189
    v_cvt_pk_bf16_f32 v195, v190, v191
    s_nop 0
    v_permlane32_swap_b32 v192, v194
    v_permlane32_swap_b32 v193, v195
    ds_write_b128 v210, v[192:195] offset:0
    v_accvgpr_read_b32 v196, a88
    v_accvgpr_read_b32 v197, a89
    v_accvgpr_read_b32 v198, a90
    v_accvgpr_read_b32 v199, a91
    v_accvgpr_read_b32 v200, a92
    v_accvgpr_read_b32 v201, a93
    v_accvgpr_read_b32 v202, a94
    v_accvgpr_read_b32 v203, a95
    v_pk_mul_f32 v[196:197], v[196:197], v[244:245]
    v_pk_mul_f32 v[198:199], v[198:199], v[244:245]
    v_pk_mul_f32 v[200:201], v[200:201], v[244:245]
    v_pk_mul_f32 v[202:203], v[202:203], v[244:245]
    v_cvt_pk_bf16_f32 v204, v196, v197
    v_cvt_pk_bf16_f32 v205, v198, v199
    v_cvt_pk_bf16_f32 v206, v200, v201
    v_cvt_pk_bf16_f32 v207, v202, v203
    s_nop 0
    v_permlane32_swap_b32 v204, v206
    v_permlane32_swap_b32 v205, v207
    ds_write_b128 v211, v[204:207] offset:0
    v_accvgpr_read_b32 v160, a96
    v_accvgpr_read_b32 v161, a97
    v_accvgpr_read_b32 v162, a98
    v_accvgpr_read_b32 v163, a99
    v_accvgpr_read_b32 v164, a100
    v_accvgpr_read_b32 v165, a101
    v_accvgpr_read_b32 v166, a102
    v_accvgpr_read_b32 v167, a103
    v_pk_mul_f32 v[160:161], v[160:161], v[244:245]
    v_pk_mul_f32 v[162:163], v[162:163], v[244:245]
    v_pk_mul_f32 v[164:165], v[164:165], v[244:245]
    v_pk_mul_f32 v[166:167], v[166:167], v[244:245]
    v_cvt_pk_bf16_f32 v168, v160, v161
    v_cvt_pk_bf16_f32 v169, v162, v163
    v_cvt_pk_bf16_f32 v170, v164, v165
    v_cvt_pk_bf16_f32 v171, v166, v167
    s_nop 0
    v_permlane32_swap_b32 v168, v170
    v_permlane32_swap_b32 v169, v171
    ds_write_b128 v212, v[168:171] offset:0
    v_accvgpr_read_b32 v172, a104
    v_accvgpr_read_b32 v173, a105
    v_accvgpr_read_b32 v174, a106
    v_accvgpr_read_b32 v175, a107
    v_accvgpr_read_b32 v176, a108
    v_accvgpr_read_b32 v177, a109
    v_accvgpr_read_b32 v178, a110
    v_accvgpr_read_b32 v179, a111
    v_pk_mul_f32 v[172:173], v[172:173], v[244:245]
    v_pk_mul_f32 v[174:175], v[174:175], v[244:245]
    v_pk_mul_f32 v[176:177], v[176:177], v[244:245]
    v_pk_mul_f32 v[178:179], v[178:179], v[244:245]
    v_cvt_pk_bf16_f32 v180, v172, v173
    v_cvt_pk_bf16_f32 v181, v174, v175
    v_cvt_pk_bf16_f32 v182, v176, v177
    v_cvt_pk_bf16_f32 v183, v178, v179
    s_nop 0
    v_permlane32_swap_b32 v180, v182
    v_permlane32_swap_b32 v181, v183
    ds_write_b128 v213, v[180:183] offset:0
    v_accvgpr_read_b32 v184, a112
    v_accvgpr_read_b32 v185, a113
    v_accvgpr_read_b32 v186, a114
    v_accvgpr_read_b32 v187, a115
    v_accvgpr_read_b32 v188, a116
    v_accvgpr_read_b32 v189, a117
    v_accvgpr_read_b32 v190, a118
    v_accvgpr_read_b32 v191, a119
    v_pk_mul_f32 v[184:185], v[184:185], v[244:245]
    v_pk_mul_f32 v[186:187], v[186:187], v[244:245]
    v_pk_mul_f32 v[188:189], v[188:189], v[244:245]
    v_pk_mul_f32 v[190:191], v[190:191], v[244:245]
    v_cvt_pk_bf16_f32 v192, v184, v185
    v_cvt_pk_bf16_f32 v193, v186, v187
    v_cvt_pk_bf16_f32 v194, v188, v189
    v_cvt_pk_bf16_f32 v195, v190, v191
    s_nop 0
    v_permlane32_swap_b32 v192, v194
    v_permlane32_swap_b32 v193, v195
    ds_write_b128 v214, v[192:195] offset:0
    v_accvgpr_read_b32 v196, a120
    v_accvgpr_read_b32 v197, a121
    v_accvgpr_read_b32 v198, a122
    v_accvgpr_read_b32 v199, a123
    v_accvgpr_read_b32 v200, a124
    v_accvgpr_read_b32 v201, a125
    v_accvgpr_read_b32 v202, a126
    v_accvgpr_read_b32 v203, a127
    v_pk_mul_f32 v[196:197], v[196:197], v[244:245]
    v_pk_mul_f32 v[198:199], v[198:199], v[244:245]
    v_pk_mul_f32 v[200:201], v[200:201], v[244:245]
    v_pk_mul_f32 v[202:203], v[202:203], v[244:245]
    v_cvt_pk_bf16_f32 v204, v196, v197
    v_cvt_pk_bf16_f32 v205, v198, v199
    v_cvt_pk_bf16_f32 v206, v200, v201
    v_cvt_pk_bf16_f32 v207, v202, v203
    s_nop 0
    v_permlane32_swap_b32 v204, v206
    v_permlane32_swap_b32 v205, v207
    ds_write_b128 v215, v[204:207] offset:0
    v_add_u32 v250, s34, v255
    s_waitcnt lgkmcnt(0)
    ds_read_b128 v[128:131], v250 offset:0
    ds_read_b128 v[132:135], v250 offset:1024
    ds_read_b128 v[136:139], v250 offset:2048
    ds_read_b128 v[140:143], v250 offset:3072
    ds_read_b128 v[144:147], v250 offset:16384
    ds_read_b128 v[148:151], v250 offset:17408
    ds_read_b128 v[152:155], v250 offset:18432
    ds_read_b128 v[156:159], v250 offset:19456
    s_add_u32 s98, s39, 8192
    s_add_u32 s99, s39, 12288
    s_waitcnt lgkmcnt(7)
    buffer_store_dwordx4 v[128:131], v235, s[24:27], s98 offen offset:0 sc1 nt
    s_waitcnt lgkmcnt(6)
    buffer_store_dwordx4 v[132:135], v236, s[24:27], s98 offen offset:1024 sc1 nt
    s_waitcnt lgkmcnt(5)
    buffer_store_dwordx4 v[136:139], v237, s[24:27], s98 offen offset:2048 sc1 nt
    s_waitcnt lgkmcnt(4)
    buffer_store_dwordx4 v[140:143], v238, s[24:27], s98 offen offset:3072 sc1 nt
    s_waitcnt lgkmcnt(3)
    buffer_store_dwordx4 v[144:147], v239, s[24:27], s99 offen offset:0 sc1 nt
    s_waitcnt lgkmcnt(2)
    buffer_store_dwordx4 v[148:151], v239, s[24:27], s99 offen offset:1024 sc1 nt
    s_waitcnt lgkmcnt(1)
    buffer_store_dwordx4 v[152:155], v239, s[24:27], s99 offen offset:2048 sc1 nt
    s_waitcnt lgkmcnt(0)
    buffer_store_dwordx4 v[156:159], v239, s[24:27], s99 offen offset:3072 sc1 nt
    s_branch L_fin
L_fin:
L_done:
    s_endpgm
L_bw1:
    s_waitcnt vmcnt(8)
    s_branch L_bwr2
L_sp3:
    s_cmp_lg_u32 s32, 3
    s_cbranch_scc1 L_c5
    s_mov_b32 s33, s20
    s_mov_b64 s[12:13], s[4:5]
    s_mov_b64 s[16:17], s[4:5]
    s_mov_b32 s14, 37748736
    s_mov_b32 s18, 37748736
    s_mov_b32 s20, s48
    s_add_u32 s21, s48, 4096
    s_branch L_spr4
L_c5:
    s_cmp_lg_u32 s32, 4
    s_cbranch_scc1 L_c6
    s_mov_b64 s[12:13], s[4:5]
    s_mov_b64 s[16:17], s[4:5]
    s_mov_b32 s14, 37748736
    s_mov_b32 s18, 37748736
    s_mov_b32 s20, s49
    s_add_u32 s21, s49, 4096
    s_branch L_spr4
L_c6:
    s_cmp_lg_u32 s32, 5
    s_cbranch_scc1 L_c7
    s_mov_b64 s[12:13], s[6:7]
    s_mov_b64 s[16:17], s[8:9]
    s_mov_b32 s14, 262144
    s_mov_b32 s18, 262144
    s_mov_b32 s20, s33
    s_mov_b32 s21, s33
    s_branch L_spr4
L_c7:
    s_cmp_lg_u32 s32, 2
    s_cbranch_scc1 L_c8
    s_mov_b32 s29, 0
    s_mov_b32 s22, s56
    s_branch L_spr4
L_c8:
    s_cmp_lg_u32 s32, 10
    s_cbranch_scc1 L_c9
    s_mov_b32 s29, 0
    s_mov_b32 s22, s56
    v_add_u32 v252, s42, v255
    ds_read_b128 v[80:83], v252 offset:0
    ds_read_b128 v[84:87], v252 offset:1024
    ds_read_b128 v[88:91], v252 offset:2048
    ds_read_b128 v[92:95], v252 offset:3072
    s_branch L_spr4
L_c9:
    v_add_u32 v252, s42, v255
    ds_read_b128 v[80:83], v252 offset:0
    ds_read_b128 v[84:87], v252 offset:1024
    ds_read_b128 v[88:91], v252 offset:2048
    ds_read_b128 v[92:95], v252 offset:3072
    s_branch L_spr4
L_ex10:
    s_cmp_lt_u32 s32, 2
    s_cbranch_scc1 L_c12
    s_waitcnt lgkmcnt(0)
    s_bitcmp1_b32 s61, 0
    s_cbranch_scc1 L_do13
    buffer_store_dwordx4 v[80:83], v235, s[24:27], s53 offen offset:0 sc1 nt
    buffer_store_dwordx4 v[84:87], v236, s[24:27], s53 offen offset:1024 sc1 nt
    buffer_store_dwordx4 v[88:91], v237, s[24:27], s53 offen offset:2048 sc1 nt
    buffer_store_dwordx4 v[92:95], v238, s[24:27], s53 offen offset:3072 sc1 nt
    s_add_u32 s42, s42, 16384
    s_add_u32 s53, s53, 4096
    s_add_u32 s61, s61, 1
    s_branch L_exr11
L_do13:
    buffer_store_dwordx4 v[80:83], v239, s[24:27], s53 offen offset:0 sc1 nt
    buffer_store_dwordx4 v[84:87], v239, s[24:27], s53 offen offset:1024 sc1 nt
    buffer_store_dwordx4 v[88:91], v239, s[24:27], s53 offen offset:2048 sc1 nt
    buffer_store_dwordx4 v[92:95], v239, s[24:27], s53 offen offset:3072 sc1 nt
    s_mov_b32 s42, s62
    s_add_u32 s53, s53, 4096
    s_add_u32 s61, s61, 1
    s_branch L_exr11
L_c12:
    s_mov_b32 m0, s34
    s_nop 0
    buffer_load_dwordx4 v235, s[12:15], s20 offen offset:0 nt lds
    buffer_load_dwordx4 v236, s[12:15], s20 offen offset:1024 nt lds
    buffer_load_dwordx4 v237, s[12:15], s20 offen offset:2048 nt lds
    buffer_load_dwordx4 v238, s[12:15], s20 offen offset:3072 nt lds
    s_add_u32 m0, s34, 16384
    s_nop 0
    buffer_load_dwordx4 v239, s[16:19], s21 offen offset:0 nt lds
    buffer_load_dwordx4 v239, s[16:19], s21 offen offset:1024 nt lds
    buffer_load_dwordx4 v239, s[16:19], s21 offen offset:2048 nt lds
    buffer_load_dwordx4 v239, s[16:19], s21 offen offset:3072 nt lds
    s_add_u32 s34, s34, 32768
    s_cmp_ge_u32 s34, s40
    s_cselect_b32 s60, s41, 0
    s_sub_u32 s34, s34, s60
    s_add_u32 s20, s20, 16384
    s_add_u32 s21, s21, 16384
    s_branch L_exr11
L_bw14:
    s_waitcnt vmcnt(8)
    s_branch L_bwr15
L_sp16:
    s_cmp_lg_u32 s32, 3
    s_cbranch_scc1 L_c18
    s_mov_b32 s33, s20
    s_mov_b64 s[12:13], s[4:5]
    s_mov_b64 s[16:17], s[4:5]
    s_mov_b32 s14, 37748736
    s_mov_b32 s18, 37748736
    s_mov_b32 s20, s48
    s_add_u32 s21, s48, 4096
    s_branch L_spr17
L_c18:
    s_cmp_lg_u32 s32, 4
    s_cbranch_scc1 L_c19
    s_mov_b64 s[12:13], s[4:5]
    s_mov_b64 s[16:17], s[4:5]
    s_mov_b32 s14, 37748736
    s_mov_b32 s18, 37748736
    s_mov_b32 s20, s49
    s_add_u32 s21, s49, 4096
    s_branch L_spr17
L_c19:
    s_cmp_lg_u32 s32, 5
    s_cbranch_scc1 L_c20
    s_mov_b64 s[12:13], s[6:7]
    s_mov_b64 s[16:17], s[8:9]
    s_mov_b32 s14, 262144
    s_mov_b32 s18, 262144
    s_mov_b32 s20, s33
    s_mov_b32 s21, s33
    s_branch L_spr17
L_c20:
    s_cmp_lg_u32 s32, 2
    s_cbranch_scc1 L_c21
    s_mov_b32 s29, 0
    s_mov_b32 s22, s56
    s_branch L_spr17
L_c21:
    s_cmp_lg_u32 s32, 10
    s_cbranch_scc1 L_c22
    s_mov_b32 s29, 0
    s_mov_b32 s22, s56
    v_add_u32 v252, s42, v255
    ds_read_b128 v[80:83], v252 offset:0
    ds_read_b128 v[84:87], v252 offset:1024
    ds_read_b128 v[88:91], v252 offset:2048
    ds_read_b128 v[92:95], v252 offset:3072
    s_branch L_spr17
L_c22:
    v_add_u32 v252, s42, v255
    ds_read_b128 v[80:83], v252 offset:0
    ds_read_b128 v[84:87], v252 offset:1024
    ds_read_b128 v[88:91], v252 offset:2048
    ds_read_b128 v[92:95], v252 offset:3072
    s_branch L_spr17
L_ex23:
    s_cmp_lt_u32 s32, 2
    s_cbranch_scc1 L_c25
    s_waitcnt lgkmcnt(0)
    s_bitcmp1_b32 s61, 0
    s_cbranch_scc1 L_do26
    buffer_store_dwordx4 v[80:83], v235, s[24:27], s53 offen offset:0 sc1 nt
    buffer_store_dwordx4 v[84:87], v236, s[24:27], s53 offen offset:1024 sc1 nt
    buffer_store_dwordx4 v[88:91], v237, s[24:27], s53 offen offset:2048 sc1 nt
    buffer_store_dwordx4 v[92:95], v238, s[24:27], s53 offen offset:3072 sc1 nt
    s_add_u32 s42, s42, 16384
    s_add_u32 s53, s53, 4096
    s_add_u32 s61, s61, 1
    s_branch L_exr24
L_do26:
    buffer_store_dwordx4 v[80:83], v239, s[24:27], s53 offen offset:0 sc1 nt
    buffer_store_dwordx4 v[84:87], v239, s[24:27], s53 offen offset:1024 sc1 nt
    buffer_store_dwordx4 v[88:91], v239, s[24:27], s53 offen offset:2048 sc1 nt
    buffer_store_dwordx4 v[92:95], v239, s[24:27], s53 offen offset:3072 sc1 nt
    s_mov_b32 s42, s62
    s_add_u32 s53, s53, 4096
    s_add_u32 s61, s61, 1
    s_branch L_exr24
L_c25:
    s_mov_b32 m0, s34
    s_nop 0
    buffer_load_dwordx4 v235, s[12:15], s20 offen offset:0 nt lds
    buffer_load_dwordx4 v236, s[12:15], s20 offen offset:1024 nt lds
    buffer_load_dwordx4 v237, s[12:15], s20 offen offset:2048 nt lds
    buffer_load_dwordx4 v238, s[12:15], s20 offen offset:3072 nt lds
    s_add_u32 m0, s34, 16384
    s_nop 0
    buffer_load_dwordx4 v239, s[16:19], s21 offen offset:0 nt lds
    buffer_load_dwordx4 v239, s[16:19], s21 offen offset:1024 nt lds
    buffer_load_dwordx4 v239, s[16:19], s21 offen offset:2048 nt lds
    buffer_load_dwordx4 v239, s[16:19], s21 offen offset:3072 nt lds
    s_add_u32 s34, s34, 32768
    s_cmp_ge_u32 s34, s40
    s_cselect_b32 s60, s41, 0
    s_sub_u32 s34, s34, s60
    s_add_u32 s20, s20, 16384
    s_add_u32 s21, s21, 16384
    s_branch L_exr24
L_bw27:
    s_waitcnt vmcnt(8)
    s_branch L_bwr28
L_sp29:
    s_cmp_lg_u32 s32, 3
    s_cbranch_scc1 L_c31
    s_mov_b32 s33, s20
    s_mov_b64 s[12:13], s[4:5]
    s_mov_b64 s[16:17], s[4:5]
    s_mov_b32 s14, 37748736
    s_mov_b32 s18, 37748736
    s_mov_b32 s20, s48
    s_add_u32 s21, s48, 4096
    s_branch L_spr30
L_c31:
    s_cmp_lg_u32 s32, 4
    s_cbranch_scc1 L_c32
    s_mov_b64 s[12:13], s[4:5]
    s_mov_b64 s[16:17], s[4:5]
    s_mov_b32 s14, 37748736
    s_mov_b32 s18, 37748736
    s_mov_b32 s20, s49
    s_add_u32 s21, s49, 4096
    s_branch L_spr30
L_c32:
    s_cmp_lg_u32 s32, 5
    s_cbranch_scc1 L_c33
    s_mov_b64 s[12:13], s[6:7]
    s_mov_b64 s[16:17], s[8:9]
    s_mov_b32 s14, 262144
    s_mov_b32 s18, 262144
    s_mov_b32 s20, s33
    s_mov_b32 s21, s33
    s_branch L_spr30
L_c33:
    s_cmp_lg_u32 s32, 2
    s_cbranch_scc1 L_c34
    s_mov_b32 s29, 0
    s_mov_b32 s22, s56
    s_branch L_spr30
L_c34:
    s_cmp_lg_u32 s32, 10
    s_cbranch_scc1 L_c35
    s_mov_b32 s29, 0
    s_mov_b32 s22, s56
    v_add_u32 v252, s42, v255
    ds_read_b128 v[80:83], v252 offset:0
    ds_read_b128 v[84:87], v252 offset:1024
    ds_read_b128 v[88:91], v252 offset:2048
    ds_read_b128 v[92:95], v252 offset:3072
    s_branch L_spr30
L_c35:
    v_add_u32 v252, s42, v255
    ds_read_b128 v[80:83], v252 offset:0
    ds_read_b128 v[84:87], v252 offset:1024
    ds_read_b128 v[88:91], v252 offset:2048
    ds_read_b128 v[92:95], v252 offset:3072
    s_branch L_spr30
L_ex36:
    s_cmp_lt_u32 s32, 2
    s_cbranch_scc1 L_c38
    s_waitcnt lgkmcnt(0)
    s_bitcmp1_b32 s61, 0
    s_cbranch_scc1 L_do39
    buffer_store_dwordx4 v[80:83], v235, s[24:27], s53 offen offset:0 sc1 nt
    buffer_store_dwordx4 v[84:87], v236, s[24:27], s53 offen offset:1024 sc1 nt
    buffer_store_dwordx4 v[88:91], v237, s[24:27], s53 offen offset:2048 sc1 nt
    buffer_store_dwordx4 v[92:95], v238, s[24:27], s53 offen offset:3072 sc1 nt
    s_add_u32 s42, s42, 16384
    s_add_u32 s53, s53, 4096
    s_add_u32 s61, s61, 1
    s_branch L_exr37
L_do39:
    buffer_store_dwordx4 v[80:83], v239, s[24:27], s53 offen offset:0 sc1 nt
    buffer_store_dwordx4 v[84:87], v239, s[24:27], s53 offen offset:1024 sc1 nt
    buffer_store_dwordx4 v[88:91], v239, s[24:27], s53 offen offset:2048 sc1 nt
    buffer_store_dwordx4 v[92:95], v239, s[24:27], s53 offen offset:3072 sc1 nt
    s_mov_b32 s42, s62
    s_add_u32 s53, s53, 4096
    s_add_u32 s61, s61, 1
    s_branch L_exr37
L_c38:
    s_mov_b32 m0, s34
    s_nop 0
    buffer_load_dwordx4 v235, s[12:15], s20 offen offset:0 nt lds
    buffer_load_dwordx4 v236, s[12:15], s20 offen offset:1024 nt lds
    buffer_load_dwordx4 v237, s[12:15], s20 offen offset:2048 nt lds
    buffer_load_dwordx4 v238, s[12:15], s20 offen offset:3072 nt lds
    s_add_u32 m0, s34, 16384
    s_nop 0
    buffer_load_dwordx4 v239, s[16:19], s21 offen offset:0 nt lds
    buffer_load_dwordx4 v239, s[16:19], s21 offen offset:1024 nt lds
    buffer_load_dwordx4 v239, s[16:19], s21 offen offset:2048 nt lds
    buffer_load_dwordx4 v239, s[16:19], s21 offen offset:3072 nt lds
    s_add_u32 s34, s34, 32768
    s_cmp_ge_u32 s34, s40
    s_cselect_b32 s60, s41, 0
    s_sub_u32 s34, s34, s60
    s_add_u32 s20, s20, 16384
    s_add_u32 s21, s21, 16384
    s_branch L_exr37
L_bw40:
    s_waitcnt vmcnt(8)
    s_branch L_bwr41
L_sp42:
    s_cmp_lg_u32 s32, 3
    s_cbranch_scc1 L_c44
    s_mov_b32 s33, s20
    s_mov_b64 s[12:13], s[4:5]
    s_mov_b64 s[16:17], s[4:5]
    s_mov_b32 s14, 37748736
    s_mov_b32 s18, 37748736
    s_mov_b32 s20, s48
    s_add_u32 s21, s48, 4096
    s_branch L_spr43
L_c44:
    s_cmp_lg_u32 s32, 4
    s_cbranch_scc1 L_c45
    s_mov_b64 s[12:13], s[4:5]
    s_mov_b64 s[16:17], s[4:5]
    s_mov_b32 s14, 37748736
    s_mov_b32 s18, 37748736
    s_mov_b32 s20, s49
    s_add_u32 s21, s49, 4096
    s_branch L_spr43
L_c45:
    s_cmp_lg_u32 s32, 5
    s_cbranch_scc1 L_c46
    s_mov_b64 s[12:13], s[6:7]
    s_mov_b64 s[16:17], s[8:9]
    s_mov_b32 s14, 262144
    s_mov_b32 s18, 262144
    s_mov_b32 s20, s33
    s_mov_b32 s21, s33
    s_branch L_spr43
L_c46:
    s_cmp_lg_u32 s32, 2
    s_cbranch_scc1 L_c47
    s_mov_b32 s29, 0
    s_mov_b32 s22, s56
    s_branch L_spr43
L_c47:
    s_cmp_lg_u32 s32, 10
    s_cbranch_scc1 L_c48
    s_mov_b32 s29, 0
    s_mov_b32 s22, s56
    v_add_u32 v252, s42, v255
    ds_read_b128 v[80:83], v252 offset:0
    ds_read_b128 v[84:87], v252 offset:1024
    ds_read_b128 v[88:91], v252 offset:2048
    ds_read_b128 v[92:95], v252 offset:3072
    s_branch L_spr43
L_c48:
    v_add_u32 v252, s42, v255
    ds_read_b128 v[80:83], v252 offset:0
    ds_read_b128 v[84:87], v252 offset:1024
    ds_read_b128 v[88:91], v252 offset:2048
    ds_read_b128 v[92:95], v252 offset:3072
    s_branch L_spr43
L_ex49:
    s_cmp_lt_u32 s32, 2
    s_cbranch_scc1 L_c51
    s_waitcnt lgkmcnt(0)
    s_bitcmp1_b32 s61, 0
    s_cbranch_scc1 L_do52
    buffer_store_dwordx4 v[80:83], v235, s[24:27], s53 offen offset:0 sc1 nt
    buffer_store_dwordx4 v[84:87], v236, s[24:27], s53 offen offset:1024 sc1 nt
    buffer_store_dwordx4 v[88:91], v237, s[24:27], s53 offen offset:2048 sc1 nt
    buffer_store_dwordx4 v[92:95], v238, s[24:27], s53 offen offset:3072 sc1 nt
    s_add_u32 s42, s42, 16384
    s_add_u32 s53, s53, 4096
    s_add_u32 s61, s61, 1
    s_branch L_exr50
L_do52:
    buffer_store_dwordx4 v[80:83], v239, s[24:27], s53 offen offset:0 sc1 nt
    buffer_store_dwordx4 v[84:87], v239, s[24:27], s53 offen offset:1024 sc1 nt
    buffer_store_dwordx4 v[88:91], v239, s[24:27], s53 offen offset:2048 sc1 nt
    buffer_store_dwordx4 v[92:95], v239, s[24:27], s53 offen offset:3072 sc1 nt
    s_mov_b32 s42, s62
    s_add_u32 s53, s53, 4096
    s_add_u32 s61, s61, 1
    s_branch L_exr50
L_c51:
    s_mov_b32 m0, s34
    s_nop 0
    buffer_load_dwordx4 v235, s[12:15], s20 offen offset:0 nt lds
    buffer_load_dwordx4 v236, s[12:15], s20 offen offset:1024 nt lds
    buffer_load_dwordx4 v237, s[12:15], s20 offen offset:2048 nt lds
    buffer_load_dwordx4 v238, s[12:15], s20 offen offset:3072 nt lds
    s_add_u32 m0, s34, 16384
    s_nop 0
    buffer_load_dwordx4 v239, s[16:19], s21 offen offset:0 nt lds
    buffer_load_dwordx4 v239, s[16:19], s21 offen offset:1024 nt lds
    buffer_load_dwordx4 v239, s[16:19], s21 offen offset:2048 nt lds
    buffer_load_dwordx4 v239, s[16:19], s21 offen offset:3072 nt lds
    s_add_u32 s34, s34, 32768
    s_cmp_ge_u32 s34, s40
    s_cselect_b32 s60, s41, 0
    s_sub_u32 s34, s34, s60
    s_add_u32 s20, s20, 16384
    s_add_u32 s21, s21, 16384
    s_branch L_exr50
L_bw53:
    s_waitcnt vmcnt(8)
    s_branch L_bwr54
L_sp55:
    s_cmp_lg_u32 s32, 3
    s_cbranch_scc1 L_c57
    s_mov_b32 s33, s20
    s_mov_b64 s[12:13], s[4:5]
    s_mov_b64 s[16:17], s[4:5]
    s_mov_b32 s14, 37748736
    s_mov_b32 s18, 37748736
    s_mov_b32 s20, s48
    s_add_u32 s21, s48, 4096
    s_branch L_spr56
L_c57:
    s_cmp_lg_u32 s32, 4
    s_cbranch_scc1 L_c58
    s_mov_b64 s[12:13], s[4:5]
    s_mov_b64 s[16:17], s[4:5]
    s_mov_b32 s14, 37748736
    s_mov_b32 s18, 37748736
    s_mov_b32 s20, s49
    s_add_u32 s21, s49, 4096
    s_branch L_spr56
L_c58:
    s_cmp_lg_u32 s32, 5
    s_cbranch_scc1 L_c59
    s_mov_b64 s[12:13], s[4:5]
    s_mov_b64 s[16:17], s[4:5]
    s_mov_b32 s14, 37748736
    s_mov_b32 s18, 37748736
    s_mov_b32 s20, s50
    s_add_u32 s21, s50, 4096
    s_branch L_spr56
L_c59:
    s_cmp_lg_u32 s32, 6
    s_cbranch_scc1 L_c60
    s_mov_b64 s[12:13], s[6:7]
    s_mov_b64 s[16:17], s[8:9]
    s_mov_b32 s14, 262144
    s_mov_b32 s18, 262144
    s_mov_b32 s20, s33
    s_mov_b32 s21, s33
    s_branch L_spr56
L_c60:
    s_cmp_lg_u32 s32, 2
    s_cbranch_scc1 L_c61
    s_mov_b32 s29, 0
    s_mov_b32 s22, s56
    s_branch L_spr56
L_c61:
    s_cmp_lg_u32 s32, 10
    s_cbranch_scc1 L_c62
    s_mov_b32 s29, 0
    s_mov_b32 s22, s56
    v_add_u32 v252, s42, v255
    ds_read_b128 v[80:83], v252 offset:0
    ds_read_b128 v[84:87], v252 offset:1024
    ds_read_b128 v[88:91], v252 offset:2048
    ds_read_b128 v[92:95], v252 offset:3072
    s_branch L_spr56
L_c62:
    v_add_u32 v252, s42, v255
    ds_read_b128 v[80:83], v252 offset:0
    ds_read_b128 v[84:87], v252 offset:1024
    ds_read_b128 v[88:91], v252 offset:2048
    ds_read_b128 v[92:95], v252 offset:3072
    s_branch L_spr56
L_ex63:
    s_cmp_lt_u32 s32, 2
    s_cbranch_scc1 L_c65
    s_waitcnt lgkmcnt(0)
    s_bitcmp1_b32 s61, 0
    s_cbranch_scc1 L_do66
    buffer_store_dwordx4 v[80:83], v235, s[24:27], s53 offen offset:0 sc1 nt
    buffer_store_dwordx4 v[84:87], v236, s[24:27], s53 offen offset:1024 sc1 nt
    buffer_store_dwordx4 v[88:91], v237, s[24:27], s53 offen offset:2048 sc1 nt
    buffer_store_dwordx4 v[92:95], v238, s[24:27], s53 offen offset:3072 sc1 nt
    s_add_u32 s42, s42, 16384
    s_add_u32 s53, s53, 4096
    s_add_u32 s61, s61, 1
    s_branch L_exr64
L_do66:
    buffer_store_dwordx4 v[80:83], v239, s[24:27], s53 offen offset:0 sc1 nt
    buffer_store_dwordx4 v[84:87], v239, s[24:27], s53 offen offset:1024 sc1 nt
    buffer_store_dwordx4 v[88:91], v239, s[24:27], s53 offen offset:2048 sc1 nt
    buffer_store_dwordx4 v[92:95], v239, s[24:27], s53 offen offset:3072 sc1 nt
    s_mov_b32 s42, s62
    s_add_u32 s53, s53, 4096
    s_add_u32 s61, s61, 1
    s_branch L_exr64
L_c65:
    s_mov_b32 m0, s34
    s_nop 0
    buffer_load_dwordx4 v235, s[12:15], s20 offen offset:0 nt lds
    buffer_load_dwordx4 v236, s[12:15], s20 offen offset:1024 nt lds
    buffer_load_dwordx4 v237, s[12:15], s20 offen offset:2048 nt lds
    buffer_load_dwordx4 v238, s[12:15], s20 offen offset:3072 nt lds
    s_add_u32 m0, s34, 16384
    s_nop 0
    buffer_load_dwordx4 v239, s[16:19], s21 offen offset:0 nt lds
    buffer_load_dwordx4 v239, s[16:19], s21 offen offset:1024 nt lds
    buffer_load_dwordx4 v239, s[16:19], s21 offen offset:2048 nt lds
    buffer_load_dwordx4 v239, s[16:19], s21 offen offset:3072 nt lds
    s_add_u32 s34, s34, 32768
    s_cmp_ge_u32 s34, s40
    s_cselect_b32 s60, s41, 0
    s_sub_u32 s34, s34, s60
    s_add_u32 s20, s20, 16384
    s_add_u32 s21, s21, 16384
    s_branch L_exr64
L_stub0:
    s_mov_b32 s100, 0
    s_call_b64 s[30:31], L_slow_0_0
    s_branch L_ret0
L_stub1:
    s_mov_b32 s100, 0
    s_call_b64 s[30:31], L_slow_1_1
    s_branch L_ret1
L_stub2:
    s_mov_b32 s100, 0
    s_call_b64 s[30:31], L_slow_2_0
    s_branch L_ret2
L_stub3:
    s_mov_b32 s100, 0
    s_call_b64 s[30:31], L_slow_0_1
    s_branch L_ret3
L_stub4:
    s_mov_b32 s100, 0
    s_call_b64 s[30:31], L_slow_1_0
    s_branch L_ret4
L_stub5:
    s_mov_b32 s100, 0
    s_call_b64 s[30:31], L_slow_0_1
    s_branch L_ret5
L_stub6:
    s_mov_b32 s100, 0
    s_call_b64 s[30:31], L_slow_1_0
    s_branch L_ret6
L_stub7:
    s_mov_b32 s100, 0
    s_call_b64 s[30:31], L_slow_2_1
    s_branch L_ret7
L_stub8:
    s_mov_b32 s100, 0
    s_call_b64 s[30:31], L_slow_0_0
    s_branch L_ret8
L_stub9:
    s_mov_b32 s100, 0
    s_call_b64 s[30:31], L_slow_1_1
    s_branch L_ret9
L_stub10:
    s_mov_b32 s100, 1
    s_call_b64 s[30:31], L_slow_0_0
    s_branch L_ret10
L_stub11:
    s_mov_b32 s100, 1
    s_call_b64 s[30:31], L_slow_0_1
    s_branch L_ret11
L_stub12:
    s_mov_b32 s100, 1
    s_call_b64 s[30:31], L_slow_0_0
    s_branch L_ret12
L_stub13:
    s_mov_b32 s100, 0
    s_call_b64 s[30:31], L_slow_0_1
    s_branch L_ret13
L_stub14:
    s_mov_b32 s100, 0
    s_call_b64 s[30:31], L_slow_1_0
    s_branch L_ret14
L_stub15:
    s_mov_b32 s100, 0
    s_call_b64 s[30:31], L_slow_2_1
    s_branch L_ret15
L_stub16:
    s_mov_b32 s100, 1
    s_call_b64 s[30:31], L_slow_1_0
    s_branch L_ret16
L_stub17:
    s_mov_b32 s100, 0
    s_call_b64 s[30:31], L_slow_1_1
    s_branch L_ret17
L_stub18:
    s_mov_b32 s100, 0
    s_call_b64 s[30:31], L_slow_2_0
    s_branch L_ret18
L_stub19:
    s_mov_b32 s100, 0
    s_call_b64 s[30:31], L_slow_1_1
    s_branch L_ret19
L_stub20:
    s_mov_b32 s100, 0
    s_call_b64 s[30:31], L_slow_0_0
    s_branch L_ret20
L_stub21:
    s_mov_b32 s100, 0
    s_call_b64 s[30:31], L_slow_1_1
    s_branch L_ret21
L_stub22:
    s_mov_b32 s100, 0
    s_call_b64 s[30:31], L_slow_0_0
    s_branch L_ret22
L_stub23:
    s_mov_b32 s100, 0
    s_call_b64 s[30:31], L_slow_1_1
    s_branch L_ret23
L_stub24:
    s_mov_b32 s100, 0
    s_call_b64 s[30:31], L_slow_2_0
    s_branch L_ret24
L_stub25:
    s_mov_b32 s100, 0
    s_call_b64 s[30:31], L_slow_0_1
    s_branch L_ret25
L_stub26:
    s_mov_b32 s100, 0
    s_call_b64 s[30:31], L_slow_1_0
    s_branch L_ret26
L_stub27:
    s_mov_b32 s100, 0
    s_call_b64 s[30:31], L_slow_0_1
    s_branch L_ret27
L_stub28:
    s_mov_b32 s100, 0
    s_call_b64 s[30:31], L_slow_1_0
    s_branch L_ret28
L_stub29:
    s_mov_b32 s100, 0
    s_call_b64 s[30:31], L_slow_2_1
    s_branch L_ret29
L_stub30:
    s_mov_b32 s100, 1
    s_call_b64 s[30:31], L_slow_0_0
    s_branch L_ret30
L_stub31:
    s_mov_b32 s100, 1
    s_call_b64 s[30:31], L_slow_0_1
    s_branch L_ret31
L_stub32:
    s_mov_b32 s100, 1
    s_call_b64 s[30:31], L_slow_0_0
    s_branch L_ret32
L_stub33:
    s_mov_b32 s100, 0
    s_call_b64 s[30:31], L_slow_0_1
    s_branch L_ret33
L_stub34:
    s_mov_b32 s100, 1
    s_call_b64 s[30:31], L_slow_1_0
    s_branch L_ret34
L_stub35:
    s_mov_b32 s100, 0
    s_call_b64 s[30:31], L_slow_1_1
    s_branch L_ret35
L_stub36:
    s_mov_b32 s100, 0
    s_call_b64 s[30:31], L_slow_2_0
    s_branch L_ret36
L_stub37:
    s_mov_b32 s100, 1
    s_call_b64 s[30:31], L_slow_1_1
    s_branch L_ret37
L_stub38:
    s_mov_b32 s100, 0
    s_call_b64 s[30:31], L_slow_1_0
    s_branch L_ret38
L_stub39:
    s_mov_b32 s100, 0
    s_call_b64 s[30:31], L_slow_2_1
    s_branch L_ret39
L_stub40:
    s_mov_b32 s100, 0
    s_call_b64 s[30:31], L_slow_0_0
    s_branch L_ret40
L_stub41:
    s_mov_b32 s100, 0
    s_call_b64 s[30:31], L_slow_1_1
    s_branch L_ret41
L_stub42:
    s_mov_b32 s100, 0
    s_call_b64 s[30:31], L_slow_0_0
    s_branch L_ret42
L_stub43:
    s_mov_b32 s100, 0
    s_call_b64 s[30:31], L_slow_1_1
    s_branch L_ret43
L_stub44:
    s_mov_b32 s100, 1
    s_call_b64 s[30:31], L_slow_0_0
    s_branch L_ret44
L_stub45:
    s_mov_b32 s100, 1
    s_call_b64 s[30:31], L_slow_0_1
    s_branch L_ret45
L_stub46:
    s_mov_b32 s100, 1
    s_call_b64 s[30:31], L_slow_0_0
    s_branch L_ret46
L_stub47:
    s_mov_b32 s100, 0
    s_call_b64 s[30:31], L_slow_0_1
    s_branch L_ret47
L_stub48:
    s_mov_b32 s100, 1
    s_call_b64 s[30:31], L_slow_1_0
    s_branch L_ret48
L_stub49:
    s_mov_b32 s100, 1
    s_call_b64 s[30:31], L_slow_1_1
    s_branch L_ret49
L_stub50:
    s_mov_b32 s100, 1
    s_call_b64 s[30:31], L_slow_1_0
    s_branch L_ret50
L_stub51:
    s_mov_b32 s100, 0
    s_call_b64 s[30:31], L_slow_1_1
    s_branch L_ret51
L_slow_0_0:
    s_nop 15
    v_max3_f32 v242, v160, v161, v162
    v_max3_f32 v242, v242, v163, v164
    v_max3_f32 v242, v242, v165, v166
    v_max3_f32 v242, v242, v167, v168
    v_max3_f32 v242, v242, v169, v170
    v_max3_f32 v242, v242, v171, v172
    v_max3_f32 v242, v242, v173, v174
    v_max_f32 v242, v242, v175
    v_mov_b32 v243, v242
    s_nop 1
    v_permlane32_swap_b32 v242, v243
    s_nop 1
    v_max_f32 v242, v242, v243
    v_mov_b32 v244, v219
    v_mov_b32 v245, v219
    s_nop 1
    v_permlane32_swap_b32 v244, v245
    s_nop 1
    v_add_f32 v244, v244, v245
    v_cmp_neq_f32 vcc, 0, v244
    v_max_f32 v245, 0, v242
    s_nop 0
    v_cndmask_b32 v242, v242, v245, vcc
    v_exp_f32 v243, -v245
    v_sub_f32 v32, v32, v242
    v_sub_f32 v33, v33, v242
    v_sub_f32 v34, v34, v242
    v_sub_f32 v35, v35, v242
    v_sub_f32 v36, v36, v242
    v_sub_f32 v37, v37, v242
    v_sub_f32 v38, v38, v242
    v_sub_f32 v39, v39, v242
    v_sub_f32 v40, v40, v242
    v_sub_f32 v41, v41, v242
    v_sub_f32 v42, v42, v242
    v_sub_f32 v43, v43, v242
    v_sub_f32 v44, v44, v242
    v_sub_f32 v45, v45, v242
    v_sub_f32 v46, v46, v242
    v_sub_f32 v47, v47, v242
    v_mul_f32 v219, v219, v243
    s_cmp_eq_u32 s100, 0
    s_cbranch_scc1 L_na67
    v_sub_f32 v176, v176, v242
    v_sub_f32 v177, v177, v242
    v_sub_f32 v178, v178, v242
    v_sub_f32 v179, v179, v242
    v_sub_f32 v180, v180, v242
    v_sub_f32 v181, v181, v242
    v_sub_f32 v182, v182, v242
    v_sub_f32 v183, v183, v242
    v_sub_f32 v184, v184, v242
    v_sub_f32 v185, v185, v242
    v_sub_f32 v186, v186, v242
    v_sub_f32 v187, v187, v242
    v_sub_f32 v188, v188, v242
    v_sub_f32 v189, v189, v242
    v_sub_f32 v190, v190, v242
    v_sub_f32 v191, v191, v242
L_na67:
    s_cbranch_vccz L_sk68
    v_accvgpr_read_b32 v246, a0
    v_accvgpr_read_b32 v247, a1
    v_accvgpr_read_b32 v248, a2
    v_accvgpr_read_b32 v249, a3
    v_mul_f32 v246, v246, v243
    v_mul_f32 v247, v247, v243
    v_mul_f32 v248, v248, v243
    v_mul_f32 v249, v249, v243
    v_accvgpr_write_b32 a0, v246
    v_accvgpr_write_b32 a1, v247
    v_accvgpr_write_b32 a2, v248
    v_accvgpr_write_b32 a3, v249
    v_accvgpr_read_b32 v246, a4
    v_accvgpr_read_b32 v247, a5
    v_accvgpr_read_b32 v248, a6
    v_accvgpr_read_b32 v249, a7
    v_mul_f32 v246, v246, v243
    v_mul_f32 v247, v247, v243
    v_mul_f32 v248, v248, v243
    v_mul_f32 v249, v249, v243
    v_accvgpr_write_b32 a4, v246
    v_accvgpr_write_b32 a5, v247
    v_accvgpr_write_b32 a6, v248
    v_accvgpr_write_b32 a7, v249
    v_accvgpr_read_b32 v246, a8
    v_accvgpr_read_b32 v247, a9
    v_accvgpr_read_b32 v248, a10
    v_accvgpr_read_b32 v249, a11
    v_mul_f32 v246, v246, v243
    v_mul_f32 v247, v247, v243
    v_mul_f32 v248, v248, v243
    v_mul_f32 v249, v249, v243
    v_accvgpr_write_b32 a8, v246
    v_accvgpr_write_b32 a9, v247
    v_accvgpr_write_b32 a10, v248
    v_accvgpr_write_b32 a11, v249
    v_accvgpr_read_b32 v246, a12
    v_accvgpr_read_b32 v247, a13
    v_accvgpr_read_b32 v248, a14
    v_accvgpr_read_b32 v249, a15
    v_mul_f32 v246, v246, v243
    v_mul_f32 v247, v247, v243
    v_mul_f32 v248, v248, v243
    v_mul_f32 v249, v249, v243
    v_accvgpr_write_b32 a12, v246
    v_accvgpr_write_b32 a13, v247
    v_accvgpr_write_b32 a14, v248
    v_accvgpr_write_b32 a15, v249
    v_accvgpr_read_b32 v246, a16
    v_accvgpr_read_b32 v247, a17
    v_accvgpr_read_b32 v248, a18
    v_accvgpr_read_b32 v249, a19
    v_mul_f32 v246, v246, v243
    v_mul_f32 v247, v247, v243
    v_mul_f32 v248, v248, v243
    v_mul_f32 v249, v249, v243
    v_accvgpr_write_b32 a16, v246
    v_accvgpr_write_b32 a17, v247
    v_accvgpr_write_b32 a18, v248
    v_accvgpr_write_b32 a19, v249
    v_accvgpr_read_b32 v246, a20
    v_accvgpr_read_b32 v247, a21
    v_accvgpr_read_b32 v248, a22
    v_accvgpr_read_b32 v249, a23
    v_mul_f32 v246, v246, v243
    v_mul_f32 v247, v247, v243
    v_mul_f32 v248, v248, v243
    v_mul_f32 v249, v249, v243
    v_accvgpr_write_b32 a20, v246
    v_accvgpr_write_b32 a21, v247
    v_accvgpr_write_b32 a22, v248
    v_accvgpr_write_b32 a23, v249
    v_accvgpr_read_b32 v246, a24
    v_accvgpr_read_b32 v247, a25
    v_accvgpr_read_b32 v248, a26
    v_accvgpr_read_b32 v249, a27
    v_mul_f32 v246, v246, v243
    v_mul_f32 v247, v247, v243
    v_mul_f32 v248, v248, v243
    v_mul_f32 v249, v249, v243
    v_accvgpr_write_b32 a24, v246
    v_accvgpr_write_b32 a25, v247
    v_accvgpr_write_b32 a26, v248
    v_accvgpr_write_b32 a27, v249
    v_accvgpr_read_b32 v246, a28
    v_accvgpr_read_b32 v247, a29
    v_accvgpr_read_b32 v248, a30
    v_accvgpr_read_b32 v249, a31
    v_mul_f32 v246, v246, v243
    v_mul_f32 v247, v247, v243
    v_mul_f32 v248, v248, v243
    v_mul_f32 v249, v249, v243
    v_accvgpr_write_b32 a28, v246
    v_accvgpr_write_b32 a29, v247
    v_accvgpr_write_b32 a30, v248
    v_accvgpr_write_b32 a31, v249
    v_accvgpr_read_b32 v246, a32
    v_accvgpr_read_b32 v247, a33
    v_accvgpr_read_b32 v248, a34
    v_accvgpr_read_b32 v249, a35
    v_mul_f32 v246, v246, v243
    v_mul_f32 v247, v247, v243
    v_mul_f32 v248, v248, v243
    v_mul_f32 v249, v249, v243
    v_accvgpr_write_b32 a32, v246
    v_accvgpr_write_b32 a33, v247
    v_accvgpr_write_b32 a34, v248
    v_accvgpr_write_b32 a35, v249
    v_accvgpr_read_b32 v246, a36
    v_accvgpr_read_b32 v247, a37
    v_accvgpr_read_b32 v248, a38
    v_accvgpr_read_b32 v249, a39
    v_mul_f32 v246, v246, v243
    v_mul_f32 v247, v247, v243
    v_mul_f32 v248, v248, v243
    v_mul_f32 v249, v249, v243
    v_accvgpr_write_b32 a36, v246
    v_accvgpr_write_b32 a37, v247
    v_accvgpr_write_b32 a38, v248
    v_accvgpr_write_b32 a39, v249
    v_accvgpr_read_b32 v246, a40
    v_accvgpr_read_b32 v247, a41
    v_accvgpr_read_b32 v248, a42
    v_accvgpr_read_b32 v249, a43
    v_mul_f32 v246, v246, v243
    v_mul_f32 v247, v247, v243
    v_mul_f32 v248, v248, v243
    v_mul_f32 v249, v249, v243
    v_accvgpr_write_b32 a40, v246
    v_accvgpr_write_b32 a41, v247
    v_accvgpr_write_b32 a42, v248
    v_accvgpr_write_b32 a43, v249
    v_accvgpr_read_b32 v246, a44
    v_accvgpr_read_b32 v247, a45
    v_accvgpr_read_b32 v248, a46
    v_accvgpr_read_b32 v249, a47
    v_mul_f32 v246, v246, v243
    v_mul_f32 v247, v247, v243
    v_mul_f32 v248, v248, v243
    v_mul_f32 v249, v249, v243
    v_accvgpr_write_b32 a44, v246
    v_accvgpr_write_b32 a45, v247
    v_accvgpr_write_b32 a46, v248
    v_accvgpr_write_b32 a47, v249
    v_accvgpr_read_b32 v246, a48
    v_accvgpr_read_b32 v247, a49
    v_accvgpr_read_b32 v248, a50
    v_accvgpr_read_b32 v249, a51
    v_mul_f32 v246, v246, v243
    v_mul_f32 v247, v247, v243
    v_mul_f32 v248, v248, v243
    v_mul_f32 v249, v249, v243
    v_accvgpr_write_b32 a48, v246
    v_accvgpr_write_b32 a49, v247
    v_accvgpr_write_b32 a50, v248
    v_accvgpr_write_b32 a51, v249
    v_accvgpr_read_b32 v246, a52
    v_accvgpr_read_b32 v247, a53
    v_accvgpr_read_b32 v248, a54
    v_accvgpr_read_b32 v249, a55
    v_mul_f32 v246, v246, v243
    v_mul_f32 v247, v247, v243
    v_mul_f32 v248, v248, v243
    v_mul_f32 v249, v249, v243
    v_accvgpr_write_b32 a52, v246
    v_accvgpr_write_b32 a53, v247
    v_accvgpr_write_b32 a54, v248
    v_accvgpr_write_b32 a55, v249
    v_accvgpr_read_b32 v246, a56
    v_accvgpr_read_b32 v247, a57
    v_accvgpr_read_b32 v248, a58
    v_accvgpr_read_b32 v249, a59
    v_mul_f32 v246, v246, v243
    v_mul_f32 v247, v247, v243
    v_mul_f32 v248, v248, v243
    v_mul_f32 v249, v249, v243
    v_accvgpr_write_b32 a56, v246
    v_accvgpr_write_b32 a57, v247
    v_accvgpr_write_b32 a58, v248
    v_accvgpr_write_b32 a59, v249
    v_accvgpr_read_b32 v246, a60
    v_accvgpr_read_b32 v247, a61
    v_accvgpr_read_b32 v248, a62
    v_accvgpr_read_b32 v249, a63
    v_mul_f32 v246, v246, v243
    v_mul_f32 v247, v247, v243
    v_mul_f32 v248, v248, v243
    v_mul_f32 v249, v249, v243
    v_accvgpr_write_b32 a60, v246
    v_accvgpr_write_b32 a61, v247
    v_accvgpr_write_b32 a62, v248
    v_accvgpr_write_b32 a63, v249
L_sk68:
    v_sub_f32 v208, v160, v242
    v_exp_f32 v208, v208
    v_sub_f32 v209, v161, v242
    v_exp_f32 v209, v209
    v_sub_f32 v210, v162, v242
    v_exp_f32 v210, v210
    v_sub_f32 v211, v163, v242
    v_exp_f32 v211, v211
    v_add_f32 v222, v208, v209
    v_cvt_pk_bf16_f32 v192, v208, v209
    v_sub_f32 v212, v164, v242
    v_exp_f32 v212, v212
    v_add_f32 v222, v222, v210
    v_sub_f32 v213, v165, v242
    v_exp_f32 v213, v213
    v_add_f32 v222, v222, v211
    v_cvt_pk_bf16_f32 v193, v210, v211
    v_sub_f32 v214, v166, v242
    v_exp_f32 v214, v214
    v_add_f32 v222, v222, v212
    v_sub_f32 v215, v167, v242
    v_exp_f32 v215, v215
    v_add_f32 v222, v222, v213
    v_cvt_pk_bf16_f32 v194, v212, v213
    v_sub_f32 v208, v168, v242
    v_exp_f32 v208, v208
    v_add_f32 v222, v222, v214
    v_sub_f32 v209, v169, v242
    v_exp_f32 v209, v209
    v_add_f32 v222, v222, v215
    v_cvt_pk_bf16_f32 v195, v214, v215
    v_sub_f32 v210, v170, v242
    v_exp_f32 v210, v210
    v_add_f32 v222, v222, v208
    v_sub_f32 v211, v171, v242
    v_exp_f32 v211, v211
    v_add_f32 v222, v222, v209
    v_cvt_pk_bf16_f32 v196, v208, v209
    v_sub_f32 v212, v172, v242
    v_exp_f32 v212, v212
    v_add_f32 v222, v222, v210
    v_sub_f32 v213, v173, v242
    v_exp_f32 v213, v213
    v_add_f32 v222, v222, v211
    v_sub_f32 v214, v174, v242
    v_exp_f32 v214, v214
    v_add_f32 v222, v222, v212
    v_sub_f32 v215, v175, v242
    v_exp_f32 v215, v215
    v_add_f32 v222, v222, v213
    v_add_f32 v222, v222, v214
    v_add_f32 v222, v222, v215
    v_cvt_pk_bf16_f32 v197, v210, v211
    v_cvt_pk_bf16_f32 v198, v212, v213
    v_cvt_pk_bf16_f32 v199, v214, v215
    s_nop 3
    s_setpc_b64 s[30:31]
L_slow_0_1:
    s_nop 15
    v_max3_f32 v242, v176, v177, v178
    v_max3_f32 v242, v242, v179, v180
    v_max3_f32 v242, v242, v181, v182
    v_max3_f32 v242, v242, v183, v184
    v_max3_f32 v242, v242, v185, v186
    v_max3_f32 v242, v242, v187, v188
    v_max3_f32 v242, v242, v189, v190
    v_max_f32 v242, v242, v191
    v_mov_b32 v243, v242
    s_nop 1
    v_permlane32_swap_b32 v242, v243
    s_nop 1
    v_max_f32 v242, v242, v243
    v_mov_b32 v244, v219
    v_mov_b32 v245, v219
    s_nop 1
    v_permlane32_swap_b32 v244, v245
    s_nop 1
    v_add_f32 v244, v244, v245
    v_cmp_neq_f32 vcc, 0, v244
    v_max_f32 v245, 0, v242
    s_nop 0
    v_cndmask_b32 v242, v242, v245, vcc
    v_exp_f32 v243, -v245
    v_sub_f32 v32, v32, v242
    v_sub_f32 v33, v33, v242
    v_sub_f32 v34, v34, v242
    v_sub_f32 v35, v35, v242
    v_sub_f32 v36, v36, v242
    v_sub_f32 v37, v37, v242
    v_sub_f32 v38, v38, v242
    v_sub_f32 v39, v39, v242
    v_sub_f32 v40, v40, v242
    v_sub_f32 v41, v41, v242
    v_sub_f32 v42, v42, v242
    v_sub_f32 v43, v43, v242
    v_sub_f32 v44, v44, v242
    v_sub_f32 v45, v45, v242
    v_sub_f32 v46, v46, v242
    v_sub_f32 v47, v47, v242
    v_mul_f32 v219, v219, v243
    s_cmp_eq_u32 s100, 0
    s_cbranch_scc1 L_na69
    v_sub_f32 v160, v160, v242
    v_sub_f32 v161, v161, v242
    v_sub_f32 v162, v162, v242
    v_sub_f32 v163, v163, v242
    v_sub_f32 v164, v164, v242
    v_sub_f32 v165, v165, v242
    v_sub_f32 v166, v166, v242
    v_sub_f32 v167, v167, v242
    v_sub_f32 v168, v168, v242
    v_sub_f32 v169, v169, v242
    v_sub_f32 v170, v170, v242
    v_sub_f32 v171, v171, v242
    v_sub_f32 v172, v172, v242
    v_sub_f32 v173, v173, v242
    v_sub_f32 v174, v174, v242
    v_sub_f32 v175, v175, v242
L_na69:
    s_cbranch_vccz L_sk70
    v_accvgpr_read_b32 v246, a0
    v_accvgpr_read_b32 v247, a1
    v_accvgpr_read_b32 v248, a2
    v_accvgpr_read_b32 v249, a3
    v_mul_f32 v246, v246, v243
    v_mul_f32 v247, v247, v243
    v_mul_f32 v248, v248, v243
    v_mul_f32 v249, v249, v243
    v_accvgpr_write_b32 a0, v246
    v_accvgpr_write_b32 a1, v247
    v_accvgpr_write_b32 a2, v248
    v_accvgpr_write_b32 a3, v249
    v_accvgpr_read_b32 v246, a4
    v_accvgpr_read_b32 v247, a5
    v_accvgpr_read_b32 v248, a6
    v_accvgpr_read_b32 v249, a7
    v_mul_f32 v246, v246, v243
    v_mul_f32 v247, v247, v243
    v_mul_f32 v248, v248, v243
    v_mul_f32 v249, v249, v243
    v_accvgpr_write_b32 a4, v246
    v_accvgpr_write_b32 a5, v247
    v_accvgpr_write_b32 a6, v248
    v_accvgpr_write_b32 a7, v249
    v_accvgpr_read_b32 v246, a8
    v_accvgpr_read_b32 v247, a9
    v_accvgpr_read_b32 v248, a10
    v_accvgpr_read_b32 v249, a11
    v_mul_f32 v246, v246, v243
    v_mul_f32 v247, v247, v243
    v_mul_f32 v248, v248, v243
    v_mul_f32 v249, v249, v243
    v_accvgpr_write_b32 a8, v246
    v_accvgpr_write_b32 a9, v247
    v_accvgpr_write_b32 a10, v248
    v_accvgpr_write_b32 a11, v249
    v_accvgpr_read_b32 v246, a12
    v_accvgpr_read_b32 v247, a13
    v_accvgpr_read_b32 v248, a14
    v_accvgpr_read_b32 v249, a15
    v_mul_f32 v246, v246, v243
    v_mul_f32 v247, v247, v243
    v_mul_f32 v248, v248, v243
    v_mul_f32 v249, v249, v243
    v_accvgpr_write_b32 a12, v246
    v_accvgpr_write_b32 a13, v247
    v_accvgpr_write_b32 a14, v248
    v_accvgpr_write_b32 a15, v249
    v_accvgpr_read_b32 v246, a16
    v_accvgpr_read_b32 v247, a17
    v_accvgpr_read_b32 v248, a18
    v_accvgpr_read_b32 v249, a19
    v_mul_f32 v246, v246, v243
    v_mul_f32 v247, v247, v243
    v_mul_f32 v248, v248, v243
    v_mul_f32 v249, v249, v243
    v_accvgpr_write_b32 a16, v246
    v_accvgpr_write_b32 a17, v247
    v_accvgpr_write_b32 a18, v248
    v_accvgpr_write_b32 a19, v249
    v_accvgpr_read_b32 v246, a20
    v_accvgpr_read_b32 v247, a21
    v_accvgpr_read_b32 v248, a22
    v_accvgpr_read_b32 v249, a23
    v_mul_f32 v246, v246, v243
    v_mul_f32 v247, v247, v243
    v_mul_f32 v248, v248, v243
    v_mul_f32 v249, v249, v243
    v_accvgpr_write_b32 a20, v246
    v_accvgpr_write_b32 a21, v247
    v_accvgpr_write_b32 a22, v248
    v_accvgpr_write_b32 a23, v249
    v_accvgpr_read_b32 v246, a24
    v_accvgpr_read_b32 v247, a25
    v_accvgpr_read_b32 v248, a26
    v_accvgpr_read_b32 v249, a27
    v_mul_f32 v246, v246, v243
    v_mul_f32 v247, v247, v243
    v_mul_f32 v248, v248, v243
    v_mul_f32 v249, v249, v243
    v_accvgpr_write_b32 a24, v246
    v_accvgpr_write_b32 a25, v247
    v_accvgpr_write_b32 a26, v248
    v_accvgpr_write_b32 a27, v249
    v_accvgpr_read_b32 v246, a28
    v_accvgpr_read_b32 v247, a29
    v_accvgpr_read_b32 v248, a30
    v_accvgpr_read_b32 v249, a31
    v_mul_f32 v246, v246, v243
    v_mul_f32 v247, v247, v243
    v_mul_f32 v248, v248, v243
    v_mul_f32 v249, v249, v243
    v_accvgpr_write_b32 a28, v246
    v_accvgpr_write_b32 a29, v247
    v_accvgpr_write_b32 a30, v248
    v_accvgpr_write_b32 a31, v249
    v_accvgpr_read_b32 v246, a32
    v_accvgpr_read_b32 v247, a33
    v_accvgpr_read_b32 v248, a34
    v_accvgpr_read_b32 v249, a35
    v_mul_f32 v246, v246, v243
    v_mul_f32 v247, v247, v243
    v_mul_f32 v248, v248, v243
    v_mul_f32 v249, v249, v243
    v_accvgpr_write_b32 a32, v246
    v_accvgpr_write_b32 a33, v247
    v_accvgpr_write_b32 a34, v248
    v_accvgpr_write_b32 a35, v249
    v_accvgpr_read_b32 v246, a36
    v_accvgpr_read_b32 v247, a37
    v_accvgpr_read_b32 v248, a38
    v_accvgpr_read_b32 v249, a39
    v_mul_f32 v246, v246, v243
    v_mul_f32 v247, v247, v243
    v_mul_f32 v248, v248, v243
    v_mul_f32 v249, v249, v243
    v_accvgpr_write_b32 a36, v246
    v_accvgpr_write_b32 a37, v247
    v_accvgpr_write_b32 a38, v248
    v_accvgpr_write_b32 a39, v249
    v_accvgpr_read_b32 v246, a40
    v_accvgpr_read_b32 v247, a41
    v_accvgpr_read_b32 v248, a42
    v_accvgpr_read_b32 v249, a43
    v_mul_f32 v246, v246, v243
    v_mul_f32 v247, v247, v243
    v_mul_f32 v248, v248, v243
    v_mul_f32 v249, v249, v243
    v_accvgpr_write_b32 a40, v246
    v_accvgpr_write_b32 a41, v247
    v_accvgpr_write_b32 a42, v248
    v_accvgpr_write_b32 a43, v249
    v_accvgpr_read_b32 v246, a44
    v_accvgpr_read_b32 v247, a45
    v_accvgpr_read_b32 v248, a46
    v_accvgpr_read_b32 v249, a47
    v_mul_f32 v246, v246, v243
    v_mul_f32 v247, v247, v243
    v_mul_f32 v248, v248, v243
    v_mul_f32 v249, v249, v243
    v_accvgpr_write_b32 a44, v246
    v_accvgpr_write_b32 a45, v247
    v_accvgpr_write_b32 a46, v248
    v_accvgpr_write_b32 a47, v249
    v_accvgpr_read_b32 v246, a48
    v_accvgpr_read_b32 v247, a49
    v_accvgpr_read_b32 v248, a50
    v_accvgpr_read_b32 v249, a51
    v_mul_f32 v246, v246, v243
    v_mul_f32 v247, v247, v243
    v_mul_f32 v248, v248, v243
    v_mul_f32 v249, v249, v243
    v_accvgpr_write_b32 a48, v246
    v_accvgpr_write_b32 a49, v247
    v_accvgpr_write_b32 a50, v248
    v_accvgpr_write_b32 a51, v249
    v_accvgpr_read_b32 v246, a52
    v_accvgpr_read_b32 v247, a53
    v_accvgpr_read_b32 v248, a54
    v_accvgpr_read_b32 v249, a55
    v_mul_f32 v246, v246, v243
    v_mul_f32 v247, v247, v243
    v_mul_f32 v248, v248, v243
    v_mul_f32 v249, v249, v243
    v_accvgpr_write_b32 a52, v246
    v_accvgpr_write_b32 a53, v247
    v_accvgpr_write_b32 a54, v248
    v_accvgpr_write_b32 a55, v249
    v_accvgpr_read_b32 v246, a56
    v_accvgpr_read_b32 v247, a57
    v_accvgpr_read_b32 v248, a58
    v_accvgpr_read_b32 v249, a59
    v_mul_f32 v246, v246, v243
    v_mul_f32 v247, v247, v243
    v_mul_f32 v248, v248, v243
    v_mul_f32 v249, v249, v243
    v_accvgpr_write_b32 a56, v246
    v_accvgpr_write_b32 a57, v247
    v_accvgpr_write_b32 a58, v248
    v_accvgpr_write_b32 a59, v249
    v_accvgpr_read_b32 v246, a60
    v_accvgpr_read_b32 v247, a61
    v_accvgpr_read_b32 v248, a62
    v_accvgpr_read_b32 v249, a63
    v_mul_f32 v246, v246, v243
    v_mul_f32 v247, v247, v243
    v_mul_f32 v248, v248, v243
    v_mul_f32 v249, v249, v243
    v_accvgpr_write_b32 a60, v246
    v_accvgpr_write_b32 a61, v247
    v_accvgpr_write_b32 a62, v248
    v_accvgpr_write_b32 a63, v249
L_sk70:
    v_sub_f32 v208, v176, v242
    v_exp_f32 v208, v208
    v_sub_f32 v209, v177, v242
    v_exp_f32 v209, v209
    v_sub_f32 v210, v178, v242
    v_exp_f32 v210, v210
    v_sub_f32 v211, v179, v242
    v_exp_f32 v211, v211
    v_add_f32 v222, v208, v209
    v_cvt_pk_bf16_f32 v200, v208, v209
    v_sub_f32 v212, v180, v242
    v_exp_f32 v212, v212
    v_add_f32 v222, v222, v210
    v_sub_f32 v213, v181, v242
    v_exp_f32 v213, v213
    v_add_f32 v222, v222, v211
    v_cvt_pk_bf16_f32 v201, v210, v211
    v_sub_f32 v214, v182, v242
    v_exp_f32 v214, v214
    v_add_f32 v222, v222, v212
    v_sub_f32 v215, v183, v242
    v_exp_f32 v215, v215
    v_add_f32 v222, v222, v213
    v_cvt_pk_bf16_f32 v202, v212, v213
    v_sub_f32 v208, v184, v242
    v_exp_f32 v208, v208
    v_add_f32 v222, v222, v214
    v_sub_f32 v209, v185, v242
    v_exp_f32 v209, v209
    v_add_f32 v222, v222, v215
    v_cvt_pk_bf16_f32 v203, v214, v215
    v_sub_f32 v210, v186, v242
    v_exp_f32 v210, v210
    v_add_f32 v222, v222, v208
    v_sub_f32 v211, v187, v242
    v_exp_f32 v211, v211
    v_add_f32 v222, v222, v209
    v_cvt_pk_bf16_f32 v204, v208, v209
    v_sub_f32 v212, v188, v242
    v_exp_f32 v212, v212
    v_add_f32 v222, v222, v210
    v_sub_f32 v213, v189, v242
    v_exp_f32 v213, v213
    v_add_f32 v222, v222, v211
    v_sub_f32 v214, v190, v242
    v_exp_f32 v214, v214
    v_add_f32 v222, v222, v212
    v_sub_f32 v215, v191, v242
    v_exp_f32 v215, v215
    v_add_f32 v222, v222, v213
    v_add_f32 v222, v222, v214
    v_add_f32 v222, v222, v215
    v_cvt_pk_bf16_f32 v205, v210, v211
    v_cvt_pk_bf16_f32 v206, v212, v213
    v_cvt_pk_bf16_f32 v207, v214, v215
    s_nop 3
    s_setpc_b64 s[30:31]
L_slow_1_0:
    s_nop 15
    v_max3_f32 v242, v160, v161, v162
    v_max3_f32 v242, v242, v163, v164
    v_max3_f32 v242, v242, v165, v166
    v_max3_f32 v242, v242, v167, v168
    v_max3_f32 v242, v242, v169, v170
    v_max3_f32 v242, v242, v171, v172
    v_max3_f32 v242, v242, v173, v174
    v_max_f32 v242, v242, v175
    v_mov_b32 v243, v242
    s_nop 1
    v_permlane32_swap_b32 v242, v243
    s_nop 1
    v_max_f32 v242, v242, v243
    v_mov_b32 v244, v220
    v_mov_b32 v245, v220
    s_nop 1
    v_permlane32_swap_b32 v244, v245
    s_nop 1
    v_add_f32 v244, v244, v245
    v_cmp_neq_f32 vcc, 0, v244
    v_max_f32 v245, 0, v242
    s_nop 0
    v_cndmask_b32 v242, v242, v245, vcc
    v_exp_f32 v243, -v245
    v_sub_f32 v48, v48, v242
    v_sub_f32 v49, v49, v242
    v_sub_f32 v50, v50, v242
    v_sub_f32 v51, v51, v242
    v_sub_f32 v52, v52, v242
    v_sub_f32 v53, v53, v242
    v_sub_f32 v54, v54, v242
    v_sub_f32 v55, v55, v242
    v_sub_f32 v56, v56, v242
    v_sub_f32 v57, v57, v242
    v_sub_f32 v58, v58, v242
    v_sub_f32 v59, v59, v242
    v_sub_f32 v60, v60, v242
    v_sub_f32 v61, v61, v242
    v_sub_f32 v62, v62, v242
    v_sub_f32 v63, v63, v242
    v_mul_f32 v220, v220, v243
    s_cmp_eq_u32 s100, 0
    s_cbranch_scc1 L_na71
    v_sub_f32 v176, v176, v242
    v_sub_f32 v177, v177, v242
    v_sub_f32 v178, v178, v242
    v_sub_f32 v179, v179, v242
    v_sub_f32 v180, v180, v242
    v_sub_f32 v181, v181, v242
    v_sub_f32 v182, v182, v242
    v_sub_f32 v183, v183, v242
    v_sub_f32 v184, v184, v242
    v_sub_f32 v185, v185, v242
    v_sub_f32 v186, v186, v242
    v_sub_f32 v187, v187, v242
    v_sub_f32 v188, v188, v242
    v_sub_f32 v189, v189, v242
    v_sub_f32 v190, v190, v242
    v_sub_f32 v191, v191, v242
L_na71:
    s_cbranch_vccz L_sk72
    v_accvgpr_read_b32 v246, a64
    v_accvgpr_read_b32 v247, a65
    v_accvgpr_read_b32 v248, a66
    v_accvgpr_read_b32 v249, a67
    v_mul_f32 v246, v246, v243
    v_mul_f32 v247, v247, v243
    v_mul_f32 v248, v248, v243
    v_mul_f32 v249, v249, v243
    v_accvgpr_write_b32 a64, v246
    v_accvgpr_write_b32 a65, v247
    v_accvgpr_write_b32 a66, v248
    v_accvgpr_write_b32 a67, v249
    v_accvgpr_read_b32 v246, a68
    v_accvgpr_read_b32 v247, a69
    v_accvgpr_read_b32 v248, a70
    v_accvgpr_read_b32 v249, a71
    v_mul_f32 v246, v246, v243
    v_mul_f32 v247, v247, v243
    v_mul_f32 v248, v248, v243
    v_mul_f32 v249, v249, v243
    v_accvgpr_write_b32 a68, v246
    v_accvgpr_write_b32 a69, v247
    v_accvgpr_write_b32 a70, v248
    v_accvgpr_write_b32 a71, v249
    v_accvgpr_read_b32 v246, a72
    v_accvgpr_read_b32 v247, a73
    v_accvgpr_read_b32 v248, a74
    v_accvgpr_read_b32 v249, a75
    v_mul_f32 v246, v246, v243
    v_mul_f32 v247, v247, v243
    v_mul_f32 v248, v248, v243
    v_mul_f32 v249, v249, v243
    v_accvgpr_write_b32 a72, v246
    v_accvgpr_write_b32 a73, v247
    v_accvgpr_write_b32 a74, v248
    v_accvgpr_write_b32 a75, v249
    v_accvgpr_read_b32 v246, a76
    v_accvgpr_read_b32 v247, a77
    v_accvgpr_read_b32 v248, a78
    v_accvgpr_read_b32 v249, a79
    v_mul_f32 v246, v246, v243
    v_mul_f32 v247, v247, v243
    v_mul_f32 v248, v248, v243
    v_mul_f32 v249, v249, v243
    v_accvgpr_write_b32 a76, v246
    v_accvgpr_write_b32 a77, v247
    v_accvgpr_write_b32 a78, v248
    v_accvgpr_write_b32 a79, v249
    v_accvgpr_read_b32 v246, a80
    v_accvgpr_read_b32 v247, a81
    v_accvgpr_read_b32 v248, a82
    v_accvgpr_read_b32 v249, a83
    v_mul_f32 v246, v246, v243
    v_mul_f32 v247, v247, v243
    v_mul_f32 v248, v248, v243
    v_mul_f32 v249, v249, v243
    v_accvgpr_write_b32 a80, v246
    v_accvgpr_write_b32 a81, v247
    v_accvgpr_write_b32 a82, v248
    v_accvgpr_write_b32 a83, v249
    v_accvgpr_read_b32 v246, a84
    v_accvgpr_read_b32 v247, a85
    v_accvgpr_read_b32 v248, a86
    v_accvgpr_read_b32 v249, a87
    v_mul_f32 v246, v246, v243
    v_mul_f32 v247, v247, v243
    v_mul_f32 v248, v248, v243
    v_mul_f32 v249, v249, v243
    v_accvgpr_write_b32 a84, v246
    v_accvgpr_write_b32 a85, v247
    v_accvgpr_write_b32 a86, v248
    v_accvgpr_write_b32 a87, v249
    v_accvgpr_read_b32 v246, a88
    v_accvgpr_read_b32 v247, a89
    v_accvgpr_read_b32 v248, a90
    v_accvgpr_read_b32 v249, a91
    v_mul_f32 v246, v246, v243
    v_mul_f32 v247, v247, v243
    v_mul_f32 v248, v248, v243
    v_mul_f32 v249, v249, v243
    v_accvgpr_write_b32 a88, v246
    v_accvgpr_write_b32 a89, v247
    v_accvgpr_write_b32 a90, v248
    v_accvgpr_write_b32 a91, v249
    v_accvgpr_read_b32 v246, a92
    v_accvgpr_read_b32 v247, a93
    v_accvgpr_read_b32 v248, a94
    v_accvgpr_read_b32 v249, a95
    v_mul_f32 v246, v246, v243
    v_mul_f32 v247, v247, v243
    v_mul_f32 v248, v248, v243
    v_mul_f32 v249, v249, v243
    v_accvgpr_write_b32 a92, v246
    v_accvgpr_write_b32 a93, v247
    v_accvgpr_write_b32 a94, v248
    v_accvgpr_write_b32 a95, v249
    v_accvgpr_read_b32 v246, a96
    v_accvgpr_read_b32 v247, a97
    v_accvgpr_read_b32 v248, a98
    v_accvgpr_read_b32 v249, a99
    v_mul_f32 v246, v246, v243
    v_mul_f32 v247, v247, v243
    v_mul_f32 v248, v248, v243
    v_mul_f32 v249, v249, v243
    v_accvgpr_write_b32 a96, v246
    v_accvgpr_write_b32 a97, v247
    v_accvgpr_write_b32 a98, v248
    v_accvgpr_write_b32 a99, v249
    v_accvgpr_read_b32 v246, a100
    v_accvgpr_read_b32 v247, a101
    v_accvgpr_read_b32 v248, a102
    v_accvgpr_read_b32 v249, a103
    v_mul_f32 v246, v246, v243
    v_mul_f32 v247, v247, v243
    v_mul_f32 v248, v248, v243
    v_mul_f32 v249, v249, v243
    v_accvgpr_write_b32 a100, v246
    v_accvgpr_write_b32 a101, v247
    v_accvgpr_write_b32 a102, v248
    v_accvgpr_write_b32 a103, v249
    v_accvgpr_read_b32 v246, a104
    v_accvgpr_read_b32 v247, a105
    v_accvgpr_read_b32 v248, a106
    v_accvgpr_read_b32 v249, a107
    v_mul_f32 v246, v246, v243
    v_mul_f32 v247, v247, v243
    v_mul_f32 v248, v248, v243
    v_mul_f32 v249, v249, v243
    v_accvgpr_write_b32 a104, v246
    v_accvgpr_write_b32 a105, v247
    v_accvgpr_write_b32 a106, v248
    v_accvgpr_write_b32 a107, v249
    v_accvgpr_read_b32 v246, a108
    v_accvgpr_read_b32 v247, a109
    v_accvgpr_read_b32 v248, a110
    v_accvgpr_read_b32 v249, a111
    v_mul_f32 v246, v246, v243
    v_mul_f32 v247, v247, v243
    v_mul_f32 v248, v248, v243
    v_mul_f32 v249, v249, v243
    v_accvgpr_write_b32 a108, v246
    v_accvgpr_write_b32 a109, v247
    v_accvgpr_write_b32 a110, v248
    v_accvgpr_write_b32 a111, v249
    v_accvgpr_read_b32 v246, a112
    v_accvgpr_read_b32 v247, a113
    v_accvgpr_read_b32 v248, a114
    v_accvgpr_read_b32 v249, a115
    v_mul_f32 v246, v246, v243
    v_mul_f32 v247, v247, v243
    v_mul_f32 v248, v248, v243
    v_mul_f32 v249, v249, v243
    v_accvgpr_write_b32 a112, v246
    v_accvgpr_write_b32 a113, v247
    v_accvgpr_write_b32 a114, v248
    v_accvgpr_write_b32 a115, v249
    v_accvgpr_read_b32 v246, a116
    v_accvgpr_read_b32 v247, a117
    v_accvgpr_read_b32 v248, a118
    v_accvgpr_read_b32 v249, a119
    v_mul_f32 v246, v246, v243
    v_mul_f32 v247, v247, v243
    v_mul_f32 v248, v248, v243
    v_mul_f32 v249, v249, v243
    v_accvgpr_write_b32 a116, v246
    v_accvgpr_write_b32 a117, v247
    v_accvgpr_write_b32 a118, v248
    v_accvgpr_write_b32 a119, v249
    v_accvgpr_read_b32 v246, a120
    v_accvgpr_read_b32 v247, a121
    v_accvgpr_read_b32 v248, a122
    v_accvgpr_read_b32 v249, a123
    v_mul_f32 v246, v246, v243
    v_mul_f32 v247, v247, v243
    v_mul_f32 v248, v248, v243
    v_mul_f32 v249, v249, v243
    v_accvgpr_write_b32 a120, v246
    v_accvgpr_write_b32 a121, v247
    v_accvgpr_write_b32 a122, v248
    v_accvgpr_write_b32 a123, v249
    v_accvgpr_read_b32 v246, a124
    v_accvgpr_read_b32 v247, a125
    v_accvgpr_read_b32 v248, a126
    v_accvgpr_read_b32 v249, a127
    v_mul_f32 v246, v246, v243
    v_mul_f32 v247, v247, v243
    v_mul_f32 v248, v248, v243
    v_mul_f32 v249, v249, v243
    v_accvgpr_write_b32 a124, v246
    v_accvgpr_write_b32 a125, v247
    v_accvgpr_write_b32 a126, v248
    v_accvgpr_write_b32 a127, v249
L_sk72:
    v_sub_f32 v208, v160, v242
    v_exp_f32 v208, v208
    v_sub_f32 v209, v161, v242
    v_exp_f32 v209, v209
    v_sub_f32 v210, v162, v242
    v_exp_f32 v210, v210
    v_sub_f32 v211, v163, v242
    v_exp_f32 v211, v211
    v_add_f32 v222, v208, v209
    v_cvt_pk_bf16_f32 v192, v208, v209
    v_sub_f32 v212, v164, v242
    v_exp_f32 v212, v212
    v_add_f32 v222, v222, v210
    v_sub_f32 v213, v165, v242
    v_exp_f32 v213, v213
    v_add_f32 v222, v222, v211
    v_cvt_pk_bf16_f32 v193, v210, v211
    v_sub_f32 v214, v166, v242
    v_exp_f32 v214, v214
    v_add_f32 v222, v222, v212
    v_sub_f32 v215, v167, v242
    v_exp_f32 v215, v215
    v_add_f32 v222, v222, v213
    v_cvt_pk_bf16_f32 v194, v212, v213
    v_sub_f32 v208, v168, v242
    v_exp_f32 v208, v208
    v_add_f32 v222, v222, v214
    v_sub_f32 v209, v169, v242
    v_exp_f32 v209, v209
    v_add_f32 v222, v222, v215
    v_cvt_pk_bf16_f32 v195, v214, v215
    v_sub_f32 v210, v170, v242
    v_exp_f32 v210, v210
    v_add_f32 v222, v222, v208
    v_sub_f32 v211, v171, v242
    v_exp_f32 v211, v211
    v_add_f32 v222, v222, v209
    v_cvt_pk_bf16_f32 v196, v208, v209
    v_sub_f32 v212, v172, v242
    v_exp_f32 v212, v212
    v_add_f32 v222, v222, v210
    v_sub_f32 v213, v173, v242
    v_exp_f32 v213, v213
    v_add_f32 v222, v222, v211
    v_sub_f32 v214, v174, v242
    v_exp_f32 v214, v214
    v_add_f32 v222, v222, v212
    v_sub_f32 v215, v175, v242
    v_exp_f32 v215, v215
    v_add_f32 v222, v222, v213
    v_add_f32 v222, v222, v214
    v_add_f32 v222, v222, v215
    v_cvt_pk_bf16_f32 v197, v210, v211
    v_cvt_pk_bf16_f32 v198, v212, v213
    v_cvt_pk_bf16_f32 v199, v214, v215
    s_nop 3
    s_setpc_b64 s[30:31]
L_slow_1_1:
    s_nop 15
    v_max3_f32 v242, v176, v177, v178
    v_max3_f32 v242, v242, v179, v180
    v_max3_f32 v242, v242, v181, v182
    v_max3_f32 v242, v242, v183, v184
    v_max3_f32 v242, v242, v185, v186
    v_max3_f32 v242, v242, v187, v188
    v_max3_f32 v242, v242, v189, v190
    v_max_f32 v242, v242, v191
    v_mov_b32 v243, v242
    s_nop 1
    v_permlane32_swap_b32 v242, v243
    s_nop 1
    v_max_f32 v242, v242, v243
    v_mov_b32 v244, v220
    v_mov_b32 v245, v220
    s_nop 1
    v_permlane32_swap_b32 v244, v245
    s_nop 1
    v_add_f32 v244, v244, v245
    v_cmp_neq_f32 vcc, 0, v244
    v_max_f32 v245, 0, v242
    s_nop 0
    v_cndmask_b32 v242, v242, v245, vcc
    v_exp_f32 v243, -v245
    v_sub_f32 v48, v48, v242
    v_sub_f32 v49, v49, v242
    v_sub_f32 v50, v50, v242
    v_sub_f32 v51, v51, v242
    v_sub_f32 v52, v52, v242
    v_sub_f32 v53, v53, v242
    v_sub_f32 v54, v54, v242
    v_sub_f32 v55, v55, v242
    v_sub_f32 v56, v56, v242
    v_sub_f32 v57, v57, v242
    v_sub_f32 v58, v58, v242
    v_sub_f32 v59, v59, v242
    v_sub_f32 v60, v60, v242
    v_sub_f32 v61, v61, v242
    v_sub_f32 v62, v62, v242
    v_sub_f32 v63, v63, v242
    v_mul_f32 v220, v220, v243
    s_cmp_eq_u32 s100, 0
    s_cbranch_scc1 L_na73
    v_sub_f32 v160, v160, v242
    v_sub_f32 v161, v161, v242
    v_sub_f32 v162, v162, v242
    v_sub_f32 v163, v163, v242
    v_sub_f32 v164, v164, v242
    v_sub_f32 v165, v165, v242
    v_sub_f32 v166, v166, v242
    v_sub_f32 v167, v167, v242
    v_sub_f32 v168, v168, v242
    v_sub_f32 v169, v169, v242
    v_sub_f32 v170, v170, v242
    v_sub_f32 v171, v171, v242
    v_sub_f32 v172, v172, v242
    v_sub_f32 v173, v173, v242
    v_sub_f32 v174, v174, v242
    v_sub_f32 v175, v175, v242
L_na73:
    s_cbranch_vccz L_sk74
    v_accvgpr_read_b32 v246, a64
    v_accvgpr_read_b32 v247, a65
    v_accvgpr_read_b32 v248, a66
    v_accvgpr_read_b32 v249, a67
    v_mul_f32 v246, v246, v243
    v_mul_f32 v247, v247, v243
    v_mul_f32 v248, v248, v243
    v_mul_f32 v249, v249, v243
    v_accvgpr_write_b32 a64, v246
    v_accvgpr_write_b32 a65, v247
    v_accvgpr_write_b32 a66, v248
    v_accvgpr_write_b32 a67, v249
    v_accvgpr_read_b32 v246, a68
    v_accvgpr_read_b32 v247, a69
    v_accvgpr_read_b32 v248, a70
    v_accvgpr_read_b32 v249, a71
    v_mul_f32 v246, v246, v243
    v_mul_f32 v247, v247, v243
    v_mul_f32 v248, v248, v243
    v_mul_f32 v249, v249, v243
    v_accvgpr_write_b32 a68, v246
    v_accvgpr_write_b32 a69, v247
    v_accvgpr_write_b32 a70, v248
    v_accvgpr_write_b32 a71, v249
    v_accvgpr_read_b32 v246, a72
    v_accvgpr_read_b32 v247, a73
    v_accvgpr_read_b32 v248, a74
    v_accvgpr_read_b32 v249, a75
    v_mul_f32 v246, v246, v243
    v_mul_f32 v247, v247, v243
    v_mul_f32 v248, v248, v243
    v_mul_f32 v249, v249, v243
    v_accvgpr_write_b32 a72, v246
    v_accvgpr_write_b32 a73, v247
    v_accvgpr_write_b32 a74, v248
    v_accvgpr_write_b32 a75, v249
    v_accvgpr_read_b32 v246, a76
    v_accvgpr_read_b32 v247, a77
    v_accvgpr_read_b32 v248, a78
    v_accvgpr_read_b32 v249, a79
    v_mul_f32 v246, v246, v243
    v_mul_f32 v247, v247, v243
    v_mul_f32 v248, v248, v243
    v_mul_f32 v249, v249, v243
    v_accvgpr_write_b32 a76, v246
    v_accvgpr_write_b32 a77, v247
    v_accvgpr_write_b32 a78, v248
    v_accvgpr_write_b32 a79, v249
    v_accvgpr_read_b32 v246, a80
    v_accvgpr_read_b32 v247, a81
    v_accvgpr_read_b32 v248, a82
    v_accvgpr_read_b32 v249, a83
    v_mul_f32 v246, v246, v243
    v_mul_f32 v247, v247, v243
    v_mul_f32 v248, v248, v243
    v_mul_f32 v249, v249, v243
    v_accvgpr_write_b32 a80, v246
    v_accvgpr_write_b32 a81, v247
    v_accvgpr_write_b32 a82, v248
    v_accvgpr_write_b32 a83, v249
    v_accvgpr_read_b32 v246, a84
    v_accvgpr_read_b32 v247, a85
    v_accvgpr_read_b32 v248, a86
    v_accvgpr_read_b32 v249, a87
    v_mul_f32 v246, v246, v243
    v_mul_f32 v247, v247, v243
    v_mul_f32 v248, v248, v243
    v_mul_f32 v249, v249, v243
    v_accvgpr_write_b32 a84, v246
    v_accvgpr_write_b32 a85, v247
    v_accvgpr_write_b32 a86, v248
    v_accvgpr_write_b32 a87, v249
    v_accvgpr_read_b32 v246, a88
    v_accvgpr_read_b32 v247, a89
    v_accvgpr_read_b32 v248, a90
    v_accvgpr_read_b32 v249, a91
    v_mul_f32 v246, v246, v243
    v_mul_f32 v247, v247, v243
    v_mul_f32 v248, v248, v243
    v_mul_f32 v249, v249, v243
    v_accvgpr_write_b32 a88, v246
    v_accvgpr_write_b32 a89, v247
    v_accvgpr_write_b32 a90, v248
    v_accvgpr_write_b32 a91, v249
    v_accvgpr_read_b32 v246, a92
    v_accvgpr_read_b32 v247, a93
    v_accvgpr_read_b32 v248, a94
    v_accvgpr_read_b32 v249, a95
    v_mul_f32 v246, v246, v243
    v_mul_f32 v247, v247, v243
    v_mul_f32 v248, v248, v243
    v_mul_f32 v249, v249, v243
    v_accvgpr_write_b32 a92, v246
    v_accvgpr_write_b32 a93, v247
    v_accvgpr_write_b32 a94, v248
    v_accvgpr_write_b32 a95, v249
    v_accvgpr_read_b32 v246, a96
    v_accvgpr_read_b32 v247, a97
    v_accvgpr_read_b32 v248, a98
    v_accvgpr_read_b32 v249, a99
    v_mul_f32 v246, v246, v243
    v_mul_f32 v247, v247, v243
    v_mul_f32 v248, v248, v243
    v_mul_f32 v249, v249, v243
    v_accvgpr_write_b32 a96, v246
    v_accvgpr_write_b32 a97, v247
    v_accvgpr_write_b32 a98, v248
    v_accvgpr_write_b32 a99, v249
    v_accvgpr_read_b32 v246, a100
    v_accvgpr_read_b32 v247, a101
    v_accvgpr_read_b32 v248, a102
    v_accvgpr_read_b32 v249, a103
    v_mul_f32 v246, v246, v243
    v_mul_f32 v247, v247, v243
    v_mul_f32 v248, v248, v243
    v_mul_f32 v249, v249, v243
    v_accvgpr_write_b32 a100, v246
    v_accvgpr_write_b32 a101, v247
    v_accvgpr_write_b32 a102, v248
    v_accvgpr_write_b32 a103, v249
    v_accvgpr_read_b32 v246, a104
    v_accvgpr_read_b32 v247, a105
    v_accvgpr_read_b32 v248, a106
    v_accvgpr_read_b32 v249, a107
    v_mul_f32 v246, v246, v243
    v_mul_f32 v247, v247, v243
    v_mul_f32 v248, v248, v243
    v_mul_f32 v249, v249, v243
    v_accvgpr_write_b32 a104, v246
    v_accvgpr_write_b32 a105, v247
    v_accvgpr_write_b32 a106, v248
    v_accvgpr_write_b32 a107, v249
    v_accvgpr_read_b32 v246, a108
    v_accvgpr_read_b32 v247, a109
    v_accvgpr_read_b32 v248, a110
    v_accvgpr_read_b32 v249, a111
    v_mul_f32 v246, v246, v243
    v_mul_f32 v247, v247, v243
    v_mul_f32 v248, v248, v243
    v_mul_f32 v249, v249, v243
    v_accvgpr_write_b32 a108, v246
    v_accvgpr_write_b32 a109, v247
    v_accvgpr_write_b32 a110, v248
    v_accvgpr_write_b32 a111, v249
    v_accvgpr_read_b32 v246, a112
    v_accvgpr_read_b32 v247, a113
    v_accvgpr_read_b32 v248, a114
    v_accvgpr_read_b32 v249, a115
    v_mul_f32 v246, v246, v243
    v_mul_f32 v247, v247, v243
    v_mul_f32 v248, v248, v243
    v_mul_f32 v249, v249, v243
    v_accvgpr_write_b32 a112, v246
    v_accvgpr_write_b32 a113, v247
    v_accvgpr_write_b32 a114, v248
    v_accvgpr_write_b32 a115, v249
    v_accvgpr_read_b32 v246, a116
    v_accvgpr_read_b32 v247, a117
    v_accvgpr_read_b32 v248, a118
    v_accvgpr_read_b32 v249, a119
    v_mul_f32 v246, v246, v243
    v_mul_f32 v247, v247, v243
    v_mul_f32 v248, v248, v243
    v_mul_f32 v249, v249, v243
    v_accvgpr_write_b32 a116, v246
    v_accvgpr_write_b32 a117, v247
    v_accvgpr_write_b32 a118, v248
    v_accvgpr_write_b32 a119, v249
    v_accvgpr_read_b32 v246, a120
    v_accvgpr_read_b32 v247, a121
    v_accvgpr_read_b32 v248, a122
    v_accvgpr_read_b32 v249, a123
    v_mul_f32 v246, v246, v243
    v_mul_f32 v247, v247, v243
    v_mul_f32 v248, v248, v243
    v_mul_f32 v249, v249, v243
    v_accvgpr_write_b32 a120, v246
    v_accvgpr_write_b32 a121, v247
    v_accvgpr_write_b32 a122, v248
    v_accvgpr_write_b32 a123, v249
    v_accvgpr_read_b32 v246, a124
    v_accvgpr_read_b32 v247, a125
    v_accvgpr_read_b32 v248, a126
    v_accvgpr_read_b32 v249, a127
    v_mul_f32 v246, v246, v243
    v_mul_f32 v247, v247, v243
    v_mul_f32 v248, v248, v243
    v_mul_f32 v249, v249, v243
    v_accvgpr_write_b32 a124, v246
    v_accvgpr_write_b32 a125, v247
    v_accvgpr_write_b32 a126, v248
    v_accvgpr_write_b32 a127, v249
L_sk74:
    v_sub_f32 v208, v176, v242
    v_exp_f32 v208, v208
    v_sub_f32 v209, v177, v242
    v_exp_f32 v209, v209
    v_sub_f32 v210, v178, v242
    v_exp_f32 v210, v210
    v_sub_f32 v211, v179, v242
    v_exp_f32 v211, v211
    v_add_f32 v222, v208, v209
    v_cvt_pk_bf16_f32 v200, v208, v209
    v_sub_f32 v212, v180, v242
    v_exp_f32 v212, v212
    v_add_f32 v222, v222, v210
    v_sub_f32 v213, v181, v242
    v_exp_f32 v213, v213
    v_add_f32 v222, v222, v211
    v_cvt_pk_bf16_f32 v201, v210, v211
    v_sub_f32 v214, v182, v242
    v_exp_f32 v214, v214
    v_add_f32 v222, v222, v212
    v_sub_f32 v215, v183, v242
    v_exp_f32 v215, v215
    v_add_f32 v222, v222, v213
    v_cvt_pk_bf16_f32 v202, v212, v213
    v_sub_f32 v208, v184, v242
    v_exp_f32 v208, v208
    v_add_f32 v222, v222, v214
    v_sub_f32 v209, v185, v242
    v_exp_f32 v209, v209
    v_add_f32 v222, v222, v215
    v_cvt_pk_bf16_f32 v203, v214, v215
    v_sub_f32 v210, v186, v242
    v_exp_f32 v210, v210
    v_add_f32 v222, v222, v208
    v_sub_f32 v211, v187, v242
    v_exp_f32 v211, v211
    v_add_f32 v222, v222, v209
    v_cvt_pk_bf16_f32 v204, v208, v209
    v_sub_f32 v212, v188, v242
    v_exp_f32 v212, v212
    v_add_f32 v222, v222, v210
    v_sub_f32 v213, v189, v242
    v_exp_f32 v213, v213
    v_add_f32 v222, v222, v211
    v_sub_f32 v214, v190, v242
    v_exp_f32 v214, v214
    v_add_f32 v222, v222, v212
    v_sub_f32 v215, v191, v242
    v_exp_f32 v215, v215
    v_add_f32 v222, v222, v213
    v_add_f32 v222, v222, v214
    v_add_f32 v222, v222, v215
    v_cvt_pk_bf16_f32 v205, v210, v211
    v_cvt_pk_bf16_f32 v206, v212, v213
    v_cvt_pk_bf16_f32 v207, v214, v215
    s_nop 3
    s_setpc_b64 s[30:31]
L_slow_2_0:
    s_nop 15
    v_max3_f32 v242, v160, v161, v162
    v_max3_f32 v242, v242, v163, v164
    v_max3_f32 v242, v242, v165, v166
    v_max3_f32 v242, v242, v167, v168
    v_max3_f32 v242, v242, v169, v170
    v_max3_f32 v242, v242, v171, v172
    v_max3_f32 v242, v242, v173, v174
    v_max_f32 v242, v242, v175
    v_mov_b32 v243, v242
    s_nop 1
    v_permlane32_swap_b32 v242, v243
    s_nop 1
    v_max_f32 v242, v242, v243
    v_mov_b32 v244, v221
    v_mov_b32 v245, v221
    s_nop 1
    v_permlane32_swap_b32 v244, v245
    s_nop 1
    v_add_f32 v244, v244, v245
    v_cmp_neq_f32 vcc, 0, v244
    v_max_f32 v245, 0, v242
    s_nop 0
    v_cndmask_b32 v242, v242, v245, vcc
    v_exp_f32 v243, -v245
    v_sub_f32 v64, v64, v242
    v_sub_f32 v65, v65, v242
    v_sub_f32 v66, v66, v242
    v_sub_f32 v67, v67, v242
    v_sub_f32 v68, v68, v242
    v_sub_f32 v69, v69, v242
    v_sub_f32 v70, v70, v242
    v_sub_f32 v71, v71, v242
    v_sub_f32 v72, v72, v242
    v_sub_f32 v73, v73, v242
    v_sub_f32 v74, v74, v242
    v_sub_f32 v75, v75, v242
    v_sub_f32 v76, v76, v242
    v_sub_f32 v77, v77, v242
    v_sub_f32 v78, v78, v242
    v_sub_f32 v79, v79, v242
    v_mul_f32 v221, v221, v243
    s_cmp_eq_u32 s100, 0
    s_cbranch_scc1 L_na75
    v_sub_f32 v176, v176, v242
    v_sub_f32 v177, v177, v242
    v_sub_f32 v178, v178, v242
    v_sub_f32 v179, v179, v242
    v_sub_f32 v180, v180, v242
    v_sub_f32 v181, v181, v242
    v_sub_f32 v182, v182, v242
    v_sub_f32 v183, v183, v242
    v_sub_f32 v184, v184, v242
    v_sub_f32 v185, v185, v242
    v_sub_f32 v186, v186, v242
    v_sub_f32 v187, v187, v242
    v_sub_f32 v188, v188, v242
    v_sub_f32 v189, v189, v242
    v_sub_f32 v190, v190, v242
    v_sub_f32 v191, v191, v242
L_na75:
    s_cbranch_vccz L_sk76
    v_accvgpr_read_b32 v246, a128
    v_accvgpr_read_b32 v247, a129
    v_accvgpr_read_b32 v248, a130
    v_accvgpr_read_b32 v249, a131
    v_mul_f32 v246, v246, v243
    v_mul_f32 v247, v247, v243
    v_mul_f32 v248, v248, v243
    v_mul_f32 v249, v249, v243
    v_accvgpr_write_b32 a128, v246
    v_accvgpr_write_b32 a129, v247
    v_accvgpr_write_b32 a130, v248
    v_accvgpr_write_b32 a131, v249
    v_accvgpr_read_b32 v246, a132
    v_accvgpr_read_b32 v247, a133
    v_accvgpr_read_b32 v248, a134
    v_accvgpr_read_b32 v249, a135
    v_mul_f32 v246, v246, v243
    v_mul_f32 v247, v247, v243
    v_mul_f32 v248, v248, v243
    v_mul_f32 v249, v249, v243
    v_accvgpr_write_b32 a132, v246
    v_accvgpr_write_b32 a133, v247
    v_accvgpr_write_b32 a134, v248
    v_accvgpr_write_b32 a135, v249
    v_accvgpr_read_b32 v246, a136
    v_accvgpr_read_b32 v247, a137
    v_accvgpr_read_b32 v248, a138
    v_accvgpr_read_b32 v249, a139
    v_mul_f32 v246, v246, v243
    v_mul_f32 v247, v247, v243
    v_mul_f32 v248, v248, v243
    v_mul_f32 v249, v249, v243
    v_accvgpr_write_b32 a136, v246
    v_accvgpr_write_b32 a137, v247
    v_accvgpr_write_b32 a138, v248
    v_accvgpr_write_b32 a139, v249
    v_accvgpr_read_b32 v246, a140
    v_accvgpr_read_b32 v247, a141
    v_accvgpr_read_b32 v248, a142
    v_accvgpr_read_b32 v249, a143
    v_mul_f32 v246, v246, v243
    v_mul_f32 v247, v247, v243
    v_mul_f32 v248, v248, v243
    v_mul_f32 v249, v249, v243
    v_accvgpr_write_b32 a140, v246
    v_accvgpr_write_b32 a141, v247
    v_accvgpr_write_b32 a142, v248
    v_accvgpr_write_b32 a143, v249
    v_accvgpr_read_b32 v246, a144
    v_accvgpr_read_b32 v247, a145
    v_accvgpr_read_b32 v248, a146
    v_accvgpr_read_b32 v249, a147
    v_mul_f32 v246, v246, v243
    v_mul_f32 v247, v247, v243
    v_mul_f32 v248, v248, v243
    v_mul_f32 v249, v249, v243
    v_accvgpr_write_b32 a144, v246
    v_accvgpr_write_b32 a145, v247
    v_accvgpr_write_b32 a146, v248
    v_accvgpr_write_b32 a147, v249
    v_accvgpr_read_b32 v246, a148
    v_accvgpr_read_b32 v247, a149
    v_accvgpr_read_b32 v248, a150
    v_accvgpr_read_b32 v249, a151
    v_mul_f32 v246, v246, v243
    v_mul_f32 v247, v247, v243
    v_mul_f32 v248, v248, v243
    v_mul_f32 v249, v249, v243
    v_accvgpr_write_b32 a148, v246
    v_accvgpr_write_b32 a149, v247
    v_accvgpr_write_b32 a150, v248
    v_accvgpr_write_b32 a151, v249
    v_accvgpr_read_b32 v246, a152
    v_accvgpr_read_b32 v247, a153
    v_accvgpr_read_b32 v248, a154
    v_accvgpr_read_b32 v249, a155
    v_mul_f32 v246, v246, v243
    v_mul_f32 v247, v247, v243
    v_mul_f32 v248, v248, v243
    v_mul_f32 v249, v249, v243
    v_accvgpr_write_b32 a152, v246
    v_accvgpr_write_b32 a153, v247
    v_accvgpr_write_b32 a154, v248
    v_accvgpr_write_b32 a155, v249
    v_accvgpr_read_b32 v246, a156
    v_accvgpr_read_b32 v247, a157
    v_accvgpr_read_b32 v248, a158
    v_accvgpr_read_b32 v249, a159
    v_mul_f32 v246, v246, v243
    v_mul_f32 v247, v247, v243
    v_mul_f32 v248, v248, v243
    v_mul_f32 v249, v249, v243
    v_accvgpr_write_b32 a156, v246
    v_accvgpr_write_b32 a157, v247
    v_accvgpr_write_b32 a158, v248
    v_accvgpr_write_b32 a159, v249
    v_accvgpr_read_b32 v246, a160
    v_accvgpr_read_b32 v247, a161
    v_accvgpr_read_b32 v248, a162
    v_accvgpr_read_b32 v249, a163
    v_mul_f32 v246, v246, v243
    v_mul_f32 v247, v247, v243
    v_mul_f32 v248, v248, v243
    v_mul_f32 v249, v249, v243
    v_accvgpr_write_b32 a160, v246
    v_accvgpr_write_b32 a161, v247
    v_accvgpr_write_b32 a162, v248
    v_accvgpr_write_b32 a163, v249
    v_accvgpr_read_b32 v246, a164
    v_accvgpr_read_b32 v247, a165
    v_accvgpr_read_b32 v248, a166
    v_accvgpr_read_b32 v249, a167
    v_mul_f32 v246, v246, v243
    v_mul_f32 v247, v247, v243
    v_mul_f32 v248, v248, v243
    v_mul_f32 v249, v249, v243
    v_accvgpr_write_b32 a164, v246
    v_accvgpr_write_b32 a165, v247
    v_accvgpr_write_b32 a166, v248
    v_accvgpr_write_b32 a167, v249
    v_accvgpr_read_b32 v246, a168
    v_accvgpr_read_b32 v247, a169
    v_accvgpr_read_b32 v248, a170
    v_accvgpr_read_b32 v249, a171
    v_mul_f32 v246, v246, v243
    v_mul_f32 v247, v247, v243
    v_mul_f32 v248, v248, v243
    v_mul_f32 v249, v249, v243
    v_accvgpr_write_b32 a168, v246
    v_accvgpr_write_b32 a169, v247
    v_accvgpr_write_b32 a170, v248
    v_accvgpr_write_b32 a171, v249
    v_accvgpr_read_b32 v246, a172
    v_accvgpr_read_b32 v247, a173
    v_accvgpr_read_b32 v248, a174
    v_accvgpr_read_b32 v249, a175
    v_mul_f32 v246, v246, v243
    v_mul_f32 v247, v247, v243
    v_mul_f32 v248, v248, v243
    v_mul_f32 v249, v249, v243
    v_accvgpr_write_b32 a172, v246
    v_accvgpr_write_b32 a173, v247
    v_accvgpr_write_b32 a174, v248
    v_accvgpr_write_b32 a175, v249
    v_accvgpr_read_b32 v246, a176
    v_accvgpr_read_b32 v247, a177
    v_accvgpr_read_b32 v248, a178
    v_accvgpr_read_b32 v249, a179
    v_mul_f32 v246, v246, v243
    v_mul_f32 v247, v247, v243
    v_mul_f32 v248, v248, v243
    v_mul_f32 v249, v249, v243
    v_accvgpr_write_b32 a176, v246
    v_accvgpr_write_b32 a177, v247
    v_accvgpr_write_b32 a178, v248
    v_accvgpr_write_b32 a179, v249
    v_accvgpr_read_b32 v246, a180
    v_accvgpr_read_b32 v247, a181
    v_accvgpr_read_b32 v248, a182
    v_accvgpr_read_b32 v249, a183
    v_mul_f32 v246, v246, v243
    v_mul_f32 v247, v247, v243
    v_mul_f32 v248, v248, v243
    v_mul_f32 v249, v249, v243
    v_accvgpr_write_b32 a180, v246
    v_accvgpr_write_b32 a181, v247
    v_accvgpr_write_b32 a182, v248
    v_accvgpr_write_b32 a183, v249
    v_accvgpr_read_b32 v246, a184
    v_accvgpr_read_b32 v247, a185
    v_accvgpr_read_b32 v248, a186
    v_accvgpr_read_b32 v249, a187
    v_mul_f32 v246, v246, v243
    v_mul_f32 v247, v247, v243
    v_mul_f32 v248, v248, v243
    v_mul_f32 v249, v249, v243
    v_accvgpr_write_b32 a184, v246
    v_accvgpr_write_b32 a185, v247
    v_accvgpr_write_b32 a186, v248
    v_accvgpr_write_b32 a187, v249
    v_accvgpr_read_b32 v246, a188
    v_accvgpr_read_b32 v247, a189
    v_accvgpr_read_b32 v248, a190
    v_accvgpr_read_b32 v249, a191
    v_mul_f32 v246, v246, v243
    v_mul_f32 v247, v247, v243
    v_mul_f32 v248, v248, v243
    v_mul_f32 v249, v249, v243
    v_accvgpr_write_b32 a188, v246
    v_accvgpr_write_b32 a189, v247
    v_accvgpr_write_b32 a190, v248
    v_accvgpr_write_b32 a191, v249
L_sk76:
    v_sub_f32 v208, v160, v242
    v_exp_f32 v208, v208
    v_sub_f32 v209, v161, v242
    v_exp_f32 v209, v209
    v_sub_f32 v210, v162, v242
    v_exp_f32 v210, v210
    v_sub_f32 v211, v163, v242
    v_exp_f32 v211, v211
    v_add_f32 v222, v208, v209
    v_cvt_pk_bf16_f32 v192, v208, v209
    v_sub_f32 v212, v164, v242
    v_exp_f32 v212, v212
    v_add_f32 v222, v222, v210
    v_sub_f32 v213, v165, v242
    v_exp_f32 v213, v213
    v_add_f32 v222, v222, v211
    v_cvt_pk_bf16_f32 v193, v210, v211
    v_sub_f32 v214, v166, v242
    v_exp_f32 v214, v214
    v_add_f32 v222, v222, v212
    v_sub_f32 v215, v167, v242
    v_exp_f32 v215, v215
    v_add_f32 v222, v222, v213
    v_cvt_pk_bf16_f32 v194, v212, v213
    v_sub_f32 v208, v168, v242
    v_exp_f32 v208, v208
    v_add_f32 v222, v222, v214
    v_sub_f32 v209, v169, v242
    v_exp_f32 v209, v209
    v_add_f32 v222, v222, v215
    v_cvt_pk_bf16_f32 v195, v214, v215
    v_sub_f32 v210, v170, v242
    v_exp_f32 v210, v210
    v_add_f32 v222, v222, v208
    v_sub_f32 v211, v171, v242
    v_exp_f32 v211, v211
    v_add_f32 v222, v222, v209
    v_cvt_pk_bf16_f32 v196, v208, v209
    v_sub_f32 v212, v172, v242
    v_exp_f32 v212, v212
    v_add_f32 v222, v222, v210
    v_sub_f32 v213, v173, v242
    v_exp_f32 v213, v213
    v_add_f32 v222, v222, v211
    v_sub_f32 v214, v174, v242
    v_exp_f32 v214, v214
    v_add_f32 v222, v222, v212
    v_sub_f32 v215, v175, v242
    v_exp_f32 v215, v215
    v_add_f32 v222, v222, v213
    v_add_f32 v222, v222, v214
    v_add_f32 v222, v222, v215
    v_cvt_pk_bf16_f32 v197, v210, v211
    v_cvt_pk_bf16_f32 v198, v212, v213
    v_cvt_pk_bf16_f32 v199, v214, v215
    s_nop 3
    s_setpc_b64 s[30:31]
L_slow_2_1:
    s_nop 15
    v_max3_f32 v242, v176, v177, v178
    v_max3_f32 v242, v242, v179, v180
    v_max3_f32 v242, v242, v181, v182
    v_max3_f32 v242, v242, v183, v184
    v_max3_f32 v242, v242, v185, v186
    v_max3_f32 v242, v242, v187, v188
    v_max3_f32 v242, v242, v189, v190
    v_max_f32 v242, v242, v191
    v_mov_b32 v243, v242
    s_nop 1
    v_permlane32_swap_b32 v242, v243
    s_nop 1
    v_max_f32 v242, v242, v243
    v_mov_b32 v244, v221
    v_mov_b32 v245, v221
    s_nop 1
    v_permlane32_swap_b32 v244, v245
    s_nop 1
    v_add_f32 v244, v244, v245
    v_cmp_neq_f32 vcc, 0, v244
    v_max_f32 v245, 0, v242
    s_nop 0
    v_cndmask_b32 v242, v242, v245, vcc
    v_exp_f32 v243, -v245
    v_sub_f32 v64, v64, v242
    v_sub_f32 v65, v65, v242
    v_sub_f32 v66, v66, v242
    v_sub_f32 v67, v67, v242
    v_sub_f32 v68, v68, v242
    v_sub_f32 v69, v69, v242
    v_sub_f32 v70, v70, v242
    v_sub_f32 v71, v71, v242
    v_sub_f32 v72, v72, v242
    v_sub_f32 v73, v73, v242
    v_sub_f32 v74, v74, v242
    v_sub_f32 v75, v75, v242
    v_sub_f32 v76, v76, v242
    v_sub_f32 v77, v77, v242
    v_sub_f32 v78, v78, v242
    v_sub_f32 v79, v79, v242
    v_mul_f32 v221, v221, v243
    s_cmp_eq_u32 s100, 0
    s_cbranch_scc1 L_na77
    v_sub_f32 v160, v160, v242
    v_sub_f32 v161, v161, v242
    v_sub_f32 v162, v162, v242
    v_sub_f32 v163, v163, v242
    v_sub_f32 v164, v164, v242
    v_sub_f32 v165, v165, v242
    v_sub_f32 v166, v166, v242
    v_sub_f32 v167, v167, v242
    v_sub_f32 v168, v168, v242
    v_sub_f32 v169, v169, v242
    v_sub_f32 v170, v170, v242
    v_sub_f32 v171, v171, v242
    v_sub_f32 v172, v172, v242
    v_sub_f32 v173, v173, v242
    v_sub_f32 v174, v174, v242
    v_sub_f32 v175, v175, v242
L_na77:
    s_cbranch_vccz L_sk78
    v_accvgpr_read_b32 v246, a128
    v_accvgpr_read_b32 v247, a129
    v_accvgpr_read_b32 v248, a130
    v_accvgpr_read_b32 v249, a131
    v_mul_f32 v246, v246, v243
    v_mul_f32 v247, v247, v243
    v_mul_f32 v248, v248, v243
    v_mul_f32 v249, v249, v243
    v_accvgpr_write_b32 a128, v246
    v_accvgpr_write_b32 a129, v247
    v_accvgpr_write_b32 a130, v248
    v_accvgpr_write_b32 a131, v249
    v_accvgpr_read_b32 v246, a132
    v_accvgpr_read_b32 v247, a133
    v_accvgpr_read_b32 v248, a134
    v_accvgpr_read_b32 v249, a135
    v_mul_f32 v246, v246, v243
    v_mul_f32 v247, v247, v243
    v_mul_f32 v248, v248, v243
    v_mul_f32 v249, v249, v243
    v_accvgpr_write_b32 a132, v246
    v_accvgpr_write_b32 a133, v247
    v_accvgpr_write_b32 a134, v248
    v_accvgpr_write_b32 a135, v249
    v_accvgpr_read_b32 v246, a136
    v_accvgpr_read_b32 v247, a137
    v_accvgpr_read_b32 v248, a138
    v_accvgpr_read_b32 v249, a139
    v_mul_f32 v246, v246, v243
    v_mul_f32 v247, v247, v243
    v_mul_f32 v248, v248, v243
    v_mul_f32 v249, v249, v243
    v_accvgpr_write_b32 a136, v246
    v_accvgpr_write_b32 a137, v247
    v_accvgpr_write_b32 a138, v248
    v_accvgpr_write_b32 a139, v249
    v_accvgpr_read_b32 v246, a140
    v_accvgpr_read_b32 v247, a141
    v_accvgpr_read_b32 v248, a142
    v_accvgpr_read_b32 v249, a143
    v_mul_f32 v246, v246, v243
    v_mul_f32 v247, v247, v243
    v_mul_f32 v248, v248, v243
    v_mul_f32 v249, v249, v243
    v_accvgpr_write_b32 a140, v246
    v_accvgpr_write_b32 a141, v247
    v_accvgpr_write_b32 a142, v248
    v_accvgpr_write_b32 a143, v249
    v_accvgpr_read_b32 v246, a144
    v_accvgpr_read_b32 v247, a145
    v_accvgpr_read_b32 v248, a146
    v_accvgpr_read_b32 v249, a147
    v_mul_f32 v246, v246, v243
    v_mul_f32 v247, v247, v243
    v_mul_f32 v248, v248, v243
    v_mul_f32 v249, v249, v243
    v_accvgpr_write_b32 a144, v246
    v_accvgpr_write_b32 a145, v247
    v_accvgpr_write_b32 a146, v248
    v_accvgpr_write_b32 a147, v249
    v_accvgpr_read_b32 v246, a148
    v_accvgpr_read_b32 v247, a149
    v_accvgpr_read_b32 v248, a150
    v_accvgpr_read_b32 v249, a151
    v_mul_f32 v246, v246, v243
    v_mul_f32 v247, v247, v243
    v_mul_f32 v248, v248, v243
    v_mul_f32 v249, v249, v243
    v_accvgpr_write_b32 a148, v246
    v_accvgpr_write_b32 a149, v247
    v_accvgpr_write_b32 a150, v248
    v_accvgpr_write_b32 a151, v249
    v_accvgpr_read_b32 v246, a152
    v_accvgpr_read_b32 v247, a153
    v_accvgpr_read_b32 v248, a154
    v_accvgpr_read_b32 v249, a155
    v_mul_f32 v246, v246, v243
    v_mul_f32 v247, v247, v243
    v_mul_f32 v248, v248, v243
    v_mul_f32 v249, v249, v243
    v_accvgpr_write_b32 a152, v246
    v_accvgpr_write_b32 a153, v247
    v_accvgpr_write_b32 a154, v248
    v_accvgpr_write_b32 a155, v249
    v_accvgpr_read_b32 v246, a156
    v_accvgpr_read_b32 v247, a157
    v_accvgpr_read_b32 v248, a158
    v_accvgpr_read_b32 v249, a159
    v_mul_f32 v246, v246, v243
    v_mul_f32 v247, v247, v243
    v_mul_f32 v248, v248, v243
    v_mul_f32 v249, v249, v243
    v_accvgpr_write_b32 a156, v246
    v_accvgpr_write_b32 a157, v247
    v_accvgpr_write_b32 a158, v248
    v_accvgpr_write_b32 a159, v249
    v_accvgpr_read_b32 v246, a160
    v_accvgpr_read_b32 v247, a161
    v_accvgpr_read_b32 v248, a162
    v_accvgpr_read_b32 v249, a163
    v_mul_f32 v246, v246, v243
    v_mul_f32 v247, v247, v243
    v_mul_f32 v248, v248, v243
    v_mul_f32 v249, v249, v243
    v_accvgpr_write_b32 a160, v246
    v_accvgpr_write_b32 a161, v247
    v_accvgpr_write_b32 a162, v248
    v_accvgpr_write_b32 a163, v249
    v_accvgpr_read_b32 v246, a164
    v_accvgpr_read_b32 v247, a165
    v_accvgpr_read_b32 v248, a166
    v_accvgpr_read_b32 v249, a167
    v_mul_f32 v246, v246, v243
    v_mul_f32 v247, v247, v243
    v_mul_f32 v248, v248, v243
    v_mul_f32 v249, v249, v243
    v_accvgpr_write_b32 a164, v246
    v_accvgpr_write_b32 a165, v247
    v_accvgpr_write_b32 a166, v248
    v_accvgpr_write_b32 a167, v249
    v_accvgpr_read_b32 v246, a168
    v_accvgpr_read_b32 v247, a169
    v_accvgpr_read_b32 v248, a170
    v_accvgpr_read_b32 v249, a171
    v_mul_f32 v246, v246, v243
    v_mul_f32 v247, v247, v243
    v_mul_f32 v248, v248, v243
    v_mul_f32 v249, v249, v243
    v_accvgpr_write_b32 a168, v246
    v_accvgpr_write_b32 a169, v247
    v_accvgpr_write_b32 a170, v248
    v_accvgpr_write_b32 a171, v249
    v_accvgpr_read_b32 v246, a172
    v_accvgpr_read_b32 v247, a173
    v_accvgpr_read_b32 v248, a174
    v_accvgpr_read_b32 v249, a175
    v_mul_f32 v246, v246, v243
    v_mul_f32 v247, v247, v243
    v_mul_f32 v248, v248, v243
    v_mul_f32 v249, v249, v243
    v_accvgpr_write_b32 a172, v246
    v_accvgpr_write_b32 a173, v247
    v_accvgpr_write_b32 a174, v248
    v_accvgpr_write_b32 a175, v249
    v_accvgpr_read_b32 v246, a176
    v_accvgpr_read_b32 v247, a177
    v_accvgpr_read_b32 v248, a178
    v_accvgpr_read_b32 v249, a179
    v_mul_f32 v246, v246, v243
    v_mul_f32 v247, v247, v243
    v_mul_f32 v248, v248, v243
    v_mul_f32 v249, v249, v243
    v_accvgpr_write_b32 a176, v246
    v_accvgpr_write_b32 a177, v247
    v_accvgpr_write_b32 a178, v248
    v_accvgpr_write_b32 a179, v249
    v_accvgpr_read_b32 v246, a180
    v_accvgpr_read_b32 v247, a181
    v_accvgpr_read_b32 v248, a182
    v_accvgpr_read_b32 v249, a183
    v_mul_f32 v246, v246, v243
    v_mul_f32 v247, v247, v243
    v_mul_f32 v248, v248, v243
    v_mul_f32 v249, v249, v243
    v_accvgpr_write_b32 a180, v246
    v_accvgpr_write_b32 a181, v247
    v_accvgpr_write_b32 a182, v248
    v_accvgpr_write_b32 a183, v249
    v_accvgpr_read_b32 v246, a184
    v_accvgpr_read_b32 v247, a185
    v_accvgpr_read_b32 v248, a186
    v_accvgpr_read_b32 v249, a187
    v_mul_f32 v246, v246, v243
    v_mul_f32 v247, v247, v243
    v_mul_f32 v248, v248, v243
    v_mul_f32 v249, v249, v243
    v_accvgpr_write_b32 a184, v246
    v_accvgpr_write_b32 a185, v247
    v_accvgpr_write_b32 a186, v248
    v_accvgpr_write_b32 a187, v249
    v_accvgpr_read_b32 v246, a188
    v_accvgpr_read_b32 v247, a189
    v_accvgpr_read_b32 v248, a190
    v_accvgpr_read_b32 v249, a191
    v_mul_f32 v246, v246, v243
    v_mul_f32 v247, v247, v243
    v_mul_f32 v248, v248, v243
    v_mul_f32 v249, v249, v243
    v_accvgpr_write_b32 a188, v246
    v_accvgpr_write_b32 a189, v247
    v_accvgpr_write_b32 a190, v248
    v_accvgpr_write_b32 a191, v249
L_sk78:
    v_sub_f32 v208, v176, v242
    v_exp_f32 v208, v208
    v_sub_f32 v209, v177, v242
    v_exp_f32 v209, v209
    v_sub_f32 v210, v178, v242
    v_exp_f32 v210, v210
    v_sub_f32 v211, v179, v242
    v_exp_f32 v211, v211
    v_add_f32 v222, v208, v209
    v_cvt_pk_bf16_f32 v200, v208, v209
    v_sub_f32 v212, v180, v242
    v_exp_f32 v212, v212
    v_add_f32 v222, v222, v210
    v_sub_f32 v213, v181, v242
    v_exp_f32 v213, v213
    v_add_f32 v222, v222, v211
    v_cvt_pk_bf16_f32 v201, v210, v211
    v_sub_f32 v214, v182, v242
    v_exp_f32 v214, v214
    v_add_f32 v222, v222, v212
    v_sub_f32 v215, v183, v242
    v_exp_f32 v215, v215
    v_add_f32 v222, v222, v213
    v_cvt_pk_bf16_f32 v202, v212, v213
    v_sub_f32 v208, v184, v242
    v_exp_f32 v208, v208
    v_add_f32 v222, v222, v214
    v_sub_f32 v209, v185, v242
    v_exp_f32 v209, v209
    v_add_f32 v222, v222, v215
    v_cvt_pk_bf16_f32 v203, v214, v215
    v_sub_f32 v210, v186, v242
    v_exp_f32 v210, v210
    v_add_f32 v222, v222, v208
    v_sub_f32 v211, v187, v242
    v_exp_f32 v211, v211
    v_add_f32 v222, v222, v209
    v_cvt_pk_bf16_f32 v204, v208, v209
    v_sub_f32 v212, v188, v242
    v_exp_f32 v212, v212
    v_add_f32 v222, v222, v210
    v_sub_f32 v213, v189, v242
    v_exp_f32 v213, v213
    v_add_f32 v222, v222, v211
    v_sub_f32 v214, v190, v242
    v_exp_f32 v214, v214
    v_add_f32 v222, v222, v212
    v_sub_f32 v215, v191, v242
    v_exp_f32 v215, v215
    v_add_f32 v222, v222, v213
    v_add_f32 v222, v222, v214
    v_add_f32 v222, v222, v215
    v_cvt_pk_bf16_f32 v205, v210, v211
    v_cvt_pk_bf16_f32 v206, v212, v213
    v_cvt_pk_bf16_f32 v207, v214, v215
    s_nop 3
    s_setpc_b64 s[30:31]
.section .rodata,"a"
.p2align 6
.amdhsa_kernel standalone__gqa_softmax__near_ridge_kernel
  .amdhsa_next_free_vgpr 512
  .amdhsa_next_free_sgpr 102
  .amdhsa_accum_offset 256
  .amdhsa_group_segment_fixed_size 0
  .amdhsa_kernarg_size 48
  .amdhsa_user_sgpr_count 2
  .amdhsa_user_sgpr_kernarg_segment_ptr 1
  .amdhsa_system_sgpr_workgroup_id_x 1
.end_amdhsa_kernel
```
